```python
import torch

def _softmax(x, axis=-1):
    return torch.softmax(x, dim=axis)
def _gelu(x):
    return torch.nn.functional.gelu(x, approximate="tanh")
def _silu(x):
    return torch.nn.functional.silu(x)
def _sigmoid(x):
    return torch.sigmoid(x)
def _layernorm(x, axis=-1, eps=1e-5):
    m = x.mean(dim=axis, keepdim=True)
    v = x.var(dim=axis, keepdim=True, unbiased=False)
    return (x - m) / torch.sqrt(v + eps)
def _scatter_add(tgt, idx, src, axis=0):
    return tgt.clone().index_add_(axis, idx, src)
def _segment_sum(src, seg, n):
    out = torch.zeros((n,) + src.shape[1:], dtype=src.dtype)
    return out.index_add_(0, seg, src)
def _pad(x, pw):
    flat = tuple(v for pair in reversed(pw) for v in pair)
    return torch.nn.functional.pad(x, flat)

kernel_name = 'interleave_layers__gqa_block_cached__gqa_block_cached__decode'

def setup_inputs():

    _w = (lambda a: (lambda t: t.to(torch.bfloat16) if t.is_floating_point() else t)(torch.as_tensor(a)))
    def _A_setup():
        B, Sq, D = 8, 1, 448
        Hq, Hkv, Sk, Dh = 16, 8, 4096, 256
        assert Hq % Hkv == 0, (Hq, Hkv)
        return {
            "x": _w((lambda *s: torch.randn(*s, dtype=torch.bfloat16) * 0.1)(B, Sq, D)),
            "k_cache": _w((lambda *s: torch.randn(*s, dtype=torch.bfloat16) * 0.8)(B, Hkv, Sk, Dh)),
            "v_cache": _w((lambda *s: torch.randn(*s, dtype=torch.bfloat16) * 3.2)(B, Hkv, Sk, Dh)),
            "wq": _w((lambda *s: torch.randn(*s, dtype=torch.bfloat16) * 0.8)(D, Hq * Dh) * (D ** -0.5)),
            "wo": _w((lambda *s: torch.randn(*s, dtype=torch.bfloat16) * 3.2)(Hq * Dh, D) * ((Hq * Dh) ** -0.5)),
        }
    _A_in = _A_setup()

    def _B_setup():
        B, Sq, D = 8, 1, 448
        Hq, Hkv, Sk, Dh = 16, 8, 4096, 256
        assert Hq % Hkv == 0, (Hq, Hkv)
        return {
            "x": _w((lambda *s: torch.randn(*s, dtype=torch.bfloat16) * 0.1)(B, Sq, D)),
            "k_cache": _w((lambda *s: torch.randn(*s, dtype=torch.bfloat16) * 1.6)(B, Hkv, Sk, Dh)),
            "v_cache": _w((lambda *s: torch.randn(*s, dtype=torch.bfloat16) * 1.6)(B, Hkv, Sk, Dh)),
            "wq": _w((lambda *s: torch.randn(*s, dtype=torch.bfloat16) * 1.6)(D, Hq * Dh) * (D ** -0.5)),
            "wo": _w((lambda *s: torch.randn(*s, dtype=torch.bfloat16) * 1.6)(Hq * Dh, D) * ((Hq * Dh) ** -0.5)),
        }
    _B_in = _B_setup()

    return {
        "A_x": _A_in["x"],
        "A_k_cache": _A_in["k_cache"],
        "A_v_cache": _A_in["v_cache"],
        "A_wq": _A_in["wq"],
        "A_wo": _A_in["wo"],
        "B_x": _B_in["x"],
        "B_k_cache": _B_in["k_cache"],
        "B_v_cache": _B_in["v_cache"],
        "B_wq": _B_in["wq"],
        "B_wo": _B_in["wo"],
    }

def reference(A_x, A_k_cache, A_v_cache, A_wq, A_wo, B_x, B_k_cache, B_v_cache, B_wq, B_wo):
    def _A_ref(x, k_cache, v_cache, wq, wo):
        B, Sq, D = x.shape
        Hq, Dh = 16, 256
        Hkv = k_cache.shape[1]
        rep = Hq // Hkv
        q = (lambda x, *d: x.permute(*d))((x @ wq).reshape(B, Sq, Hq, Dh), 0, 2, 1, 3)
        k = (lambda x, n, axis: torch.repeat_interleave(x, n, dim=axis))(k_cache, rep, axis=1)
        v = (lambda x, n, axis: torch.repeat_interleave(x, n, dim=axis))(v_cache, rep, axis=1)
        scores = torch.einsum("bhqd,bhkd->bhqk", q, k) * (Dh ** -0.5)
        p = _softmax(scores, axis=-1)
        o = torch.einsum("bhqk,bhkd->bhqd", p, v)
        return (lambda x, *d: x.permute(*d))(o, 0, 2, 1, 3).reshape(B, Sq, Hq * Dh) @ wo

    def _B_ref(x, k_cache, v_cache, wq, wo):
        B, Sq, D = x.shape
        Hq, Dh = 16, 256
        Hkv = k_cache.shape[1]
        rep = Hq // Hkv
        q = (lambda x, *d: x.permute(*d))((x @ wq).reshape(B, Sq, Hq, Dh), 0, 2, 1, 3)
        k = (lambda x, n, axis: torch.repeat_interleave(x, n, dim=axis))(k_cache, rep, axis=1)
        v = (lambda x, n, axis: torch.repeat_interleave(x, n, dim=axis))(v_cache, rep, axis=1)
        scores = torch.einsum("bhqd,bhkd->bhqk", q, k) * (Dh ** -0.5)
        p = _softmax(scores, axis=-1)
        o = torch.einsum("bhqk,bhkd->bhqd", p, v)
        return (lambda x, *d: x.permute(*d))(o, 0, 2, 1, 3).reshape(B, Sq, Hq * Dh) @ wo

    x = A_x
    x = x + _A_ref(_layernorm(x, axis=-1), A_k_cache, A_v_cache, A_wq, A_wo)
    x = x + _B_ref(_layernorm(x, axis=-1), B_k_cache, B_v_cache, B_wq, B_wo)
    x = x + _A_ref(_layernorm(x, axis=-1), A_k_cache, A_v_cache, A_wq, A_wo)
    x = x + _B_ref(_layernorm(x, axis=-1), B_k_cache, B_v_cache, B_wq, B_wo)
    return x
```

```asm
; @launch grid=(256,1,1) block=(256,1,1) lds=162560
.amdgcn_target "amdgcn-amd-amdhsa--gfx950"
.text
.globl interleave_layers__gqa_block_cached__gqa_block_cached__decode_kernel
.p2align 8
.type interleave_layers__gqa_block_cached__gqa_block_cached__decode_kernel,@function
interleave_layers__gqa_block_cached__gqa_block_cached__decode_kernel:
    s_cmp_ge_u32 s2, 256
    s_cbranch_scc1 Lend
    s_load_dwordx16 s[72:87], s[0:1], 0
    s_load_dwordx8 s[88:95], s[0:1], 64
    s_load_dwordx2 s[96:97], s[0:1], 96
    v_lshrrev_b32 v30, 6, v0
    v_and_b32 v1, 63, v0
    s_nop 1
    v_readfirstlane_b32 s52, v30
    s_and_b32 s53, s2, 7
    s_lshr_b32 s55, s2, 3
    s_lshr_b32 s54, s52, 1
    s_mov_b32 s65, 200000
    s_mov_b32 s68, 0x3db8aa3b
    s_mov_b32 s66, -1
    s_mov_b32 s67, 0x00ffffff
    s_mov_b32 s70, 0x00030003
    s_mov_b32 s71, 0x00030003
    v_lshrrev_b32 v30, 5, v1
    v_and_b32 v31, 31, v1
    v_lshlrev_b32 v3, 1, v30
    v_xor_b32 v31, v31, v3
    v_lshlrev_b32 v31, 4, v31
    v_lshl_add_u32 v2, v30, 9, v31
    v_xor_b32 v3, 64, v2
    v_xor_b32 v4, 0x80, v2
    v_xor_b32 v5, 0xc0, v2
    s_mul_i32 s56, s52, 16384
    v_mov_b32 v0, 0
    v_and_b32 v30, 15, v1
    v_lshlrev_b32 v30, 2, v30
    v_add_u32 v30, 135232, v30
    ds_write_b32 v30, v0
    s_waitcnt lgkmcnt(0)
    s_barrier
    s_lshr_b32 s3, s55, 3
    s_lshl_b32 s69, s54, 2
    s_add_u32 s69, s69, s3
    s_lshl_b32 s69, s69, 3
    s_add_u32 s69, s69, s53
    s_lshl_b32 s3, s69, 21
    s_add_u32 s4, s74, s3
    s_addc_u32 s5, s75, 0
    s_and_b32 s5, s5, 0xffff
    s_mov_b32 s6, 2097152
    s_mov_b32 s7, 0x00020000
    s_add_u32 s8, s76, s3
    s_addc_u32 s9, s77, 0
    s_and_b32 s9, s9, 0xffff
    s_mov_b32 s10, 2097152
    s_mov_b32 s11, 0x00020000
    s_add_u32 s12, s84, s3
    s_addc_u32 s13, s85, 0
    s_and_b32 s13, s13, 0xffff
    s_mov_b32 s14, 2097152
    s_mov_b32 s15, 0x00020000
    s_add_u32 s16, s86, s3
    s_addc_u32 s17, s87, 0
    s_and_b32 s17, s17, 0xffff
    s_mov_b32 s18, 2097152
    s_mov_b32 s19, 0x00020000
    s_mov_b32 s20, s78
    s_and_b32 s21, s79, 0xffff
    s_mov_b32 s22, 3670016
    s_mov_b32 s23, 0x00020000
    s_mov_b32 s24, s80
    s_and_b32 s25, s81, 0xffff
    s_mov_b32 s26, 3670016
    s_mov_b32 s27, 0x00020000
    s_mov_b32 s28, s88
    s_and_b32 s29, s89, 0xffff
    s_mov_b32 s30, 3670016
    s_mov_b32 s31, 0x00020000
    s_mov_b32 s32, s90
    s_and_b32 s33, s91, 0xffff
    s_mov_b32 s34, 3670016
    s_mov_b32 s35, 0x00020000
    s_mov_b32 s36, s96
    s_and_b32 s37, s97, 0xffff
    s_mov_b32 s38, 4194304
    s_mov_b32 s39, 0x00020000
    s_mov_b32 s40, s94
    s_and_b32 s41, s95, 0xffff
    s_mov_b32 s42, 256
    s_mov_b32 s43, 0x00020000
    s_mov_b32 s44, s72
    s_and_b32 s45, s73, 0xffff
    s_mov_b32 s46, 7168
    s_mov_b32 s47, 0x00020000
    s_mov_b32 s48, s92
    s_and_b32 s49, s93, 0xffff
    s_mov_b32 s50, 7168
    s_mov_b32 s51, 0x00020000
    s_lshr_b32 s78, s55, 3
    s_and_b32 s82, s52, 1
    s_mov_b32 s83, 4000000
    s_lshl_b32 s84, s52, 2
    s_add_u32 s84, s84, 135232
    s_xor_b32 s85, s84, 4
    s_mov_b32 s86, 0x00003f80
    s_mov_b32 s87, 0x3f800000
    s_min_u32 s88, s55, 27
    s_getreg_b32 s92, hwreg(HW_REG_XCC_ID, 0, 4)
    s_lshl_b32 s92, s92, 1
    s_or_b32 s92, s92, 1
    s_mov_b32 s100, 0
    s_and_b32 s69, s55, 7
    s_lshl_b32 s69, s69, 1
    s_add_u32 s69, s69, s82
    s_mul_i32 s57, s69, 8192
    s_lshl_b32 s69, s53, 1
    s_add_u32 s69, s69, s82
    s_mul_i32 s58, s69, 229376
    s_lshl_b32 s69, s88, 5
    s_add_u32 s58, s58, s69
    s_mul_i32 s59, s82, 1835008
    s_lshl_b32 s69, s53, 10
    s_add_u32 s59, s59, s69
    s_lshl_b32 s69, s55, 5
    s_add_u32 s59, s59, s69
    s_mul_i32 s60, s54, 1572864
    s_mul_i32 s69, s53, 196608
    s_add_u32 s61, s60, s69
    s_lshl_b32 s69, s55, 9
    s_add_u32 s76, s61, s69
    s_lshl_b32 s69, s82, 14
    s_add_u32 s76, s76, s69
    s_add_u32 s62, s61, 163840
    s_lshl_b32 s69, s82, 7
    s_add_u32 s62, s62, s69
    s_lshl_b32 s69, s55, 8
    s_add_u32 s77, s62, s69
    s_lshl_b32 s69, s88, 7
    s_add_u32 s63, s61, s69
    s_add_u32 s63, s63, 135168
    s_lshl_b32 s69, s54, 3
    s_add_u32 s69, s69, s53
    s_lshl_b32 s69, s69, 11
    s_add_u32 s88, s69, 3735552
    s_lshl_b32 s64, s78, 5
    s_lshl_b32 s75, s55, 7
    s_lshl_b32 s69, s54, 3
    s_add_u32 s69, s69, s53
    s_mul_i32 s101, s69, 0x3000
    s_add_u32 s101, s101, 3211264
    s_lshl_b32 s69, s54, 1
    s_add_u32 s69, s69, s82
    s_mul_i32 s69, s69, 1792
    v_lshlrev_b32 v30, 4, v1
    v_mov_b32 v31, 2147483648
    v_cndmask_b32 v30, v31, v30, s[66:67]
    buffer_load_dwordx4 v[64:67], v30, s[44:47], s69 offen
    buffer_load_dwordx4 v[68:71], v30, s[44:47], s69 offen offset:896
    v_lshrrev_b32 v30, 1, v1
    v_lshlrev_b32 v30, 13, v30
    v_and_b32 v31, 1, v1
    v_lshl_add_u32 v30, v31, 4, v30
    s_mul_i32 s72, s82, 7168
    s_add_u32 s72, s72, 98304
    s_lshl_b32 s73, s54, 2
    s_add_u32 s73, s73, 0
    s_min_u32 s73, s73, 6
    s_lshl_b32 s69, s73, 10
    s_add_u32 m0, s72, s69
    s_lshl_b32 s69, s73, 18
    s_add_u32 s69, s69, s59
    buffer_load_dwordx4 v30, s[20:23], s69 offen nt lds
    s_lshl_b32 s73, s54, 2
    s_add_u32 s73, s73, 1
    s_min_u32 s73, s73, 6
    s_lshl_b32 s69, s73, 10
    s_add_u32 m0, s72, s69
    s_lshl_b32 s69, s73, 18
    s_add_u32 s69, s69, s59
    buffer_load_dwordx4 v30, s[20:23], s69 offen nt lds
    s_lshl_b32 s73, s54, 2
    s_add_u32 s73, s73, 2
    s_min_u32 s73, s73, 6
    s_lshl_b32 s69, s73, 10
    s_add_u32 m0, s72, s69
    s_lshl_b32 s69, s73, 18
    s_add_u32 s69, s69, s59
    buffer_load_dwordx4 v30, s[20:23], s69 offen nt lds
    s_lshl_b32 s73, s54, 2
    s_add_u32 s73, s73, 3
    s_min_u32 s73, s73, 6
    s_lshl_b32 s69, s73, 10
    s_add_u32 m0, s72, s69
    s_lshl_b32 s69, s73, 18
    s_add_u32 s69, s69, s59
    buffer_load_dwordx4 v30, s[20:23], s69 offen nt lds
    s_mul_i32 s69, s55, 6144
    s_add_u32 s69, s69, s61
    s_lshl_b32 s72, s82, 10
    s_add_u32 s69, s69, s72
    v_lshlrev_b32 v30, 4, v1
    v_mov_b32 v72, -1
    v_mov_b32 v73, -1
    v_mov_b32 v74, -1
    v_mov_b32 v75, -1
    buffer_store_dwordx4 v[72:75], v30, s[36:39], s69 offen offset:0 sc1
    buffer_store_dwordx4 v[72:75], v30, s[36:39], s69 offen offset:2048 sc1
    s_add_u32 s72, s69, 4096
    buffer_store_dwordx4 v[72:75], v30, s[36:39], s72 offen sc1
    v_lshrrev_b32 v30, 3, v1
    v_lshlrev_b32 v30, 12, v30
    v_and_b32 v31, 7, v1
    v_lshl_add_u32 v30, v31, 4, v30
    s_cmp_eq_u32 s82, 0
    s_cselect_b32 s69, 24, 0
    v_cmp_gt_u32 vcc, s69, v1
    v_mov_b32 v31, 2147483648
    s_lshl_b32 s69, s55, 7
    s_add_u32 s69, s69, s101
    v_cndmask_b32 v30, v31, v30, vcc
    buffer_store_dwordx4 v[72:75], v30, s[36:39], s69 offen sc1
    v_lshlrev_b32 v30, 4, v1
    s_cmp_eq_u32 s82, 0
    s_cselect_b32 s69, 8, 0
    s_cmp_lt_u32 s55, 16
    s_cselect_b32 s69, s69, 0
    v_cmp_gt_u32 vcc, s69, v1
    v_mov_b32 v31, 2147483648
    s_lshl_b32 s69, s55, 7
    s_add_u32 s69, s69, s88
    v_cndmask_b32 v30, v31, v30, vcc
    buffer_store_dwordx4 v[72:75], v30, s[36:39], s69 offen sc1
    s_add_u32 m0, s56, 0
    s_add_u32 s69, s57, 0
    buffer_load_dwordx4 v2, s[4:7], s69 offen offset:0 nt lds
    buffer_load_dwordx4 v3, s[4:7], s69 offen offset:1024 nt lds
    buffer_load_dwordx4 v4, s[4:7], s69 offen offset:2048 nt lds
    buffer_load_dwordx4 v5, s[4:7], s69 offen offset:3072 nt lds
    s_add_u32 m0, s56, 4096
    s_add_u32 s69, s69, 4096
    buffer_load_dwordx4 v2, s[4:7], s69 offen offset:0 nt lds
    buffer_load_dwordx4 v3, s[4:7], s69 offen offset:1024 nt lds
    buffer_load_dwordx4 v4, s[4:7], s69 offen offset:2048 nt lds
    buffer_load_dwordx4 v5, s[4:7], s69 offen offset:3072 nt lds
    s_add_u32 m0, s56, 8192
    s_add_u32 s69, s57, 131072
    buffer_load_dwordx4 v2, s[4:7], s69 offen offset:0 nt lds
    buffer_load_dwordx4 v3, s[4:7], s69 offen offset:1024 nt lds
    buffer_load_dwordx4 v4, s[4:7], s69 offen offset:2048 nt lds
    buffer_load_dwordx4 v5, s[4:7], s69 offen offset:3072 nt lds
    s_add_u32 m0, s56, 12288
    s_add_u32 s69, s69, 4096
    buffer_load_dwordx4 v2, s[4:7], s69 offen offset:0 nt lds
    buffer_load_dwordx4 v3, s[4:7], s69 offen offset:1024 nt lds
    buffer_load_dwordx4 v4, s[4:7], s69 offen offset:2048 nt lds
    buffer_load_dwordx4 v5, s[4:7], s69 offen offset:3072 nt lds
    s_waitcnt vmcnt(25)
    v_lshlrev_b32 v14, 16, v64
    v_and_b32 v15, 0xffff0000, v64
    v_lshlrev_b32 v16, 16, v65
    v_and_b32 v17, 0xffff0000, v65
    v_lshlrev_b32 v18, 16, v66
    v_and_b32 v19, 0xffff0000, v66
    v_lshlrev_b32 v20, 16, v67
    v_and_b32 v21, 0xffff0000, v67
    v_lshlrev_b32 v22, 16, v68
    v_and_b32 v23, 0xffff0000, v68
    v_lshlrev_b32 v24, 16, v69
    v_and_b32 v25, 0xffff0000, v69
    v_lshlrev_b32 v26, 16, v70
    v_and_b32 v27, 0xffff0000, v70
    v_lshlrev_b32 v28, 16, v71
    v_and_b32 v29, 0xffff0000, v71
    s_lshl_b32 s69, s54, 1
    s_add_u32 s69, s69, s82
    s_mul_i32 s69, s69, 3584
    s_add_u32 s69, s69, 148224
    v_lshlrev_b32 v31, 5, v1
    v_add_u32 v31, s69, v31
    s_mov_b64 exec, s[66:67]
    ds_write_b128 v31, v[14:17] offset:0
    ds_write_b128 v31, v[18:21] offset:16
    ds_write_b128 v31, v[22:25] offset:1792
    ds_write_b128 v31, v[26:29] offset:1808
    s_mov_b64 exec, -1
    v_add_f32 v80, v14, v15
    v_add_f32 v80, v80, v16
    v_add_f32 v80, v80, v17
    v_add_f32 v80, v80, v18
    v_add_f32 v80, v80, v19
    v_add_f32 v80, v80, v20
    v_add_f32 v80, v80, v21
    v_add_f32 v81, v22, v23
    v_add_f32 v81, v81, v24
    v_add_f32 v81, v81, v25
    v_add_f32 v81, v81, v26
    v_add_f32 v81, v81, v27
    v_add_f32 v81, v81, v28
    v_add_f32 v81, v81, v29
    s_nop 0
    v_add_f32_dpp v80, v80, v80 row_ror:8 row_mask:0xf bank_mask:0xf
    v_add_f32_dpp v81, v81, v81 row_ror:8 row_mask:0xf bank_mask:0xf
    s_nop 0
    v_add_f32_dpp v80, v80, v80 row_ror:4 row_mask:0xf bank_mask:0xf
    v_add_f32_dpp v81, v81, v81 row_ror:4 row_mask:0xf bank_mask:0xf
    s_nop 0
    v_add_f32_dpp v80, v80, v80 row_ror:2 row_mask:0xf bank_mask:0xf
    v_add_f32_dpp v81, v81, v81 row_ror:2 row_mask:0xf bank_mask:0xf
    s_nop 0
    v_add_f32_dpp v80, v80, v80 row_ror:1 row_mask:0xf bank_mask:0xf
    v_add_f32_dpp v81, v81, v81 row_ror:1 row_mask:0xf bank_mask:0xf
    s_nop 0
    v_mov_b32 v82, v80
    v_mov_b32 v83, v81
    s_nop 0
    v_permlane32_swap_b32 v82, v80
    v_permlane32_swap_b32 v83, v81
    s_nop 0
    v_add_f32 v80, v80, v82
    v_add_f32 v81, v81, v83
    v_mov_b32 v82, v80
    v_mov_b32 v83, v81
    s_nop 0
    v_permlane16_swap_b32 v82, v80
    v_permlane16_swap_b32 v83, v81
    s_nop 0
    v_add_f32 v80, v80, v82
    v_add_f32 v81, v81, v83
    v_mul_f32 v80, 0x3b124925, v80
    v_mul_f32 v81, 0x3b124925, v81
    v_sub_f32 v64, v14, v80
    v_sub_f32 v65, v15, v80
    v_sub_f32 v66, v16, v80
    v_sub_f32 v67, v17, v80
    v_sub_f32 v68, v18, v80
    v_sub_f32 v69, v19, v80
    v_sub_f32 v70, v20, v80
    v_sub_f32 v71, v21, v80
    v_sub_f32 v72, v22, v81
    v_sub_f32 v73, v23, v81
    v_sub_f32 v74, v24, v81
    v_sub_f32 v75, v25, v81
    v_sub_f32 v76, v26, v81
    v_sub_f32 v77, v27, v81
    v_sub_f32 v78, v28, v81
    v_sub_f32 v79, v29, v81
    v_mul_f32 v80, v64, v64
    v_fmac_f32 v80, v65, v65
    v_fmac_f32 v80, v66, v66
    v_fmac_f32 v80, v67, v67
    v_fmac_f32 v80, v68, v68
    v_fmac_f32 v80, v69, v69
    v_fmac_f32 v80, v70, v70
    v_fmac_f32 v80, v71, v71
    v_mul_f32 v81, v72, v72
    v_fmac_f32 v81, v73, v73
    v_fmac_f32 v81, v74, v74
    v_fmac_f32 v81, v75, v75
    v_fmac_f32 v81, v76, v76
    v_fmac_f32 v81, v77, v77
    v_fmac_f32 v81, v78, v78
    v_fmac_f32 v81, v79, v79
    v_cndmask_b32 v80, 0, v80, s[66:67]
    v_cndmask_b32 v81, 0, v81, s[66:67]
    s_nop 0
    v_add_f32_dpp v80, v80, v80 row_ror:8 row_mask:0xf bank_mask:0xf
    v_add_f32_dpp v81, v81, v81 row_ror:8 row_mask:0xf bank_mask:0xf
    s_nop 0
    v_add_f32_dpp v80, v80, v80 row_ror:4 row_mask:0xf bank_mask:0xf
    v_add_f32_dpp v81, v81, v81 row_ror:4 row_mask:0xf bank_mask:0xf
    s_nop 0
    v_add_f32_dpp v80, v80, v80 row_ror:2 row_mask:0xf bank_mask:0xf
    v_add_f32_dpp v81, v81, v81 row_ror:2 row_mask:0xf bank_mask:0xf
    s_nop 0
    v_add_f32_dpp v80, v80, v80 row_ror:1 row_mask:0xf bank_mask:0xf
    v_add_f32_dpp v81, v81, v81 row_ror:1 row_mask:0xf bank_mask:0xf
    s_nop 0
    v_mov_b32 v82, v80
    v_mov_b32 v83, v81
    s_nop 0
    v_permlane32_swap_b32 v82, v80
    v_permlane32_swap_b32 v83, v81
    s_nop 0
    v_add_f32 v80, v80, v82
    v_add_f32 v81, v81, v83
    v_mov_b32 v82, v80
    v_mov_b32 v83, v81
    s_nop 0
    v_permlane16_swap_b32 v82, v80
    v_permlane16_swap_b32 v83, v81
    s_nop 0
    v_add_f32 v80, v80, v82
    v_add_f32 v81, v81, v83
    v_mov_b32 v82, 0x3727c5ac
    v_mov_b32 v83, 0x3727c5ac
    v_fmac_f32 v82, 0x3b124925, v80
    v_fmac_f32 v83, 0x3b124925, v81
    v_rsq_f32 v82, v82
    v_rsq_f32 v83, v83
    s_nop 0
    v_mul_f32 v64, v64, v82
    v_mul_f32 v65, v65, v82
    v_mul_f32 v66, v66, v82
    v_mul_f32 v67, v67, v82
    v_mul_f32 v68, v68, v82
    v_mul_f32 v69, v69, v82
    v_mul_f32 v70, v70, v82
    v_mul_f32 v71, v71, v82
    v_mul_f32 v72, v72, v83
    v_mul_f32 v73, v73, v83
    v_mul_f32 v74, v74, v83
    v_mul_f32 v75, v75, v83
    v_mul_f32 v76, v76, v83
    v_mul_f32 v77, v77, v83
    v_mul_f32 v78, v78, v83
    v_mul_f32 v79, v79, v83
    v_cvt_pk_bf16_f32 v84, v64, v65
    v_cvt_pk_bf16_f32 v85, v66, v67
    v_cvt_pk_bf16_f32 v86, v68, v69
    v_cvt_pk_bf16_f32 v87, v70, v71
    v_cvt_pk_bf16_f32 v88, v72, v73
    v_cvt_pk_bf16_f32 v89, v74, v75
    v_cvt_pk_bf16_f32 v90, v76, v77
    v_cvt_pk_bf16_f32 v91, v78, v79
    s_lshl_b32 s69, s52, 11
    s_add_u32 s69, s69, 137472
    v_lshlrev_b32 v30, 4, v1
    v_add_u32 v30, s69, v30
    ds_write_b128 v30, v[84:87]
    ds_write_b128 v30, v[88:91] offset:1024
    s_waitcnt vmcnt(21)
    s_waitcnt lgkmcnt(0)
    s_barrier
    v_lshrrev_b32 v124, 4, v1
    v_lshlrev_b32 v124, 8, v124
    v_bfe_u32 v125, v1, 2, 2
    v_lshl_add_u32 v124, v125, 5, v124
    v_and_b32 v125, 3, v1
    v_lshl_add_u32 v124, v125, 3, v124
    s_mul_i32 s69, s82, 7168
    s_add_u32 s69, s69, 98304
    v_add_u32 v124, s69, v124
    ds_read_b64_tr_b16 v[96:97], v124 offset:0
    ds_read_b64_tr_b16 v[98:99], v124 offset:128
    ds_read_b64_tr_b16 v[100:101], v124 offset:1024
    ds_read_b64_tr_b16 v[102:103], v124 offset:1152
    ds_read_b64_tr_b16 v[104:105], v124 offset:2048
    ds_read_b64_tr_b16 v[106:107], v124 offset:2176
    ds_read_b64_tr_b16 v[108:109], v124 offset:3072
    ds_read_b64_tr_b16 v[110:111], v124 offset:3200
    s_waitcnt lgkmcnt(4)
    ds_read_b64_tr_b16 v[112:113], v124 offset:4096
    ds_read_b64_tr_b16 v[114:115], v124 offset:4224
    ds_read_b64_tr_b16 v[116:117], v124 offset:5120
    ds_read_b64_tr_b16 v[118:119], v124 offset:5248
    ds_read_b64_tr_b16 v[120:121], v124 offset:6144
    ds_read_b64_tr_b16 v[122:123], v124 offset:6272
    s_waitcnt lgkmcnt(0)
    v_and_b32 v30, 3, v1
    v_lshlrev_b32 v30, 10, v30
    s_lshl_b32 s69, s54, 12
    s_add_u32 s69, s69, 137472
    v_lshrrev_b32 v31, 4, v1
    v_lshl_add_u32 v30, v31, 4, v30
    s_mul_i32 s72, s82, 448
    s_add_u32 s69, s69, s72
    v_add_u32 v30, s69, v30
    ds_read_b128 v[32:35], v30 offset:0
    ds_read_b128 v[36:39], v30 offset:64
    ds_read_b128 v[40:43], v30 offset:128
    ds_read_b128 v[44:47], v30 offset:192
    ds_read_b128 v[48:51], v30 offset:256
    ds_read_b128 v[52:55], v30 offset:320
    ds_read_b128 v[56:59], v30 offset:384
    s_waitcnt lgkmcnt(6)
    v_mfma_f32_16x16x32_bf16 v[92:95], v[96:99], v[32:35], 0
    s_waitcnt lgkmcnt(5)
    v_mfma_f32_16x16x32_bf16 v[92:95], v[100:103], v[36:39], v[92:95]
    s_waitcnt lgkmcnt(4)
    v_mfma_f32_16x16x32_bf16 v[92:95], v[104:107], v[40:43], v[92:95]
    s_waitcnt lgkmcnt(3)
    v_mfma_f32_16x16x32_bf16 v[92:95], v[108:111], v[44:47], v[92:95]
    s_waitcnt lgkmcnt(2)
    v_mfma_f32_16x16x32_bf16 v[92:95], v[112:115], v[48:51], v[92:95]
    s_waitcnt lgkmcnt(1)
    v_mfma_f32_16x16x32_bf16 v[92:95], v[116:119], v[52:55], v[92:95]
    s_waitcnt lgkmcnt(0)
    v_mfma_f32_16x16x32_bf16 v[92:95], v[120:123], v[56:59], v[92:95]
    v_and_b32 v30, 3, v1
    v_lshlrev_b32 v30, 6, v30
    v_lshrrev_b32 v31, 4, v1
    v_lshl_add_u32 v30, v31, 4, v30
    s_lshl_b32 s69, s52, 8
    s_add_u32 s69, s69, 136448
    v_add_u32 v30, s69, v30
    s_nop 7
    ds_write_b128 v30, v[92:95]
    s_waitcnt lgkmcnt(0)
    v_mov_b32 v30, s84
    v_mov_b32 v31, 1
    ds_write_b32 v30, v31
    v_mov_b32 v30, s85
Lps_1:
    ds_read_b32 v31, v30
    s_waitcnt lgkmcnt(0)
    v_cmp_gt_u32 vcc, 1, v31
    s_cbranch_vccz Lpd_2
    s_cmp_eq_u32 s83, 0
    s_cbranch_scc1 Lpd_2
    s_sub_u32 s83, s83, 1
    s_branch Lps_1
Lpd_2:
    s_lshl_b32 s72, s54, 3
    s_add_u32 s72, s72, s53
    s_lshl_b32 s72, s72, 12
    s_add_u32 s72, s72, 3145728
    s_add_u32 s72, s72, s75
    s_lshl_b32 s69, s54, 9
    s_add_u32 s69, s69, 136448
    v_and_b32 v30, 7, v1
    v_lshlrev_b32 v30, 5, v30
    v_add_u32 v30, s69, v30
    ds_read_b128 v[64:67], v30 offset:0
    ds_read_b128 v[68:71], v30 offset:16
    ds_read_b128 v[72:75], v30 offset:256
    ds_read_b128 v[76:79], v30 offset:272
    v_lshlrev_b32 v31, 4, v1
    s_cmp_eq_u32 s82, 0
    s_cselect_b32 s69, 8, 0
    v_cmp_gt_u32 vcc, s69, v1
    v_mov_b32 v80, 2147483648
    s_nop 0
    v_cndmask_b32 v31, v80, v31, vcc
    s_waitcnt lgkmcnt(0)
    v_add_f32 v64, v64, v72
    v_add_f32 v65, v65, v73
    v_add_f32 v66, v66, v74
    v_add_f32 v67, v67, v75
    v_add_f32 v68, v68, v76
    v_add_f32 v69, v69, v77
    v_add_f32 v70, v70, v78
    v_add_f32 v71, v71, v79
    v_cvt_pk_bf16_f32 v72, v64, v65
    v_cvt_pk_bf16_f32 v73, v66, v67
    v_cvt_pk_bf16_f32 v74, v68, v69
    v_cvt_pk_bf16_f32 v75, v70, v71
    v_min_u32 v72, -2, v72
    v_min_u32 v73, -2, v73
    v_min_u32 v74, -2, v74
    v_min_u32 v75, -2, v75
    buffer_store_dwordx4 v[72:75], v31, s[36:39], s72 offen sc1
    s_waitcnt vmcnt(0)
    s_barrier
    s_cmp_eq_u32 s52, 0
    s_cselect_b32 s69, 1, 0
    v_cmp_gt_u32 vcc, s69, v1
    v_mov_b32 v30, 2147483648
    s_lshl_b32 s69, s53, 5
    v_mov_b32 v31, s69
    s_lshr_b32 s69, s92, 1
    s_mul_i32 s72, s69, s69
    s_lshl_b32 s69, s69, 6
    s_lshl_b32 s72, s72, 15
    s_or_b32 s69, s69, s72
    s_or_b32 s92, s69, 1
    v_cndmask_b32 v30, v30, v31, vcc
    v_mov_b32 v31, s92
    buffer_atomic_add v31, v30, s[40:43], 0 offen sc1
    v_and_b32 v7, 15, v1
    v_lshlrev_b32 v6, 9, v7
    v_and_b32 v7, 7, v7
    v_lshl_add_u32 v6, v7, 5, v6
    v_lshrrev_b32 v7, 5, v1
    v_lshl_add_u32 v6, v7, 8, v6
    v_bfe_u32 v7, v1, 4, 1
    v_lshl_add_u32 v6, v7, 4, v6
    v_add_u32 v6, s56, v6
    v_xor_b32 v7, 32, v6
    v_xor_b32 v8, 64, v6
    v_xor_b32 v9, 96, v6
    v_xor_b32 v10, 128, v6
    v_xor_b32 v11, 160, v6
    v_xor_b32 v12, 192, v6
    v_xor_b32 v13, 224, v6
    ds_read_b128 a[0:3], v6 offset:0
    ds_read_b128 a[4:7], v7 offset:0
    ds_read_b128 a[8:11], v8 offset:0
    ds_read_b128 a[12:15], v9 offset:0
    ds_read_b128 a[16:19], v10 offset:0
    ds_read_b128 a[20:23], v11 offset:0
    ds_read_b128 a[24:27], v12 offset:0
    ds_read_b128 a[28:31], v13 offset:0
    s_waitcnt lgkmcnt(0)
    s_add_u32 m0, s56, 0
    s_add_u32 s69, s57, 262144
    buffer_load_dwordx4 v2, s[4:7], s69 offen offset:0 nt lds
    buffer_load_dwordx4 v3, s[4:7], s69 offen offset:1024 nt lds
    buffer_load_dwordx4 v4, s[4:7], s69 offen offset:2048 nt lds
    buffer_load_dwordx4 v5, s[4:7], s69 offen offset:3072 nt lds
    s_add_u32 m0, s56, 4096
    s_add_u32 s69, s69, 4096
    buffer_load_dwordx4 v2, s[4:7], s69 offen offset:0 nt lds
    buffer_load_dwordx4 v3, s[4:7], s69 offen offset:1024 nt lds
    buffer_load_dwordx4 v4, s[4:7], s69 offen offset:2048 nt lds
    buffer_load_dwordx4 v5, s[4:7], s69 offen offset:3072 nt lds
    ds_read_b128 a[32:35], v6 offset:8192
    ds_read_b128 a[36:39], v7 offset:8192
    ds_read_b128 a[40:43], v8 offset:8192
    ds_read_b128 a[44:47], v9 offset:8192
    ds_read_b128 a[48:51], v10 offset:8192
    ds_read_b128 a[52:55], v11 offset:8192
    ds_read_b128 a[56:59], v12 offset:8192
    ds_read_b128 a[60:63], v13 offset:8192
    s_waitcnt lgkmcnt(0)
    s_add_u32 m0, s56, 8192
    s_add_u32 s69, s57, 393216
    buffer_load_dwordx4 v2, s[4:7], s69 offen offset:0 nt lds
    buffer_load_dwordx4 v3, s[4:7], s69 offen offset:1024 nt lds
    buffer_load_dwordx4 v4, s[4:7], s69 offen offset:2048 nt lds
    buffer_load_dwordx4 v5, s[4:7], s69 offen offset:3072 nt lds
    s_add_u32 m0, s56, 12288
    s_add_u32 s69, s69, 4096
    buffer_load_dwordx4 v2, s[4:7], s69 offen offset:0 nt lds
    buffer_load_dwordx4 v3, s[4:7], s69 offen offset:1024 nt lds
    buffer_load_dwordx4 v4, s[4:7], s69 offen offset:2048 nt lds
    buffer_load_dwordx4 v5, s[4:7], s69 offen offset:3072 nt lds
    s_waitcnt vmcnt(8)
    ds_read_b128 a[64:67], v6 offset:0
    ds_read_b128 a[68:71], v7 offset:0
    ds_read_b128 a[72:75], v8 offset:0
    ds_read_b128 a[76:79], v9 offset:0
    ds_read_b128 a[80:83], v10 offset:0
    ds_read_b128 a[84:87], v11 offset:0
    ds_read_b128 a[88:91], v12 offset:0
    ds_read_b128 a[92:95], v13 offset:0
    s_waitcnt lgkmcnt(0)
    s_add_u32 m0, s56, 0
    s_add_u32 s69, s57, 524288
    buffer_load_dwordx4 v2, s[4:7], s69 offen offset:0 nt lds
    buffer_load_dwordx4 v3, s[4:7], s69 offen offset:1024 nt lds
    buffer_load_dwordx4 v4, s[4:7], s69 offen offset:2048 nt lds
    buffer_load_dwordx4 v5, s[4:7], s69 offen offset:3072 nt lds
    s_add_u32 m0, s56, 4096
    s_add_u32 s69, s69, 4096
    buffer_load_dwordx4 v2, s[4:7], s69 offen offset:0 nt lds
    buffer_load_dwordx4 v3, s[4:7], s69 offen offset:1024 nt lds
    buffer_load_dwordx4 v4, s[4:7], s69 offen offset:2048 nt lds
    buffer_load_dwordx4 v5, s[4:7], s69 offen offset:3072 nt lds
    s_waitcnt vmcnt(8)
    ds_read_b128 a[96:99], v6 offset:8192
    ds_read_b128 a[100:103], v7 offset:8192
    ds_read_b128 a[104:107], v8 offset:8192
    ds_read_b128 a[108:111], v9 offset:8192
    ds_read_b128 a[112:115], v10 offset:8192
    ds_read_b128 a[116:119], v11 offset:8192
    ds_read_b128 a[120:123], v12 offset:8192
    ds_read_b128 a[124:127], v13 offset:8192
    s_waitcnt lgkmcnt(0)
    s_add_u32 m0, s56, 8192
    s_add_u32 s69, s57, 655360
    buffer_load_dwordx4 v2, s[4:7], s69 offen offset:0 nt lds
    buffer_load_dwordx4 v3, s[4:7], s69 offen offset:1024 nt lds
    buffer_load_dwordx4 v4, s[4:7], s69 offen offset:2048 nt lds
    buffer_load_dwordx4 v5, s[4:7], s69 offen offset:3072 nt lds
    s_add_u32 m0, s56, 12288
    s_add_u32 s69, s69, 4096
    buffer_load_dwordx4 v2, s[4:7], s69 offen offset:0 nt lds
    buffer_load_dwordx4 v3, s[4:7], s69 offen offset:1024 nt lds
    buffer_load_dwordx4 v4, s[4:7], s69 offen offset:2048 nt lds
    buffer_load_dwordx4 v5, s[4:7], s69 offen offset:3072 nt lds
    s_cmp_lg_u32 s52, 0
    s_cbranch_scc1 Lip_3
    v_and_b32 v30, 7, v1
    v_lshlrev_b32 v30, 5, v30
    buffer_load_dword v64, v30, s[40:43], 0 offen sc1
    s_waitcnt vmcnt(0)
    v_and_b32 v65, 63, v64
    v_cmp_ne_u32 vcc, 32, v65
    s_cbranch_vccz Ldoneinit_5
Lpollinit_4:
    s_cmp_eq_u32 s65, 0
    s_cbranch_scc1 Ldoneinit_5
    s_sub_u32 s65, s65, 1
    s_sleep 8
    buffer_load_dword v64, v30, s[40:43], 0 offen sc1
    s_waitcnt vmcnt(0)
    v_and_b32 v65, 63, v64
    v_cmp_ne_u32 vcc, 32, v65
    s_cbranch_vccnz Lpollinit_4
Ldoneinit_5:
    s_lshl_b32 s69, s92, 5
    v_cmp_ne_u32 vcc, s69, v64
    s_lshl_b32 s72, 1, s53
    s_and_b32 s69, vcc_lo, s72
    s_cmp_eq_u32 s69, 0
    s_cselect_b32 s100, 1, 0
    v_mov_b32 v30, 147712
    v_mov_b32 v31, s100
    ds_write_b32 v30, v31
    s_waitcnt lgkmcnt(0)
Lip_3:
    s_barrier
    v_mov_b32 v30, 147712
    ds_read_b32 v31, v30
    s_waitcnt lgkmcnt(0)
    v_readfirstlane_b32 s100, v31
    s_lshl_b32 s72, s54, 3
    s_add_u32 s72, s72, s53
    s_lshl_b32 s72, s72, 12
    s_add_u32 s72, s72, 3145728
    s_add_u32 s72, s72, s64
    v_lshrrev_b32 v30, 1, v1
    v_lshlrev_b32 v30, 7, v30
    v_and_b32 v31, 1, v1
    v_lshl_add_u32 v30, v31, 4, v30
    buffer_load_dwordx4 v[64:67], v30, s[36:39], s72 offen sc1
    s_waitcnt vmcnt(9)
    ds_read_b128 a[128:131], v6 offset:0
    ds_read_b128 a[132:135], v7 offset:0
    ds_read_b128 a[136:139], v8 offset:0
    ds_read_b128 a[140:143], v9 offset:0
    ds_read_b128 a[144:147], v10 offset:0
    ds_read_b128 a[148:151], v11 offset:0
    ds_read_b128 a[152:155], v12 offset:0
    ds_read_b128 a[156:159], v13 offset:0
    s_waitcnt lgkmcnt(0)
    s_add_u32 m0, s56, 0
    s_add_u32 s69, s57, 0
    buffer_load_dwordx4 v2, s[12:15], s69 offen offset:0 nt lds
    buffer_load_dwordx4 v3, s[12:15], s69 offen offset:1024 nt lds
    buffer_load_dwordx4 v4, s[12:15], s69 offen offset:2048 nt lds
    buffer_load_dwordx4 v5, s[12:15], s69 offen offset:3072 nt lds
    s_add_u32 m0, s56, 4096
    s_add_u32 s69, s69, 4096
    buffer_load_dwordx4 v2, s[12:15], s69 offen offset:0 nt lds
    buffer_load_dwordx4 v3, s[12:15], s69 offen offset:1024 nt lds
    buffer_load_dwordx4 v4, s[12:15], s69 offen offset:2048 nt lds
    buffer_load_dwordx4 v5, s[12:15], s69 offen offset:3072 nt lds
    s_waitcnt vmcnt(9)
    ds_read_b128 a[160:163], v6 offset:8192
    ds_read_b128 a[164:167], v7 offset:8192
    ds_read_b128 a[168:171], v8 offset:8192
    ds_read_b128 a[172:175], v9 offset:8192
    ds_read_b128 a[176:179], v10 offset:8192
    ds_read_b128 a[180:183], v11 offset:8192
    ds_read_b128 a[184:187], v12 offset:8192
    ds_read_b128 a[188:191], v13 offset:8192
    s_waitcnt lgkmcnt(0)
    s_add_u32 m0, s56, 8192
    s_add_u32 s69, s57, 131072
    buffer_load_dwordx4 v2, s[12:15], s69 offen offset:0 nt lds
    buffer_load_dwordx4 v3, s[12:15], s69 offen offset:1024 nt lds
    buffer_load_dwordx4 v4, s[12:15], s69 offen offset:2048 nt lds
    buffer_load_dwordx4 v5, s[12:15], s69 offen offset:3072 nt lds
    s_add_u32 m0, s56, 12288
    s_add_u32 s69, s69, 4096
    buffer_load_dwordx4 v2, s[12:15], s69 offen offset:0 nt lds
    buffer_load_dwordx4 v3, s[12:15], s69 offen offset:1024 nt lds
    buffer_load_dwordx4 v4, s[12:15], s69 offen offset:2048 nt lds
    buffer_load_dwordx4 v5, s[12:15], s69 offen offset:3072 nt lds
    s_lshl_b32 s72, s54, 3
    s_add_u32 s72, s72, s53
    s_lshl_b32 s72, s72, 12
    s_add_u32 s72, s72, 3145728
    s_add_u32 s72, s72, s64
    s_waitcnt vmcnt(16)
    s_lshl_b32 s69, s54, 10
    s_add_u32 s69, s69, 145664
    v_lshlrev_b32 v30, 4, v1
    v_add_u32 v30, s69, v30
    ds_write_b128 v30, v[64:67]
    v_and_b32 v31, 1, v1
    v_lshlrev_b32 v31, 9, v31
    v_bfe_u32 v30, v1, 4, 1
    v_lshl_add_u32 v31, v30, 4, v31
    v_lshrrev_b32 v30, 5, v1
    v_lshl_add_u32 v31, v30, 8, v31
    v_add_u32 v31, s69, v31
    s_waitcnt lgkmcnt(0)
    ds_read_b128 v[32:35], v31 offset:0
    ds_read_b128 v[36:39], v31 offset:32
    ds_read_b128 v[40:43], v31 offset:64
    ds_read_b128 v[44:47], v31 offset:96
    ds_read_b128 v[48:51], v31 offset:128
    ds_read_b128 v[52:55], v31 offset:160
    ds_read_b128 v[56:59], v31 offset:192
    ds_read_b128 v[60:63], v31 offset:224
    s_waitcnt lgkmcnt(0)
    s_waitcnt vmcnt(8)
    ds_read_b128 a[192:195], v6 offset:0
    ds_read_b128 a[196:199], v7 offset:0
    ds_read_b128 a[200:203], v8 offset:0
    ds_read_b128 a[204:207], v9 offset:0
    ds_read_b128 a[208:211], v10 offset:0
    ds_read_b128 a[212:215], v11 offset:0
    ds_read_b128 a[216:219], v12 offset:0
    ds_read_b128 a[220:223], v13 offset:0
    s_waitcnt lgkmcnt(0)
    s_add_u32 m0, s56, 0
    s_add_u32 s69, s57, 262144
    buffer_load_dwordx4 v2, s[12:15], s69 offen offset:0 nt lds
    buffer_load_dwordx4 v3, s[12:15], s69 offen offset:1024 nt lds
    buffer_load_dwordx4 v4, s[12:15], s69 offen offset:2048 nt lds
    buffer_load_dwordx4 v5, s[12:15], s69 offen offset:3072 nt lds
    s_add_u32 m0, s56, 4096
    s_add_u32 s69, s69, 4096
    buffer_load_dwordx4 v2, s[12:15], s69 offen offset:0 nt lds
    buffer_load_dwordx4 v3, s[12:15], s69 offen offset:1024 nt lds
    buffer_load_dwordx4 v4, s[12:15], s69 offen offset:2048 nt lds
    buffer_load_dwordx4 v5, s[12:15], s69 offen offset:3072 nt lds
    s_waitcnt vmcnt(8)
    ds_read_b128 a[224:227], v6 offset:8192
    ds_read_b128 a[228:231], v7 offset:8192
    ds_read_b128 a[232:235], v8 offset:8192
    ds_read_b128 a[236:239], v9 offset:8192
    ds_read_b128 a[240:243], v10 offset:8192
    ds_read_b128 a[244:247], v11 offset:8192
    ds_read_b128 a[248:251], v12 offset:8192
    ds_read_b128 a[252:255], v13 offset:8192
    s_waitcnt lgkmcnt(0)
    s_add_u32 m0, s56, 8192
    s_add_u32 s69, s57, 393216
    buffer_load_dwordx4 v2, s[12:15], s69 offen offset:0 nt lds
    buffer_load_dwordx4 v3, s[12:15], s69 offen offset:1024 nt lds
    buffer_load_dwordx4 v4, s[12:15], s69 offen offset:2048 nt lds
    buffer_load_dwordx4 v5, s[12:15], s69 offen offset:3072 nt lds
    s_add_u32 m0, s56, 12288
    s_add_u32 s69, s69, 4096
    buffer_load_dwordx4 v2, s[12:15], s69 offen offset:0 nt lds
    buffer_load_dwordx4 v3, s[12:15], s69 offen offset:1024 nt lds
    buffer_load_dwordx4 v4, s[12:15], s69 offen offset:2048 nt lds
    buffer_load_dwordx4 v5, s[12:15], s69 offen offset:3072 nt lds
    s_waitcnt vmcnt(8)
    ds_read_b128 v[160:163], v6 offset:0
    ds_read_b128 v[164:167], v7 offset:0
    ds_read_b128 v[168:171], v8 offset:0
    ds_read_b128 v[172:175], v9 offset:0
    ds_read_b128 v[176:179], v10 offset:0
    ds_read_b128 v[180:183], v11 offset:0
    ds_read_b128 v[184:187], v12 offset:0
    ds_read_b128 v[188:191], v13 offset:0
    s_waitcnt lgkmcnt(0)
    s_add_u32 m0, s56, 0
    s_add_u32 s69, s57, 524288
    buffer_load_dwordx4 v2, s[12:15], s69 offen offset:0 nt lds
    buffer_load_dwordx4 v3, s[12:15], s69 offen offset:1024 nt lds
    buffer_load_dwordx4 v4, s[12:15], s69 offen offset:2048 nt lds
    buffer_load_dwordx4 v5, s[12:15], s69 offen offset:3072 nt lds
    s_add_u32 m0, s56, 4096
    s_add_u32 s69, s69, 4096
    buffer_load_dwordx4 v2, s[12:15], s69 offen offset:0 nt lds
    buffer_load_dwordx4 v3, s[12:15], s69 offen offset:1024 nt lds
    buffer_load_dwordx4 v4, s[12:15], s69 offen offset:2048 nt lds
    buffer_load_dwordx4 v5, s[12:15], s69 offen offset:3072 nt lds
    s_waitcnt vmcnt(8)
    ds_read_b128 v[192:195], v6 offset:8192
    ds_read_b128 v[196:199], v7 offset:8192
    ds_read_b128 v[200:203], v8 offset:8192
    ds_read_b128 v[204:207], v9 offset:8192
    ds_read_b128 v[208:211], v10 offset:8192
    ds_read_b128 v[212:215], v11 offset:8192
    ds_read_b128 v[216:219], v12 offset:8192
    ds_read_b128 v[220:223], v13 offset:8192
    s_waitcnt lgkmcnt(0)
    s_add_u32 m0, s56, 8192
    s_add_u32 s69, s57, 786432
    buffer_load_dwordx4 v2, s[4:7], s69 offen offset:0 nt lds
    buffer_load_dwordx4 v3, s[4:7], s69 offen offset:1024 nt lds
    buffer_load_dwordx4 v4, s[4:7], s69 offen offset:2048 nt lds
    buffer_load_dwordx4 v5, s[4:7], s69 offen offset:3072 nt lds
    s_add_u32 m0, s56, 12288
    s_add_u32 s69, s69, 4096
    buffer_load_dwordx4 v2, s[4:7], s69 offen offset:0 nt lds
    buffer_load_dwordx4 v3, s[4:7], s69 offen offset:1024 nt lds
    buffer_load_dwordx4 v4, s[4:7], s69 offen offset:2048 nt lds
    buffer_load_dwordx4 v5, s[4:7], s69 offen offset:3072 nt lds
    s_waitcnt vmcnt(8)
    ds_read_b128 v[224:227], v6 offset:0
    ds_read_b128 v[228:231], v7 offset:0
    ds_read_b128 v[232:235], v8 offset:0
    ds_read_b128 v[236:239], v9 offset:0
    ds_read_b128 v[240:243], v10 offset:0
    ds_read_b128 v[244:247], v11 offset:0
    ds_read_b128 v[248:251], v12 offset:0
    ds_read_b128 v[252:255], v13 offset:0
    s_waitcnt lgkmcnt(0)
    s_add_u32 m0, s56, 0
    s_add_u32 s69, s57, 917504
    buffer_load_dwordx4 v2, s[4:7], s69 offen offset:0 nt lds
    buffer_load_dwordx4 v3, s[4:7], s69 offen offset:1024 nt lds
    buffer_load_dwordx4 v4, s[4:7], s69 offen offset:2048 nt lds
    buffer_load_dwordx4 v5, s[4:7], s69 offen offset:3072 nt lds
    s_add_u32 m0, s56, 4096
    s_add_u32 s69, s69, 4096
    buffer_load_dwordx4 v2, s[4:7], s69 offen offset:0 nt lds
    buffer_load_dwordx4 v3, s[4:7], s69 offen offset:1024 nt lds
    buffer_load_dwordx4 v4, s[4:7], s69 offen offset:2048 nt lds
    buffer_load_dwordx4 v5, s[4:7], s69 offen offset:3072 nt lds
    s_cmp_eq_u32 s54, 0
    s_cbranch_scc1 Lwskip_6
    v_lshrrev_b32 v30, 1, v1
    v_mul_u32_u24 v30, 896, v30
    v_and_b32 v31, 1, v1
    v_lshl_add_u32 v30, v31, 4, v30
    s_mul_i32 s72, s82, 8192
    s_add_u32 s72, s72, 65536
    s_add_u32 m0, s72, 0
    s_add_u32 s69, s58, 0
    buffer_load_dwordx4 v30, s[24:27], s69 offen nt lds
    s_add_u32 m0, s72, 1024
    s_add_u32 s69, s58, 28672
    buffer_load_dwordx4 v30, s[24:27], s69 offen nt lds
    s_add_u32 m0, s72, 2048
    s_add_u32 s69, s58, 57344
    buffer_load_dwordx4 v30, s[24:27], s69 offen nt lds
    s_add_u32 m0, s72, 3072
    s_add_u32 s69, s58, 86016
    buffer_load_dwordx4 v30, s[24:27], s69 offen nt lds
    s_add_u32 m0, s72, 4096
    s_add_u32 s69, s58, 114688
    buffer_load_dwordx4 v30, s[24:27], s69 offen nt lds
    s_add_u32 m0, s72, 5120
    s_add_u32 s69, s58, 143360
    buffer_load_dwordx4 v30, s[24:27], s69 offen nt lds
    s_add_u32 m0, s72, 6144
    s_add_u32 s69, s58, 172032
    buffer_load_dwordx4 v30, s[24:27], s69 offen nt lds
    s_add_u32 m0, s72, 7168
    s_add_u32 s69, s58, 200704
    buffer_load_dwordx4 v30, s[24:27], s69 offen nt lds
    s_mul_i32 s72, s82, 8192
    s_add_u32 s72, s72, 81920
    s_add_u32 m0, s72, 0
    s_add_u32 s69, s58, 0
    buffer_load_dwordx4 v30, s[32:35], s69 offen nt lds
    s_add_u32 m0, s72, 1024
    s_add_u32 s69, s58, 28672
    buffer_load_dwordx4 v30, s[32:35], s69 offen nt lds
    s_add_u32 m0, s72, 2048
    s_add_u32 s69, s58, 57344
    buffer_load_dwordx4 v30, s[32:35], s69 offen nt lds
    s_add_u32 m0, s72, 3072
    s_add_u32 s69, s58, 86016
    buffer_load_dwordx4 v30, s[32:35], s69 offen nt lds
    s_add_u32 m0, s72, 4096
    s_add_u32 s69, s58, 114688
    buffer_load_dwordx4 v30, s[32:35], s69 offen nt lds
    s_add_u32 m0, s72, 5120
    s_add_u32 s69, s58, 143360
    buffer_load_dwordx4 v30, s[32:35], s69 offen nt lds
    s_add_u32 m0, s72, 6144
    s_add_u32 s69, s58, 172032
    buffer_load_dwordx4 v30, s[32:35], s69 offen nt lds
    s_add_u32 m0, s72, 7168
    s_add_u32 s69, s58, 200704
    buffer_load_dwordx4 v30, s[32:35], s69 offen nt lds
    v_lshrrev_b32 v30, 1, v1
    v_lshlrev_b32 v30, 13, v30
    v_and_b32 v31, 1, v1
    v_lshl_add_u32 v30, v31, 4, v30
    s_mul_i32 s72, s82, 7168
    s_add_u32 s72, s72, 112640
    s_add_u32 m0, s72, 0
    s_add_u32 s69, s59, 0
    buffer_load_dwordx4 v30, s[28:31], s69 offen nt lds
    s_add_u32 m0, s72, 1024
    s_add_u32 s69, s59, 262144
    buffer_load_dwordx4 v30, s[28:31], s69 offen nt lds
    s_add_u32 m0, s72, 2048
    s_add_u32 s69, s59, 524288
    buffer_load_dwordx4 v30, s[28:31], s69 offen nt lds
    s_add_u32 m0, s72, 3072
    s_add_u32 s69, s59, 786432
    buffer_load_dwordx4 v30, s[28:31], s69 offen nt lds
    s_add_u32 m0, s72, 4096
    s_add_u32 s69, s59, 1048576
    buffer_load_dwordx4 v30, s[28:31], s69 offen nt lds
    s_add_u32 m0, s72, 5120
    s_add_u32 s69, s59, 1310720
    buffer_load_dwordx4 v30, s[28:31], s69 offen nt lds
    s_add_u32 m0, s72, 6144
    s_add_u32 s69, s59, 1572864
    buffer_load_dwordx4 v30, s[28:31], s69 offen nt lds
    s_waitcnt vmcnt(0)
    s_lshl_b32 s69, s82, 2
    s_add_u32 s69, s69, 135256
    v_mov_b32 v30, s69
    v_mov_b32 v31, 1
    ds_write_b32 v30, v31
Lwskip_6:
    v_mov_b32 v30, 135248
Lstg_7:
    ds_read_b32 v31, v30
    s_waitcnt lgkmcnt(0)
    v_cmp_gt_u32 vcc, s54, v31
    s_cbranch_vccz Lstgd_8
    s_cmp_eq_u32 s83, 0
    s_cbranch_scc1 Lstgd_8
    s_sub_u32 s83, s83, 1
    s_sleep 2
    s_branch Lstg_7
Lstgd_8:
    v_mfma_f32_16x16x32_bf16 v[64:67], a[0:3], v[32:35], 0
    v_mfma_f32_16x16x32_bf16 v[64:67], a[4:7], v[36:39], v[64:67]
    v_mfma_f32_16x16x32_bf16 v[64:67], a[8:11], v[40:43], v[64:67]
    v_mfma_f32_16x16x32_bf16 v[64:67], a[12:15], v[44:47], v[64:67]
    v_mfma_f32_16x16x32_bf16 v[64:67], a[16:19], v[48:51], v[64:67]
    v_mfma_f32_16x16x32_bf16 v[64:67], a[20:23], v[52:55], v[64:67]
    v_mfma_f32_16x16x32_bf16 v[64:67], a[24:27], v[56:59], v[64:67]
    v_mfma_f32_16x16x32_bf16 v[64:67], a[28:31], v[60:63], v[64:67]
    v_mfma_f32_16x16x32_bf16 v[68:71], a[32:35], v[32:35], 0
    v_mfma_f32_16x16x32_bf16 v[68:71], a[36:39], v[36:39], v[68:71]
    v_mfma_f32_16x16x32_bf16 v[68:71], a[40:43], v[40:43], v[68:71]
    v_mfma_f32_16x16x32_bf16 v[68:71], a[44:47], v[44:47], v[68:71]
    v_mfma_f32_16x16x32_bf16 v[68:71], a[48:51], v[48:51], v[68:71]
    v_mfma_f32_16x16x32_bf16 v[68:71], a[52:55], v[52:55], v[68:71]
    v_mfma_f32_16x16x32_bf16 v[68:71], a[56:59], v[56:59], v[68:71]
    v_mfma_f32_16x16x32_bf16 v[68:71], a[60:63], v[60:63], v[68:71]
    v_mfma_f32_16x16x32_bf16 v[72:75], a[64:67], v[32:35], 0
    v_mfma_f32_16x16x32_bf16 v[72:75], a[68:71], v[36:39], v[72:75]
    v_mfma_f32_16x16x32_bf16 v[72:75], a[72:75], v[40:43], v[72:75]
    v_mfma_f32_16x16x32_bf16 v[72:75], a[76:79], v[44:47], v[72:75]
    v_mfma_f32_16x16x32_bf16 v[72:75], a[80:83], v[48:51], v[72:75]
    v_mfma_f32_16x16x32_bf16 v[72:75], a[84:87], v[52:55], v[72:75]
    v_mfma_f32_16x16x32_bf16 v[72:75], a[88:91], v[56:59], v[72:75]
    v_mfma_f32_16x16x32_bf16 v[72:75], a[92:95], v[60:63], v[72:75]
    v_mfma_f32_16x16x32_bf16 v[76:79], a[96:99], v[32:35], 0
    v_mfma_f32_16x16x32_bf16 v[76:79], a[100:103], v[36:39], v[76:79]
    v_mfma_f32_16x16x32_bf16 v[76:79], a[104:107], v[40:43], v[76:79]
    v_mfma_f32_16x16x32_bf16 v[76:79], a[108:111], v[44:47], v[76:79]
    v_mfma_f32_16x16x32_bf16 v[76:79], a[112:115], v[48:51], v[76:79]
    v_mfma_f32_16x16x32_bf16 v[76:79], a[116:119], v[52:55], v[76:79]
    v_mfma_f32_16x16x32_bf16 v[76:79], a[120:123], v[56:59], v[76:79]
    v_mfma_f32_16x16x32_bf16 v[76:79], a[124:127], v[60:63], v[76:79]
    v_mfma_f32_16x16x32_bf16 v[80:83], a[128:131], v[32:35], 0
    v_mfma_f32_16x16x32_bf16 v[80:83], a[132:135], v[36:39], v[80:83]
    v_mfma_f32_16x16x32_bf16 v[80:83], a[136:139], v[40:43], v[80:83]
    v_mfma_f32_16x16x32_bf16 v[80:83], a[140:143], v[44:47], v[80:83]
    v_mfma_f32_16x16x32_bf16 v[80:83], a[144:147], v[48:51], v[80:83]
    v_mfma_f32_16x16x32_bf16 v[80:83], a[148:151], v[52:55], v[80:83]
    v_mfma_f32_16x16x32_bf16 v[80:83], a[152:155], v[56:59], v[80:83]
    v_mfma_f32_16x16x32_bf16 v[80:83], a[156:159], v[60:63], v[80:83]
    v_mfma_f32_16x16x32_bf16 v[84:87], a[160:163], v[32:35], 0
    v_mfma_f32_16x16x32_bf16 v[84:87], a[164:167], v[36:39], v[84:87]
    v_mfma_f32_16x16x32_bf16 v[84:87], a[168:171], v[40:43], v[84:87]
    v_mfma_f32_16x16x32_bf16 v[84:87], a[172:175], v[44:47], v[84:87]
    v_mfma_f32_16x16x32_bf16 v[84:87], a[176:179], v[48:51], v[84:87]
    v_mfma_f32_16x16x32_bf16 v[84:87], a[180:183], v[52:55], v[84:87]
    v_mfma_f32_16x16x32_bf16 v[84:87], a[184:187], v[56:59], v[84:87]
    v_mfma_f32_16x16x32_bf16 v[84:87], a[188:191], v[60:63], v[84:87]
    s_waitcnt vmcnt(8)
    ds_read_b128 a[0:3], v6 offset:8192
    ds_read_b128 a[4:7], v7 offset:8192
    ds_read_b128 a[8:11], v8 offset:8192
    ds_read_b128 a[12:15], v9 offset:8192
    ds_read_b128 a[16:19], v10 offset:8192
    ds_read_b128 a[20:23], v11 offset:8192
    ds_read_b128 a[24:27], v12 offset:8192
    ds_read_b128 a[28:31], v13 offset:8192
    s_waitcnt lgkmcnt(7)
    v_mfma_f32_16x16x32_bf16 v[88:91], a[0:3], v[32:35], 0
    s_waitcnt lgkmcnt(6)
    v_mfma_f32_16x16x32_bf16 v[88:91], a[4:7], v[36:39], v[88:91]
    s_waitcnt lgkmcnt(5)
    v_mfma_f32_16x16x32_bf16 v[88:91], a[8:11], v[40:43], v[88:91]
    s_waitcnt lgkmcnt(4)
    v_mfma_f32_16x16x32_bf16 v[88:91], a[12:15], v[44:47], v[88:91]
    s_waitcnt lgkmcnt(3)
    v_mfma_f32_16x16x32_bf16 v[88:91], a[16:19], v[48:51], v[88:91]
    s_waitcnt lgkmcnt(2)
    v_mfma_f32_16x16x32_bf16 v[88:91], a[20:23], v[52:55], v[88:91]
    s_waitcnt lgkmcnt(1)
    v_mfma_f32_16x16x32_bf16 v[88:91], a[24:27], v[56:59], v[88:91]
    s_waitcnt lgkmcnt(0)
    v_mfma_f32_16x16x32_bf16 v[88:91], a[28:31], v[60:63], v[88:91]
    s_add_u32 m0, s56, 8192
    s_add_u32 s69, s57, 1048576
    buffer_load_dwordx4 v2, s[4:7], s69 offen offset:0 nt lds
    buffer_load_dwordx4 v3, s[4:7], s69 offen offset:1024 nt lds
    buffer_load_dwordx4 v4, s[4:7], s69 offen offset:2048 nt lds
    buffer_load_dwordx4 v5, s[4:7], s69 offen offset:3072 nt lds
    s_add_u32 m0, s56, 12288
    s_add_u32 s69, s69, 4096
    buffer_load_dwordx4 v2, s[4:7], s69 offen offset:0 nt lds
    buffer_load_dwordx4 v3, s[4:7], s69 offen offset:1024 nt lds
    buffer_load_dwordx4 v4, s[4:7], s69 offen offset:2048 nt lds
    buffer_load_dwordx4 v5, s[4:7], s69 offen offset:3072 nt lds
    s_waitcnt vmcnt(8)
    ds_read_b128 a[32:35], v6 offset:0
    ds_read_b128 a[36:39], v7 offset:0
    ds_read_b128 a[40:43], v8 offset:0
    ds_read_b128 a[44:47], v9 offset:0
    ds_read_b128 a[48:51], v10 offset:0
    ds_read_b128 a[52:55], v11 offset:0
    ds_read_b128 a[56:59], v12 offset:0
    ds_read_b128 a[60:63], v13 offset:0
    s_waitcnt lgkmcnt(7)
    v_mfma_f32_16x16x32_bf16 v[92:95], a[32:35], v[32:35], 0
    s_waitcnt lgkmcnt(6)
    v_mfma_f32_16x16x32_bf16 v[92:95], a[36:39], v[36:39], v[92:95]
    s_waitcnt lgkmcnt(5)
    v_mfma_f32_16x16x32_bf16 v[92:95], a[40:43], v[40:43], v[92:95]
    s_waitcnt lgkmcnt(4)
    v_mfma_f32_16x16x32_bf16 v[92:95], a[44:47], v[44:47], v[92:95]
    s_waitcnt lgkmcnt(3)
    v_mfma_f32_16x16x32_bf16 v[92:95], a[48:51], v[48:51], v[92:95]
    s_waitcnt lgkmcnt(2)
    v_mfma_f32_16x16x32_bf16 v[92:95], a[52:55], v[52:55], v[92:95]
    s_waitcnt lgkmcnt(1)
    v_mfma_f32_16x16x32_bf16 v[92:95], a[56:59], v[56:59], v[92:95]
    s_waitcnt lgkmcnt(0)
    v_mfma_f32_16x16x32_bf16 v[92:95], a[60:63], v[60:63], v[92:95]
    s_add_u32 m0, s56, 0
    s_add_u32 s69, s57, 1179648
    buffer_load_dwordx4 v2, s[4:7], s69 offen offset:0 nt lds
    buffer_load_dwordx4 v3, s[4:7], s69 offen offset:1024 nt lds
    buffer_load_dwordx4 v4, s[4:7], s69 offen offset:2048 nt lds
    buffer_load_dwordx4 v5, s[4:7], s69 offen offset:3072 nt lds
    s_add_u32 m0, s56, 4096
    s_add_u32 s69, s69, 4096
    buffer_load_dwordx4 v2, s[4:7], s69 offen offset:0 nt lds
    buffer_load_dwordx4 v3, s[4:7], s69 offen offset:1024 nt lds
    buffer_load_dwordx4 v4, s[4:7], s69 offen offset:2048 nt lds
    buffer_load_dwordx4 v5, s[4:7], s69 offen offset:3072 nt lds
    s_waitcnt vmcnt(8)
    ds_read_b128 a[64:67], v6 offset:8192
    ds_read_b128 a[68:71], v7 offset:8192
    ds_read_b128 a[72:75], v8 offset:8192
    ds_read_b128 a[76:79], v9 offset:8192
    ds_read_b128 a[80:83], v10 offset:8192
    ds_read_b128 a[84:87], v11 offset:8192
    ds_read_b128 a[88:91], v12 offset:8192
    ds_read_b128 a[92:95], v13 offset:8192
    s_waitcnt lgkmcnt(7)
    v_mfma_f32_16x16x32_bf16 v[96:99], a[64:67], v[32:35], 0
    s_waitcnt lgkmcnt(6)
    v_mfma_f32_16x16x32_bf16 v[96:99], a[68:71], v[36:39], v[96:99]
    s_waitcnt lgkmcnt(5)
    v_mfma_f32_16x16x32_bf16 v[96:99], a[72:75], v[40:43], v[96:99]
    s_waitcnt lgkmcnt(4)
    v_mfma_f32_16x16x32_bf16 v[96:99], a[76:79], v[44:47], v[96:99]
    s_waitcnt lgkmcnt(3)
    v_mfma_f32_16x16x32_bf16 v[96:99], a[80:83], v[48:51], v[96:99]
    s_waitcnt lgkmcnt(2)
    v_mfma_f32_16x16x32_bf16 v[96:99], a[84:87], v[52:55], v[96:99]
    s_waitcnt lgkmcnt(1)
    v_mfma_f32_16x16x32_bf16 v[96:99], a[88:91], v[56:59], v[96:99]
    s_waitcnt lgkmcnt(0)
    v_mfma_f32_16x16x32_bf16 v[96:99], a[92:95], v[60:63], v[96:99]
    s_add_u32 m0, s56, 8192
    s_add_u32 s69, s57, 1310720
    buffer_load_dwordx4 v2, s[4:7], s69 offen offset:0 nt lds
    buffer_load_dwordx4 v3, s[4:7], s69 offen offset:1024 nt lds
    buffer_load_dwordx4 v4, s[4:7], s69 offen offset:2048 nt lds
    buffer_load_dwordx4 v5, s[4:7], s69 offen offset:3072 nt lds
    s_add_u32 m0, s56, 12288
    s_add_u32 s69, s69, 4096
    buffer_load_dwordx4 v2, s[4:7], s69 offen offset:0 nt lds
    buffer_load_dwordx4 v3, s[4:7], s69 offen offset:1024 nt lds
    buffer_load_dwordx4 v4, s[4:7], s69 offen offset:2048 nt lds
    buffer_load_dwordx4 v5, s[4:7], s69 offen offset:3072 nt lds
    s_waitcnt vmcnt(8)
    ds_read_b128 a[96:99], v6 offset:0
    ds_read_b128 a[100:103], v7 offset:0
    ds_read_b128 a[104:107], v8 offset:0
    ds_read_b128 a[108:111], v9 offset:0
    ds_read_b128 a[112:115], v10 offset:0
    ds_read_b128 a[116:119], v11 offset:0
    ds_read_b128 a[120:123], v12 offset:0
    ds_read_b128 a[124:127], v13 offset:0
    s_waitcnt lgkmcnt(7)
    v_mfma_f32_16x16x32_bf16 v[100:103], a[96:99], v[32:35], 0
    s_waitcnt lgkmcnt(6)
    v_mfma_f32_16x16x32_bf16 v[100:103], a[100:103], v[36:39], v[100:103]
    s_waitcnt lgkmcnt(5)
    v_mfma_f32_16x16x32_bf16 v[100:103], a[104:107], v[40:43], v[100:103]
    s_waitcnt lgkmcnt(4)
    v_mfma_f32_16x16x32_bf16 v[100:103], a[108:111], v[44:47], v[100:103]
    s_waitcnt lgkmcnt(3)
    v_mfma_f32_16x16x32_bf16 v[100:103], a[112:115], v[48:51], v[100:103]
    s_waitcnt lgkmcnt(2)
    v_mfma_f32_16x16x32_bf16 v[100:103], a[116:119], v[52:55], v[100:103]
    s_waitcnt lgkmcnt(1)
    v_mfma_f32_16x16x32_bf16 v[100:103], a[120:123], v[56:59], v[100:103]
    s_waitcnt lgkmcnt(0)
    v_mfma_f32_16x16x32_bf16 v[100:103], a[124:127], v[60:63], v[100:103]
    s_add_u32 m0, s56, 0
    s_add_u32 s69, s57, 1441792
    buffer_load_dwordx4 v2, s[4:7], s69 offen offset:0 nt lds
    buffer_load_dwordx4 v3, s[4:7], s69 offen offset:1024 nt lds
    buffer_load_dwordx4 v4, s[4:7], s69 offen offset:2048 nt lds
    buffer_load_dwordx4 v5, s[4:7], s69 offen offset:3072 nt lds
    s_add_u32 m0, s56, 4096
    s_add_u32 s69, s69, 4096
    buffer_load_dwordx4 v2, s[4:7], s69 offen offset:0 nt lds
    buffer_load_dwordx4 v3, s[4:7], s69 offen offset:1024 nt lds
    buffer_load_dwordx4 v4, s[4:7], s69 offen offset:2048 nt lds
    buffer_load_dwordx4 v5, s[4:7], s69 offen offset:3072 nt lds
    s_waitcnt vmcnt(8)
    ds_read_b128 a[128:131], v6 offset:8192
    ds_read_b128 a[132:135], v7 offset:8192
    ds_read_b128 a[136:139], v8 offset:8192
    ds_read_b128 a[140:143], v9 offset:8192
    ds_read_b128 a[144:147], v10 offset:8192
    ds_read_b128 a[148:151], v11 offset:8192
    ds_read_b128 a[152:155], v12 offset:8192
    ds_read_b128 a[156:159], v13 offset:8192
    s_waitcnt lgkmcnt(7)
    v_mfma_f32_16x16x32_bf16 v[104:107], a[128:131], v[32:35], 0
    s_waitcnt lgkmcnt(6)
    v_mfma_f32_16x16x32_bf16 v[104:107], a[132:135], v[36:39], v[104:107]
    s_waitcnt lgkmcnt(5)
    v_mfma_f32_16x16x32_bf16 v[104:107], a[136:139], v[40:43], v[104:107]
    s_waitcnt lgkmcnt(4)
    v_mfma_f32_16x16x32_bf16 v[104:107], a[140:143], v[44:47], v[104:107]
    s_waitcnt lgkmcnt(3)
    v_mfma_f32_16x16x32_bf16 v[104:107], a[144:147], v[48:51], v[104:107]
    s_waitcnt lgkmcnt(2)
    v_mfma_f32_16x16x32_bf16 v[104:107], a[148:151], v[52:55], v[104:107]
    s_waitcnt lgkmcnt(1)
    v_mfma_f32_16x16x32_bf16 v[104:107], a[152:155], v[56:59], v[104:107]
    s_waitcnt lgkmcnt(0)
    v_mfma_f32_16x16x32_bf16 v[104:107], a[156:159], v[60:63], v[104:107]
    s_add_u32 m0, s56, 8192
    s_add_u32 s69, s57, 1572864
    buffer_load_dwordx4 v2, s[4:7], s69 offen offset:0 nt lds
    buffer_load_dwordx4 v3, s[4:7], s69 offen offset:1024 nt lds
    buffer_load_dwordx4 v4, s[4:7], s69 offen offset:2048 nt lds
    buffer_load_dwordx4 v5, s[4:7], s69 offen offset:3072 nt lds
    s_add_u32 m0, s56, 12288
    s_add_u32 s69, s69, 4096
    buffer_load_dwordx4 v2, s[4:7], s69 offen offset:0 nt lds
    buffer_load_dwordx4 v3, s[4:7], s69 offen offset:1024 nt lds
    buffer_load_dwordx4 v4, s[4:7], s69 offen offset:2048 nt lds
    buffer_load_dwordx4 v5, s[4:7], s69 offen offset:3072 nt lds
    s_waitcnt vmcnt(8)
    ds_read_b128 a[160:163], v6 offset:0
    ds_read_b128 a[164:167], v7 offset:0
    ds_read_b128 a[168:171], v8 offset:0
    ds_read_b128 a[172:175], v9 offset:0
    ds_read_b128 a[176:179], v10 offset:0
    ds_read_b128 a[180:183], v11 offset:0
    ds_read_b128 a[184:187], v12 offset:0
    ds_read_b128 a[188:191], v13 offset:0
    s_waitcnt lgkmcnt(7)
    v_mfma_f32_16x16x32_bf16 v[108:111], a[160:163], v[32:35], 0
    s_waitcnt lgkmcnt(6)
    v_mfma_f32_16x16x32_bf16 v[108:111], a[164:167], v[36:39], v[108:111]
    s_waitcnt lgkmcnt(5)
    v_mfma_f32_16x16x32_bf16 v[108:111], a[168:171], v[40:43], v[108:111]
    s_waitcnt lgkmcnt(4)
    v_mfma_f32_16x16x32_bf16 v[108:111], a[172:175], v[44:47], v[108:111]
    s_waitcnt lgkmcnt(3)
    v_mfma_f32_16x16x32_bf16 v[108:111], a[176:179], v[48:51], v[108:111]
    s_waitcnt lgkmcnt(2)
    v_mfma_f32_16x16x32_bf16 v[108:111], a[180:183], v[52:55], v[108:111]
    s_waitcnt lgkmcnt(1)
    v_mfma_f32_16x16x32_bf16 v[108:111], a[184:187], v[56:59], v[108:111]
    s_waitcnt lgkmcnt(0)
    v_mfma_f32_16x16x32_bf16 v[108:111], a[188:191], v[60:63], v[108:111]
    s_add_u32 m0, s56, 0
    s_add_u32 s69, s57, 1703936
    buffer_load_dwordx4 v2, s[4:7], s69 offen offset:0 nt lds
    buffer_load_dwordx4 v3, s[4:7], s69 offen offset:1024 nt lds
    buffer_load_dwordx4 v4, s[4:7], s69 offen offset:2048 nt lds
    buffer_load_dwordx4 v5, s[4:7], s69 offen offset:3072 nt lds
    s_add_u32 m0, s56, 4096
    s_add_u32 s69, s69, 4096
    buffer_load_dwordx4 v2, s[4:7], s69 offen offset:0 nt lds
    buffer_load_dwordx4 v3, s[4:7], s69 offen offset:1024 nt lds
    buffer_load_dwordx4 v4, s[4:7], s69 offen offset:2048 nt lds
    buffer_load_dwordx4 v5, s[4:7], s69 offen offset:3072 nt lds
    s_waitcnt vmcnt(8)
    ds_read_b128 v[14:17], v6 offset:8192
    ds_read_b128 v[18:21], v7 offset:8192
    ds_read_b128 v[22:25], v8 offset:8192
    ds_read_b128 v[26:29], v9 offset:8192
    s_waitcnt lgkmcnt(3)
    v_mfma_f32_16x16x32_bf16 v[112:115], v[14:17], v[32:35], 0
    s_waitcnt lgkmcnt(2)
    v_mfma_f32_16x16x32_bf16 v[112:115], v[18:21], v[36:39], v[112:115]
    ds_read_b128 v[14:17], v10 offset:8192
    s_waitcnt lgkmcnt(2)
    v_mfma_f32_16x16x32_bf16 v[112:115], v[22:25], v[40:43], v[112:115]
    ds_read_b128 v[18:21], v11 offset:8192
    s_waitcnt lgkmcnt(2)
    v_mfma_f32_16x16x32_bf16 v[112:115], v[26:29], v[44:47], v[112:115]
    ds_read_b128 v[22:25], v12 offset:8192
    s_waitcnt lgkmcnt(2)
    v_mfma_f32_16x16x32_bf16 v[112:115], v[14:17], v[48:51], v[112:115]
    ds_read_b128 v[26:29], v13 offset:8192
    s_waitcnt lgkmcnt(2)
    v_mfma_f32_16x16x32_bf16 v[112:115], v[18:21], v[52:55], v[112:115]
    s_waitcnt lgkmcnt(1)
    v_mfma_f32_16x16x32_bf16 v[112:115], v[22:25], v[56:59], v[112:115]
    s_waitcnt lgkmcnt(0)
    v_mfma_f32_16x16x32_bf16 v[112:115], v[26:29], v[60:63], v[112:115]
    s_add_u32 m0, s56, 8192
    s_add_u32 s69, s57, 1835008
    buffer_load_dwordx4 v2, s[4:7], s69 offen offset:0 nt lds
    buffer_load_dwordx4 v3, s[4:7], s69 offen offset:1024 nt lds
    buffer_load_dwordx4 v4, s[4:7], s69 offen offset:2048 nt lds
    buffer_load_dwordx4 v5, s[4:7], s69 offen offset:3072 nt lds
    s_add_u32 m0, s56, 12288
    s_add_u32 s69, s69, 4096
    buffer_load_dwordx4 v2, s[4:7], s69 offen offset:0 nt lds
    buffer_load_dwordx4 v3, s[4:7], s69 offen offset:1024 nt lds
    buffer_load_dwordx4 v4, s[4:7], s69 offen offset:2048 nt lds
    buffer_load_dwordx4 v5, s[4:7], s69 offen offset:3072 nt lds
    s_waitcnt vmcnt(8)
    ds_read_b128 v[14:17], v6 offset:0
    ds_read_b128 v[18:21], v7 offset:0
    ds_read_b128 v[22:25], v8 offset:0
    ds_read_b128 v[26:29], v9 offset:0
    s_waitcnt lgkmcnt(3)
    v_mfma_f32_16x16x32_bf16 v[116:119], v[14:17], v[32:35], 0
    s_waitcnt lgkmcnt(2)
    v_mfma_f32_16x16x32_bf16 v[116:119], v[18:21], v[36:39], v[116:119]
    ds_read_b128 v[14:17], v10 offset:0
    s_waitcnt lgkmcnt(2)
    v_mfma_f32_16x16x32_bf16 v[116:119], v[22:25], v[40:43], v[116:119]
    ds_read_b128 v[18:21], v11 offset:0
    s_waitcnt lgkmcnt(2)
    v_mfma_f32_16x16x32_bf16 v[116:119], v[26:29], v[44:47], v[116:119]
    ds_read_b128 v[22:25], v12 offset:0
    s_waitcnt lgkmcnt(2)
    v_mfma_f32_16x16x32_bf16 v[116:119], v[14:17], v[48:51], v[116:119]
    ds_read_b128 v[26:29], v13 offset:0
    s_waitcnt lgkmcnt(2)
    v_mfma_f32_16x16x32_bf16 v[116:119], v[18:21], v[52:55], v[116:119]
    s_waitcnt lgkmcnt(1)
    v_mfma_f32_16x16x32_bf16 v[116:119], v[22:25], v[56:59], v[116:119]
    s_waitcnt lgkmcnt(0)
    v_mfma_f32_16x16x32_bf16 v[116:119], v[26:29], v[60:63], v[116:119]
    s_add_u32 m0, s56, 0
    s_add_u32 s69, s57, 1966080
    buffer_load_dwordx4 v2, s[4:7], s69 offen offset:0 nt lds
    buffer_load_dwordx4 v3, s[4:7], s69 offen offset:1024 nt lds
    buffer_load_dwordx4 v4, s[4:7], s69 offen offset:2048 nt lds
    buffer_load_dwordx4 v5, s[4:7], s69 offen offset:3072 nt lds
    s_add_u32 m0, s56, 4096
    s_add_u32 s69, s69, 4096
    buffer_load_dwordx4 v2, s[4:7], s69 offen offset:0 nt lds
    buffer_load_dwordx4 v3, s[4:7], s69 offen offset:1024 nt lds
    buffer_load_dwordx4 v4, s[4:7], s69 offen offset:2048 nt lds
    buffer_load_dwordx4 v5, s[4:7], s69 offen offset:3072 nt lds
    s_waitcnt vmcnt(8)
    ds_read_b128 v[14:17], v6 offset:8192
    ds_read_b128 v[18:21], v7 offset:8192
    ds_read_b128 v[22:25], v8 offset:8192
    ds_read_b128 v[26:29], v9 offset:8192
    s_waitcnt lgkmcnt(3)
    v_mfma_f32_16x16x32_bf16 v[120:123], v[14:17], v[32:35], 0
    s_waitcnt lgkmcnt(2)
    v_mfma_f32_16x16x32_bf16 v[120:123], v[18:21], v[36:39], v[120:123]
    ds_read_b128 v[14:17], v10 offset:8192
    s_waitcnt lgkmcnt(2)
    v_mfma_f32_16x16x32_bf16 v[120:123], v[22:25], v[40:43], v[120:123]
    ds_read_b128 v[18:21], v11 offset:8192
    s_waitcnt lgkmcnt(2)
    v_mfma_f32_16x16x32_bf16 v[120:123], v[26:29], v[44:47], v[120:123]
    ds_read_b128 v[22:25], v12 offset:8192
    s_waitcnt lgkmcnt(2)
    v_mfma_f32_16x16x32_bf16 v[120:123], v[14:17], v[48:51], v[120:123]
    ds_read_b128 v[26:29], v13 offset:8192
    s_waitcnt lgkmcnt(2)
    v_mfma_f32_16x16x32_bf16 v[120:123], v[18:21], v[52:55], v[120:123]
    s_waitcnt lgkmcnt(1)
    v_mfma_f32_16x16x32_bf16 v[120:123], v[22:25], v[56:59], v[120:123]
    s_waitcnt lgkmcnt(0)
    v_mfma_f32_16x16x32_bf16 v[120:123], v[26:29], v[60:63], v[120:123]
    s_add_u32 m0, s56, 8192
    s_add_u32 s69, s57, 0
    buffer_load_dwordx4 v2, s[8:11], s69 offen offset:0 nt lds
    buffer_load_dwordx4 v3, s[8:11], s69 offen offset:1024 nt lds
    buffer_load_dwordx4 v4, s[8:11], s69 offen offset:2048 nt lds
    buffer_load_dwordx4 v5, s[8:11], s69 offen offset:3072 nt lds
    s_add_u32 m0, s56, 12288
    s_add_u32 s69, s69, 4096
    buffer_load_dwordx4 v2, s[8:11], s69 offen offset:0 nt lds
    buffer_load_dwordx4 v3, s[8:11], s69 offen offset:1024 nt lds
    buffer_load_dwordx4 v4, s[8:11], s69 offen offset:2048 nt lds
    buffer_load_dwordx4 v5, s[8:11], s69 offen offset:3072 nt lds
    s_waitcnt vmcnt(8)
    ds_read_b128 v[14:17], v6 offset:0
    ds_read_b128 v[18:21], v7 offset:0
    ds_read_b128 v[22:25], v8 offset:0
    ds_read_b128 v[26:29], v9 offset:0
    s_waitcnt lgkmcnt(3)
    v_mfma_f32_16x16x32_bf16 v[124:127], v[14:17], v[32:35], 0
    s_waitcnt lgkmcnt(2)
    v_mfma_f32_16x16x32_bf16 v[124:127], v[18:21], v[36:39], v[124:127]
    ds_read_b128 v[14:17], v10 offset:0
    s_waitcnt lgkmcnt(2)
    v_mfma_f32_16x16x32_bf16 v[124:127], v[22:25], v[40:43], v[124:127]
    ds_read_b128 v[18:21], v11 offset:0
    s_waitcnt lgkmcnt(2)
    v_mfma_f32_16x16x32_bf16 v[124:127], v[26:29], v[44:47], v[124:127]
    ds_read_b128 v[22:25], v12 offset:0
    s_waitcnt lgkmcnt(2)
    v_mfma_f32_16x16x32_bf16 v[124:127], v[14:17], v[48:51], v[124:127]
    ds_read_b128 v[26:29], v13 offset:0
    s_waitcnt lgkmcnt(2)
    v_mfma_f32_16x16x32_bf16 v[124:127], v[18:21], v[52:55], v[124:127]
    s_waitcnt lgkmcnt(1)
    v_mfma_f32_16x16x32_bf16 v[124:127], v[22:25], v[56:59], v[124:127]
    s_waitcnt lgkmcnt(0)
    v_mfma_f32_16x16x32_bf16 v[124:127], v[26:29], v[60:63], v[124:127]
    s_add_u32 m0, s56, 0
    s_add_u32 s69, s57, 131072
    buffer_load_dwordx4 v2, s[8:11], s69 offen offset:0 nt lds
    buffer_load_dwordx4 v3, s[8:11], s69 offen offset:1024 nt lds
    buffer_load_dwordx4 v4, s[8:11], s69 offen offset:2048 nt lds
    buffer_load_dwordx4 v5, s[8:11], s69 offen offset:3072 nt lds
    s_add_u32 m0, s56, 4096
    s_add_u32 s69, s69, 4096
    buffer_load_dwordx4 v2, s[8:11], s69 offen offset:0 nt lds
    buffer_load_dwordx4 v3, s[8:11], s69 offen offset:1024 nt lds
    buffer_load_dwordx4 v4, s[8:11], s69 offen offset:2048 nt lds
    buffer_load_dwordx4 v5, s[8:11], s69 offen offset:3072 nt lds
    s_nop 7
    v_max3_f32 v14, v64, v65, v66
    v_max3_f32 v15, v67, v68, v69
    v_max3_f32 v14, v14, v70, v71
    v_max3_f32 v15, v15, v72, v73
    v_max3_f32 v14, v14, v74, v75
    v_max3_f32 v15, v15, v76, v77
    v_max3_f32 v14, v14, v78, v79
    v_max3_f32 v15, v15, v80, v81
    v_max3_f32 v14, v14, v82, v83
    v_max3_f32 v15, v15, v84, v85
    v_max3_f32 v14, v14, v86, v87
    v_max3_f32 v15, v15, v88, v89
    v_max3_f32 v14, v14, v90, v91
    v_max3_f32 v15, v15, v92, v93
    v_max3_f32 v14, v14, v94, v95
    v_max3_f32 v15, v15, v96, v97
    v_max3_f32 v14, v14, v98, v99
    v_max3_f32 v15, v15, v100, v101
    v_max3_f32 v14, v14, v102, v103
    v_max3_f32 v15, v15, v104, v105
    v_max3_f32 v14, v14, v106, v107
    v_max3_f32 v15, v15, v108, v109
    v_max3_f32 v14, v14, v110, v111
    v_max3_f32 v15, v15, v112, v113
    v_max3_f32 v14, v14, v114, v115
    v_max3_f32 v15, v15, v116, v117
    v_max3_f32 v14, v14, v118, v119
    v_max3_f32 v15, v15, v120, v121
    v_max3_f32 v14, v14, v122, v123
    v_max3_f32 v15, v15, v124, v125
    v_max3_f32 v14, v14, v126, v127
    v_max_f32 v14, v14, v15
    v_mov_b32 v15, v14
    s_nop 1
    v_permlane32_swap_b32 v15, v14
    s_nop 1
    v_max_f32 v14, v14, v15
    v_mov_b32 v15, v14
    s_nop 1
    v_permlane16_swap_b32 v15, v14
    s_nop 1
    v_max_f32 v14, v14, v15
    v_mul_f32 v14, s68, v14
    v_mov_b32 v16, 0
    v_mov_b32 v17, 0
    v_fma_f32 v64, v64, s68, -v14
    v_fma_f32 v65, v65, s68, -v14
    v_fma_f32 v66, v66, s68, -v14
    v_fma_f32 v67, v67, s68, -v14
    v_exp_f32 v64, v64
    v_exp_f32 v65, v65
    v_exp_f32 v66, v66
    v_exp_f32 v67, v67
    v_cvt_pk_bf16_f32 v32, v64, v65
    v_add_f32 v16, v16, v64
    v_add_f32 v17, v17, v65
    v_cvt_pk_bf16_f32 v33, v66, v67
    v_add_f32 v16, v16, v66
    v_add_f32 v17, v17, v67
    v_fma_f32 v68, v68, s68, -v14
    v_fma_f32 v69, v69, s68, -v14
    v_fma_f32 v70, v70, s68, -v14
    v_fma_f32 v71, v71, s68, -v14
    v_exp_f32 v68, v68
    v_exp_f32 v69, v69
    v_exp_f32 v70, v70
    v_exp_f32 v71, v71
    v_cvt_pk_bf16_f32 v34, v68, v69
    v_add_f32 v16, v16, v68
    v_add_f32 v17, v17, v69
    v_cvt_pk_bf16_f32 v35, v70, v71
    v_add_f32 v16, v16, v70
    v_add_f32 v17, v17, v71
    v_fma_f32 v72, v72, s68, -v14
    v_fma_f32 v73, v73, s68, -v14
    v_fma_f32 v74, v74, s68, -v14
    v_fma_f32 v75, v75, s68, -v14
    v_exp_f32 v72, v72
    v_exp_f32 v73, v73
    v_exp_f32 v74, v74
    v_exp_f32 v75, v75
    v_cvt_pk_bf16_f32 v36, v72, v73
    v_add_f32 v16, v16, v72
    v_add_f32 v17, v17, v73
    v_cvt_pk_bf16_f32 v37, v74, v75
    v_add_f32 v16, v16, v74
    v_add_f32 v17, v17, v75
    v_fma_f32 v76, v76, s68, -v14
    v_fma_f32 v77, v77, s68, -v14
    v_fma_f32 v78, v78, s68, -v14
    v_fma_f32 v79, v79, s68, -v14
    v_exp_f32 v76, v76
    v_exp_f32 v77, v77
    v_exp_f32 v78, v78
    v_exp_f32 v79, v79
    v_cvt_pk_bf16_f32 v38, v76, v77
    v_add_f32 v16, v16, v76
    v_add_f32 v17, v17, v77
    v_cvt_pk_bf16_f32 v39, v78, v79
    v_add_f32 v16, v16, v78
    v_add_f32 v17, v17, v79
    v_fma_f32 v80, v80, s68, -v14
    v_fma_f32 v81, v81, s68, -v14
    v_fma_f32 v82, v82, s68, -v14
    v_fma_f32 v83, v83, s68, -v14
    v_exp_f32 v80, v80
    v_exp_f32 v81, v81
    v_exp_f32 v82, v82
    v_exp_f32 v83, v83
    v_cvt_pk_bf16_f32 v40, v80, v81
    v_add_f32 v16, v16, v80
    v_add_f32 v17, v17, v81
    v_cvt_pk_bf16_f32 v41, v82, v83
    v_add_f32 v16, v16, v82
    v_add_f32 v17, v17, v83
    v_fma_f32 v84, v84, s68, -v14
    v_fma_f32 v85, v85, s68, -v14
    v_fma_f32 v86, v86, s68, -v14
    v_fma_f32 v87, v87, s68, -v14
    v_exp_f32 v84, v84
    v_exp_f32 v85, v85
    v_exp_f32 v86, v86
    v_exp_f32 v87, v87
    v_cvt_pk_bf16_f32 v42, v84, v85
    v_add_f32 v16, v16, v84
    v_add_f32 v17, v17, v85
    v_cvt_pk_bf16_f32 v43, v86, v87
    v_add_f32 v16, v16, v86
    v_add_f32 v17, v17, v87
    v_fma_f32 v88, v88, s68, -v14
    v_fma_f32 v89, v89, s68, -v14
    v_fma_f32 v90, v90, s68, -v14
    v_fma_f32 v91, v91, s68, -v14
    v_exp_f32 v88, v88
    v_exp_f32 v89, v89
    v_exp_f32 v90, v90
    v_exp_f32 v91, v91
    v_cvt_pk_bf16_f32 v44, v88, v89
    v_add_f32 v16, v16, v88
    v_add_f32 v17, v17, v89
    v_cvt_pk_bf16_f32 v45, v90, v91
    v_add_f32 v16, v16, v90
    v_add_f32 v17, v17, v91
    v_fma_f32 v92, v92, s68, -v14
    v_fma_f32 v93, v93, s68, -v14
    v_fma_f32 v94, v94, s68, -v14
    v_fma_f32 v95, v95, s68, -v14
    v_exp_f32 v92, v92
    v_exp_f32 v93, v93
    v_exp_f32 v94, v94
    v_exp_f32 v95, v95
    v_cvt_pk_bf16_f32 v46, v92, v93
    v_add_f32 v16, v16, v92
    v_add_f32 v17, v17, v93
    v_cvt_pk_bf16_f32 v47, v94, v95
    v_add_f32 v16, v16, v94
    v_add_f32 v17, v17, v95
    v_fma_f32 v96, v96, s68, -v14
    v_fma_f32 v97, v97, s68, -v14
    v_fma_f32 v98, v98, s68, -v14
    v_fma_f32 v99, v99, s68, -v14
    v_exp_f32 v96, v96
    v_exp_f32 v97, v97
    v_exp_f32 v98, v98
    v_exp_f32 v99, v99
    v_cvt_pk_bf16_f32 v48, v96, v97
    v_add_f32 v16, v16, v96
    v_add_f32 v17, v17, v97
    v_cvt_pk_bf16_f32 v49, v98, v99
    v_add_f32 v16, v16, v98
    v_add_f32 v17, v17, v99
    v_fma_f32 v100, v100, s68, -v14
    v_fma_f32 v101, v101, s68, -v14
    v_fma_f32 v102, v102, s68, -v14
    v_fma_f32 v103, v103, s68, -v14
    v_exp_f32 v100, v100
    v_exp_f32 v101, v101
    v_exp_f32 v102, v102
    v_exp_f32 v103, v103
    v_cvt_pk_bf16_f32 v50, v100, v101
    v_add_f32 v16, v16, v100
    v_add_f32 v17, v17, v101
    v_cvt_pk_bf16_f32 v51, v102, v103
    v_add_f32 v16, v16, v102
    v_add_f32 v17, v17, v103
    v_fma_f32 v104, v104, s68, -v14
    v_fma_f32 v105, v105, s68, -v14
    v_fma_f32 v106, v106, s68, -v14
    v_fma_f32 v107, v107, s68, -v14
    v_exp_f32 v104, v104
    v_exp_f32 v105, v105
    v_exp_f32 v106, v106
    v_exp_f32 v107, v107
    v_cvt_pk_bf16_f32 v52, v104, v105
    v_add_f32 v16, v16, v104
    v_add_f32 v17, v17, v105
    v_cvt_pk_bf16_f32 v53, v106, v107
    v_add_f32 v16, v16, v106
    v_add_f32 v17, v17, v107
    v_fma_f32 v108, v108, s68, -v14
    v_fma_f32 v109, v109, s68, -v14
    v_fma_f32 v110, v110, s68, -v14
    v_fma_f32 v111, v111, s68, -v14
    v_exp_f32 v108, v108
    v_exp_f32 v109, v109
    v_exp_f32 v110, v110
    v_exp_f32 v111, v111
    v_cvt_pk_bf16_f32 v54, v108, v109
    v_add_f32 v16, v16, v108
    v_add_f32 v17, v17, v109
    v_cvt_pk_bf16_f32 v55, v110, v111
    v_add_f32 v16, v16, v110
    v_add_f32 v17, v17, v111
    v_fma_f32 v112, v112, s68, -v14
    v_fma_f32 v113, v113, s68, -v14
    v_fma_f32 v114, v114, s68, -v14
    v_fma_f32 v115, v115, s68, -v14
    v_exp_f32 v112, v112
    v_exp_f32 v113, v113
    v_exp_f32 v114, v114
    v_exp_f32 v115, v115
    v_cvt_pk_bf16_f32 v56, v112, v113
    v_add_f32 v16, v16, v112
    v_add_f32 v17, v17, v113
    v_cvt_pk_bf16_f32 v57, v114, v115
    v_add_f32 v16, v16, v114
    v_add_f32 v17, v17, v115
    v_fma_f32 v116, v116, s68, -v14
    v_fma_f32 v117, v117, s68, -v14
    v_fma_f32 v118, v118, s68, -v14
    v_fma_f32 v119, v119, s68, -v14
    v_exp_f32 v116, v116
    v_exp_f32 v117, v117
    v_exp_f32 v118, v118
    v_exp_f32 v119, v119
    v_cvt_pk_bf16_f32 v58, v116, v117
    v_add_f32 v16, v16, v116
    v_add_f32 v17, v17, v117
    v_cvt_pk_bf16_f32 v59, v118, v119
    v_add_f32 v16, v16, v118
    v_add_f32 v17, v17, v119
    v_fma_f32 v120, v120, s68, -v14
    v_fma_f32 v121, v121, s68, -v14
    v_fma_f32 v122, v122, s68, -v14
    v_fma_f32 v123, v123, s68, -v14
    v_exp_f32 v120, v120
    v_exp_f32 v121, v121
    v_exp_f32 v122, v122
    v_exp_f32 v123, v123
    v_cvt_pk_bf16_f32 v60, v120, v121
    v_add_f32 v16, v16, v120
    v_add_f32 v17, v17, v121
    v_cvt_pk_bf16_f32 v61, v122, v123
    v_add_f32 v16, v16, v122
    v_add_f32 v17, v17, v123
    v_fma_f32 v124, v124, s68, -v14
    v_fma_f32 v125, v125, s68, -v14
    v_fma_f32 v126, v126, s68, -v14
    v_fma_f32 v127, v127, s68, -v14
    v_exp_f32 v124, v124
    v_exp_f32 v125, v125
    v_exp_f32 v126, v126
    v_exp_f32 v127, v127
    v_cvt_pk_bf16_f32 v62, v124, v125
    v_add_f32 v16, v16, v124
    v_add_f32 v17, v17, v125
    v_cvt_pk_bf16_f32 v63, v126, v127
    v_add_f32 v16, v16, v126
    v_add_f32 v17, v17, v127
    v_add_f32 v16, v16, v17
    v_mov_b32 v15, v16
    s_nop 1
    v_permlane32_swap_b32 v15, v16
    s_nop 1
    v_add_f32 v16, v16, v15
    v_mov_b32 v15, v16
    s_nop 1
    v_permlane16_swap_b32 v15, v16
    s_nop 1
    v_add_f32 v16, v16, v15
    v_mov_b32 v15, v16
    v_and_b32 v17, 1, v1
    v_lshlrev_b32 v17, 3, v17
    s_lshl_b32 s69, s52, 4
    s_add_u32 s69, s69, 135168
    v_add_u32 v17, s69, v17
    ds_write_b64 v17, v[14:15]
    s_waitcnt lgkmcnt(0)
    v_lshrrev_b32 v7, 2, v1
    v_lshlrev_b32 v6, 9, v7
    v_and_b32 v7, 7, v7
    v_lshl_add_u32 v6, v7, 5, v6
    v_and_b32 v7, 3, v1
    v_lshl_add_u32 v6, v7, 3, v6
    v_add_u32 v6, s56, v6
    v_xor_b32 v7, 32, v6
    v_xor_b32 v8, 64, v6
    v_xor_b32 v9, 96, v6
    v_xor_b32 v10, 128, v6
    v_xor_b32 v11, 160, v6
    v_xor_b32 v12, 192, v6
    v_xor_b32 v13, 224, v6
    s_waitcnt vmcnt(8)
    ds_read_b64_tr_b16 v[14:15], v6 offset:8192
    ds_read_b64_tr_b16 v[16:17], v7 offset:8192
    ds_read_b64_tr_b16 v[18:19], v8 offset:8192
    ds_read_b64_tr_b16 v[20:21], v9 offset:8192
    ds_read_b64_tr_b16 v[22:23], v10 offset:8192
    ds_read_b64_tr_b16 v[24:25], v11 offset:8192
    ds_read_b64_tr_b16 v[26:27], v12 offset:8192
    ds_read_b64_tr_b16 v[28:29], v13 offset:8192
    s_waitcnt lgkmcnt(7)
    v_mfma_f32_16x16x16_bf16 v[64:67], v[14:15], v[32:33], 0
    s_waitcnt lgkmcnt(6)
    v_mfma_f32_16x16x16_bf16 v[68:71], v[16:17], v[32:33], 0
    ds_read_b64_tr_b16 v[14:15], v6 offset:8448
    s_waitcnt lgkmcnt(6)
    v_mfma_f32_16x16x16_bf16 v[72:75], v[18:19], v[32:33], 0
    ds_read_b64_tr_b16 v[16:17], v7 offset:8448
    s_waitcnt lgkmcnt(6)
    v_mfma_f32_16x16x16_bf16 v[76:79], v[20:21], v[32:33], 0
    ds_read_b64_tr_b16 v[18:19], v8 offset:8448
    s_waitcnt lgkmcnt(6)
    v_mfma_f32_16x16x16_bf16 v[80:83], v[22:23], v[32:33], 0
    ds_read_b64_tr_b16 v[20:21], v9 offset:8448
    s_waitcnt lgkmcnt(6)
    v_mfma_f32_16x16x16_bf16 v[84:87], v[24:25], v[32:33], 0
    ds_read_b64_tr_b16 v[22:23], v10 offset:8448
    s_waitcnt lgkmcnt(6)
    v_mfma_f32_16x16x16_bf16 v[88:91], v[26:27], v[32:33], 0
    ds_read_b64_tr_b16 v[24:25], v11 offset:8448
    s_waitcnt lgkmcnt(6)
    v_mfma_f32_16x16x16_bf16 v[92:95], v[28:29], v[32:33], 0
    ds_read_b64_tr_b16 v[26:27], v12 offset:8448
    s_waitcnt lgkmcnt(6)
    v_mfma_f32_16x16x16_bf16 v[96:99], v[14:15], v[32:33], 0
    ds_read_b64_tr_b16 v[28:29], v13 offset:8448
    s_waitcnt lgkmcnt(6)
    v_mfma_f32_16x16x16_bf16 v[100:103], v[16:17], v[32:33], 0
    s_waitcnt lgkmcnt(5)
    v_mfma_f32_16x16x16_bf16 v[104:107], v[18:19], v[32:33], 0
    s_waitcnt lgkmcnt(4)
    v_mfma_f32_16x16x16_bf16 v[108:111], v[20:21], v[32:33], 0
    s_waitcnt lgkmcnt(3)
    v_mfma_f32_16x16x16_bf16 v[112:115], v[22:23], v[32:33], 0
    s_waitcnt lgkmcnt(2)
    v_mfma_f32_16x16x16_bf16 v[116:119], v[24:25], v[32:33], 0
    s_waitcnt lgkmcnt(1)
    v_mfma_f32_16x16x16_bf16 v[120:123], v[26:27], v[32:33], 0
    s_waitcnt lgkmcnt(0)
    v_mfma_f32_16x16x16_bf16 v[124:127], v[28:29], v[32:33], 0
    s_add_u32 m0, s56, 8192
    s_add_u32 s69, s57, 262144
    buffer_load_dwordx4 v2, s[8:11], s69 offen offset:0 nt lds
    buffer_load_dwordx4 v3, s[8:11], s69 offen offset:1024 nt lds
    buffer_load_dwordx4 v4, s[8:11], s69 offen offset:2048 nt lds
    buffer_load_dwordx4 v5, s[8:11], s69 offen offset:3072 nt lds
    s_add_u32 m0, s56, 12288
    s_add_u32 s69, s69, 4096
    buffer_load_dwordx4 v2, s[8:11], s69 offen offset:0 nt lds
    buffer_load_dwordx4 v3, s[8:11], s69 offen offset:1024 nt lds
    buffer_load_dwordx4 v4, s[8:11], s69 offen offset:2048 nt lds
    buffer_load_dwordx4 v5, s[8:11], s69 offen offset:3072 nt lds
    s_waitcnt vmcnt(8)
    ds_read_b64_tr_b16 v[14:15], v6 offset:0
    ds_read_b64_tr_b16 v[16:17], v7 offset:0
    ds_read_b64_tr_b16 v[18:19], v8 offset:0
    ds_read_b64_tr_b16 v[20:21], v9 offset:0
    ds_read_b64_tr_b16 v[22:23], v10 offset:0
    ds_read_b64_tr_b16 v[24:25], v11 offset:0
    ds_read_b64_tr_b16 v[26:27], v12 offset:0
    ds_read_b64_tr_b16 v[28:29], v13 offset:0
    s_waitcnt lgkmcnt(7)
    v_mfma_f32_16x16x16_bf16 v[64:67], v[14:15], v[34:35], v[64:67]
    s_waitcnt lgkmcnt(6)
    v_mfma_f32_16x16x16_bf16 v[68:71], v[16:17], v[34:35], v[68:71]
    ds_read_b64_tr_b16 v[14:15], v6 offset:256
    s_waitcnt lgkmcnt(6)
    v_mfma_f32_16x16x16_bf16 v[72:75], v[18:19], v[34:35], v[72:75]
    ds_read_b64_tr_b16 v[16:17], v7 offset:256
    s_waitcnt lgkmcnt(6)
    v_mfma_f32_16x16x16_bf16 v[76:79], v[20:21], v[34:35], v[76:79]
    ds_read_b64_tr_b16 v[18:19], v8 offset:256
    s_waitcnt lgkmcnt(6)
    v_mfma_f32_16x16x16_bf16 v[80:83], v[22:23], v[34:35], v[80:83]
    ds_read_b64_tr_b16 v[20:21], v9 offset:256
    s_waitcnt lgkmcnt(6)
    v_mfma_f32_16x16x16_bf16 v[84:87], v[24:25], v[34:35], v[84:87]
    ds_read_b64_tr_b16 v[22:23], v10 offset:256
    s_waitcnt lgkmcnt(6)
    v_mfma_f32_16x16x16_bf16 v[88:91], v[26:27], v[34:35], v[88:91]
    ds_read_b64_tr_b16 v[24:25], v11 offset:256
    s_waitcnt lgkmcnt(6)
    v_mfma_f32_16x16x16_bf16 v[92:95], v[28:29], v[34:35], v[92:95]
    ds_read_b64_tr_b16 v[26:27], v12 offset:256
    s_waitcnt lgkmcnt(6)
    v_mfma_f32_16x16x16_bf16 v[96:99], v[14:15], v[34:35], v[96:99]
    ds_read_b64_tr_b16 v[28:29], v13 offset:256
    s_waitcnt lgkmcnt(6)
    v_mfma_f32_16x16x16_bf16 v[100:103], v[16:17], v[34:35], v[100:103]
    s_waitcnt lgkmcnt(5)
    v_mfma_f32_16x16x16_bf16 v[104:107], v[18:19], v[34:35], v[104:107]
    s_waitcnt lgkmcnt(4)
    v_mfma_f32_16x16x16_bf16 v[108:111], v[20:21], v[34:35], v[108:111]
    s_waitcnt lgkmcnt(3)
    v_mfma_f32_16x16x16_bf16 v[112:115], v[22:23], v[34:35], v[112:115]
    s_waitcnt lgkmcnt(2)
    v_mfma_f32_16x16x16_bf16 v[116:119], v[24:25], v[34:35], v[116:119]
    s_waitcnt lgkmcnt(1)
    v_mfma_f32_16x16x16_bf16 v[120:123], v[26:27], v[34:35], v[120:123]
    s_waitcnt lgkmcnt(0)
    v_mfma_f32_16x16x16_bf16 v[124:127], v[28:29], v[34:35], v[124:127]
    s_add_u32 m0, s56, 0
    s_add_u32 s69, s57, 393216
    buffer_load_dwordx4 v2, s[8:11], s69 offen offset:0 nt lds
    buffer_load_dwordx4 v3, s[8:11], s69 offen offset:1024 nt lds
    buffer_load_dwordx4 v4, s[8:11], s69 offen offset:2048 nt lds
    buffer_load_dwordx4 v5, s[8:11], s69 offen offset:3072 nt lds
    s_add_u32 m0, s56, 4096
    s_add_u32 s69, s69, 4096
    buffer_load_dwordx4 v2, s[8:11], s69 offen offset:0 nt lds
    buffer_load_dwordx4 v3, s[8:11], s69 offen offset:1024 nt lds
    buffer_load_dwordx4 v4, s[8:11], s69 offen offset:2048 nt lds
    buffer_load_dwordx4 v5, s[8:11], s69 offen offset:3072 nt lds
    s_waitcnt vmcnt(8)
    ds_read_b64_tr_b16 v[14:15], v6 offset:8192
    ds_read_b64_tr_b16 v[16:17], v7 offset:8192
    ds_read_b64_tr_b16 v[18:19], v8 offset:8192
    ds_read_b64_tr_b16 v[20:21], v9 offset:8192
    ds_read_b64_tr_b16 v[22:23], v10 offset:8192
    ds_read_b64_tr_b16 v[24:25], v11 offset:8192
    ds_read_b64_tr_b16 v[26:27], v12 offset:8192
    ds_read_b64_tr_b16 v[28:29], v13 offset:8192
    s_waitcnt lgkmcnt(7)
    v_mfma_f32_16x16x16_bf16 v[64:67], v[14:15], v[36:37], v[64:67]
    s_waitcnt lgkmcnt(6)
    v_mfma_f32_16x16x16_bf16 v[68:71], v[16:17], v[36:37], v[68:71]
    ds_read_b64_tr_b16 v[14:15], v6 offset:8448
    s_waitcnt lgkmcnt(6)
    v_mfma_f32_16x16x16_bf16 v[72:75], v[18:19], v[36:37], v[72:75]
    ds_read_b64_tr_b16 v[16:17], v7 offset:8448
    s_waitcnt lgkmcnt(6)
    v_mfma_f32_16x16x16_bf16 v[76:79], v[20:21], v[36:37], v[76:79]
    ds_read_b64_tr_b16 v[18:19], v8 offset:8448
    s_waitcnt lgkmcnt(6)
    v_mfma_f32_16x16x16_bf16 v[80:83], v[22:23], v[36:37], v[80:83]
    ds_read_b64_tr_b16 v[20:21], v9 offset:8448
    s_waitcnt lgkmcnt(6)
    v_mfma_f32_16x16x16_bf16 v[84:87], v[24:25], v[36:37], v[84:87]
    ds_read_b64_tr_b16 v[22:23], v10 offset:8448
    s_waitcnt lgkmcnt(6)
    v_mfma_f32_16x16x16_bf16 v[88:91], v[26:27], v[36:37], v[88:91]
    ds_read_b64_tr_b16 v[24:25], v11 offset:8448
    s_waitcnt lgkmcnt(6)
    v_mfma_f32_16x16x16_bf16 v[92:95], v[28:29], v[36:37], v[92:95]
    ds_read_b64_tr_b16 v[26:27], v12 offset:8448
    s_waitcnt lgkmcnt(6)
    v_mfma_f32_16x16x16_bf16 v[96:99], v[14:15], v[36:37], v[96:99]
    ds_read_b64_tr_b16 v[28:29], v13 offset:8448
    s_waitcnt lgkmcnt(6)
    v_mfma_f32_16x16x16_bf16 v[100:103], v[16:17], v[36:37], v[100:103]
    s_waitcnt lgkmcnt(5)
    v_mfma_f32_16x16x16_bf16 v[104:107], v[18:19], v[36:37], v[104:107]
    s_waitcnt lgkmcnt(4)
    v_mfma_f32_16x16x16_bf16 v[108:111], v[20:21], v[36:37], v[108:111]
    s_waitcnt lgkmcnt(3)
    v_mfma_f32_16x16x16_bf16 v[112:115], v[22:23], v[36:37], v[112:115]
    s_waitcnt lgkmcnt(2)
    v_mfma_f32_16x16x16_bf16 v[116:119], v[24:25], v[36:37], v[116:119]
    s_waitcnt lgkmcnt(1)
    v_mfma_f32_16x16x16_bf16 v[120:123], v[26:27], v[36:37], v[120:123]
    s_waitcnt lgkmcnt(0)
    v_mfma_f32_16x16x16_bf16 v[124:127], v[28:29], v[36:37], v[124:127]
    s_add_u32 m0, s56, 8192
    s_add_u32 s69, s57, 524288
    buffer_load_dwordx4 v2, s[8:11], s69 offen offset:0 nt lds
    buffer_load_dwordx4 v3, s[8:11], s69 offen offset:1024 nt lds
    buffer_load_dwordx4 v4, s[8:11], s69 offen offset:2048 nt lds
    buffer_load_dwordx4 v5, s[8:11], s69 offen offset:3072 nt lds
    s_add_u32 m0, s56, 12288
    s_add_u32 s69, s69, 4096
    buffer_load_dwordx4 v2, s[8:11], s69 offen offset:0 nt lds
    buffer_load_dwordx4 v3, s[8:11], s69 offen offset:1024 nt lds
    buffer_load_dwordx4 v4, s[8:11], s69 offen offset:2048 nt lds
    buffer_load_dwordx4 v5, s[8:11], s69 offen offset:3072 nt lds
    s_waitcnt vmcnt(8)
    ds_read_b64_tr_b16 v[14:15], v6 offset:0
    ds_read_b64_tr_b16 v[16:17], v7 offset:0
    ds_read_b64_tr_b16 v[18:19], v8 offset:0
    ds_read_b64_tr_b16 v[20:21], v9 offset:0
    ds_read_b64_tr_b16 v[22:23], v10 offset:0
    ds_read_b64_tr_b16 v[24:25], v11 offset:0
    ds_read_b64_tr_b16 v[26:27], v12 offset:0
    ds_read_b64_tr_b16 v[28:29], v13 offset:0
    s_waitcnt lgkmcnt(7)
    v_mfma_f32_16x16x16_bf16 v[64:67], v[14:15], v[38:39], v[64:67]
    s_waitcnt lgkmcnt(6)
    v_mfma_f32_16x16x16_bf16 v[68:71], v[16:17], v[38:39], v[68:71]
    ds_read_b64_tr_b16 v[14:15], v6 offset:256
    s_waitcnt lgkmcnt(6)
    v_mfma_f32_16x16x16_bf16 v[72:75], v[18:19], v[38:39], v[72:75]
    ds_read_b64_tr_b16 v[16:17], v7 offset:256
    s_waitcnt lgkmcnt(6)
    v_mfma_f32_16x16x16_bf16 v[76:79], v[20:21], v[38:39], v[76:79]
    ds_read_b64_tr_b16 v[18:19], v8 offset:256
    s_waitcnt lgkmcnt(6)
    v_mfma_f32_16x16x16_bf16 v[80:83], v[22:23], v[38:39], v[80:83]
    ds_read_b64_tr_b16 v[20:21], v9 offset:256
    s_waitcnt lgkmcnt(6)
    v_mfma_f32_16x16x16_bf16 v[84:87], v[24:25], v[38:39], v[84:87]
    ds_read_b64_tr_b16 v[22:23], v10 offset:256
    s_waitcnt lgkmcnt(6)
    v_mfma_f32_16x16x16_bf16 v[88:91], v[26:27], v[38:39], v[88:91]
    ds_read_b64_tr_b16 v[24:25], v11 offset:256
    s_waitcnt lgkmcnt(6)
    v_mfma_f32_16x16x16_bf16 v[92:95], v[28:29], v[38:39], v[92:95]
    ds_read_b64_tr_b16 v[26:27], v12 offset:256
    s_waitcnt lgkmcnt(6)
    v_mfma_f32_16x16x16_bf16 v[96:99], v[14:15], v[38:39], v[96:99]
    ds_read_b64_tr_b16 v[28:29], v13 offset:256
    s_waitcnt lgkmcnt(6)
    v_mfma_f32_16x16x16_bf16 v[100:103], v[16:17], v[38:39], v[100:103]
    s_waitcnt lgkmcnt(5)
    v_mfma_f32_16x16x16_bf16 v[104:107], v[18:19], v[38:39], v[104:107]
    s_waitcnt lgkmcnt(4)
    v_mfma_f32_16x16x16_bf16 v[108:111], v[20:21], v[38:39], v[108:111]
    s_waitcnt lgkmcnt(3)
    v_mfma_f32_16x16x16_bf16 v[112:115], v[22:23], v[38:39], v[112:115]
    s_waitcnt lgkmcnt(2)
    v_mfma_f32_16x16x16_bf16 v[116:119], v[24:25], v[38:39], v[116:119]
    s_waitcnt lgkmcnt(1)
    v_mfma_f32_16x16x16_bf16 v[120:123], v[26:27], v[38:39], v[120:123]
    s_waitcnt lgkmcnt(0)
    v_mfma_f32_16x16x16_bf16 v[124:127], v[28:29], v[38:39], v[124:127]
    s_add_u32 m0, s56, 0
    s_add_u32 s69, s57, 655360
    buffer_load_dwordx4 v2, s[8:11], s69 offen offset:0 nt lds
    buffer_load_dwordx4 v3, s[8:11], s69 offen offset:1024 nt lds
    buffer_load_dwordx4 v4, s[8:11], s69 offen offset:2048 nt lds
    buffer_load_dwordx4 v5, s[8:11], s69 offen offset:3072 nt lds
    s_add_u32 m0, s56, 4096
    s_add_u32 s69, s69, 4096
    buffer_load_dwordx4 v2, s[8:11], s69 offen offset:0 nt lds
    buffer_load_dwordx4 v3, s[8:11], s69 offen offset:1024 nt lds
    buffer_load_dwordx4 v4, s[8:11], s69 offen offset:2048 nt lds
    buffer_load_dwordx4 v5, s[8:11], s69 offen offset:3072 nt lds
    s_waitcnt vmcnt(8)
    ds_read_b64_tr_b16 v[14:15], v6 offset:8192
    ds_read_b64_tr_b16 v[16:17], v7 offset:8192
    ds_read_b64_tr_b16 v[18:19], v8 offset:8192
    ds_read_b64_tr_b16 v[20:21], v9 offset:8192
    ds_read_b64_tr_b16 v[22:23], v10 offset:8192
    ds_read_b64_tr_b16 v[24:25], v11 offset:8192
    ds_read_b64_tr_b16 v[26:27], v12 offset:8192
    ds_read_b64_tr_b16 v[28:29], v13 offset:8192
    s_waitcnt lgkmcnt(7)
    v_mfma_f32_16x16x16_bf16 v[64:67], v[14:15], v[40:41], v[64:67]
    s_waitcnt lgkmcnt(6)
    v_mfma_f32_16x16x16_bf16 v[68:71], v[16:17], v[40:41], v[68:71]
    ds_read_b64_tr_b16 v[14:15], v6 offset:8448
    s_waitcnt lgkmcnt(6)
    v_mfma_f32_16x16x16_bf16 v[72:75], v[18:19], v[40:41], v[72:75]
    ds_read_b64_tr_b16 v[16:17], v7 offset:8448
    s_waitcnt lgkmcnt(6)
    v_mfma_f32_16x16x16_bf16 v[76:79], v[20:21], v[40:41], v[76:79]
    ds_read_b64_tr_b16 v[18:19], v8 offset:8448
    s_waitcnt lgkmcnt(6)
    v_mfma_f32_16x16x16_bf16 v[80:83], v[22:23], v[40:41], v[80:83]
    ds_read_b64_tr_b16 v[20:21], v9 offset:8448
    s_waitcnt lgkmcnt(6)
    v_mfma_f32_16x16x16_bf16 v[84:87], v[24:25], v[40:41], v[84:87]
    ds_read_b64_tr_b16 v[22:23], v10 offset:8448
    s_waitcnt lgkmcnt(6)
    v_mfma_f32_16x16x16_bf16 v[88:91], v[26:27], v[40:41], v[88:91]
    ds_read_b64_tr_b16 v[24:25], v11 offset:8448
    s_waitcnt lgkmcnt(6)
    v_mfma_f32_16x16x16_bf16 v[92:95], v[28:29], v[40:41], v[92:95]
    ds_read_b64_tr_b16 v[26:27], v12 offset:8448
    s_waitcnt lgkmcnt(6)
    v_mfma_f32_16x16x16_bf16 v[96:99], v[14:15], v[40:41], v[96:99]
    ds_read_b64_tr_b16 v[28:29], v13 offset:8448
    s_waitcnt lgkmcnt(6)
    v_mfma_f32_16x16x16_bf16 v[100:103], v[16:17], v[40:41], v[100:103]
    s_waitcnt lgkmcnt(5)
    v_mfma_f32_16x16x16_bf16 v[104:107], v[18:19], v[40:41], v[104:107]
    s_waitcnt lgkmcnt(4)
    v_mfma_f32_16x16x16_bf16 v[108:111], v[20:21], v[40:41], v[108:111]
    s_waitcnt lgkmcnt(3)
    v_mfma_f32_16x16x16_bf16 v[112:115], v[22:23], v[40:41], v[112:115]
    s_waitcnt lgkmcnt(2)
    v_mfma_f32_16x16x16_bf16 v[116:119], v[24:25], v[40:41], v[116:119]
    s_waitcnt lgkmcnt(1)
    v_mfma_f32_16x16x16_bf16 v[120:123], v[26:27], v[40:41], v[120:123]
    s_waitcnt lgkmcnt(0)
    v_mfma_f32_16x16x16_bf16 v[124:127], v[28:29], v[40:41], v[124:127]
    s_add_u32 m0, s56, 8192
    s_add_u32 s69, s57, 786432
    buffer_load_dwordx4 v2, s[8:11], s69 offen offset:0 nt lds
    buffer_load_dwordx4 v3, s[8:11], s69 offen offset:1024 nt lds
    buffer_load_dwordx4 v4, s[8:11], s69 offen offset:2048 nt lds
    buffer_load_dwordx4 v5, s[8:11], s69 offen offset:3072 nt lds
    s_add_u32 m0, s56, 12288
    s_add_u32 s69, s69, 4096
    buffer_load_dwordx4 v2, s[8:11], s69 offen offset:0 nt lds
    buffer_load_dwordx4 v3, s[8:11], s69 offen offset:1024 nt lds
    buffer_load_dwordx4 v4, s[8:11], s69 offen offset:2048 nt lds
    buffer_load_dwordx4 v5, s[8:11], s69 offen offset:3072 nt lds
    s_waitcnt vmcnt(8)
    ds_read_b64_tr_b16 v[14:15], v6 offset:0
    ds_read_b64_tr_b16 v[16:17], v7 offset:0
    ds_read_b64_tr_b16 v[18:19], v8 offset:0
    ds_read_b64_tr_b16 v[20:21], v9 offset:0
    ds_read_b64_tr_b16 v[22:23], v10 offset:0
    ds_read_b64_tr_b16 v[24:25], v11 offset:0
    ds_read_b64_tr_b16 v[26:27], v12 offset:0
    ds_read_b64_tr_b16 v[28:29], v13 offset:0
    s_waitcnt lgkmcnt(7)
    v_mfma_f32_16x16x16_bf16 v[64:67], v[14:15], v[42:43], v[64:67]
    s_waitcnt lgkmcnt(6)
    v_mfma_f32_16x16x16_bf16 v[68:71], v[16:17], v[42:43], v[68:71]
    ds_read_b64_tr_b16 v[14:15], v6 offset:256
    s_waitcnt lgkmcnt(6)
    v_mfma_f32_16x16x16_bf16 v[72:75], v[18:19], v[42:43], v[72:75]
    ds_read_b64_tr_b16 v[16:17], v7 offset:256
    s_waitcnt lgkmcnt(6)
    v_mfma_f32_16x16x16_bf16 v[76:79], v[20:21], v[42:43], v[76:79]
    ds_read_b64_tr_b16 v[18:19], v8 offset:256
    s_waitcnt lgkmcnt(6)
    v_mfma_f32_16x16x16_bf16 v[80:83], v[22:23], v[42:43], v[80:83]
    ds_read_b64_tr_b16 v[20:21], v9 offset:256
    s_waitcnt lgkmcnt(6)
    v_mfma_f32_16x16x16_bf16 v[84:87], v[24:25], v[42:43], v[84:87]
    ds_read_b64_tr_b16 v[22:23], v10 offset:256
    s_waitcnt lgkmcnt(6)
    v_mfma_f32_16x16x16_bf16 v[88:91], v[26:27], v[42:43], v[88:91]
    ds_read_b64_tr_b16 v[24:25], v11 offset:256
    s_waitcnt lgkmcnt(6)
    v_mfma_f32_16x16x16_bf16 v[92:95], v[28:29], v[42:43], v[92:95]
    ds_read_b64_tr_b16 v[26:27], v12 offset:256
    s_waitcnt lgkmcnt(6)
    v_mfma_f32_16x16x16_bf16 v[96:99], v[14:15], v[42:43], v[96:99]
    ds_read_b64_tr_b16 v[28:29], v13 offset:256
    s_waitcnt lgkmcnt(6)
    v_mfma_f32_16x16x16_bf16 v[100:103], v[16:17], v[42:43], v[100:103]
    s_waitcnt lgkmcnt(5)
    v_mfma_f32_16x16x16_bf16 v[104:107], v[18:19], v[42:43], v[104:107]
    s_waitcnt lgkmcnt(4)
    v_mfma_f32_16x16x16_bf16 v[108:111], v[20:21], v[42:43], v[108:111]
    s_waitcnt lgkmcnt(3)
    v_mfma_f32_16x16x16_bf16 v[112:115], v[22:23], v[42:43], v[112:115]
    s_waitcnt lgkmcnt(2)
    v_mfma_f32_16x16x16_bf16 v[116:119], v[24:25], v[42:43], v[116:119]
    s_waitcnt lgkmcnt(1)
    v_mfma_f32_16x16x16_bf16 v[120:123], v[26:27], v[42:43], v[120:123]
    s_waitcnt lgkmcnt(0)
    v_mfma_f32_16x16x16_bf16 v[124:127], v[28:29], v[42:43], v[124:127]
    s_add_u32 m0, s56, 0
    s_add_u32 s69, s57, 917504
    buffer_load_dwordx4 v2, s[8:11], s69 offen offset:0 nt lds
    buffer_load_dwordx4 v3, s[8:11], s69 offen offset:1024 nt lds
    buffer_load_dwordx4 v4, s[8:11], s69 offen offset:2048 nt lds
    buffer_load_dwordx4 v5, s[8:11], s69 offen offset:3072 nt lds
    s_add_u32 m0, s56, 4096
    s_add_u32 s69, s69, 4096
    buffer_load_dwordx4 v2, s[8:11], s69 offen offset:0 nt lds
    buffer_load_dwordx4 v3, s[8:11], s69 offen offset:1024 nt lds
    buffer_load_dwordx4 v4, s[8:11], s69 offen offset:2048 nt lds
    buffer_load_dwordx4 v5, s[8:11], s69 offen offset:3072 nt lds
    s_waitcnt vmcnt(8)
    ds_read_b64_tr_b16 v[14:15], v6 offset:8192
    ds_read_b64_tr_b16 v[16:17], v7 offset:8192
    ds_read_b64_tr_b16 v[18:19], v8 offset:8192
    ds_read_b64_tr_b16 v[20:21], v9 offset:8192
    ds_read_b64_tr_b16 v[22:23], v10 offset:8192
    ds_read_b64_tr_b16 v[24:25], v11 offset:8192
    ds_read_b64_tr_b16 v[26:27], v12 offset:8192
    ds_read_b64_tr_b16 v[28:29], v13 offset:8192
    s_waitcnt lgkmcnt(7)
    v_mfma_f32_16x16x16_bf16 v[64:67], v[14:15], v[44:45], v[64:67]
    s_waitcnt lgkmcnt(6)
    v_mfma_f32_16x16x16_bf16 v[68:71], v[16:17], v[44:45], v[68:71]
    ds_read_b64_tr_b16 v[14:15], v6 offset:8448
    s_waitcnt lgkmcnt(6)
    v_mfma_f32_16x16x16_bf16 v[72:75], v[18:19], v[44:45], v[72:75]
    ds_read_b64_tr_b16 v[16:17], v7 offset:8448
    s_waitcnt lgkmcnt(6)
    v_mfma_f32_16x16x16_bf16 v[76:79], v[20:21], v[44:45], v[76:79]
    ds_read_b64_tr_b16 v[18:19], v8 offset:8448
    s_waitcnt lgkmcnt(6)
    v_mfma_f32_16x16x16_bf16 v[80:83], v[22:23], v[44:45], v[80:83]
    ds_read_b64_tr_b16 v[20:21], v9 offset:8448
    s_waitcnt lgkmcnt(6)
    v_mfma_f32_16x16x16_bf16 v[84:87], v[24:25], v[44:45], v[84:87]
    ds_read_b64_tr_b16 v[22:23], v10 offset:8448
    s_waitcnt lgkmcnt(6)
    v_mfma_f32_16x16x16_bf16 v[88:91], v[26:27], v[44:45], v[88:91]
    ds_read_b64_tr_b16 v[24:25], v11 offset:8448
    s_waitcnt lgkmcnt(6)
    v_mfma_f32_16x16x16_bf16 v[92:95], v[28:29], v[44:45], v[92:95]
    ds_read_b64_tr_b16 v[26:27], v12 offset:8448
    s_waitcnt lgkmcnt(6)
    v_mfma_f32_16x16x16_bf16 v[96:99], v[14:15], v[44:45], v[96:99]
    ds_read_b64_tr_b16 v[28:29], v13 offset:8448
    s_waitcnt lgkmcnt(6)
    v_mfma_f32_16x16x16_bf16 v[100:103], v[16:17], v[44:45], v[100:103]
    s_waitcnt lgkmcnt(5)
    v_mfma_f32_16x16x16_bf16 v[104:107], v[18:19], v[44:45], v[104:107]
    s_waitcnt lgkmcnt(4)
    v_mfma_f32_16x16x16_bf16 v[108:111], v[20:21], v[44:45], v[108:111]
    s_waitcnt lgkmcnt(3)
    v_mfma_f32_16x16x16_bf16 v[112:115], v[22:23], v[44:45], v[112:115]
    s_waitcnt lgkmcnt(2)
    v_mfma_f32_16x16x16_bf16 v[116:119], v[24:25], v[44:45], v[116:119]
    s_waitcnt lgkmcnt(1)
    v_mfma_f32_16x16x16_bf16 v[120:123], v[26:27], v[44:45], v[120:123]
    s_waitcnt lgkmcnt(0)
    v_mfma_f32_16x16x16_bf16 v[124:127], v[28:29], v[44:45], v[124:127]
    s_add_u32 m0, s56, 8192
    s_add_u32 s69, s57, 1048576
    buffer_load_dwordx4 v2, s[8:11], s69 offen offset:0 nt lds
    buffer_load_dwordx4 v3, s[8:11], s69 offen offset:1024 nt lds
    buffer_load_dwordx4 v4, s[8:11], s69 offen offset:2048 nt lds
    buffer_load_dwordx4 v5, s[8:11], s69 offen offset:3072 nt lds
    s_add_u32 m0, s56, 12288
    s_add_u32 s69, s69, 4096
    buffer_load_dwordx4 v2, s[8:11], s69 offen offset:0 nt lds
    buffer_load_dwordx4 v3, s[8:11], s69 offen offset:1024 nt lds
    buffer_load_dwordx4 v4, s[8:11], s69 offen offset:2048 nt lds
    buffer_load_dwordx4 v5, s[8:11], s69 offen offset:3072 nt lds
    s_waitcnt vmcnt(8)
    ds_read_b64_tr_b16 v[14:15], v6 offset:0
    ds_read_b64_tr_b16 v[16:17], v7 offset:0
    ds_read_b64_tr_b16 v[18:19], v8 offset:0
    ds_read_b64_tr_b16 v[20:21], v9 offset:0
    ds_read_b64_tr_b16 v[22:23], v10 offset:0
    ds_read_b64_tr_b16 v[24:25], v11 offset:0
    ds_read_b64_tr_b16 v[26:27], v12 offset:0
    ds_read_b64_tr_b16 v[28:29], v13 offset:0
    s_waitcnt lgkmcnt(7)
    v_mfma_f32_16x16x16_bf16 v[64:67], v[14:15], v[46:47], v[64:67]
    s_waitcnt lgkmcnt(6)
    v_mfma_f32_16x16x16_bf16 v[68:71], v[16:17], v[46:47], v[68:71]
    ds_read_b64_tr_b16 v[14:15], v6 offset:256
    s_waitcnt lgkmcnt(6)
    v_mfma_f32_16x16x16_bf16 v[72:75], v[18:19], v[46:47], v[72:75]
    ds_read_b64_tr_b16 v[16:17], v7 offset:256
    s_waitcnt lgkmcnt(6)
    v_mfma_f32_16x16x16_bf16 v[76:79], v[20:21], v[46:47], v[76:79]
    ds_read_b64_tr_b16 v[18:19], v8 offset:256
    s_waitcnt lgkmcnt(6)
    v_mfma_f32_16x16x16_bf16 v[80:83], v[22:23], v[46:47], v[80:83]
    ds_read_b64_tr_b16 v[20:21], v9 offset:256
    s_waitcnt lgkmcnt(6)
    v_mfma_f32_16x16x16_bf16 v[84:87], v[24:25], v[46:47], v[84:87]
    ds_read_b64_tr_b16 v[22:23], v10 offset:256
    s_waitcnt lgkmcnt(6)
    v_mfma_f32_16x16x16_bf16 v[88:91], v[26:27], v[46:47], v[88:91]
    ds_read_b64_tr_b16 v[24:25], v11 offset:256
    s_waitcnt lgkmcnt(6)
    v_mfma_f32_16x16x16_bf16 v[92:95], v[28:29], v[46:47], v[92:95]
    ds_read_b64_tr_b16 v[26:27], v12 offset:256
    s_waitcnt lgkmcnt(6)
    v_mfma_f32_16x16x16_bf16 v[96:99], v[14:15], v[46:47], v[96:99]
    ds_read_b64_tr_b16 v[28:29], v13 offset:256
    s_waitcnt lgkmcnt(6)
    v_mfma_f32_16x16x16_bf16 v[100:103], v[16:17], v[46:47], v[100:103]
    s_waitcnt lgkmcnt(5)
    v_mfma_f32_16x16x16_bf16 v[104:107], v[18:19], v[46:47], v[104:107]
    s_waitcnt lgkmcnt(4)
    v_mfma_f32_16x16x16_bf16 v[108:111], v[20:21], v[46:47], v[108:111]
    s_waitcnt lgkmcnt(3)
    v_mfma_f32_16x16x16_bf16 v[112:115], v[22:23], v[46:47], v[112:115]
    s_waitcnt lgkmcnt(2)
    v_mfma_f32_16x16x16_bf16 v[116:119], v[24:25], v[46:47], v[116:119]
    s_waitcnt lgkmcnt(1)
    v_mfma_f32_16x16x16_bf16 v[120:123], v[26:27], v[46:47], v[120:123]
    s_waitcnt lgkmcnt(0)
    v_mfma_f32_16x16x16_bf16 v[124:127], v[28:29], v[46:47], v[124:127]
    s_add_u32 m0, s56, 0
    s_add_u32 s69, s57, 1179648
    buffer_load_dwordx4 v2, s[8:11], s69 offen offset:0 nt lds
    buffer_load_dwordx4 v3, s[8:11], s69 offen offset:1024 nt lds
    buffer_load_dwordx4 v4, s[8:11], s69 offen offset:2048 nt lds
    buffer_load_dwordx4 v5, s[8:11], s69 offen offset:3072 nt lds
    s_add_u32 m0, s56, 4096
    s_add_u32 s69, s69, 4096
    buffer_load_dwordx4 v2, s[8:11], s69 offen offset:0 nt lds
    buffer_load_dwordx4 v3, s[8:11], s69 offen offset:1024 nt lds
    buffer_load_dwordx4 v4, s[8:11], s69 offen offset:2048 nt lds
    buffer_load_dwordx4 v5, s[8:11], s69 offen offset:3072 nt lds
    s_waitcnt vmcnt(8)
    ds_read_b64_tr_b16 v[14:15], v6 offset:8192
    ds_read_b64_tr_b16 v[16:17], v7 offset:8192
    ds_read_b64_tr_b16 v[18:19], v8 offset:8192
    ds_read_b64_tr_b16 v[20:21], v9 offset:8192
    ds_read_b64_tr_b16 v[22:23], v10 offset:8192
    ds_read_b64_tr_b16 v[24:25], v11 offset:8192
    ds_read_b64_tr_b16 v[26:27], v12 offset:8192
    ds_read_b64_tr_b16 v[28:29], v13 offset:8192
    s_waitcnt lgkmcnt(7)
    v_mfma_f32_16x16x16_bf16 v[64:67], v[14:15], v[48:49], v[64:67]
    s_waitcnt lgkmcnt(6)
    v_mfma_f32_16x16x16_bf16 v[68:71], v[16:17], v[48:49], v[68:71]
    ds_read_b64_tr_b16 v[14:15], v6 offset:8448
    s_waitcnt lgkmcnt(6)
    v_mfma_f32_16x16x16_bf16 v[72:75], v[18:19], v[48:49], v[72:75]
    ds_read_b64_tr_b16 v[16:17], v7 offset:8448
    s_waitcnt lgkmcnt(6)
    v_mfma_f32_16x16x16_bf16 v[76:79], v[20:21], v[48:49], v[76:79]
    ds_read_b64_tr_b16 v[18:19], v8 offset:8448
    s_waitcnt lgkmcnt(6)
    v_mfma_f32_16x16x16_bf16 v[80:83], v[22:23], v[48:49], v[80:83]
    ds_read_b64_tr_b16 v[20:21], v9 offset:8448
    s_waitcnt lgkmcnt(6)
    v_mfma_f32_16x16x16_bf16 v[84:87], v[24:25], v[48:49], v[84:87]
    ds_read_b64_tr_b16 v[22:23], v10 offset:8448
    s_waitcnt lgkmcnt(6)
    v_mfma_f32_16x16x16_bf16 v[88:91], v[26:27], v[48:49], v[88:91]
    ds_read_b64_tr_b16 v[24:25], v11 offset:8448
    s_waitcnt lgkmcnt(6)
    v_mfma_f32_16x16x16_bf16 v[92:95], v[28:29], v[48:49], v[92:95]
    ds_read_b64_tr_b16 v[26:27], v12 offset:8448
    s_waitcnt lgkmcnt(6)
    v_mfma_f32_16x16x16_bf16 v[96:99], v[14:15], v[48:49], v[96:99]
    ds_read_b64_tr_b16 v[28:29], v13 offset:8448
    s_waitcnt lgkmcnt(6)
    v_mfma_f32_16x16x16_bf16 v[100:103], v[16:17], v[48:49], v[100:103]
    s_waitcnt lgkmcnt(5)
    v_mfma_f32_16x16x16_bf16 v[104:107], v[18:19], v[48:49], v[104:107]
    s_waitcnt lgkmcnt(4)
    v_mfma_f32_16x16x16_bf16 v[108:111], v[20:21], v[48:49], v[108:111]
    s_waitcnt lgkmcnt(3)
    v_mfma_f32_16x16x16_bf16 v[112:115], v[22:23], v[48:49], v[112:115]
    s_waitcnt lgkmcnt(2)
    v_mfma_f32_16x16x16_bf16 v[116:119], v[24:25], v[48:49], v[116:119]
    s_waitcnt lgkmcnt(1)
    v_mfma_f32_16x16x16_bf16 v[120:123], v[26:27], v[48:49], v[120:123]
    s_waitcnt lgkmcnt(0)
    v_mfma_f32_16x16x16_bf16 v[124:127], v[28:29], v[48:49], v[124:127]
    s_add_u32 m0, s56, 8192
    s_add_u32 s69, s57, 1310720
    buffer_load_dwordx4 v2, s[8:11], s69 offen offset:0 nt lds
    buffer_load_dwordx4 v3, s[8:11], s69 offen offset:1024 nt lds
    buffer_load_dwordx4 v4, s[8:11], s69 offen offset:2048 nt lds
    buffer_load_dwordx4 v5, s[8:11], s69 offen offset:3072 nt lds
    s_add_u32 m0, s56, 12288
    s_add_u32 s69, s69, 4096
    buffer_load_dwordx4 v2, s[8:11], s69 offen offset:0 nt lds
    buffer_load_dwordx4 v3, s[8:11], s69 offen offset:1024 nt lds
    buffer_load_dwordx4 v4, s[8:11], s69 offen offset:2048 nt lds
    buffer_load_dwordx4 v5, s[8:11], s69 offen offset:3072 nt lds
    s_waitcnt vmcnt(8)
    ds_read_b64_tr_b16 v[14:15], v6 offset:0
    ds_read_b64_tr_b16 v[16:17], v7 offset:0
    ds_read_b64_tr_b16 v[18:19], v8 offset:0
    ds_read_b64_tr_b16 v[20:21], v9 offset:0
    ds_read_b64_tr_b16 v[22:23], v10 offset:0
    ds_read_b64_tr_b16 v[24:25], v11 offset:0
    ds_read_b64_tr_b16 v[26:27], v12 offset:0
    ds_read_b64_tr_b16 v[28:29], v13 offset:0
    s_waitcnt lgkmcnt(7)
    v_mfma_f32_16x16x16_bf16 v[64:67], v[14:15], v[50:51], v[64:67]
    s_waitcnt lgkmcnt(6)
    v_mfma_f32_16x16x16_bf16 v[68:71], v[16:17], v[50:51], v[68:71]
    ds_read_b64_tr_b16 v[14:15], v6 offset:256
    s_waitcnt lgkmcnt(6)
    v_mfma_f32_16x16x16_bf16 v[72:75], v[18:19], v[50:51], v[72:75]
    ds_read_b64_tr_b16 v[16:17], v7 offset:256
    s_waitcnt lgkmcnt(6)
    v_mfma_f32_16x16x16_bf16 v[76:79], v[20:21], v[50:51], v[76:79]
    ds_read_b64_tr_b16 v[18:19], v8 offset:256
    s_waitcnt lgkmcnt(6)
    v_mfma_f32_16x16x16_bf16 v[80:83], v[22:23], v[50:51], v[80:83]
    ds_read_b64_tr_b16 v[20:21], v9 offset:256
    s_waitcnt lgkmcnt(6)
    v_mfma_f32_16x16x16_bf16 v[84:87], v[24:25], v[50:51], v[84:87]
    ds_read_b64_tr_b16 v[22:23], v10 offset:256
    s_waitcnt lgkmcnt(6)
    v_mfma_f32_16x16x16_bf16 v[88:91], v[26:27], v[50:51], v[88:91]
    ds_read_b64_tr_b16 v[24:25], v11 offset:256
    s_waitcnt lgkmcnt(6)
    v_mfma_f32_16x16x16_bf16 v[92:95], v[28:29], v[50:51], v[92:95]
    ds_read_b64_tr_b16 v[26:27], v12 offset:256
    s_waitcnt lgkmcnt(6)
    v_mfma_f32_16x16x16_bf16 v[96:99], v[14:15], v[50:51], v[96:99]
    ds_read_b64_tr_b16 v[28:29], v13 offset:256
    s_waitcnt lgkmcnt(6)
    v_mfma_f32_16x16x16_bf16 v[100:103], v[16:17], v[50:51], v[100:103]
    s_waitcnt lgkmcnt(5)
    v_mfma_f32_16x16x16_bf16 v[104:107], v[18:19], v[50:51], v[104:107]
    s_waitcnt lgkmcnt(4)
    v_mfma_f32_16x16x16_bf16 v[108:111], v[20:21], v[50:51], v[108:111]
    s_waitcnt lgkmcnt(3)
    v_mfma_f32_16x16x16_bf16 v[112:115], v[22:23], v[50:51], v[112:115]
    s_waitcnt lgkmcnt(2)
    v_mfma_f32_16x16x16_bf16 v[116:119], v[24:25], v[50:51], v[116:119]
    s_waitcnt lgkmcnt(1)
    v_mfma_f32_16x16x16_bf16 v[120:123], v[26:27], v[50:51], v[120:123]
    s_waitcnt lgkmcnt(0)
    v_mfma_f32_16x16x16_bf16 v[124:127], v[28:29], v[50:51], v[124:127]
    s_add_u32 m0, s56, 0
    s_add_u32 s69, s57, 1441792
    buffer_load_dwordx4 v2, s[8:11], s69 offen offset:0 nt lds
    buffer_load_dwordx4 v3, s[8:11], s69 offen offset:1024 nt lds
    buffer_load_dwordx4 v4, s[8:11], s69 offen offset:2048 nt lds
    buffer_load_dwordx4 v5, s[8:11], s69 offen offset:3072 nt lds
    s_add_u32 m0, s56, 4096
    s_add_u32 s69, s69, 4096
    buffer_load_dwordx4 v2, s[8:11], s69 offen offset:0 nt lds
    buffer_load_dwordx4 v3, s[8:11], s69 offen offset:1024 nt lds
    buffer_load_dwordx4 v4, s[8:11], s69 offen offset:2048 nt lds
    buffer_load_dwordx4 v5, s[8:11], s69 offen offset:3072 nt lds
    s_waitcnt vmcnt(8)
    ds_read_b64_tr_b16 v[14:15], v6 offset:8192
    ds_read_b64_tr_b16 v[16:17], v7 offset:8192
    ds_read_b64_tr_b16 v[18:19], v8 offset:8192
    ds_read_b64_tr_b16 v[20:21], v9 offset:8192
    ds_read_b64_tr_b16 v[22:23], v10 offset:8192
    ds_read_b64_tr_b16 v[24:25], v11 offset:8192
    ds_read_b64_tr_b16 v[26:27], v12 offset:8192
    ds_read_b64_tr_b16 v[28:29], v13 offset:8192
    s_waitcnt lgkmcnt(7)
    v_mfma_f32_16x16x16_bf16 v[64:67], v[14:15], v[52:53], v[64:67]
    s_waitcnt lgkmcnt(6)
    v_mfma_f32_16x16x16_bf16 v[68:71], v[16:17], v[52:53], v[68:71]
    ds_read_b64_tr_b16 v[14:15], v6 offset:8448
    s_waitcnt lgkmcnt(6)
    v_mfma_f32_16x16x16_bf16 v[72:75], v[18:19], v[52:53], v[72:75]
    ds_read_b64_tr_b16 v[16:17], v7 offset:8448
    s_waitcnt lgkmcnt(6)
    v_mfma_f32_16x16x16_bf16 v[76:79], v[20:21], v[52:53], v[76:79]
    ds_read_b64_tr_b16 v[18:19], v8 offset:8448
    s_waitcnt lgkmcnt(6)
    v_mfma_f32_16x16x16_bf16 v[80:83], v[22:23], v[52:53], v[80:83]
    ds_read_b64_tr_b16 v[20:21], v9 offset:8448
    s_waitcnt lgkmcnt(6)
    v_mfma_f32_16x16x16_bf16 v[84:87], v[24:25], v[52:53], v[84:87]
    ds_read_b64_tr_b16 v[22:23], v10 offset:8448
    s_waitcnt lgkmcnt(6)
    v_mfma_f32_16x16x16_bf16 v[88:91], v[26:27], v[52:53], v[88:91]
    ds_read_b64_tr_b16 v[24:25], v11 offset:8448
    s_waitcnt lgkmcnt(6)
    v_mfma_f32_16x16x16_bf16 v[92:95], v[28:29], v[52:53], v[92:95]
    ds_read_b64_tr_b16 v[26:27], v12 offset:8448
    s_waitcnt lgkmcnt(6)
    v_mfma_f32_16x16x16_bf16 v[96:99], v[14:15], v[52:53], v[96:99]
    ds_read_b64_tr_b16 v[28:29], v13 offset:8448
    s_waitcnt lgkmcnt(6)
    v_mfma_f32_16x16x16_bf16 v[100:103], v[16:17], v[52:53], v[100:103]
    s_waitcnt lgkmcnt(5)
    v_mfma_f32_16x16x16_bf16 v[104:107], v[18:19], v[52:53], v[104:107]
    s_waitcnt lgkmcnt(4)
    v_mfma_f32_16x16x16_bf16 v[108:111], v[20:21], v[52:53], v[108:111]
    s_waitcnt lgkmcnt(3)
    v_mfma_f32_16x16x16_bf16 v[112:115], v[22:23], v[52:53], v[112:115]
    s_waitcnt lgkmcnt(2)
    v_mfma_f32_16x16x16_bf16 v[116:119], v[24:25], v[52:53], v[116:119]
    s_waitcnt lgkmcnt(1)
    v_mfma_f32_16x16x16_bf16 v[120:123], v[26:27], v[52:53], v[120:123]
    s_waitcnt lgkmcnt(0)
    v_mfma_f32_16x16x16_bf16 v[124:127], v[28:29], v[52:53], v[124:127]
    s_add_u32 m0, s56, 8192
    s_add_u32 s69, s57, 1572864
    buffer_load_dwordx4 v2, s[8:11], s69 offen offset:0 nt lds
    buffer_load_dwordx4 v3, s[8:11], s69 offen offset:1024 nt lds
    buffer_load_dwordx4 v4, s[8:11], s69 offen offset:2048 nt lds
    buffer_load_dwordx4 v5, s[8:11], s69 offen offset:3072 nt lds
    s_add_u32 m0, s56, 12288
    s_add_u32 s69, s69, 4096
    buffer_load_dwordx4 v2, s[8:11], s69 offen offset:0 nt lds
    buffer_load_dwordx4 v3, s[8:11], s69 offen offset:1024 nt lds
    buffer_load_dwordx4 v4, s[8:11], s69 offen offset:2048 nt lds
    buffer_load_dwordx4 v5, s[8:11], s69 offen offset:3072 nt lds
    s_waitcnt vmcnt(8)
    ds_read_b64_tr_b16 v[14:15], v6 offset:0
    ds_read_b64_tr_b16 v[16:17], v7 offset:0
    ds_read_b64_tr_b16 v[18:19], v8 offset:0
    ds_read_b64_tr_b16 v[20:21], v9 offset:0
    ds_read_b64_tr_b16 v[22:23], v10 offset:0
    ds_read_b64_tr_b16 v[24:25], v11 offset:0
    ds_read_b64_tr_b16 v[26:27], v12 offset:0
    ds_read_b64_tr_b16 v[28:29], v13 offset:0
    s_waitcnt lgkmcnt(7)
    v_mfma_f32_16x16x16_bf16 v[64:67], v[14:15], v[54:55], v[64:67]
    s_waitcnt lgkmcnt(6)
    v_mfma_f32_16x16x16_bf16 v[68:71], v[16:17], v[54:55], v[68:71]
    ds_read_b64_tr_b16 v[14:15], v6 offset:256
    s_waitcnt lgkmcnt(6)
    v_mfma_f32_16x16x16_bf16 v[72:75], v[18:19], v[54:55], v[72:75]
    ds_read_b64_tr_b16 v[16:17], v7 offset:256
    s_waitcnt lgkmcnt(6)
    v_mfma_f32_16x16x16_bf16 v[76:79], v[20:21], v[54:55], v[76:79]
    ds_read_b64_tr_b16 v[18:19], v8 offset:256
    s_waitcnt lgkmcnt(6)
    v_mfma_f32_16x16x16_bf16 v[80:83], v[22:23], v[54:55], v[80:83]
    ds_read_b64_tr_b16 v[20:21], v9 offset:256
    s_waitcnt lgkmcnt(6)
    v_mfma_f32_16x16x16_bf16 v[84:87], v[24:25], v[54:55], v[84:87]
    ds_read_b64_tr_b16 v[22:23], v10 offset:256
    s_waitcnt lgkmcnt(6)
    v_mfma_f32_16x16x16_bf16 v[88:91], v[26:27], v[54:55], v[88:91]
    ds_read_b64_tr_b16 v[24:25], v11 offset:256
    s_waitcnt lgkmcnt(6)
    v_mfma_f32_16x16x16_bf16 v[92:95], v[28:29], v[54:55], v[92:95]
    ds_read_b64_tr_b16 v[26:27], v12 offset:256
    s_waitcnt lgkmcnt(6)
    v_mfma_f32_16x16x16_bf16 v[96:99], v[14:15], v[54:55], v[96:99]
    ds_read_b64_tr_b16 v[28:29], v13 offset:256
    s_waitcnt lgkmcnt(6)
    v_mfma_f32_16x16x16_bf16 v[100:103], v[16:17], v[54:55], v[100:103]
    s_waitcnt lgkmcnt(5)
    v_mfma_f32_16x16x16_bf16 v[104:107], v[18:19], v[54:55], v[104:107]
    s_waitcnt lgkmcnt(4)
    v_mfma_f32_16x16x16_bf16 v[108:111], v[20:21], v[54:55], v[108:111]
    s_waitcnt lgkmcnt(3)
    v_mfma_f32_16x16x16_bf16 v[112:115], v[22:23], v[54:55], v[112:115]
    s_waitcnt lgkmcnt(2)
    v_mfma_f32_16x16x16_bf16 v[116:119], v[24:25], v[54:55], v[116:119]
    s_waitcnt lgkmcnt(1)
    v_mfma_f32_16x16x16_bf16 v[120:123], v[26:27], v[54:55], v[120:123]
    s_waitcnt lgkmcnt(0)
    v_mfma_f32_16x16x16_bf16 v[124:127], v[28:29], v[54:55], v[124:127]
    s_add_u32 m0, s56, 0
    s_add_u32 s69, s57, 1703936
    buffer_load_dwordx4 v2, s[8:11], s69 offen offset:0 nt lds
    buffer_load_dwordx4 v3, s[8:11], s69 offen offset:1024 nt lds
    buffer_load_dwordx4 v4, s[8:11], s69 offen offset:2048 nt lds
    buffer_load_dwordx4 v5, s[8:11], s69 offen offset:3072 nt lds
    s_add_u32 m0, s56, 4096
    s_add_u32 s69, s69, 4096
    buffer_load_dwordx4 v2, s[8:11], s69 offen offset:0 nt lds
    buffer_load_dwordx4 v3, s[8:11], s69 offen offset:1024 nt lds
    buffer_load_dwordx4 v4, s[8:11], s69 offen offset:2048 nt lds
    buffer_load_dwordx4 v5, s[8:11], s69 offen offset:3072 nt lds
    s_waitcnt vmcnt(8)
    ds_read_b64_tr_b16 v[14:15], v6 offset:8192
    ds_read_b64_tr_b16 v[16:17], v7 offset:8192
    ds_read_b64_tr_b16 v[18:19], v8 offset:8192
    ds_read_b64_tr_b16 v[20:21], v9 offset:8192
    ds_read_b64_tr_b16 v[22:23], v10 offset:8192
    ds_read_b64_tr_b16 v[24:25], v11 offset:8192
    ds_read_b64_tr_b16 v[26:27], v12 offset:8192
    ds_read_b64_tr_b16 v[28:29], v13 offset:8192
    s_waitcnt lgkmcnt(7)
    v_mfma_f32_16x16x16_bf16 v[64:67], v[14:15], v[56:57], v[64:67]
    s_waitcnt lgkmcnt(6)
    v_mfma_f32_16x16x16_bf16 v[68:71], v[16:17], v[56:57], v[68:71]
    ds_read_b64_tr_b16 v[14:15], v6 offset:8448
    s_waitcnt lgkmcnt(6)
    v_mfma_f32_16x16x16_bf16 v[72:75], v[18:19], v[56:57], v[72:75]
    ds_read_b64_tr_b16 v[16:17], v7 offset:8448
    s_waitcnt lgkmcnt(6)
    v_mfma_f32_16x16x16_bf16 v[76:79], v[20:21], v[56:57], v[76:79]
    ds_read_b64_tr_b16 v[18:19], v8 offset:8448
    s_waitcnt lgkmcnt(6)
    v_mfma_f32_16x16x16_bf16 v[80:83], v[22:23], v[56:57], v[80:83]
    ds_read_b64_tr_b16 v[20:21], v9 offset:8448
    s_waitcnt lgkmcnt(6)
    v_mfma_f32_16x16x16_bf16 v[84:87], v[24:25], v[56:57], v[84:87]
    ds_read_b64_tr_b16 v[22:23], v10 offset:8448
    s_waitcnt lgkmcnt(6)
    v_mfma_f32_16x16x16_bf16 v[88:91], v[26:27], v[56:57], v[88:91]
    ds_read_b64_tr_b16 v[24:25], v11 offset:8448
    s_waitcnt lgkmcnt(6)
    v_mfma_f32_16x16x16_bf16 v[92:95], v[28:29], v[56:57], v[92:95]
    ds_read_b64_tr_b16 v[26:27], v12 offset:8448
    s_waitcnt lgkmcnt(6)
    v_mfma_f32_16x16x16_bf16 v[96:99], v[14:15], v[56:57], v[96:99]
    ds_read_b64_tr_b16 v[28:29], v13 offset:8448
    s_waitcnt lgkmcnt(6)
    v_mfma_f32_16x16x16_bf16 v[100:103], v[16:17], v[56:57], v[100:103]
    s_waitcnt lgkmcnt(5)
    v_mfma_f32_16x16x16_bf16 v[104:107], v[18:19], v[56:57], v[104:107]
    s_waitcnt lgkmcnt(4)
    v_mfma_f32_16x16x16_bf16 v[108:111], v[20:21], v[56:57], v[108:111]
    s_waitcnt lgkmcnt(3)
    v_mfma_f32_16x16x16_bf16 v[112:115], v[22:23], v[56:57], v[112:115]
    s_waitcnt lgkmcnt(2)
    v_mfma_f32_16x16x16_bf16 v[116:119], v[24:25], v[56:57], v[116:119]
    s_waitcnt lgkmcnt(1)
    v_mfma_f32_16x16x16_bf16 v[120:123], v[26:27], v[56:57], v[120:123]
    s_waitcnt lgkmcnt(0)
    v_mfma_f32_16x16x16_bf16 v[124:127], v[28:29], v[56:57], v[124:127]
    s_add_u32 m0, s56, 8192
    s_add_u32 s69, s57, 1835008
    buffer_load_dwordx4 v2, s[8:11], s69 offen offset:0 nt lds
    buffer_load_dwordx4 v3, s[8:11], s69 offen offset:1024 nt lds
    buffer_load_dwordx4 v4, s[8:11], s69 offen offset:2048 nt lds
    buffer_load_dwordx4 v5, s[8:11], s69 offen offset:3072 nt lds
    s_add_u32 m0, s56, 12288
    s_add_u32 s69, s69, 4096
    buffer_load_dwordx4 v2, s[8:11], s69 offen offset:0 nt lds
    buffer_load_dwordx4 v3, s[8:11], s69 offen offset:1024 nt lds
    buffer_load_dwordx4 v4, s[8:11], s69 offen offset:2048 nt lds
    buffer_load_dwordx4 v5, s[8:11], s69 offen offset:3072 nt lds
    s_lshl_b32 s69, s54, 2
    s_add_u32 s69, s69, 135248
    v_mov_b32 v30, s69
    v_mov_b32 v31, 1
    ds_write_b32 v30, v31
    s_waitcnt vmcnt(8)
    ds_read_b64_tr_b16 v[14:15], v6 offset:0
    ds_read_b64_tr_b16 v[16:17], v7 offset:0
    ds_read_b64_tr_b16 v[18:19], v8 offset:0
    ds_read_b64_tr_b16 v[20:21], v9 offset:0
    ds_read_b64_tr_b16 v[22:23], v10 offset:0
    ds_read_b64_tr_b16 v[24:25], v11 offset:0
    ds_read_b64_tr_b16 v[26:27], v12 offset:0
    ds_read_b64_tr_b16 v[28:29], v13 offset:0
    s_waitcnt lgkmcnt(7)
    v_mfma_f32_16x16x16_bf16 v[64:67], v[14:15], v[58:59], v[64:67]
    s_waitcnt lgkmcnt(6)
    v_mfma_f32_16x16x16_bf16 v[68:71], v[16:17], v[58:59], v[68:71]
    ds_read_b64_tr_b16 v[14:15], v6 offset:256
    s_waitcnt lgkmcnt(6)
    v_mfma_f32_16x16x16_bf16 v[72:75], v[18:19], v[58:59], v[72:75]
    ds_read_b64_tr_b16 v[16:17], v7 offset:256
    s_waitcnt lgkmcnt(6)
    v_mfma_f32_16x16x16_bf16 v[76:79], v[20:21], v[58:59], v[76:79]
    ds_read_b64_tr_b16 v[18:19], v8 offset:256
    s_waitcnt lgkmcnt(6)
    v_mfma_f32_16x16x16_bf16 v[80:83], v[22:23], v[58:59], v[80:83]
    ds_read_b64_tr_b16 v[20:21], v9 offset:256
    s_waitcnt lgkmcnt(6)
    v_mfma_f32_16x16x16_bf16 v[84:87], v[24:25], v[58:59], v[84:87]
    ds_read_b64_tr_b16 v[22:23], v10 offset:256
    s_waitcnt lgkmcnt(6)
    v_mfma_f32_16x16x16_bf16 v[88:91], v[26:27], v[58:59], v[88:91]
    ds_read_b64_tr_b16 v[24:25], v11 offset:256
    s_waitcnt lgkmcnt(6)
    v_mfma_f32_16x16x16_bf16 v[92:95], v[28:29], v[58:59], v[92:95]
    ds_read_b64_tr_b16 v[26:27], v12 offset:256
    s_waitcnt lgkmcnt(6)
    v_mfma_f32_16x16x16_bf16 v[96:99], v[14:15], v[58:59], v[96:99]
    ds_read_b64_tr_b16 v[28:29], v13 offset:256
    s_waitcnt lgkmcnt(6)
    v_mfma_f32_16x16x16_bf16 v[100:103], v[16:17], v[58:59], v[100:103]
    s_waitcnt lgkmcnt(5)
    v_mfma_f32_16x16x16_bf16 v[104:107], v[18:19], v[58:59], v[104:107]
    s_waitcnt lgkmcnt(4)
    v_mfma_f32_16x16x16_bf16 v[108:111], v[20:21], v[58:59], v[108:111]
    s_waitcnt lgkmcnt(3)
    v_mfma_f32_16x16x16_bf16 v[112:115], v[22:23], v[58:59], v[112:115]
    s_waitcnt lgkmcnt(2)
    v_mfma_f32_16x16x16_bf16 v[116:119], v[24:25], v[58:59], v[116:119]
    s_waitcnt lgkmcnt(1)
    v_mfma_f32_16x16x16_bf16 v[120:123], v[26:27], v[58:59], v[120:123]
    s_waitcnt lgkmcnt(0)
    v_mfma_f32_16x16x16_bf16 v[124:127], v[28:29], v[58:59], v[124:127]
    s_add_u32 m0, s56, 0
    s_add_u32 s69, s57, 1966080
    buffer_load_dwordx4 v2, s[8:11], s69 offen offset:0 nt lds
    buffer_load_dwordx4 v3, s[8:11], s69 offen offset:1024 nt lds
    buffer_load_dwordx4 v4, s[8:11], s69 offen offset:2048 nt lds
    buffer_load_dwordx4 v5, s[8:11], s69 offen offset:3072 nt lds
    s_add_u32 m0, s56, 4096
    s_add_u32 s69, s69, 4096
    buffer_load_dwordx4 v2, s[8:11], s69 offen offset:0 nt lds
    buffer_load_dwordx4 v3, s[8:11], s69 offen offset:1024 nt lds
    buffer_load_dwordx4 v4, s[8:11], s69 offen offset:2048 nt lds
    buffer_load_dwordx4 v5, s[8:11], s69 offen offset:3072 nt lds
    s_waitcnt vmcnt(8)
    ds_read_b64_tr_b16 v[14:15], v6 offset:8192
    ds_read_b64_tr_b16 v[16:17], v7 offset:8192
    ds_read_b64_tr_b16 v[18:19], v8 offset:8192
    ds_read_b64_tr_b16 v[20:21], v9 offset:8192
    ds_read_b64_tr_b16 v[22:23], v10 offset:8192
    ds_read_b64_tr_b16 v[24:25], v11 offset:8192
    ds_read_b64_tr_b16 v[26:27], v12 offset:8192
    ds_read_b64_tr_b16 v[28:29], v13 offset:8192
    s_waitcnt lgkmcnt(7)
    v_mfma_f32_16x16x16_bf16 v[64:67], v[14:15], v[60:61], v[64:67]
    s_waitcnt lgkmcnt(6)
    v_mfma_f32_16x16x16_bf16 v[68:71], v[16:17], v[60:61], v[68:71]
    ds_read_b64_tr_b16 v[14:15], v6 offset:8448
    s_waitcnt lgkmcnt(6)
    v_mfma_f32_16x16x16_bf16 v[72:75], v[18:19], v[60:61], v[72:75]
    ds_read_b64_tr_b16 v[16:17], v7 offset:8448
    s_waitcnt lgkmcnt(6)
    v_mfma_f32_16x16x16_bf16 v[76:79], v[20:21], v[60:61], v[76:79]
    ds_read_b64_tr_b16 v[18:19], v8 offset:8448
    s_waitcnt lgkmcnt(6)
    v_mfma_f32_16x16x16_bf16 v[80:83], v[22:23], v[60:61], v[80:83]
    ds_read_b64_tr_b16 v[20:21], v9 offset:8448
    s_waitcnt lgkmcnt(6)
    v_mfma_f32_16x16x16_bf16 v[84:87], v[24:25], v[60:61], v[84:87]
    ds_read_b64_tr_b16 v[22:23], v10 offset:8448
    s_waitcnt lgkmcnt(6)
    v_mfma_f32_16x16x16_bf16 v[88:91], v[26:27], v[60:61], v[88:91]
    ds_read_b64_tr_b16 v[24:25], v11 offset:8448
    s_waitcnt lgkmcnt(6)
    v_mfma_f32_16x16x16_bf16 v[92:95], v[28:29], v[60:61], v[92:95]
    ds_read_b64_tr_b16 v[26:27], v12 offset:8448
    s_waitcnt lgkmcnt(6)
    v_mfma_f32_16x16x16_bf16 v[96:99], v[14:15], v[60:61], v[96:99]
    ds_read_b64_tr_b16 v[28:29], v13 offset:8448
    s_waitcnt lgkmcnt(6)
    v_mfma_f32_16x16x16_bf16 v[100:103], v[16:17], v[60:61], v[100:103]
    s_waitcnt lgkmcnt(5)
    v_mfma_f32_16x16x16_bf16 v[104:107], v[18:19], v[60:61], v[104:107]
    s_waitcnt lgkmcnt(4)
    v_mfma_f32_16x16x16_bf16 v[108:111], v[20:21], v[60:61], v[108:111]
    s_waitcnt lgkmcnt(3)
    v_mfma_f32_16x16x16_bf16 v[112:115], v[22:23], v[60:61], v[112:115]
    s_waitcnt lgkmcnt(2)
    v_mfma_f32_16x16x16_bf16 v[116:119], v[24:25], v[60:61], v[116:119]
    s_waitcnt lgkmcnt(1)
    v_mfma_f32_16x16x16_bf16 v[120:123], v[26:27], v[60:61], v[120:123]
    s_waitcnt lgkmcnt(0)
    v_mfma_f32_16x16x16_bf16 v[124:127], v[28:29], v[60:61], v[124:127]
    s_add_u32 m0, s56, 8192
    s_add_u32 s69, s57, 655360
    buffer_load_dwordx4 v2, s[12:15], s69 offen offset:0 nt lds
    buffer_load_dwordx4 v3, s[12:15], s69 offen offset:1024 nt lds
    buffer_load_dwordx4 v4, s[12:15], s69 offen offset:2048 nt lds
    buffer_load_dwordx4 v5, s[12:15], s69 offen offset:3072 nt lds
    s_add_u32 m0, s56, 12288
    s_add_u32 s69, s69, 4096
    buffer_load_dwordx4 v2, s[12:15], s69 offen offset:0 nt lds
    buffer_load_dwordx4 v3, s[12:15], s69 offen offset:1024 nt lds
    buffer_load_dwordx4 v4, s[12:15], s69 offen offset:2048 nt lds
    buffer_load_dwordx4 v5, s[12:15], s69 offen offset:3072 nt lds
    s_waitcnt vmcnt(8)
    ds_read_b64_tr_b16 v[14:15], v6 offset:0
    ds_read_b64_tr_b16 v[16:17], v7 offset:0
    ds_read_b64_tr_b16 v[18:19], v8 offset:0
    ds_read_b64_tr_b16 v[20:21], v9 offset:0
    ds_read_b64_tr_b16 v[22:23], v10 offset:0
    ds_read_b64_tr_b16 v[24:25], v11 offset:0
    ds_read_b64_tr_b16 v[26:27], v12 offset:0
    ds_read_b64_tr_b16 v[28:29], v13 offset:0
    s_waitcnt lgkmcnt(7)
    v_mfma_f32_16x16x16_bf16 v[64:67], v[14:15], v[62:63], v[64:67]
    s_waitcnt lgkmcnt(6)
    v_mfma_f32_16x16x16_bf16 v[68:71], v[16:17], v[62:63], v[68:71]
    ds_read_b64_tr_b16 v[14:15], v6 offset:256
    s_waitcnt lgkmcnt(6)
    v_mfma_f32_16x16x16_bf16 v[72:75], v[18:19], v[62:63], v[72:75]
    ds_read_b64_tr_b16 v[16:17], v7 offset:256
    s_waitcnt lgkmcnt(6)
    v_mfma_f32_16x16x16_bf16 v[76:79], v[20:21], v[62:63], v[76:79]
    ds_read_b64_tr_b16 v[18:19], v8 offset:256
    s_waitcnt lgkmcnt(6)
    v_mfma_f32_16x16x16_bf16 v[80:83], v[22:23], v[62:63], v[80:83]
    ds_read_b64_tr_b16 v[20:21], v9 offset:256
    s_waitcnt lgkmcnt(6)
    v_mfma_f32_16x16x16_bf16 v[84:87], v[24:25], v[62:63], v[84:87]
    ds_read_b64_tr_b16 v[22:23], v10 offset:256
    s_waitcnt lgkmcnt(6)
    v_mfma_f32_16x16x16_bf16 v[88:91], v[26:27], v[62:63], v[88:91]
    ds_read_b64_tr_b16 v[24:25], v11 offset:256
    s_waitcnt lgkmcnt(6)
    v_mfma_f32_16x16x16_bf16 v[92:95], v[28:29], v[62:63], v[92:95]
    ds_read_b64_tr_b16 v[26:27], v12 offset:256
    s_waitcnt lgkmcnt(6)
    v_mfma_f32_16x16x16_bf16 v[96:99], v[14:15], v[62:63], v[96:99]
    ds_read_b64_tr_b16 v[28:29], v13 offset:256
    s_waitcnt lgkmcnt(6)
    v_mfma_f32_16x16x16_bf16 v[100:103], v[16:17], v[62:63], v[100:103]
    s_waitcnt lgkmcnt(5)
    v_mfma_f32_16x16x16_bf16 v[104:107], v[18:19], v[62:63], v[104:107]
    s_waitcnt lgkmcnt(4)
    v_mfma_f32_16x16x16_bf16 v[108:111], v[20:21], v[62:63], v[108:111]
    s_waitcnt lgkmcnt(3)
    v_mfma_f32_16x16x16_bf16 v[112:115], v[22:23], v[62:63], v[112:115]
    s_waitcnt lgkmcnt(2)
    v_mfma_f32_16x16x16_bf16 v[116:119], v[24:25], v[62:63], v[116:119]
    s_waitcnt lgkmcnt(1)
    v_mfma_f32_16x16x16_bf16 v[120:123], v[26:27], v[62:63], v[120:123]
    s_waitcnt lgkmcnt(0)
    v_mfma_f32_16x16x16_bf16 v[124:127], v[28:29], v[62:63], v[124:127]
    v_and_b32 v30, 1, v1
    v_lshlrev_b32 v30, 10, v30
    v_lshrrev_b32 v31, 4, v1
    v_lshl_add_u32 v30, v31, 4, v30
    s_lshl_b32 s69, s52, 11
    s_add_u32 s69, s69, 126976
    v_add_u32 v30, s69, v30
    s_nop 7
    s_mov_b64 exec, s[70:71]
    ds_write_b128 v30, v[64:67] offset:0
    ds_write_b128 v30, v[68:71] offset:64
    ds_write_b128 v30, v[72:75] offset:128
    ds_write_b128 v30, v[76:79] offset:192
    ds_write_b128 v30, v[80:83] offset:256
    ds_write_b128 v30, v[84:87] offset:320
    ds_write_b128 v30, v[88:91] offset:384
    ds_write_b128 v30, v[92:95] offset:448
    ds_write_b128 v30, v[96:99] offset:512
    ds_write_b128 v30, v[100:103] offset:576
    ds_write_b128 v30, v[104:107] offset:640
    ds_write_b128 v30, v[108:111] offset:704
    s_waitcnt lgkmcnt(4)
    ds_write_b128 v30, v[112:115] offset:768
    ds_write_b128 v30, v[116:119] offset:832
    ds_write_b128 v30, v[120:123] offset:896
    ds_write_b128 v30, v[124:127] offset:960
    s_mov_b64 exec, -1
    s_waitcnt lgkmcnt(0)
    v_mov_b32 v30, s84
    v_mov_b32 v31, 2
    ds_write_b32 v30, v31
    v_mov_b32 v30, s85
Lps_9:
    ds_read_b32 v31, v30
    s_waitcnt lgkmcnt(0)
    v_cmp_gt_u32 vcc, 2, v31
    s_cbranch_vccz Lpd_10
    s_cmp_eq_u32 s83, 0
    s_cbranch_scc1 Lpd_10
    s_sub_u32 s83, s83, 1
    s_branch Lps_9
Lpd_10:
    s_lshl_b32 s69, s54, 5
    s_lshl_b32 s72, s82, 3
    s_add_u32 s69, s69, s72
    s_add_u32 s69, s69, 135168
    v_mov_b32 v30, s69
    s_mul_i32 s69, s54, 4096
    s_lshl_b32 s72, s82, 10
    s_add_u32 s69, s69, s72
    s_add_u32 s69, s69, 126976
    v_and_b32 v31, 31, v1
    v_lshlrev_b32 v31, 5, v31
    v_add_u32 v31, s69, v31
    ds_read_b64 v[32:33], v30 offset:0
    ds_read_b64 v[34:35], v30 offset:16
    ds_read_b128 v[40:43], v31 offset:0
    ds_read_b128 v[44:47], v31 offset:16
    ds_read_b128 v[48:51], v31 offset:2048
    ds_read_b128 v[52:55], v31 offset:2064
    v_lshlrev_b32 v56, 4, v1
    v_cmp_gt_u32 vcc, 32, v1
    v_mov_b32 v58, 2147483648
    s_nop 0
    v_cndmask_b32 v56, v58, v56, vcc
    v_cmp_eq_u32 vcc, 0, v1
    v_mov_b32 v57, 0
    s_nop 0
    v_cndmask_b32 v57, v58, v57, vcc
    s_waitcnt lgkmcnt(4)
    v_max_f32 v36, v32, v34
    v_sub_f32 v32, v32, v36
    v_sub_f32 v34, v34, v36
    v_exp_f32 v32, v32
    v_exp_f32 v34, v34
    s_nop 0
    v_mul_f32 v37, v32, v33
    v_fmac_f32 v37, v34, v35
    s_waitcnt lgkmcnt(0)
    v_mul_f32 v40, v40, v32
    v_mul_f32 v41, v41, v32
    v_mul_f32 v42, v42, v32
    v_mul_f32 v43, v43, v32
    v_mul_f32 v44, v44, v32
    v_mul_f32 v45, v45, v32
    v_mul_f32 v46, v46, v32
    v_mul_f32 v47, v47, v32
    v_fmac_f32 v40, v48, v34
    v_fmac_f32 v41, v49, v34
    v_fmac_f32 v42, v50, v34
    v_fmac_f32 v43, v51, v34
    v_fmac_f32 v44, v52, v34
    v_fmac_f32 v45, v53, v34
    v_fmac_f32 v46, v54, v34
    v_fmac_f32 v47, v55, v34
    v_cvt_pk_bf16_f32 v48, v40, v41
    v_cvt_pk_bf16_f32 v49, v42, v43
    v_cvt_pk_bf16_f32 v50, v44, v45
    v_cvt_pk_bf16_f32 v51, v46, v47
    v_min_u32 v48, -2, v48
    v_min_u32 v49, -2, v49
    v_min_u32 v50, -2, v50
    v_min_u32 v51, -2, v51
    s_add_u32 s72, s76, 0
    s_add_u32 s73, s77, 0
    s_cmp_eq_u32 s100, 0
    s_cbranch_scc1 Lwt_11
    buffer_store_dwordx4 v[48:51], v56, s[36:39], s72 offen
    buffer_store_dwordx2 v[36:37], v57, s[36:39], s73 offen
    s_branch Lwd_12
Lwt_11:
    buffer_store_dwordx4 v[48:51], v56, s[36:39], s72 offen sc1
    buffer_store_dwordx2 v[36:37], v57, s[36:39], s73 offen sc1
Lwd_12:
    s_nop 1
    v_and_b32 v6, 15, v1
    v_lshlrev_b32 v7, 8, v6
    v_lshlrev_b32 v6, 9, v6
    v_lshrrev_b32 v30, 4, v1
    v_lshl_add_u32 v6, v30, 4, v6
    s_lshl_b32 s69, s82, 14
    s_add_u32 s72, s61, 0
    s_add_u32 s72, s72, s69
    s_add_u32 s73, s62, 0
    buffer_load_dwordx2 v[22:23], v7, s[36:39], s73 offen offset:0 sc1
    buffer_load_dwordx4 v[32:35], v6, s[36:39], s72 offen offset:0 sc1
    buffer_load_dwordx4 v[36:39], v6, s[36:39], s72 offen offset:64 sc1
    buffer_load_dwordx4 v[40:43], v6, s[36:39], s72 offen offset:128 sc1
    buffer_load_dwordx4 v[44:47], v6, s[36:39], s72 offen offset:192 sc1
    buffer_load_dwordx4 v[48:51], v6, s[36:39], s72 offen offset:256 sc1
    buffer_load_dwordx4 v[52:55], v6, s[36:39], s72 offen offset:320 sc1
    buffer_load_dwordx4 v[56:59], v6, s[36:39], s72 offen offset:384 sc1
    buffer_load_dwordx4 v[60:63], v6, s[36:39], s72 offen offset:448 sc1
    s_add_u32 s79, s73, 4096
    buffer_load_dwordx2 v[24:25], v7, s[36:39], s79 offen sc1
    s_add_u32 s79, s72, 8192
    buffer_load_dwordx4 v[64:67], v6, s[36:39], s79 offen offset:0 sc1
    buffer_load_dwordx4 v[68:71], v6, s[36:39], s79 offen offset:64 sc1
    buffer_load_dwordx4 v[72:75], v6, s[36:39], s79 offen offset:128 sc1
    buffer_load_dwordx4 v[76:79], v6, s[36:39], s79 offen offset:192 sc1
    buffer_load_dwordx4 v[80:83], v6, s[36:39], s79 offen offset:256 sc1
    buffer_load_dwordx4 v[84:87], v6, s[36:39], s79 offen offset:320 sc1
    buffer_load_dwordx4 v[88:91], v6, s[36:39], s79 offen offset:384 sc1
    buffer_load_dwordx4 v[92:95], v6, s[36:39], s79 offen offset:448 sc1
    s_lshl_b32 s69, s82, 2
    s_add_u32 s69, s69, 135256
    v_mov_b32 v30, s69
Llw_15:
    ds_read_b32 v31, v30
    s_waitcnt lgkmcnt(0)
    v_cmp_gt_u32 vcc, 1, v31
    s_cbranch_vccz Llwd_16
    s_cmp_eq_u32 s83, 0
    s_cbranch_scc1 Llwd_16
    s_sub_u32 s83, s83, 1
    s_sleep 2
    s_branch Llw_15
Llwd_16:
    s_add_u32 m0, s56, 0
    s_add_u32 s69, s57, 786432
    buffer_load_dwordx4 v2, s[12:15], s69 offen offset:0 nt lds
    buffer_load_dwordx4 v3, s[12:15], s69 offen offset:1024 nt lds
    buffer_load_dwordx4 v4, s[12:15], s69 offen offset:2048 nt lds
    buffer_load_dwordx4 v5, s[12:15], s69 offen offset:3072 nt lds
    s_add_u32 m0, s56, 4096
    s_add_u32 s69, s69, 4096
    buffer_load_dwordx4 v2, s[12:15], s69 offen offset:0 nt lds
    buffer_load_dwordx4 v3, s[12:15], s69 offen offset:1024 nt lds
    buffer_load_dwordx4 v4, s[12:15], s69 offen offset:2048 nt lds
    buffer_load_dwordx4 v5, s[12:15], s69 offen offset:3072 nt lds
    v_lshrrev_b32 v8, 4, v1
    v_lshlrev_b32 v8, 8, v8
    v_bfe_u32 v9, v1, 2, 2
    v_lshl_add_u32 v8, v9, 5, v8
    v_and_b32 v9, 3, v1
    v_lshl_add_u32 v8, v9, 3, v8
    s_mul_i32 s69, s82, 8192
    s_add_u32 s69, s69, 65536
    v_add_u32 v8, s69, v8
    ds_read_b64_tr_b16 v[96:97], v8 offset:0
    ds_read_b64_tr_b16 v[98:99], v8 offset:128
    ds_read_b64_tr_b16 v[100:101], v8 offset:1024
    ds_read_b64_tr_b16 v[102:103], v8 offset:1152
    ds_read_b64_tr_b16 v[104:105], v8 offset:2048
    ds_read_b64_tr_b16 v[106:107], v8 offset:2176
    ds_read_b64_tr_b16 v[108:109], v8 offset:3072
    ds_read_b64_tr_b16 v[110:111], v8 offset:3200
    s_waitcnt lgkmcnt(4)
    ds_read_b64_tr_b16 v[112:113], v8 offset:4096
    ds_read_b64_tr_b16 v[114:115], v8 offset:4224
    ds_read_b64_tr_b16 v[116:117], v8 offset:5120
    ds_read_b64_tr_b16 v[118:119], v8 offset:5248
    ds_read_b64_tr_b16 v[120:121], v8 offset:6144
    ds_read_b64_tr_b16 v[122:123], v8 offset:6272
    ds_read_b64_tr_b16 v[124:125], v8 offset:7168
    ds_read_b64_tr_b16 v[126:127], v8 offset:7296
    s_waitcnt lgkmcnt(0)
    s_waitcnt vmcnt(8)
Lpolls1_0_13:
    s_mov_b32 s90, 0
    v_max3_u32 v31, v22, v23, v32
    v_max3_u32 v31, v31, v33, v34
    v_max3_u32 v31, v31, v35, v36
    v_max3_u32 v31, v31, v37, v38
    v_max3_u32 v31, v31, v39, v40
    v_max3_u32 v31, v31, v41, v42
    v_max3_u32 v31, v31, v43, v44
    v_max3_u32 v31, v31, v45, v46
    v_max3_u32 v31, v31, v47, v48
    v_max3_u32 v31, v31, v49, v50
    v_max3_u32 v31, v31, v51, v52
    v_max3_u32 v31, v31, v53, v54
    v_max3_u32 v31, v31, v55, v56
    v_max3_u32 v31, v31, v57, v58
    v_max3_u32 v31, v31, v59, v60
    v_max3_u32 v31, v31, v61, v62
    v_max_u32 v31, v31, v63
    v_cmp_eq_u32 vcc, -1, v31
    s_cbranch_vccz Lsks1_0_17
    s_mov_b64 exec, vcc
    buffer_load_dwordx2 v[22:23], v7, s[36:39], s73 offen offset:0 sc1
    buffer_load_dwordx4 v[32:35], v6, s[36:39], s72 offen offset:0 sc1
    buffer_load_dwordx4 v[36:39], v6, s[36:39], s72 offen offset:64 sc1
    buffer_load_dwordx4 v[40:43], v6, s[36:39], s72 offen offset:128 sc1
    buffer_load_dwordx4 v[44:47], v6, s[36:39], s72 offen offset:192 sc1
    buffer_load_dwordx4 v[48:51], v6, s[36:39], s72 offen offset:256 sc1
    buffer_load_dwordx4 v[52:55], v6, s[36:39], s72 offen offset:320 sc1
    buffer_load_dwordx4 v[56:59], v6, s[36:39], s72 offen offset:384 sc1
    buffer_load_dwordx4 v[60:63], v6, s[36:39], s72 offen offset:448 sc1
    s_mov_b64 exec, -1
    s_mov_b32 s90, 1
Lsks1_0_17:
    v_max3_u32 v31, v24, v25, v64
    v_max3_u32 v31, v31, v65, v66
    v_max3_u32 v31, v31, v67, v68
    v_max3_u32 v31, v31, v69, v70
    v_max3_u32 v31, v31, v71, v72
    v_max3_u32 v31, v31, v73, v74
    v_max3_u32 v31, v31, v75, v76
    v_max3_u32 v31, v31, v77, v78
    v_max3_u32 v31, v31, v79, v80
    v_max3_u32 v31, v31, v81, v82
    v_max3_u32 v31, v31, v83, v84
    v_max3_u32 v31, v31, v85, v86
    v_max3_u32 v31, v31, v87, v88
    v_max3_u32 v31, v31, v89, v90
    v_max3_u32 v31, v31, v91, v92
    v_max3_u32 v31, v31, v93, v94
    v_max_u32 v31, v31, v95
    v_cmp_eq_u32 vcc, -1, v31
    s_cbranch_vccz Lsks1_0_18
    s_mov_b64 exec, vcc
    s_add_u32 s79, s73, 4096
    buffer_load_dwordx2 v[24:25], v7, s[36:39], s79 offen sc1
    s_add_u32 s79, s72, 8192
    buffer_load_dwordx4 v[64:67], v6, s[36:39], s79 offen offset:0 sc1
    buffer_load_dwordx4 v[68:71], v6, s[36:39], s79 offen offset:64 sc1
    buffer_load_dwordx4 v[72:75], v6, s[36:39], s79 offen offset:128 sc1
    buffer_load_dwordx4 v[76:79], v6, s[36:39], s79 offen offset:192 sc1
    buffer_load_dwordx4 v[80:83], v6, s[36:39], s79 offen offset:256 sc1
    buffer_load_dwordx4 v[84:87], v6, s[36:39], s79 offen offset:320 sc1
    buffer_load_dwordx4 v[88:91], v6, s[36:39], s79 offen offset:384 sc1
    buffer_load_dwordx4 v[92:95], v6, s[36:39], s79 offen offset:448 sc1
    s_mov_b64 exec, -1
    s_mov_b32 s90, 1
Lsks1_0_18:
    s_cmp_eq_u32 s90, 0
    s_cbranch_scc1 Ldones1_0_14
    s_waitcnt vmcnt(0)
    s_cmp_eq_u32 s65, 0
    s_cbranch_scc1 Ldones1_0_14
    s_sub_u32 s65, s65, 1
    s_sleep 1
    s_branch Lpolls1_0_13
Ldones1_0_14:
    v_mfma_f32_16x16x32_bf16 v[14:17], v[96:99], v[32:35], 0
    v_mfma_f32_16x16x32_bf16 v[18:21], v[96:99], v[64:67], 0
    v_mfma_f32_16x16x32_bf16 v[14:17], v[100:103], v[36:39], v[14:17]
    v_mfma_f32_16x16x32_bf16 v[18:21], v[100:103], v[68:71], v[18:21]
    v_mfma_f32_16x16x32_bf16 v[14:17], v[104:107], v[40:43], v[14:17]
    v_mfma_f32_16x16x32_bf16 v[18:21], v[104:107], v[72:75], v[18:21]
    v_mfma_f32_16x16x32_bf16 v[14:17], v[108:111], v[44:47], v[14:17]
    v_mfma_f32_16x16x32_bf16 v[18:21], v[108:111], v[76:79], v[18:21]
    v_mfma_f32_16x16x32_bf16 v[14:17], v[112:115], v[48:51], v[14:17]
    v_mfma_f32_16x16x32_bf16 v[18:21], v[112:115], v[80:83], v[18:21]
    v_mfma_f32_16x16x32_bf16 v[14:17], v[116:119], v[52:55], v[14:17]
    v_mfma_f32_16x16x32_bf16 v[18:21], v[116:119], v[84:87], v[18:21]
    v_mfma_f32_16x16x32_bf16 v[14:17], v[120:123], v[56:59], v[14:17]
    v_mfma_f32_16x16x32_bf16 v[18:21], v[120:123], v[88:91], v[18:21]
    v_mfma_f32_16x16x32_bf16 v[14:17], v[124:127], v[60:63], v[14:17]
    v_mfma_f32_16x16x32_bf16 v[18:21], v[124:127], v[92:95], v[18:21]
    v_mov_b32 v26, v22
    v_mov_b32 v27, v24
    s_nop 0
    v_max_f32_dpp v26, v26, v26 quad_perm:[1,0,3,2] row_mask:0xf bank_mask:0xf
    v_max_f32_dpp v27, v27, v27 quad_perm:[1,0,3,2] row_mask:0xf bank_mask:0xf
    s_nop 0
    v_max_f32_dpp v26, v26, v26 quad_perm:[2,3,0,1] row_mask:0xf bank_mask:0xf
    v_max_f32_dpp v27, v27, v27 quad_perm:[2,3,0,1] row_mask:0xf bank_mask:0xf
    s_nop 0
    v_max_f32_dpp v26, v26, v26 row_half_mirror row_mask:0xf bank_mask:0xf
    v_max_f32_dpp v27, v27, v27 row_half_mirror row_mask:0xf bank_mask:0xf
    v_sub_f32 v26, v22, v26
    v_sub_f32 v27, v24, v27
    v_exp_f32 v26, v26
    v_exp_f32 v27, v27
    s_nop 0
    v_mul_f32 v28, v26, v23
    v_mul_f32 v29, v27, v25
    s_nop 0
    v_add_f32_dpp v28, v28, v28 quad_perm:[1,0,3,2] row_mask:0xf bank_mask:0xf
    v_add_f32_dpp v29, v29, v29 quad_perm:[1,0,3,2] row_mask:0xf bank_mask:0xf
    s_nop 0
    v_add_f32_dpp v28, v28, v28 quad_perm:[2,3,0,1] row_mask:0xf bank_mask:0xf
    v_add_f32_dpp v29, v29, v29 quad_perm:[2,3,0,1] row_mask:0xf bank_mask:0xf
    s_nop 0
    v_add_f32_dpp v28, v28, v28 row_half_mirror row_mask:0xf bank_mask:0xf
    v_add_f32_dpp v29, v29, v29 row_half_mirror row_mask:0xf bank_mask:0xf
    v_rcp_f32 v28, v28
    v_rcp_f32 v29, v29
    s_nop 0
    v_mul_f32 v26, v26, v28
    v_mul_f32 v27, v27, v29
    v_bfe_u32 v30, v1, 3, 1
    v_lshlrev_b32 v30, 6, v30
    v_lshrrev_b32 v31, 4, v1
    v_lshl_add_u32 v30, v31, 4, v30
    s_lshl_b32 s69, s52, 8
    s_add_u32 s69, s69, 135424
    v_add_u32 v30, s69, v30
    s_nop 3
    v_mul_f32 v14, v14, v26
    v_mul_f32 v18, v18, v27
    v_mul_f32 v15, v15, v26
    v_mul_f32 v19, v19, v27
    v_mul_f32 v16, v16, v26
    v_mul_f32 v20, v20, v27
    v_mul_f32 v17, v17, v26
    v_mul_f32 v21, v21, v27
    v_add_f32_dpp v14, v14, v14 quad_perm:[1,0,3,2] row_mask:0xf bank_mask:0xf
    v_add_f32_dpp v15, v15, v15 quad_perm:[1,0,3,2] row_mask:0xf bank_mask:0xf
    v_add_f32_dpp v16, v16, v16 quad_perm:[1,0,3,2] row_mask:0xf bank_mask:0xf
    v_add_f32_dpp v17, v17, v17 quad_perm:[1,0,3,2] row_mask:0xf bank_mask:0xf
    v_add_f32_dpp v18, v18, v18 quad_perm:[1,0,3,2] row_mask:0xf bank_mask:0xf
    v_add_f32_dpp v19, v19, v19 quad_perm:[1,0,3,2] row_mask:0xf bank_mask:0xf
    v_add_f32_dpp v20, v20, v20 quad_perm:[1,0,3,2] row_mask:0xf bank_mask:0xf
    v_add_f32_dpp v21, v21, v21 quad_perm:[1,0,3,2] row_mask:0xf bank_mask:0xf
    v_add_f32_dpp v14, v14, v14 quad_perm:[2,3,0,1] row_mask:0xf bank_mask:0xf
    v_add_f32_dpp v15, v15, v15 quad_perm:[2,3,0,1] row_mask:0xf bank_mask:0xf
    v_add_f32_dpp v16, v16, v16 quad_perm:[2,3,0,1] row_mask:0xf bank_mask:0xf
    v_add_f32_dpp v17, v17, v17 quad_perm:[2,3,0,1] row_mask:0xf bank_mask:0xf
    v_add_f32_dpp v18, v18, v18 quad_perm:[2,3,0,1] row_mask:0xf bank_mask:0xf
    v_add_f32_dpp v19, v19, v19 quad_perm:[2,3,0,1] row_mask:0xf bank_mask:0xf
    v_add_f32_dpp v20, v20, v20 quad_perm:[2,3,0,1] row_mask:0xf bank_mask:0xf
    v_add_f32_dpp v21, v21, v21 quad_perm:[2,3,0,1] row_mask:0xf bank_mask:0xf
    v_add_f32_dpp v14, v14, v14 row_half_mirror row_mask:0xf bank_mask:0xf
    v_add_f32_dpp v15, v15, v15 row_half_mirror row_mask:0xf bank_mask:0xf
    v_add_f32_dpp v16, v16, v16 row_half_mirror row_mask:0xf bank_mask:0xf
    v_add_f32_dpp v17, v17, v17 row_half_mirror row_mask:0xf bank_mask:0xf
    v_add_f32_dpp v18, v18, v18 row_half_mirror row_mask:0xf bank_mask:0xf
    v_add_f32_dpp v19, v19, v19 row_half_mirror row_mask:0xf bank_mask:0xf
    v_add_f32_dpp v20, v20, v20 row_half_mirror row_mask:0xf bank_mask:0xf
    v_add_f32_dpp v21, v21, v21 row_half_mirror row_mask:0xf bank_mask:0xf
    ds_write_b128 v30, v[14:17]
    ds_write_b128 v30, v[18:21] offset:128
    s_waitcnt lgkmcnt(0)
    v_mov_b32 v30, s84
    v_mov_b32 v31, 3
    ds_write_b32 v30, v31
    v_mov_b32 v30, s85
Lps_19:
    ds_read_b32 v31, v30
    s_waitcnt lgkmcnt(0)
    v_cmp_gt_u32 vcc, 3, v31
    s_cbranch_vccz Lpd_20
    s_cmp_eq_u32 s83, 0
    s_cbranch_scc1 Lpd_20
    s_sub_u32 s83, s83, 1
    s_branch Lps_19
Lpd_20:
    s_add_u32 s72, s63, 0
    s_lshl_b32 s69, s54, 9
    s_add_u32 s69, s69, 135424
    v_and_b32 v30, 7, v1
    v_lshlrev_b32 v30, 5, v30
    v_add_u32 v30, s69, v30
    ds_read_b128 v[64:67], v30 offset:0
    ds_read_b128 v[68:71], v30 offset:16
    ds_read_b128 v[72:75], v30 offset:256
    ds_read_b128 v[76:79], v30 offset:272
    v_lshlrev_b32 v31, 4, v1
    s_cmp_eq_u32 s82, 0
    s_cselect_b32 s69, 8, 0
    s_cmp_lt_u32 s55, 28
    s_cselect_b32 s69, s69, 0
    v_cmp_gt_u32 vcc, s69, v1
    v_mov_b32 v80, 2147483648
    s_nop 0
    v_cndmask_b32 v31, v80, v31, vcc
    s_waitcnt lgkmcnt(0)
    v_add_f32 v64, v64, v72
    v_add_f32 v65, v65, v73
    v_add_f32 v66, v66, v74
    v_add_f32 v67, v67, v75
    v_add_f32 v68, v68, v76
    v_add_f32 v69, v69, v77
    v_add_f32 v70, v70, v78
    v_add_f32 v71, v71, v79
    v_cvt_pk_bf16_f32 v72, v64, v65
    v_cvt_pk_bf16_f32 v73, v66, v67
    v_cvt_pk_bf16_f32 v74, v68, v69
    v_cvt_pk_bf16_f32 v75, v70, v71
    v_min_u32 v72, -2, v72
    v_min_u32 v73, -2, v73
    v_min_u32 v74, -2, v74
    v_min_u32 v75, -2, v75
    buffer_store_dwordx4 v[72:75], v31, s[36:39], s72 offen sc1
    s_cmp_lg_u32 s82, 0
    s_cbranch_scc1 Lxs_21
    s_cmp_ge_u32 s55, 28
    s_cbranch_scc1 Lxs_21
    v_lshrrev_b32 v30, 3, v1
    v_mul_u32_u24 v30, 196608, v30
    v_and_b32 v31, 7, v1
    v_lshl_add_u32 v30, v31, 4, v30
    s_lshl_b32 s72, s55, 7
    s_add_u32 s72, s72, s60
    s_add_u32 s72, s72, 135168
    buffer_load_dwordx4 v[32:35], v30, s[36:39], s72 offen sc1
    s_waitcnt vmcnt(0)
Lpollxs_0_22:
    v_max3_u32 v31, v32, v33, v34
    v_max_u32 v31, v31, v35
    v_cmp_eq_u32 vcc, -1, v31
    s_cbranch_vccz Ldonexs_0_23
Lhsxs_0_24:
    s_add_u32 s3, s72, 786432
    s_buffer_load_dword s92, s[36:39], s72 offset:124 glc
    s_buffer_load_dword s93, s[36:39], s72 offset:196732 glc
    s_buffer_load_dword s94, s[36:39], s72 offset:393340 glc
    s_buffer_load_dword s95, s[36:39], s72 offset:589948 glc
    s_buffer_load_dword s96, s[36:39], s3 offset:124 glc
    s_buffer_load_dword s97, s[36:39], s3 offset:196732 glc
    s_buffer_load_dword s98, s[36:39], s3 offset:393340 glc
    s_buffer_load_dword s99, s[36:39], s3 offset:589948 glc
    s_waitcnt lgkmcnt(0)
    s_max_u32 s92, s92, s93
    s_max_u32 s92, s92, s94
    s_max_u32 s92, s92, s95
    s_max_u32 s92, s92, s96
    s_max_u32 s92, s92, s97
    s_max_u32 s92, s92, s98
    s_max_u32 s92, s92, s99
    s_cmp_lg_u32 s92, -1
    s_cbranch_scc1 Lhrxs_0_25
    s_cmp_eq_u32 s65, 0
    s_cbranch_scc1 Ldonexs_0_23
    s_sub_u32 s65, s65, 1
    s_sleep 2
    s_branch Lhsxs_0_24
Lhrxs_0_25:
    s_cbranch_vccz Ldonexs_0_23
    s_mov_b64 exec, vcc
    buffer_load_dwordx4 v[32:35], v30, s[36:39], s72 offen sc1
    s_mov_b64 exec, -1
    s_waitcnt vmcnt(0)
    s_cmp_eq_u32 s65, 0
    s_cbranch_scc1 Ldonexs_0_23
    s_sub_u32 s65, s65, 1
    s_branch Lpollxs_0_22
Ldonexs_0_23:
    v_lshlrev_b32 v40, 16, v32
    v_and_b32 v41, 0xffff0000, v32
    v_lshlrev_b32 v42, 16, v33
    v_and_b32 v43, 0xffff0000, v33
    v_lshlrev_b32 v44, 16, v34
    v_and_b32 v45, 0xffff0000, v34
    v_lshlrev_b32 v46, 16, v35
    v_and_b32 v47, 0xffff0000, v35
    v_add_f32_dpp v40, v40, v40 row_ror:8 row_mask:0xf bank_mask:0xf
    v_add_f32_dpp v41, v41, v41 row_ror:8 row_mask:0xf bank_mask:0xf
    v_add_f32_dpp v42, v42, v42 row_ror:8 row_mask:0xf bank_mask:0xf
    v_add_f32_dpp v43, v43, v43 row_ror:8 row_mask:0xf bank_mask:0xf
    v_add_f32_dpp v44, v44, v44 row_ror:8 row_mask:0xf bank_mask:0xf
    v_add_f32_dpp v45, v45, v45 row_ror:8 row_mask:0xf bank_mask:0xf
    v_add_f32_dpp v46, v46, v46 row_ror:8 row_mask:0xf bank_mask:0xf
    v_add_f32_dpp v47, v47, v47 row_ror:8 row_mask:0xf bank_mask:0xf
    s_nop 0
    v_mov_b32 v48, v40
    v_mov_b32 v49, v41
    v_mov_b32 v50, v42
    v_mov_b32 v51, v43
    v_mov_b32 v52, v44
    v_mov_b32 v53, v45
    v_mov_b32 v54, v46
    v_mov_b32 v55, v47
    s_nop 0
    v_permlane32_swap_b32 v48, v40
    v_permlane32_swap_b32 v49, v41
    v_permlane32_swap_b32 v50, v42
    v_permlane32_swap_b32 v51, v43
    v_permlane32_swap_b32 v52, v44
    v_permlane32_swap_b32 v53, v45
    v_permlane32_swap_b32 v54, v46
    v_permlane32_swap_b32 v55, v47
    s_nop 0
    v_add_f32 v40, v40, v48
    v_add_f32 v41, v41, v49
    v_add_f32 v42, v42, v50
    v_add_f32 v43, v43, v51
    v_add_f32 v44, v44, v52
    v_add_f32 v45, v45, v53
    v_add_f32 v46, v46, v54
    v_add_f32 v47, v47, v55
    v_mov_b32 v48, v40
    v_mov_b32 v49, v41
    v_mov_b32 v50, v42
    v_mov_b32 v51, v43
    v_mov_b32 v52, v44
    v_mov_b32 v53, v45
    v_mov_b32 v54, v46
    v_mov_b32 v55, v47
    s_nop 0
    v_permlane16_swap_b32 v48, v40
    v_permlane16_swap_b32 v49, v41
    v_permlane16_swap_b32 v50, v42
    v_permlane16_swap_b32 v51, v43
    v_permlane16_swap_b32 v52, v44
    v_permlane16_swap_b32 v53, v45
    v_permlane16_swap_b32 v54, v46
    v_permlane16_swap_b32 v55, v47
    s_nop 0
    v_add_f32 v40, v40, v48
    v_add_f32 v41, v41, v49
    v_add_f32 v42, v42, v50
    v_add_f32 v43, v43, v51
    v_add_f32 v44, v44, v52
    v_add_f32 v45, v45, v53
    v_add_f32 v46, v46, v54
    v_add_f32 v47, v47, v55
    v_cvt_pk_bf16_f32 v32, v40, v41
    v_cvt_pk_bf16_f32 v33, v42, v43
    v_cvt_pk_bf16_f32 v34, v44, v45
    v_cvt_pk_bf16_f32 v35, v46, v47
    v_min_u32 v32, -2, v32
    v_min_u32 v33, -2, v33
    v_min_u32 v34, -2, v34
    v_min_u32 v35, -2, v35
    v_lshlrev_b32 v30, 4, v1
    s_lshl_b32 s72, s55, 7
    s_add_u32 s72, s72, s101
    s_add_u32 s72, s72, 0
    v_cmp_gt_u32 vcc, 8, v1
    v_mov_b32 v31, 2147483648
    s_nop 0
    v_cndmask_b32 v30, v31, v30, vcc
    s_cmp_eq_u32 s100, 0
    s_cbranch_scc1 Lwt_26
    buffer_store_dwordx4 v[32:35], v30, s[36:39], s72 offen
    s_branch Lwd_27
Lwt_26:
    buffer_store_dwordx4 v[32:35], v30, s[36:39], s72 offen sc1
Lwd_27:
    s_nop 1
Lxs_21:
    s_nop 1
    s_lshl_b32 s69, s82, 6
    v_lshrrev_b32 v30, 1, v1
    v_lshlrev_b32 v30, 7, v30
    v_and_b32 v31, 1, v1
    v_lshl_add_u32 v30, v31, 4, v30
    v_add_u32 v30, s69, v30
    v_mov_b32 v31, 2147483648
    v_cndmask_b32 v30, v31, v30, s[66:67]
    s_add_u32 s72, s60, 135168
    s_add_u32 s72, s101, 0
    buffer_load_dwordx4 v[60:63], v30, s[36:39], s72 offen sc1
    buffer_load_dwordx4 v[124:127], v30, s[36:39], s72 offen offset:32 sc1
    s_lshl_b32 s69, s54, 1
    s_add_u32 s69, s69, s82
    s_mul_i32 s69, s69, 3584
    s_add_u32 s69, s69, 148224
    v_lshlrev_b32 v31, 5, v1
    v_add_u32 v31, s69, v31
    v_mov_b32 v14, 0
    v_mov_b32 v15, 0
    v_mov_b32 v16, 0
    v_mov_b32 v17, 0
    v_mov_b32 v18, 0
    v_mov_b32 v19, 0
    v_mov_b32 v20, 0
    v_mov_b32 v21, 0
    v_mov_b32 v22, 0
    v_mov_b32 v23, 0
    v_mov_b32 v24, 0
    v_mov_b32 v25, 0
    v_mov_b32 v26, 0
    v_mov_b32 v27, 0
    v_mov_b32 v28, 0
    v_mov_b32 v29, 0
    s_mov_b64 exec, s[66:67]
    ds_read_b128 v[14:17], v31 offset:0
    ds_read_b128 v[18:21], v31 offset:16
    ds_read_b128 v[22:25], v31 offset:1792
    ds_read_b128 v[26:29], v31 offset:1808
    s_mov_b64 exec, -1
    v_lshrrev_b32 v84, 4, v1
    v_lshlrev_b32 v84, 8, v84
    v_bfe_u32 v85, v1, 2, 2
    v_lshl_add_u32 v84, v85, 5, v84
    v_and_b32 v85, 3, v1
    v_lshl_add_u32 v84, v85, 3, v84
    s_mul_i32 s69, s82, 7168
    s_add_u32 s69, s69, 112640
    v_add_u32 v84, s69, v84
    ds_read_b64_tr_b16 v[96:97], v84 offset:0
    ds_read_b64_tr_b16 v[98:99], v84 offset:128
    ds_read_b64_tr_b16 v[100:101], v84 offset:1024
    ds_read_b64_tr_b16 v[102:103], v84 offset:1152
    ds_read_b64_tr_b16 v[104:105], v84 offset:2048
    ds_read_b64_tr_b16 v[106:107], v84 offset:2176
    ds_read_b64_tr_b16 v[108:109], v84 offset:3072
    ds_read_b64_tr_b16 v[110:111], v84 offset:3200
    s_waitcnt lgkmcnt(4)
    ds_read_b64_tr_b16 v[112:113], v84 offset:4096
    ds_read_b64_tr_b16 v[114:115], v84 offset:4224
    ds_read_b64_tr_b16 v[116:117], v84 offset:5120
    ds_read_b64_tr_b16 v[118:119], v84 offset:5248
    ds_read_b64_tr_b16 v[120:121], v84 offset:6144
    ds_read_b64_tr_b16 v[122:123], v84 offset:6272
    s_waitcnt lgkmcnt(0)
    s_waitcnt vmcnt(0)
    v_max3_u32 v31, v60, v61, v62
    v_max3_u32 v31, v31, v63, v124
    v_max3_u32 v31, v31, v125, v126
    v_max_u32 v31, v31, v127
    v_cmp_eq_u32 vcc, -1, v31
    s_or_b64 s[92:93], vcc, 1
    s_cbranch_vccz Ldones2_0_30
    s_mov_b64 exec, s[92:93]
    buffer_load_dwordx4 v[60:63], v30, s[36:39], s72 offen sc1
    buffer_load_dwordx4 v[124:127], v30, s[36:39], s72 offen offset:32 sc1
    s_mov_b64 exec, -1
    s_sleep 8
Lpolls2_0_29:
    s_mov_b64 exec, s[92:93]
    buffer_load_dwordx4 v[60:63], v30, s[36:39], s72 offen sc1
    buffer_load_dwordx4 v[124:127], v30, s[36:39], s72 offen offset:32 sc1
    s_mov_b64 exec, -1
    s_waitcnt vmcnt(2)
    s_cmp_eq_u32 s65, 0
    s_cbranch_scc1 Ldones2_0_30
    s_sub_u32 s65, s65, 1
    v_max3_u32 v31, v60, v61, v62
    v_max3_u32 v31, v31, v63, v124
    v_max3_u32 v31, v31, v125, v126
    v_max_u32 v31, v31, v127
    v_cmp_eq_u32 vcc, -1, v31
    s_or_b64 s[92:93], vcc, 1
    s_cbranch_vccz Ldones2_0_30
    s_branch Lpolls2_0_29
Ldones2_0_30:
    v_dot2c_f32_bf16 v14, s86, v60
    v_dot2c_f32_bf16 v15, s87, v60
    v_dot2c_f32_bf16 v16, s86, v61
    v_dot2c_f32_bf16 v17, s87, v61
    v_dot2c_f32_bf16 v18, s86, v62
    v_dot2c_f32_bf16 v19, s87, v62
    v_dot2c_f32_bf16 v20, s86, v63
    v_dot2c_f32_bf16 v21, s87, v63
    v_dot2c_f32_bf16 v22, s86, v124
    v_dot2c_f32_bf16 v23, s87, v124
    v_dot2c_f32_bf16 v24, s86, v125
    v_dot2c_f32_bf16 v25, s87, v125
    v_dot2c_f32_bf16 v26, s86, v126
    v_dot2c_f32_bf16 v27, s87, v126
    v_dot2c_f32_bf16 v28, s86, v127
    v_dot2c_f32_bf16 v29, s87, v127
    s_lshl_b32 s69, s54, 1
    s_add_u32 s69, s69, s82
    s_mul_i32 s69, s69, 3584
    s_add_u32 s69, s69, 148224
    v_lshlrev_b32 v31, 5, v1
    v_add_u32 v31, s69, v31
    s_mov_b64 exec, s[66:67]
    ds_write_b128 v31, v[14:17] offset:0
    ds_write_b128 v31, v[18:21] offset:16
    ds_write_b128 v31, v[22:25] offset:1792
    ds_write_b128 v31, v[26:29] offset:1808
    s_mov_b64 exec, -1
    v_add_f32 v80, v14, v15
    v_add_f32 v80, v80, v16
    v_add_f32 v80, v80, v17
    v_add_f32 v80, v80, v18
    v_add_f32 v80, v80, v19
    v_add_f32 v80, v80, v20
    v_add_f32 v80, v80, v21
    v_add_f32 v81, v22, v23
    v_add_f32 v81, v81, v24
    v_add_f32 v81, v81, v25
    v_add_f32 v81, v81, v26
    v_add_f32 v81, v81, v27
    v_add_f32 v81, v81, v28
    v_add_f32 v81, v81, v29
    s_nop 0
    v_add_f32_dpp v80, v80, v80 row_ror:8 row_mask:0xf bank_mask:0xf
    v_add_f32_dpp v81, v81, v81 row_ror:8 row_mask:0xf bank_mask:0xf
    s_nop 0
    v_add_f32_dpp v80, v80, v80 row_ror:4 row_mask:0xf bank_mask:0xf
    v_add_f32_dpp v81, v81, v81 row_ror:4 row_mask:0xf bank_mask:0xf
    s_nop 0
    v_add_f32_dpp v80, v80, v80 row_ror:2 row_mask:0xf bank_mask:0xf
    v_add_f32_dpp v81, v81, v81 row_ror:2 row_mask:0xf bank_mask:0xf
    s_nop 0
    v_add_f32_dpp v80, v80, v80 row_ror:1 row_mask:0xf bank_mask:0xf
    v_add_f32_dpp v81, v81, v81 row_ror:1 row_mask:0xf bank_mask:0xf
    s_nop 0
    v_mov_b32 v82, v80
    v_mov_b32 v83, v81
    s_nop 0
    v_permlane32_swap_b32 v82, v80
    v_permlane32_swap_b32 v83, v81
    s_nop 0
    v_add_f32 v80, v80, v82
    v_add_f32 v81, v81, v83
    v_mov_b32 v82, v80
    v_mov_b32 v83, v81
    s_nop 0
    v_permlane16_swap_b32 v82, v80
    v_permlane16_swap_b32 v83, v81
    s_nop 0
    v_add_f32 v80, v80, v82
    v_add_f32 v81, v81, v83
    v_mul_f32 v80, 0x3b124925, v80
    v_mul_f32 v81, 0x3b124925, v81
    v_sub_f32 v64, v14, v80
    v_sub_f32 v65, v15, v80
    v_sub_f32 v66, v16, v80
    v_sub_f32 v67, v17, v80
    v_sub_f32 v68, v18, v80
    v_sub_f32 v69, v19, v80
    v_sub_f32 v70, v20, v80
    v_sub_f32 v71, v21, v80
    v_sub_f32 v72, v22, v81
    v_sub_f32 v73, v23, v81
    v_sub_f32 v74, v24, v81
    v_sub_f32 v75, v25, v81
    v_sub_f32 v76, v26, v81
    v_sub_f32 v77, v27, v81
    v_sub_f32 v78, v28, v81
    v_sub_f32 v79, v29, v81
    v_mul_f32 v80, v64, v64
    v_fmac_f32 v80, v65, v65
    v_fmac_f32 v80, v66, v66
    v_fmac_f32 v80, v67, v67
    v_fmac_f32 v80, v68, v68
    v_fmac_f32 v80, v69, v69
    v_fmac_f32 v80, v70, v70
    v_fmac_f32 v80, v71, v71
    v_mul_f32 v81, v72, v72
    v_fmac_f32 v81, v73, v73
    v_fmac_f32 v81, v74, v74
    v_fmac_f32 v81, v75, v75
    v_fmac_f32 v81, v76, v76
    v_fmac_f32 v81, v77, v77
    v_fmac_f32 v81, v78, v78
    v_fmac_f32 v81, v79, v79
    v_cndmask_b32 v80, 0, v80, s[66:67]
    v_cndmask_b32 v81, 0, v81, s[66:67]
    s_nop 0
    v_add_f32_dpp v80, v80, v80 row_ror:8 row_mask:0xf bank_mask:0xf
    v_add_f32_dpp v81, v81, v81 row_ror:8 row_mask:0xf bank_mask:0xf
    s_nop 0
    v_add_f32_dpp v80, v80, v80 row_ror:4 row_mask:0xf bank_mask:0xf
    v_add_f32_dpp v81, v81, v81 row_ror:4 row_mask:0xf bank_mask:0xf
    s_nop 0
    v_add_f32_dpp v80, v80, v80 row_ror:2 row_mask:0xf bank_mask:0xf
    v_add_f32_dpp v81, v81, v81 row_ror:2 row_mask:0xf bank_mask:0xf
    s_nop 0
    v_add_f32_dpp v80, v80, v80 row_ror:1 row_mask:0xf bank_mask:0xf
    v_add_f32_dpp v81, v81, v81 row_ror:1 row_mask:0xf bank_mask:0xf
    s_nop 0
    v_mov_b32 v82, v80
    v_mov_b32 v83, v81
    s_nop 0
    v_permlane32_swap_b32 v82, v80
    v_permlane32_swap_b32 v83, v81
    s_nop 0
    v_add_f32 v80, v80, v82
    v_add_f32 v81, v81, v83
    v_mov_b32 v82, v80
    v_mov_b32 v83, v81
    s_nop 0
    v_permlane16_swap_b32 v82, v80
    v_permlane16_swap_b32 v83, v81
    s_nop 0
    v_add_f32 v80, v80, v82
    v_add_f32 v81, v81, v83
    v_mov_b32 v82, 0x3727c5ac
    v_mov_b32 v83, 0x3727c5ac
    v_fmac_f32 v82, 0x3b124925, v80
    v_fmac_f32 v83, 0x3b124925, v81
    v_rsq_f32 v82, v82
    v_rsq_f32 v83, v83
    s_nop 0
    v_mul_f32 v64, v64, v82
    v_mul_f32 v65, v65, v82
    v_mul_f32 v66, v66, v82
    v_mul_f32 v67, v67, v82
    v_mul_f32 v68, v68, v82
    v_mul_f32 v69, v69, v82
    v_mul_f32 v70, v70, v82
    v_mul_f32 v71, v71, v82
    v_mul_f32 v72, v72, v83
    v_mul_f32 v73, v73, v83
    v_mul_f32 v74, v74, v83
    v_mul_f32 v75, v75, v83
    v_mul_f32 v76, v76, v83
    v_mul_f32 v77, v77, v83
    v_mul_f32 v78, v78, v83
    v_mul_f32 v79, v79, v83
    v_cvt_pk_bf16_f32 v84, v64, v65
    v_cvt_pk_bf16_f32 v85, v66, v67
    v_cvt_pk_bf16_f32 v86, v68, v69
    v_cvt_pk_bf16_f32 v87, v70, v71
    v_cvt_pk_bf16_f32 v88, v72, v73
    v_cvt_pk_bf16_f32 v89, v74, v75
    v_cvt_pk_bf16_f32 v90, v76, v77
    v_cvt_pk_bf16_f32 v91, v78, v79
    s_lshl_b32 s69, s52, 11
    s_add_u32 s69, s69, 137472
    v_lshlrev_b32 v30, 4, v1
    v_add_u32 v30, s69, v30
    ds_write_b128 v30, v[84:87]
    ds_write_b128 v30, v[88:91] offset:1024
    s_waitcnt lgkmcnt(0)
    v_mov_b32 v30, s84
    v_mov_b32 v31, 4
    ds_write_b32 v30, v31
    v_mov_b32 v30, s85
Lps_31:
    ds_read_b32 v31, v30
    s_waitcnt lgkmcnt(0)
    v_cmp_gt_u32 vcc, 4, v31
    s_cbranch_vccz Lpd_32
    s_cmp_eq_u32 s83, 0
    s_cbranch_scc1 Lpd_32
    s_sub_u32 s83, s83, 1
    s_branch Lps_31
Lpd_32:
    v_and_b32 v30, 3, v1
    v_lshlrev_b32 v30, 10, v30
    s_lshl_b32 s69, s54, 12
    s_add_u32 s69, s69, 137472
    v_lshrrev_b32 v31, 4, v1
    v_lshl_add_u32 v30, v31, 4, v30
    s_mul_i32 s72, s82, 448
    s_add_u32 s69, s69, s72
    v_add_u32 v30, s69, v30
    ds_read_b128 v[32:35], v30 offset:0
    ds_read_b128 v[36:39], v30 offset:64
    ds_read_b128 v[40:43], v30 offset:128
    ds_read_b128 v[44:47], v30 offset:192
    ds_read_b128 v[48:51], v30 offset:256
    ds_read_b128 v[52:55], v30 offset:320
    ds_read_b128 v[56:59], v30 offset:384
    s_waitcnt lgkmcnt(6)
    v_mfma_f32_16x16x32_bf16 v[92:95], v[96:99], v[32:35], 0
    s_waitcnt lgkmcnt(5)
    v_mfma_f32_16x16x32_bf16 v[92:95], v[100:103], v[36:39], v[92:95]
    s_waitcnt lgkmcnt(4)
    v_mfma_f32_16x16x32_bf16 v[92:95], v[104:107], v[40:43], v[92:95]
    s_waitcnt lgkmcnt(3)
    v_mfma_f32_16x16x32_bf16 v[92:95], v[108:111], v[44:47], v[92:95]
    s_waitcnt lgkmcnt(2)
    v_mfma_f32_16x16x32_bf16 v[92:95], v[112:115], v[48:51], v[92:95]
    s_waitcnt lgkmcnt(1)
    v_mfma_f32_16x16x32_bf16 v[92:95], v[116:119], v[52:55], v[92:95]
    s_waitcnt lgkmcnt(0)
    v_mfma_f32_16x16x32_bf16 v[92:95], v[120:123], v[56:59], v[92:95]
    v_and_b32 v30, 3, v1
    v_lshlrev_b32 v30, 6, v30
    v_lshrrev_b32 v31, 4, v1
    v_lshl_add_u32 v30, v31, 4, v30
    s_lshl_b32 s69, s52, 8
    s_add_u32 s69, s69, 136448
    v_add_u32 v30, s69, v30
    s_nop 7
    ds_write_b128 v30, v[92:95]
    s_waitcnt lgkmcnt(0)
    v_mov_b32 v30, s84
    v_mov_b32 v31, 5
    ds_write_b32 v30, v31
    v_mov_b32 v30, s85
Lps_33:
    ds_read_b32 v31, v30
    s_waitcnt lgkmcnt(0)
    v_cmp_gt_u32 vcc, 5, v31
    s_cbranch_vccz Lpd_34
    s_cmp_eq_u32 s83, 0
    s_cbranch_scc1 Lpd_34
    s_sub_u32 s83, s83, 1
    s_branch Lps_33
Lpd_34:
    s_add_u32 s72, s61, 151552
    s_add_u32 s72, s72, s75
    s_lshl_b32 s69, s54, 9
    s_add_u32 s69, s69, 136448
    v_and_b32 v30, 7, v1
    v_lshlrev_b32 v30, 5, v30
    v_add_u32 v30, s69, v30
    ds_read_b128 v[64:67], v30 offset:0
    ds_read_b128 v[68:71], v30 offset:16
    ds_read_b128 v[72:75], v30 offset:256
    ds_read_b128 v[76:79], v30 offset:272
    v_lshlrev_b32 v31, 4, v1
    s_cmp_eq_u32 s82, 0
    s_cselect_b32 s69, 8, 0
    v_cmp_gt_u32 vcc, s69, v1
    v_mov_b32 v80, 2147483648
    s_nop 0
    v_cndmask_b32 v31, v80, v31, vcc
    s_waitcnt lgkmcnt(0)
    v_add_f32 v64, v64, v72
    v_add_f32 v65, v65, v73
    v_add_f32 v66, v66, v74
    v_add_f32 v67, v67, v75
    v_add_f32 v68, v68, v76
    v_add_f32 v69, v69, v77
    v_add_f32 v70, v70, v78
    v_add_f32 v71, v71, v79
    v_cvt_pk_bf16_f32 v72, v64, v65
    v_cvt_pk_bf16_f32 v73, v66, v67
    v_cvt_pk_bf16_f32 v74, v68, v69
    v_cvt_pk_bf16_f32 v75, v70, v71
    v_min_u32 v72, -2, v72
    v_min_u32 v73, -2, v73
    v_min_u32 v74, -2, v74
    v_min_u32 v75, -2, v75
    s_cmp_eq_u32 s100, 0
    s_cbranch_scc1 Lwt_35
    buffer_store_dwordx4 v[72:75], v31, s[36:39], s72 offen
    s_branch Lwd_36
Lwt_35:
    buffer_store_dwordx4 v[72:75], v31, s[36:39], s72 offen sc1
Lwd_36:
    s_nop 1
    s_add_u32 s72, s61, 151552
    s_add_u32 s72, s72, s64
    v_lshrrev_b32 v30, 1, v1
    v_lshlrev_b32 v30, 7, v30
    v_and_b32 v31, 1, v1
    v_lshl_add_u32 v30, v31, 4, v30
    buffer_load_dwordx4 v[124:127], v30, s[36:39], s72 offen sc1
    s_waitcnt vmcnt(0)
    v_max3_u32 v31, v124, v125, v126
    v_max_u32 v31, v31, v127
    v_cmp_eq_u32 vcc, -1, v31
    s_or_b64 s[92:93], vcc, 1
    s_cbranch_vccz Ldoneq1_39
    s_mov_b64 exec, s[92:93]
    buffer_load_dwordx4 v[124:127], v30, s[36:39], s72 offen sc1
    s_mov_b64 exec, -1
    s_sleep 8
Lpollq1_38:
    s_mov_b64 exec, s[92:93]
    buffer_load_dwordx4 v[124:127], v30, s[36:39], s72 offen sc1
    s_mov_b64 exec, -1
    s_waitcnt vmcnt(1)
    s_cmp_eq_u32 s65, 0
    s_cbranch_scc1 Ldoneq1_39
    s_sub_u32 s65, s65, 1
    v_max3_u32 v31, v124, v125, v126
    v_max_u32 v31, v31, v127
    v_cmp_eq_u32 vcc, -1, v31
    s_or_b64 s[92:93], vcc, 1
    s_cbranch_vccz Ldoneq1_39
    s_branch Lpollq1_38
Ldoneq1_39:
    s_lshl_b32 s69, s54, 10
    s_add_u32 s69, s69, 145664
    v_lshlrev_b32 v30, 4, v1
    v_add_u32 v30, s69, v30
    ds_write_b128 v30, v[124:127]
    v_and_b32 v31, 1, v1
    v_lshlrev_b32 v31, 9, v31
    v_bfe_u32 v30, v1, 4, 1
    v_lshl_add_u32 v31, v30, 4, v31
    v_lshrrev_b32 v30, 5, v1
    v_lshl_add_u32 v31, v30, 8, v31
    v_add_u32 v31, s69, v31
    s_waitcnt lgkmcnt(0)
    ds_read_b128 v[32:35], v31 offset:0
    ds_read_b128 v[36:39], v31 offset:32
    ds_read_b128 v[40:43], v31 offset:64
    ds_read_b128 v[44:47], v31 offset:96
    ds_read_b128 v[48:51], v31 offset:128
    ds_read_b128 v[52:55], v31 offset:160
    ds_read_b128 v[56:59], v31 offset:192
    ds_read_b128 v[60:63], v31 offset:224
    s_waitcnt lgkmcnt(0)
    v_mfma_f32_16x16x32_bf16 v[64:67], a[192:195], v[32:35], 0
    v_mfma_f32_16x16x32_bf16 v[64:67], a[196:199], v[36:39], v[64:67]
    v_mfma_f32_16x16x32_bf16 v[64:67], a[200:203], v[40:43], v[64:67]
    v_mfma_f32_16x16x32_bf16 v[64:67], a[204:207], v[44:47], v[64:67]
    v_mfma_f32_16x16x32_bf16 v[64:67], a[208:211], v[48:51], v[64:67]
    v_mfma_f32_16x16x32_bf16 v[64:67], a[212:215], v[52:55], v[64:67]
    v_mfma_f32_16x16x32_bf16 v[64:67], a[216:219], v[56:59], v[64:67]
    v_mfma_f32_16x16x32_bf16 v[64:67], a[220:223], v[60:63], v[64:67]
    v_mfma_f32_16x16x32_bf16 v[68:71], a[224:227], v[32:35], 0
    v_mfma_f32_16x16x32_bf16 v[68:71], a[228:231], v[36:39], v[68:71]
    v_mfma_f32_16x16x32_bf16 v[68:71], a[232:235], v[40:43], v[68:71]
    v_mfma_f32_16x16x32_bf16 v[68:71], a[236:239], v[44:47], v[68:71]
    v_mfma_f32_16x16x32_bf16 v[68:71], a[240:243], v[48:51], v[68:71]
    v_mfma_f32_16x16x32_bf16 v[68:71], a[244:247], v[52:55], v[68:71]
    v_mfma_f32_16x16x32_bf16 v[68:71], a[248:251], v[56:59], v[68:71]
    v_mfma_f32_16x16x32_bf16 v[68:71], a[252:255], v[60:63], v[68:71]
    v_mfma_f32_16x16x32_bf16 v[72:75], v[160:163], v[32:35], 0
    v_mfma_f32_16x16x32_bf16 v[72:75], v[164:167], v[36:39], v[72:75]
    v_mfma_f32_16x16x32_bf16 v[72:75], v[168:171], v[40:43], v[72:75]
    v_mfma_f32_16x16x32_bf16 v[72:75], v[172:175], v[44:47], v[72:75]
    v_mfma_f32_16x16x32_bf16 v[72:75], v[176:179], v[48:51], v[72:75]
    v_mfma_f32_16x16x32_bf16 v[72:75], v[180:183], v[52:55], v[72:75]
    v_mfma_f32_16x16x32_bf16 v[72:75], v[184:187], v[56:59], v[72:75]
    v_mfma_f32_16x16x32_bf16 v[72:75], v[188:191], v[60:63], v[72:75]
    v_mfma_f32_16x16x32_bf16 v[76:79], v[192:195], v[32:35], 0
    v_mfma_f32_16x16x32_bf16 v[76:79], v[196:199], v[36:39], v[76:79]
    v_mfma_f32_16x16x32_bf16 v[76:79], v[200:203], v[40:43], v[76:79]
    v_mfma_f32_16x16x32_bf16 v[76:79], v[204:207], v[44:47], v[76:79]
    v_mfma_f32_16x16x32_bf16 v[76:79], v[208:211], v[48:51], v[76:79]
    v_mfma_f32_16x16x32_bf16 v[76:79], v[212:215], v[52:55], v[76:79]
    v_mfma_f32_16x16x32_bf16 v[76:79], v[216:219], v[56:59], v[76:79]
    v_mfma_f32_16x16x32_bf16 v[76:79], v[220:223], v[60:63], v[76:79]
    v_mfma_f32_16x16x32_bf16 v[80:83], v[224:227], v[32:35], 0
    v_mfma_f32_16x16x32_bf16 v[80:83], v[228:231], v[36:39], v[80:83]
    v_mfma_f32_16x16x32_bf16 v[80:83], v[232:235], v[40:43], v[80:83]
    v_mfma_f32_16x16x32_bf16 v[80:83], v[236:239], v[44:47], v[80:83]
    v_mfma_f32_16x16x32_bf16 v[80:83], v[240:243], v[48:51], v[80:83]
    v_mfma_f32_16x16x32_bf16 v[80:83], v[244:247], v[52:55], v[80:83]
    v_mfma_f32_16x16x32_bf16 v[80:83], v[248:251], v[56:59], v[80:83]
    v_mfma_f32_16x16x32_bf16 v[80:83], v[252:255], v[60:63], v[80:83]
    v_and_b32 v7, 15, v1
    v_lshlrev_b32 v6, 9, v7
    v_and_b32 v7, 7, v7
    v_lshl_add_u32 v6, v7, 5, v6
    v_lshrrev_b32 v7, 5, v1
    v_lshl_add_u32 v6, v7, 8, v6
    v_bfe_u32 v7, v1, 4, 1
    v_lshl_add_u32 v6, v7, 4, v6
    v_add_u32 v6, s56, v6
    v_xor_b32 v7, 32, v6
    v_xor_b32 v8, 64, v6
    v_xor_b32 v9, 96, v6
    v_xor_b32 v10, 128, v6
    v_xor_b32 v11, 160, v6
    v_xor_b32 v12, 192, v6
    v_xor_b32 v13, 224, v6
    ds_read_b128 a[192:195], v6 offset:8192
    ds_read_b128 a[196:199], v7 offset:8192
    ds_read_b128 a[200:203], v8 offset:8192
    ds_read_b128 a[204:207], v9 offset:8192
    ds_read_b128 a[208:211], v10 offset:8192
    ds_read_b128 a[212:215], v11 offset:8192
    ds_read_b128 a[216:219], v12 offset:8192
    ds_read_b128 a[220:223], v13 offset:8192
    s_waitcnt lgkmcnt(7)
    v_mfma_f32_16x16x32_bf16 v[84:87], a[192:195], v[32:35], 0
    s_waitcnt lgkmcnt(6)
    v_mfma_f32_16x16x32_bf16 v[84:87], a[196:199], v[36:39], v[84:87]
    s_waitcnt lgkmcnt(5)
    v_mfma_f32_16x16x32_bf16 v[84:87], a[200:203], v[40:43], v[84:87]
    s_waitcnt lgkmcnt(4)
    v_mfma_f32_16x16x32_bf16 v[84:87], a[204:207], v[44:47], v[84:87]
    s_waitcnt lgkmcnt(3)
    v_mfma_f32_16x16x32_bf16 v[84:87], a[208:211], v[48:51], v[84:87]
    s_waitcnt lgkmcnt(2)
    v_mfma_f32_16x16x32_bf16 v[84:87], a[212:215], v[52:55], v[84:87]
    s_waitcnt lgkmcnt(1)
    v_mfma_f32_16x16x32_bf16 v[84:87], a[216:219], v[56:59], v[84:87]
    s_waitcnt lgkmcnt(0)
    v_mfma_f32_16x16x32_bf16 v[84:87], a[220:223], v[60:63], v[84:87]
    s_add_u32 m0, s56, 8192
    s_add_u32 s69, s57, 917504
    buffer_load_dwordx4 v2, s[12:15], s69 offen offset:0 nt lds
    buffer_load_dwordx4 v3, s[12:15], s69 offen offset:1024 nt lds
    buffer_load_dwordx4 v4, s[12:15], s69 offen offset:2048 nt lds
    buffer_load_dwordx4 v5, s[12:15], s69 offen offset:3072 nt lds
    s_add_u32 m0, s56, 12288
    s_add_u32 s69, s69, 4096
    buffer_load_dwordx4 v2, s[12:15], s69 offen offset:0 nt lds
    buffer_load_dwordx4 v3, s[12:15], s69 offen offset:1024 nt lds
    buffer_load_dwordx4 v4, s[12:15], s69 offen offset:2048 nt lds
    buffer_load_dwordx4 v5, s[12:15], s69 offen offset:3072 nt lds
    ds_read_b128 a[224:227], v6 offset:0
    ds_read_b128 a[228:231], v7 offset:0
    ds_read_b128 a[232:235], v8 offset:0
    ds_read_b128 a[236:239], v9 offset:0
    ds_read_b128 a[240:243], v10 offset:0
    ds_read_b128 a[244:247], v11 offset:0
    ds_read_b128 a[248:251], v12 offset:0
    ds_read_b128 a[252:255], v13 offset:0
    s_waitcnt lgkmcnt(7)
    v_mfma_f32_16x16x32_bf16 v[88:91], a[224:227], v[32:35], 0
    s_waitcnt lgkmcnt(6)
    v_mfma_f32_16x16x32_bf16 v[88:91], a[228:231], v[36:39], v[88:91]
    s_waitcnt lgkmcnt(5)
    v_mfma_f32_16x16x32_bf16 v[88:91], a[232:235], v[40:43], v[88:91]
    s_waitcnt lgkmcnt(4)
    v_mfma_f32_16x16x32_bf16 v[88:91], a[236:239], v[44:47], v[88:91]
    s_waitcnt lgkmcnt(3)
    v_mfma_f32_16x16x32_bf16 v[88:91], a[240:243], v[48:51], v[88:91]
    s_waitcnt lgkmcnt(2)
    v_mfma_f32_16x16x32_bf16 v[88:91], a[244:247], v[52:55], v[88:91]
    s_waitcnt lgkmcnt(1)
    v_mfma_f32_16x16x32_bf16 v[88:91], a[248:251], v[56:59], v[88:91]
    s_waitcnt lgkmcnt(0)
    v_mfma_f32_16x16x32_bf16 v[88:91], a[252:255], v[60:63], v[88:91]
    s_add_u32 m0, s56, 0
    s_add_u32 s69, s57, 1048576
    buffer_load_dwordx4 v2, s[12:15], s69 offen offset:0 nt lds
    buffer_load_dwordx4 v3, s[12:15], s69 offen offset:1024 nt lds
    buffer_load_dwordx4 v4, s[12:15], s69 offen offset:2048 nt lds
    buffer_load_dwordx4 v5, s[12:15], s69 offen offset:3072 nt lds
    s_add_u32 m0, s56, 4096
    s_add_u32 s69, s69, 4096
    buffer_load_dwordx4 v2, s[12:15], s69 offen offset:0 nt lds
    buffer_load_dwordx4 v3, s[12:15], s69 offen offset:1024 nt lds
    buffer_load_dwordx4 v4, s[12:15], s69 offen offset:2048 nt lds
    buffer_load_dwordx4 v5, s[12:15], s69 offen offset:3072 nt lds
    s_waitcnt vmcnt(8)
    ds_read_b128 v[160:163], v6 offset:8192
    ds_read_b128 v[164:167], v7 offset:8192
    ds_read_b128 v[168:171], v8 offset:8192
    ds_read_b128 v[172:175], v9 offset:8192
    ds_read_b128 v[176:179], v10 offset:8192
    ds_read_b128 v[180:183], v11 offset:8192
    ds_read_b128 v[184:187], v12 offset:8192
    ds_read_b128 v[188:191], v13 offset:8192
    s_waitcnt lgkmcnt(7)
    v_mfma_f32_16x16x32_bf16 v[92:95], v[160:163], v[32:35], 0
    s_waitcnt lgkmcnt(6)
    v_mfma_f32_16x16x32_bf16 v[92:95], v[164:167], v[36:39], v[92:95]
    s_waitcnt lgkmcnt(5)
    v_mfma_f32_16x16x32_bf16 v[92:95], v[168:171], v[40:43], v[92:95]
    s_waitcnt lgkmcnt(4)
    v_mfma_f32_16x16x32_bf16 v[92:95], v[172:175], v[44:47], v[92:95]
    s_waitcnt lgkmcnt(3)
    v_mfma_f32_16x16x32_bf16 v[92:95], v[176:179], v[48:51], v[92:95]
    s_waitcnt lgkmcnt(2)
    v_mfma_f32_16x16x32_bf16 v[92:95], v[180:183], v[52:55], v[92:95]
    s_waitcnt lgkmcnt(1)
    v_mfma_f32_16x16x32_bf16 v[92:95], v[184:187], v[56:59], v[92:95]
    s_waitcnt lgkmcnt(0)
    v_mfma_f32_16x16x32_bf16 v[92:95], v[188:191], v[60:63], v[92:95]
    s_add_u32 m0, s56, 8192
    s_add_u32 s69, s57, 1179648
    buffer_load_dwordx4 v2, s[12:15], s69 offen offset:0 nt lds
    buffer_load_dwordx4 v3, s[12:15], s69 offen offset:1024 nt lds
    buffer_load_dwordx4 v4, s[12:15], s69 offen offset:2048 nt lds
    buffer_load_dwordx4 v5, s[12:15], s69 offen offset:3072 nt lds
    s_add_u32 m0, s56, 12288
    s_add_u32 s69, s69, 4096
    buffer_load_dwordx4 v2, s[12:15], s69 offen offset:0 nt lds
    buffer_load_dwordx4 v3, s[12:15], s69 offen offset:1024 nt lds
    buffer_load_dwordx4 v4, s[12:15], s69 offen offset:2048 nt lds
    buffer_load_dwordx4 v5, s[12:15], s69 offen offset:3072 nt lds
    s_waitcnt vmcnt(8)
    ds_read_b128 v[192:195], v6 offset:0
    ds_read_b128 v[196:199], v7 offset:0
    ds_read_b128 v[200:203], v8 offset:0
    ds_read_b128 v[204:207], v9 offset:0
    ds_read_b128 v[208:211], v10 offset:0
    ds_read_b128 v[212:215], v11 offset:0
    ds_read_b128 v[216:219], v12 offset:0
    ds_read_b128 v[220:223], v13 offset:0
    s_waitcnt lgkmcnt(7)
    v_mfma_f32_16x16x32_bf16 v[96:99], v[192:195], v[32:35], 0
    s_waitcnt lgkmcnt(6)
    v_mfma_f32_16x16x32_bf16 v[96:99], v[196:199], v[36:39], v[96:99]
    s_waitcnt lgkmcnt(5)
    v_mfma_f32_16x16x32_bf16 v[96:99], v[200:203], v[40:43], v[96:99]
    s_waitcnt lgkmcnt(4)
    v_mfma_f32_16x16x32_bf16 v[96:99], v[204:207], v[44:47], v[96:99]
    s_waitcnt lgkmcnt(3)
    v_mfma_f32_16x16x32_bf16 v[96:99], v[208:211], v[48:51], v[96:99]
    s_waitcnt lgkmcnt(2)
    v_mfma_f32_16x16x32_bf16 v[96:99], v[212:215], v[52:55], v[96:99]
    s_waitcnt lgkmcnt(1)
    v_mfma_f32_16x16x32_bf16 v[96:99], v[216:219], v[56:59], v[96:99]
    s_waitcnt lgkmcnt(0)
    v_mfma_f32_16x16x32_bf16 v[96:99], v[220:223], v[60:63], v[96:99]
    s_add_u32 m0, s56, 0
    s_add_u32 s69, s57, 1310720
    buffer_load_dwordx4 v2, s[12:15], s69 offen offset:0 nt lds
    buffer_load_dwordx4 v3, s[12:15], s69 offen offset:1024 nt lds
    buffer_load_dwordx4 v4, s[12:15], s69 offen offset:2048 nt lds
    buffer_load_dwordx4 v5, s[12:15], s69 offen offset:3072 nt lds
    s_add_u32 m0, s56, 4096
    s_add_u32 s69, s69, 4096
    buffer_load_dwordx4 v2, s[12:15], s69 offen offset:0 nt lds
    buffer_load_dwordx4 v3, s[12:15], s69 offen offset:1024 nt lds
    buffer_load_dwordx4 v4, s[12:15], s69 offen offset:2048 nt lds
    buffer_load_dwordx4 v5, s[12:15], s69 offen offset:3072 nt lds
    s_waitcnt vmcnt(8)
    ds_read_b128 v[224:227], v6 offset:8192
    ds_read_b128 v[228:231], v7 offset:8192
    ds_read_b128 v[232:235], v8 offset:8192
    ds_read_b128 v[236:239], v9 offset:8192
    ds_read_b128 v[240:243], v10 offset:8192
    ds_read_b128 v[244:247], v11 offset:8192
    ds_read_b128 v[248:251], v12 offset:8192
    ds_read_b128 v[252:255], v13 offset:8192
    s_waitcnt lgkmcnt(7)
    v_mfma_f32_16x16x32_bf16 v[100:103], v[224:227], v[32:35], 0
    s_waitcnt lgkmcnt(6)
    v_mfma_f32_16x16x32_bf16 v[100:103], v[228:231], v[36:39], v[100:103]
    s_waitcnt lgkmcnt(5)
    v_mfma_f32_16x16x32_bf16 v[100:103], v[232:235], v[40:43], v[100:103]
    s_waitcnt lgkmcnt(4)
    v_mfma_f32_16x16x32_bf16 v[100:103], v[236:239], v[44:47], v[100:103]
    s_waitcnt lgkmcnt(3)
    v_mfma_f32_16x16x32_bf16 v[100:103], v[240:243], v[48:51], v[100:103]
    s_waitcnt lgkmcnt(2)
    v_mfma_f32_16x16x32_bf16 v[100:103], v[244:247], v[52:55], v[100:103]
    s_waitcnt lgkmcnt(1)
    v_mfma_f32_16x16x32_bf16 v[100:103], v[248:251], v[56:59], v[100:103]
    s_waitcnt lgkmcnt(0)
    v_mfma_f32_16x16x32_bf16 v[100:103], v[252:255], v[60:63], v[100:103]
    s_add_u32 m0, s56, 8192
    s_add_u32 s69, s57, 1441792
    buffer_load_dwordx4 v2, s[12:15], s69 offen offset:0 nt lds
    buffer_load_dwordx4 v3, s[12:15], s69 offen offset:1024 nt lds
    buffer_load_dwordx4 v4, s[12:15], s69 offen offset:2048 nt lds
    buffer_load_dwordx4 v5, s[12:15], s69 offen offset:3072 nt lds
    s_add_u32 m0, s56, 12288
    s_add_u32 s69, s69, 4096
    buffer_load_dwordx4 v2, s[12:15], s69 offen offset:0 nt lds
    buffer_load_dwordx4 v3, s[12:15], s69 offen offset:1024 nt lds
    buffer_load_dwordx4 v4, s[12:15], s69 offen offset:2048 nt lds
    buffer_load_dwordx4 v5, s[12:15], s69 offen offset:3072 nt lds
    s_waitcnt vmcnt(8)
    ds_read_b128 v[128:131], v6 offset:0
    ds_read_b128 v[132:135], v7 offset:0
    ds_read_b128 v[136:139], v8 offset:0
    ds_read_b128 v[140:143], v9 offset:0
    ds_read_b128 v[144:147], v10 offset:0
    ds_read_b128 v[148:151], v11 offset:0
    ds_read_b128 v[152:155], v12 offset:0
    ds_read_b128 v[156:159], v13 offset:0
    s_waitcnt lgkmcnt(7)
    v_mfma_f32_16x16x32_bf16 v[104:107], v[128:131], v[32:35], 0
    s_waitcnt lgkmcnt(6)
    v_mfma_f32_16x16x32_bf16 v[104:107], v[132:135], v[36:39], v[104:107]
    s_waitcnt lgkmcnt(5)
    v_mfma_f32_16x16x32_bf16 v[104:107], v[136:139], v[40:43], v[104:107]
    s_waitcnt lgkmcnt(4)
    v_mfma_f32_16x16x32_bf16 v[104:107], v[140:143], v[44:47], v[104:107]
    s_waitcnt lgkmcnt(3)
    v_mfma_f32_16x16x32_bf16 v[104:107], v[144:147], v[48:51], v[104:107]
    s_waitcnt lgkmcnt(2)
    v_mfma_f32_16x16x32_bf16 v[104:107], v[148:151], v[52:55], v[104:107]
    s_waitcnt lgkmcnt(1)
    v_mfma_f32_16x16x32_bf16 v[104:107], v[152:155], v[56:59], v[104:107]
    s_waitcnt lgkmcnt(0)
    v_mfma_f32_16x16x32_bf16 v[104:107], v[156:159], v[60:63], v[104:107]
    s_add_u32 m0, s56, 0
    s_add_u32 s69, s57, 1572864
    buffer_load_dwordx4 v2, s[12:15], s69 offen offset:0 nt lds
    buffer_load_dwordx4 v3, s[12:15], s69 offen offset:1024 nt lds
    buffer_load_dwordx4 v4, s[12:15], s69 offen offset:2048 nt lds
    buffer_load_dwordx4 v5, s[12:15], s69 offen offset:3072 nt lds
    s_add_u32 m0, s56, 4096
    s_add_u32 s69, s69, 4096
    buffer_load_dwordx4 v2, s[12:15], s69 offen offset:0 nt lds
    buffer_load_dwordx4 v3, s[12:15], s69 offen offset:1024 nt lds
    buffer_load_dwordx4 v4, s[12:15], s69 offen offset:2048 nt lds
    buffer_load_dwordx4 v5, s[12:15], s69 offen offset:3072 nt lds
    s_waitcnt vmcnt(8)
    ds_read_b128 v[14:17], v6 offset:8192
    ds_read_b128 v[18:21], v7 offset:8192
    ds_read_b128 v[22:25], v8 offset:8192
    ds_read_b128 v[26:29], v9 offset:8192
    s_waitcnt lgkmcnt(3)
    v_mfma_f32_16x16x32_bf16 v[108:111], v[14:17], v[32:35], 0
    s_waitcnt lgkmcnt(2)
    v_mfma_f32_16x16x32_bf16 v[108:111], v[18:21], v[36:39], v[108:111]
    ds_read_b128 v[14:17], v10 offset:8192
    s_waitcnt lgkmcnt(2)
    v_mfma_f32_16x16x32_bf16 v[108:111], v[22:25], v[40:43], v[108:111]
    ds_read_b128 v[18:21], v11 offset:8192
    s_waitcnt lgkmcnt(2)
    v_mfma_f32_16x16x32_bf16 v[108:111], v[26:29], v[44:47], v[108:111]
    ds_read_b128 v[22:25], v12 offset:8192
    s_waitcnt lgkmcnt(2)
    v_mfma_f32_16x16x32_bf16 v[108:111], v[14:17], v[48:51], v[108:111]
    ds_read_b128 v[26:29], v13 offset:8192
    s_waitcnt lgkmcnt(2)
    v_mfma_f32_16x16x32_bf16 v[108:111], v[18:21], v[52:55], v[108:111]
    s_waitcnt lgkmcnt(1)
    v_mfma_f32_16x16x32_bf16 v[108:111], v[22:25], v[56:59], v[108:111]
    s_waitcnt lgkmcnt(0)
    v_mfma_f32_16x16x32_bf16 v[108:111], v[26:29], v[60:63], v[108:111]
    s_add_u32 m0, s56, 8192
    s_add_u32 s69, s57, 1703936
    buffer_load_dwordx4 v2, s[12:15], s69 offen offset:0 nt lds
    buffer_load_dwordx4 v3, s[12:15], s69 offen offset:1024 nt lds
    buffer_load_dwordx4 v4, s[12:15], s69 offen offset:2048 nt lds
    buffer_load_dwordx4 v5, s[12:15], s69 offen offset:3072 nt lds
    s_add_u32 m0, s56, 12288
    s_add_u32 s69, s69, 4096
    buffer_load_dwordx4 v2, s[12:15], s69 offen offset:0 nt lds
    buffer_load_dwordx4 v3, s[12:15], s69 offen offset:1024 nt lds
    buffer_load_dwordx4 v4, s[12:15], s69 offen offset:2048 nt lds
    buffer_load_dwordx4 v5, s[12:15], s69 offen offset:3072 nt lds
    s_waitcnt vmcnt(8)
    ds_read_b128 v[14:17], v6 offset:0
    ds_read_b128 v[18:21], v7 offset:0
    ds_read_b128 v[22:25], v8 offset:0
    ds_read_b128 v[26:29], v9 offset:0
    s_waitcnt lgkmcnt(3)
    v_mfma_f32_16x16x32_bf16 v[112:115], v[14:17], v[32:35], 0
    s_waitcnt lgkmcnt(2)
    v_mfma_f32_16x16x32_bf16 v[112:115], v[18:21], v[36:39], v[112:115]
    ds_read_b128 v[14:17], v10 offset:0
    s_waitcnt lgkmcnt(2)
    v_mfma_f32_16x16x32_bf16 v[112:115], v[22:25], v[40:43], v[112:115]
    ds_read_b128 v[18:21], v11 offset:0
    s_waitcnt lgkmcnt(2)
    v_mfma_f32_16x16x32_bf16 v[112:115], v[26:29], v[44:47], v[112:115]
    ds_read_b128 v[22:25], v12 offset:0
    s_waitcnt lgkmcnt(2)
    v_mfma_f32_16x16x32_bf16 v[112:115], v[14:17], v[48:51], v[112:115]
    ds_read_b128 v[26:29], v13 offset:0
    s_waitcnt lgkmcnt(2)
    v_mfma_f32_16x16x32_bf16 v[112:115], v[18:21], v[52:55], v[112:115]
    s_waitcnt lgkmcnt(1)
    v_mfma_f32_16x16x32_bf16 v[112:115], v[22:25], v[56:59], v[112:115]
    s_waitcnt lgkmcnt(0)
    v_mfma_f32_16x16x32_bf16 v[112:115], v[26:29], v[60:63], v[112:115]
    s_add_u32 m0, s56, 0
    s_add_u32 s69, s57, 1835008
    buffer_load_dwordx4 v2, s[12:15], s69 offen offset:0 nt lds
    buffer_load_dwordx4 v3, s[12:15], s69 offen offset:1024 nt lds
    buffer_load_dwordx4 v4, s[12:15], s69 offen offset:2048 nt lds
    buffer_load_dwordx4 v5, s[12:15], s69 offen offset:3072 nt lds
    s_add_u32 m0, s56, 4096
    s_add_u32 s69, s69, 4096
    buffer_load_dwordx4 v2, s[12:15], s69 offen offset:0 nt lds
    buffer_load_dwordx4 v3, s[12:15], s69 offen offset:1024 nt lds
    buffer_load_dwordx4 v4, s[12:15], s69 offen offset:2048 nt lds
    buffer_load_dwordx4 v5, s[12:15], s69 offen offset:3072 nt lds
    s_waitcnt vmcnt(8)
    ds_read_b128 v[14:17], v6 offset:8192
    ds_read_b128 v[18:21], v7 offset:8192
    ds_read_b128 v[22:25], v8 offset:8192
    ds_read_b128 v[26:29], v9 offset:8192
    s_waitcnt lgkmcnt(3)
    v_mfma_f32_16x16x32_bf16 v[116:119], v[14:17], v[32:35], 0
    s_waitcnt lgkmcnt(2)
    v_mfma_f32_16x16x32_bf16 v[116:119], v[18:21], v[36:39], v[116:119]
    ds_read_b128 v[14:17], v10 offset:8192
    s_waitcnt lgkmcnt(2)
    v_mfma_f32_16x16x32_bf16 v[116:119], v[22:25], v[40:43], v[116:119]
    ds_read_b128 v[18:21], v11 offset:8192
    s_waitcnt lgkmcnt(2)
    v_mfma_f32_16x16x32_bf16 v[116:119], v[26:29], v[44:47], v[116:119]
    ds_read_b128 v[22:25], v12 offset:8192
    s_waitcnt lgkmcnt(2)
    v_mfma_f32_16x16x32_bf16 v[116:119], v[14:17], v[48:51], v[116:119]
    ds_read_b128 v[26:29], v13 offset:8192
    s_waitcnt lgkmcnt(2)
    v_mfma_f32_16x16x32_bf16 v[116:119], v[18:21], v[52:55], v[116:119]
    s_waitcnt lgkmcnt(1)
    v_mfma_f32_16x16x32_bf16 v[116:119], v[22:25], v[56:59], v[116:119]
    s_waitcnt lgkmcnt(0)
    v_mfma_f32_16x16x32_bf16 v[116:119], v[26:29], v[60:63], v[116:119]
    s_add_u32 m0, s56, 8192
    s_add_u32 s69, s57, 1966080
    buffer_load_dwordx4 v2, s[12:15], s69 offen offset:0 nt lds
    buffer_load_dwordx4 v3, s[12:15], s69 offen offset:1024 nt lds
    buffer_load_dwordx4 v4, s[12:15], s69 offen offset:2048 nt lds
    buffer_load_dwordx4 v5, s[12:15], s69 offen offset:3072 nt lds
    s_add_u32 m0, s56, 12288
    s_add_u32 s69, s69, 4096
    buffer_load_dwordx4 v2, s[12:15], s69 offen offset:0 nt lds
    buffer_load_dwordx4 v3, s[12:15], s69 offen offset:1024 nt lds
    buffer_load_dwordx4 v4, s[12:15], s69 offen offset:2048 nt lds
    buffer_load_dwordx4 v5, s[12:15], s69 offen offset:3072 nt lds
    s_waitcnt vmcnt(8)
    ds_read_b128 v[14:17], v6 offset:0
    ds_read_b128 v[18:21], v7 offset:0
    ds_read_b128 v[22:25], v8 offset:0
    ds_read_b128 v[26:29], v9 offset:0
    s_waitcnt lgkmcnt(3)
    v_mfma_f32_16x16x32_bf16 v[120:123], v[14:17], v[32:35], 0
    s_waitcnt lgkmcnt(2)
    v_mfma_f32_16x16x32_bf16 v[120:123], v[18:21], v[36:39], v[120:123]
    ds_read_b128 v[14:17], v10 offset:0
    s_waitcnt lgkmcnt(2)
    v_mfma_f32_16x16x32_bf16 v[120:123], v[22:25], v[40:43], v[120:123]
    ds_read_b128 v[18:21], v11 offset:0
    s_waitcnt lgkmcnt(2)
    v_mfma_f32_16x16x32_bf16 v[120:123], v[26:29], v[44:47], v[120:123]
    ds_read_b128 v[22:25], v12 offset:0
    s_waitcnt lgkmcnt(2)
    v_mfma_f32_16x16x32_bf16 v[120:123], v[14:17], v[48:51], v[120:123]
    ds_read_b128 v[26:29], v13 offset:0
    s_waitcnt lgkmcnt(2)
    v_mfma_f32_16x16x32_bf16 v[120:123], v[18:21], v[52:55], v[120:123]
    s_waitcnt lgkmcnt(1)
    v_mfma_f32_16x16x32_bf16 v[120:123], v[22:25], v[56:59], v[120:123]
    s_waitcnt lgkmcnt(0)
    v_mfma_f32_16x16x32_bf16 v[120:123], v[26:29], v[60:63], v[120:123]
    s_add_u32 m0, s56, 0
    s_add_u32 s69, s57, 0
    buffer_load_dwordx4 v2, s[16:19], s69 offen offset:0 nt lds
    buffer_load_dwordx4 v3, s[16:19], s69 offen offset:1024 nt lds
    buffer_load_dwordx4 v4, s[16:19], s69 offen offset:2048 nt lds
    buffer_load_dwordx4 v5, s[16:19], s69 offen offset:3072 nt lds
    s_add_u32 m0, s56, 4096
    s_add_u32 s69, s69, 4096
    buffer_load_dwordx4 v2, s[16:19], s69 offen offset:0 nt lds
    buffer_load_dwordx4 v3, s[16:19], s69 offen offset:1024 nt lds
    buffer_load_dwordx4 v4, s[16:19], s69 offen offset:2048 nt lds
    buffer_load_dwordx4 v5, s[16:19], s69 offen offset:3072 nt lds
    s_waitcnt vmcnt(8)
    ds_read_b128 v[14:17], v6 offset:8192
    ds_read_b128 v[18:21], v7 offset:8192
    ds_read_b128 v[22:25], v8 offset:8192
    ds_read_b128 v[26:29], v9 offset:8192
    s_waitcnt lgkmcnt(3)
    v_mfma_f32_16x16x32_bf16 v[124:127], v[14:17], v[32:35], 0
    s_waitcnt lgkmcnt(2)
    v_mfma_f32_16x16x32_bf16 v[124:127], v[18:21], v[36:39], v[124:127]
    ds_read_b128 v[14:17], v10 offset:8192
    s_waitcnt lgkmcnt(2)
    v_mfma_f32_16x16x32_bf16 v[124:127], v[22:25], v[40:43], v[124:127]
    ds_read_b128 v[18:21], v11 offset:8192
    s_waitcnt lgkmcnt(2)
    v_mfma_f32_16x16x32_bf16 v[124:127], v[26:29], v[44:47], v[124:127]
    ds_read_b128 v[22:25], v12 offset:8192
    s_waitcnt lgkmcnt(2)
    v_mfma_f32_16x16x32_bf16 v[124:127], v[14:17], v[48:51], v[124:127]
    ds_read_b128 v[26:29], v13 offset:8192
    s_waitcnt lgkmcnt(2)
    v_mfma_f32_16x16x32_bf16 v[124:127], v[18:21], v[52:55], v[124:127]
    s_waitcnt lgkmcnt(1)
    v_mfma_f32_16x16x32_bf16 v[124:127], v[22:25], v[56:59], v[124:127]
    s_waitcnt lgkmcnt(0)
    v_mfma_f32_16x16x32_bf16 v[124:127], v[26:29], v[60:63], v[124:127]
    s_add_u32 m0, s56, 8192
    s_add_u32 s69, s57, 131072
    buffer_load_dwordx4 v2, s[16:19], s69 offen offset:0 nt lds
    buffer_load_dwordx4 v3, s[16:19], s69 offen offset:1024 nt lds
    buffer_load_dwordx4 v4, s[16:19], s69 offen offset:2048 nt lds
    buffer_load_dwordx4 v5, s[16:19], s69 offen offset:3072 nt lds
    s_add_u32 m0, s56, 12288
    s_add_u32 s69, s69, 4096
    buffer_load_dwordx4 v2, s[16:19], s69 offen offset:0 nt lds
    buffer_load_dwordx4 v3, s[16:19], s69 offen offset:1024 nt lds
    buffer_load_dwordx4 v4, s[16:19], s69 offen offset:2048 nt lds
    buffer_load_dwordx4 v5, s[16:19], s69 offen offset:3072 nt lds
    s_nop 7
    v_max3_f32 v14, v64, v65, v66
    v_max3_f32 v15, v67, v68, v69
    v_max3_f32 v14, v14, v70, v71
    v_max3_f32 v15, v15, v72, v73
    v_max3_f32 v14, v14, v74, v75
    v_max3_f32 v15, v15, v76, v77
    v_max3_f32 v14, v14, v78, v79
    v_max3_f32 v15, v15, v80, v81
    v_max3_f32 v14, v14, v82, v83
    v_max3_f32 v15, v15, v84, v85
    v_max3_f32 v14, v14, v86, v87
    v_max3_f32 v15, v15, v88, v89
    v_max3_f32 v14, v14, v90, v91
    v_max3_f32 v15, v15, v92, v93
    v_max3_f32 v14, v14, v94, v95
    v_max3_f32 v15, v15, v96, v97
    v_max3_f32 v14, v14, v98, v99
    v_max3_f32 v15, v15, v100, v101
    v_max3_f32 v14, v14, v102, v103
    v_max3_f32 v15, v15, v104, v105
    v_max3_f32 v14, v14, v106, v107
    v_max3_f32 v15, v15, v108, v109
    v_max3_f32 v14, v14, v110, v111
    v_max3_f32 v15, v15, v112, v113
    v_max3_f32 v14, v14, v114, v115
    v_max3_f32 v15, v15, v116, v117
    v_max3_f32 v14, v14, v118, v119
    v_max3_f32 v15, v15, v120, v121
    v_max3_f32 v14, v14, v122, v123
    v_max3_f32 v15, v15, v124, v125
    v_max3_f32 v14, v14, v126, v127
    v_max_f32 v14, v14, v15
    v_mov_b32 v15, v14
    s_nop 1
    v_permlane32_swap_b32 v15, v14
    s_nop 1
    v_max_f32 v14, v14, v15
    v_mov_b32 v15, v14
    s_nop 1
    v_permlane16_swap_b32 v15, v14
    s_nop 1
    v_max_f32 v14, v14, v15
    v_mul_f32 v14, s68, v14
    v_mov_b32 v16, 0
    v_mov_b32 v17, 0
    v_fma_f32 v64, v64, s68, -v14
    v_fma_f32 v65, v65, s68, -v14
    v_fma_f32 v66, v66, s68, -v14
    v_fma_f32 v67, v67, s68, -v14
    v_exp_f32 v64, v64
    v_exp_f32 v65, v65
    v_exp_f32 v66, v66
    v_exp_f32 v67, v67
    v_cvt_pk_bf16_f32 v32, v64, v65
    v_add_f32 v16, v16, v64
    v_add_f32 v17, v17, v65
    v_cvt_pk_bf16_f32 v33, v66, v67
    v_add_f32 v16, v16, v66
    v_add_f32 v17, v17, v67
    v_fma_f32 v68, v68, s68, -v14
    v_fma_f32 v69, v69, s68, -v14
    v_fma_f32 v70, v70, s68, -v14
    v_fma_f32 v71, v71, s68, -v14
    v_exp_f32 v68, v68
    v_exp_f32 v69, v69
    v_exp_f32 v70, v70
    v_exp_f32 v71, v71
    v_cvt_pk_bf16_f32 v34, v68, v69
    v_add_f32 v16, v16, v68
    v_add_f32 v17, v17, v69
    v_cvt_pk_bf16_f32 v35, v70, v71
    v_add_f32 v16, v16, v70
    v_add_f32 v17, v17, v71
    v_fma_f32 v72, v72, s68, -v14
    v_fma_f32 v73, v73, s68, -v14
    v_fma_f32 v74, v74, s68, -v14
    v_fma_f32 v75, v75, s68, -v14
    v_exp_f32 v72, v72
    v_exp_f32 v73, v73
    v_exp_f32 v74, v74
    v_exp_f32 v75, v75
    v_cvt_pk_bf16_f32 v36, v72, v73
    v_add_f32 v16, v16, v72
    v_add_f32 v17, v17, v73
    v_cvt_pk_bf16_f32 v37, v74, v75
    v_add_f32 v16, v16, v74
    v_add_f32 v17, v17, v75
    v_fma_f32 v76, v76, s68, -v14
    v_fma_f32 v77, v77, s68, -v14
    v_fma_f32 v78, v78, s68, -v14
    v_fma_f32 v79, v79, s68, -v14
    v_exp_f32 v76, v76
    v_exp_f32 v77, v77
    v_exp_f32 v78, v78
    v_exp_f32 v79, v79
    v_cvt_pk_bf16_f32 v38, v76, v77
    v_add_f32 v16, v16, v76
    v_add_f32 v17, v17, v77
    v_cvt_pk_bf16_f32 v39, v78, v79
    v_add_f32 v16, v16, v78
    v_add_f32 v17, v17, v79
    v_fma_f32 v80, v80, s68, -v14
    v_fma_f32 v81, v81, s68, -v14
    v_fma_f32 v82, v82, s68, -v14
    v_fma_f32 v83, v83, s68, -v14
    v_exp_f32 v80, v80
    v_exp_f32 v81, v81
    v_exp_f32 v82, v82
    v_exp_f32 v83, v83
    v_cvt_pk_bf16_f32 v40, v80, v81
    v_add_f32 v16, v16, v80
    v_add_f32 v17, v17, v81
    v_cvt_pk_bf16_f32 v41, v82, v83
    v_add_f32 v16, v16, v82
    v_add_f32 v17, v17, v83
    v_fma_f32 v84, v84, s68, -v14
    v_fma_f32 v85, v85, s68, -v14
    v_fma_f32 v86, v86, s68, -v14
    v_fma_f32 v87, v87, s68, -v14
    v_exp_f32 v84, v84
    v_exp_f32 v85, v85
    v_exp_f32 v86, v86
    v_exp_f32 v87, v87
    v_cvt_pk_bf16_f32 v42, v84, v85
    v_add_f32 v16, v16, v84
    v_add_f32 v17, v17, v85
    v_cvt_pk_bf16_f32 v43, v86, v87
    v_add_f32 v16, v16, v86
    v_add_f32 v17, v17, v87
    v_fma_f32 v88, v88, s68, -v14
    v_fma_f32 v89, v89, s68, -v14
    v_fma_f32 v90, v90, s68, -v14
    v_fma_f32 v91, v91, s68, -v14
    v_exp_f32 v88, v88
    v_exp_f32 v89, v89
    v_exp_f32 v90, v90
    v_exp_f32 v91, v91
    v_cvt_pk_bf16_f32 v44, v88, v89
    v_add_f32 v16, v16, v88
    v_add_f32 v17, v17, v89
    v_cvt_pk_bf16_f32 v45, v90, v91
    v_add_f32 v16, v16, v90
    v_add_f32 v17, v17, v91
    v_fma_f32 v92, v92, s68, -v14
    v_fma_f32 v93, v93, s68, -v14
    v_fma_f32 v94, v94, s68, -v14
    v_fma_f32 v95, v95, s68, -v14
    v_exp_f32 v92, v92
    v_exp_f32 v93, v93
    v_exp_f32 v94, v94
    v_exp_f32 v95, v95
    v_cvt_pk_bf16_f32 v46, v92, v93
    v_add_f32 v16, v16, v92
    v_add_f32 v17, v17, v93
    v_cvt_pk_bf16_f32 v47, v94, v95
    v_add_f32 v16, v16, v94
    v_add_f32 v17, v17, v95
    v_fma_f32 v96, v96, s68, -v14
    v_fma_f32 v97, v97, s68, -v14
    v_fma_f32 v98, v98, s68, -v14
    v_fma_f32 v99, v99, s68, -v14
    v_exp_f32 v96, v96
    v_exp_f32 v97, v97
    v_exp_f32 v98, v98
    v_exp_f32 v99, v99
    v_cvt_pk_bf16_f32 v48, v96, v97
    v_add_f32 v16, v16, v96
    v_add_f32 v17, v17, v97
    v_cvt_pk_bf16_f32 v49, v98, v99
    v_add_f32 v16, v16, v98
    v_add_f32 v17, v17, v99
    v_fma_f32 v100, v100, s68, -v14
    v_fma_f32 v101, v101, s68, -v14
    v_fma_f32 v102, v102, s68, -v14
    v_fma_f32 v103, v103, s68, -v14
    v_exp_f32 v100, v100
    v_exp_f32 v101, v101
    v_exp_f32 v102, v102
    v_exp_f32 v103, v103
    v_cvt_pk_bf16_f32 v50, v100, v101
    v_add_f32 v16, v16, v100
    v_add_f32 v17, v17, v101
    v_cvt_pk_bf16_f32 v51, v102, v103
    v_add_f32 v16, v16, v102
    v_add_f32 v17, v17, v103
    v_fma_f32 v104, v104, s68, -v14
    v_fma_f32 v105, v105, s68, -v14
    v_fma_f32 v106, v106, s68, -v14
    v_fma_f32 v107, v107, s68, -v14
    v_exp_f32 v104, v104
    v_exp_f32 v105, v105
    v_exp_f32 v106, v106
    v_exp_f32 v107, v107
    v_cvt_pk_bf16_f32 v52, v104, v105
    v_add_f32 v16, v16, v104
    v_add_f32 v17, v17, v105
    v_cvt_pk_bf16_f32 v53, v106, v107
    v_add_f32 v16, v16, v106
    v_add_f32 v17, v17, v107
    v_fma_f32 v108, v108, s68, -v14
    v_fma_f32 v109, v109, s68, -v14
    v_fma_f32 v110, v110, s68, -v14
    v_fma_f32 v111, v111, s68, -v14
    v_exp_f32 v108, v108
    v_exp_f32 v109, v109
    v_exp_f32 v110, v110
    v_exp_f32 v111, v111
    v_cvt_pk_bf16_f32 v54, v108, v109
    v_add_f32 v16, v16, v108
    v_add_f32 v17, v17, v109
    v_cvt_pk_bf16_f32 v55, v110, v111
    v_add_f32 v16, v16, v110
    v_add_f32 v17, v17, v111
    v_fma_f32 v112, v112, s68, -v14
    v_fma_f32 v113, v113, s68, -v14
    v_fma_f32 v114, v114, s68, -v14
    v_fma_f32 v115, v115, s68, -v14
    v_exp_f32 v112, v112
    v_exp_f32 v113, v113
    v_exp_f32 v114, v114
    v_exp_f32 v115, v115
    v_cvt_pk_bf16_f32 v56, v112, v113
    v_add_f32 v16, v16, v112
    v_add_f32 v17, v17, v113
    v_cvt_pk_bf16_f32 v57, v114, v115
    v_add_f32 v16, v16, v114
    v_add_f32 v17, v17, v115
    v_fma_f32 v116, v116, s68, -v14
    v_fma_f32 v117, v117, s68, -v14
    v_fma_f32 v118, v118, s68, -v14
    v_fma_f32 v119, v119, s68, -v14
    v_exp_f32 v116, v116
    v_exp_f32 v117, v117
    v_exp_f32 v118, v118
    v_exp_f32 v119, v119
    v_cvt_pk_bf16_f32 v58, v116, v117
    v_add_f32 v16, v16, v116
    v_add_f32 v17, v17, v117
    v_cvt_pk_bf16_f32 v59, v118, v119
    v_add_f32 v16, v16, v118
    v_add_f32 v17, v17, v119
    v_fma_f32 v120, v120, s68, -v14
    v_fma_f32 v121, v121, s68, -v14
    v_fma_f32 v122, v122, s68, -v14
    v_fma_f32 v123, v123, s68, -v14
    v_exp_f32 v120, v120
    v_exp_f32 v121, v121
    v_exp_f32 v122, v122
    v_exp_f32 v123, v123
    v_cvt_pk_bf16_f32 v60, v120, v121
    v_add_f32 v16, v16, v120
    v_add_f32 v17, v17, v121
    v_cvt_pk_bf16_f32 v61, v122, v123
    v_add_f32 v16, v16, v122
    v_add_f32 v17, v17, v123
    v_fma_f32 v124, v124, s68, -v14
    v_fma_f32 v125, v125, s68, -v14
    v_fma_f32 v126, v126, s68, -v14
    v_fma_f32 v127, v127, s68, -v14
    v_exp_f32 v124, v124
    v_exp_f32 v125, v125
    v_exp_f32 v126, v126
    v_exp_f32 v127, v127
    v_cvt_pk_bf16_f32 v62, v124, v125
    v_add_f32 v16, v16, v124
    v_add_f32 v17, v17, v125
    v_cvt_pk_bf16_f32 v63, v126, v127
    v_add_f32 v16, v16, v126
    v_add_f32 v17, v17, v127
    v_add_f32 v16, v16, v17
    v_mov_b32 v15, v16
    s_nop 1
    v_permlane32_swap_b32 v15, v16
    s_nop 1
    v_add_f32 v16, v16, v15
    v_mov_b32 v15, v16
    s_nop 1
    v_permlane16_swap_b32 v15, v16
    s_nop 1
    v_add_f32 v16, v16, v15
    v_mov_b32 v15, v16
    v_and_b32 v17, 1, v1
    v_lshlrev_b32 v17, 3, v17
    s_lshl_b32 s69, s52, 4
    s_add_u32 s69, s69, 135168
    v_add_u32 v17, s69, v17
    ds_write_b64 v17, v[14:15]
    s_waitcnt lgkmcnt(0)
    v_lshrrev_b32 v7, 2, v1
    v_lshlrev_b32 v6, 9, v7
    v_and_b32 v7, 7, v7
    v_lshl_add_u32 v6, v7, 5, v6
    v_and_b32 v7, 3, v1
    v_lshl_add_u32 v6, v7, 3, v6
    v_add_u32 v6, s56, v6
    v_xor_b32 v7, 32, v6
    v_xor_b32 v8, 64, v6
    v_xor_b32 v9, 96, v6
    v_xor_b32 v10, 128, v6
    v_xor_b32 v11, 160, v6
    v_xor_b32 v12, 192, v6
    v_xor_b32 v13, 224, v6
    s_waitcnt vmcnt(8)
    ds_read_b64_tr_b16 v[14:15], v6 offset:0
    ds_read_b64_tr_b16 v[16:17], v7 offset:0
    ds_read_b64_tr_b16 v[18:19], v8 offset:0
    ds_read_b64_tr_b16 v[20:21], v9 offset:0
    ds_read_b64_tr_b16 v[22:23], v10 offset:0
    ds_read_b64_tr_b16 v[24:25], v11 offset:0
    ds_read_b64_tr_b16 v[26:27], v12 offset:0
    ds_read_b64_tr_b16 v[28:29], v13 offset:0
    s_waitcnt lgkmcnt(7)
    v_mfma_f32_16x16x16_bf16 v[64:67], v[14:15], v[32:33], 0
    s_waitcnt lgkmcnt(6)
    v_mfma_f32_16x16x16_bf16 v[68:71], v[16:17], v[32:33], 0
    ds_read_b64_tr_b16 v[14:15], v6 offset:256
    s_waitcnt lgkmcnt(6)
    v_mfma_f32_16x16x16_bf16 v[72:75], v[18:19], v[32:33], 0
    ds_read_b64_tr_b16 v[16:17], v7 offset:256
    s_waitcnt lgkmcnt(6)
    v_mfma_f32_16x16x16_bf16 v[76:79], v[20:21], v[32:33], 0
    ds_read_b64_tr_b16 v[18:19], v8 offset:256
    s_waitcnt lgkmcnt(6)
    v_mfma_f32_16x16x16_bf16 v[80:83], v[22:23], v[32:33], 0
    ds_read_b64_tr_b16 v[20:21], v9 offset:256
    s_waitcnt lgkmcnt(6)
    v_mfma_f32_16x16x16_bf16 v[84:87], v[24:25], v[32:33], 0
    ds_read_b64_tr_b16 v[22:23], v10 offset:256
    s_waitcnt lgkmcnt(6)
    v_mfma_f32_16x16x16_bf16 v[88:91], v[26:27], v[32:33], 0
    ds_read_b64_tr_b16 v[24:25], v11 offset:256
    s_waitcnt lgkmcnt(6)
    v_mfma_f32_16x16x16_bf16 v[92:95], v[28:29], v[32:33], 0
    ds_read_b64_tr_b16 v[26:27], v12 offset:256
    s_waitcnt lgkmcnt(6)
    v_mfma_f32_16x16x16_bf16 v[96:99], v[14:15], v[32:33], 0
    ds_read_b64_tr_b16 v[28:29], v13 offset:256
    s_waitcnt lgkmcnt(6)
    v_mfma_f32_16x16x16_bf16 v[100:103], v[16:17], v[32:33], 0
    s_waitcnt lgkmcnt(5)
    v_mfma_f32_16x16x16_bf16 v[104:107], v[18:19], v[32:33], 0
    s_waitcnt lgkmcnt(4)
    v_mfma_f32_16x16x16_bf16 v[108:111], v[20:21], v[32:33], 0
    s_waitcnt lgkmcnt(3)
    v_mfma_f32_16x16x16_bf16 v[112:115], v[22:23], v[32:33], 0
    s_waitcnt lgkmcnt(2)
    v_mfma_f32_16x16x16_bf16 v[116:119], v[24:25], v[32:33], 0
    s_waitcnt lgkmcnt(1)
    v_mfma_f32_16x16x16_bf16 v[120:123], v[26:27], v[32:33], 0
    s_waitcnt lgkmcnt(0)
    v_mfma_f32_16x16x16_bf16 v[124:127], v[28:29], v[32:33], 0
    s_add_u32 m0, s56, 0
    s_add_u32 s69, s57, 262144
    buffer_load_dwordx4 v2, s[16:19], s69 offen offset:0 nt lds
    buffer_load_dwordx4 v3, s[16:19], s69 offen offset:1024 nt lds
    buffer_load_dwordx4 v4, s[16:19], s69 offen offset:2048 nt lds
    buffer_load_dwordx4 v5, s[16:19], s69 offen offset:3072 nt lds
    s_add_u32 m0, s56, 4096
    s_add_u32 s69, s69, 4096
    buffer_load_dwordx4 v2, s[16:19], s69 offen offset:0 nt lds
    buffer_load_dwordx4 v3, s[16:19], s69 offen offset:1024 nt lds
    buffer_load_dwordx4 v4, s[16:19], s69 offen offset:2048 nt lds
    buffer_load_dwordx4 v5, s[16:19], s69 offen offset:3072 nt lds
    s_waitcnt vmcnt(8)
    ds_read_b64_tr_b16 v[14:15], v6 offset:8192
    ds_read_b64_tr_b16 v[16:17], v7 offset:8192
    ds_read_b64_tr_b16 v[18:19], v8 offset:8192
    ds_read_b64_tr_b16 v[20:21], v9 offset:8192
    ds_read_b64_tr_b16 v[22:23], v10 offset:8192
    ds_read_b64_tr_b16 v[24:25], v11 offset:8192
    ds_read_b64_tr_b16 v[26:27], v12 offset:8192
    ds_read_b64_tr_b16 v[28:29], v13 offset:8192
    s_waitcnt lgkmcnt(7)
    v_mfma_f32_16x16x16_bf16 v[64:67], v[14:15], v[34:35], v[64:67]
    s_waitcnt lgkmcnt(6)
    v_mfma_f32_16x16x16_bf16 v[68:71], v[16:17], v[34:35], v[68:71]
    ds_read_b64_tr_b16 v[14:15], v6 offset:8448
    s_waitcnt lgkmcnt(6)
    v_mfma_f32_16x16x16_bf16 v[72:75], v[18:19], v[34:35], v[72:75]
    ds_read_b64_tr_b16 v[16:17], v7 offset:8448
    s_waitcnt lgkmcnt(6)
    v_mfma_f32_16x16x16_bf16 v[76:79], v[20:21], v[34:35], v[76:79]
    ds_read_b64_tr_b16 v[18:19], v8 offset:8448
    s_waitcnt lgkmcnt(6)
    v_mfma_f32_16x16x16_bf16 v[80:83], v[22:23], v[34:35], v[80:83]
    ds_read_b64_tr_b16 v[20:21], v9 offset:8448
    s_waitcnt lgkmcnt(6)
    v_mfma_f32_16x16x16_bf16 v[84:87], v[24:25], v[34:35], v[84:87]
    ds_read_b64_tr_b16 v[22:23], v10 offset:8448
    s_waitcnt lgkmcnt(6)
    v_mfma_f32_16x16x16_bf16 v[88:91], v[26:27], v[34:35], v[88:91]
    ds_read_b64_tr_b16 v[24:25], v11 offset:8448
    s_waitcnt lgkmcnt(6)
    v_mfma_f32_16x16x16_bf16 v[92:95], v[28:29], v[34:35], v[92:95]
    ds_read_b64_tr_b16 v[26:27], v12 offset:8448
    s_waitcnt lgkmcnt(6)
    v_mfma_f32_16x16x16_bf16 v[96:99], v[14:15], v[34:35], v[96:99]
    ds_read_b64_tr_b16 v[28:29], v13 offset:8448
    s_waitcnt lgkmcnt(6)
    v_mfma_f32_16x16x16_bf16 v[100:103], v[16:17], v[34:35], v[100:103]
    s_waitcnt lgkmcnt(5)
    v_mfma_f32_16x16x16_bf16 v[104:107], v[18:19], v[34:35], v[104:107]
    s_waitcnt lgkmcnt(4)
    v_mfma_f32_16x16x16_bf16 v[108:111], v[20:21], v[34:35], v[108:111]
    s_waitcnt lgkmcnt(3)
    v_mfma_f32_16x16x16_bf16 v[112:115], v[22:23], v[34:35], v[112:115]
    s_waitcnt lgkmcnt(2)
    v_mfma_f32_16x16x16_bf16 v[116:119], v[24:25], v[34:35], v[116:119]
    s_waitcnt lgkmcnt(1)
    v_mfma_f32_16x16x16_bf16 v[120:123], v[26:27], v[34:35], v[120:123]
    s_waitcnt lgkmcnt(0)
    v_mfma_f32_16x16x16_bf16 v[124:127], v[28:29], v[34:35], v[124:127]
    s_add_u32 m0, s56, 8192
    s_add_u32 s69, s57, 393216
    buffer_load_dwordx4 v2, s[16:19], s69 offen offset:0 nt lds
    buffer_load_dwordx4 v3, s[16:19], s69 offen offset:1024 nt lds
    buffer_load_dwordx4 v4, s[16:19], s69 offen offset:2048 nt lds
    buffer_load_dwordx4 v5, s[16:19], s69 offen offset:3072 nt lds
    s_add_u32 m0, s56, 12288
    s_add_u32 s69, s69, 4096
    buffer_load_dwordx4 v2, s[16:19], s69 offen offset:0 nt lds
    buffer_load_dwordx4 v3, s[16:19], s69 offen offset:1024 nt lds
    buffer_load_dwordx4 v4, s[16:19], s69 offen offset:2048 nt lds
    buffer_load_dwordx4 v5, s[16:19], s69 offen offset:3072 nt lds
    s_waitcnt vmcnt(8)
    ds_read_b64_tr_b16 v[14:15], v6 offset:0
    ds_read_b64_tr_b16 v[16:17], v7 offset:0
    ds_read_b64_tr_b16 v[18:19], v8 offset:0
    ds_read_b64_tr_b16 v[20:21], v9 offset:0
    ds_read_b64_tr_b16 v[22:23], v10 offset:0
    ds_read_b64_tr_b16 v[24:25], v11 offset:0
    ds_read_b64_tr_b16 v[26:27], v12 offset:0
    ds_read_b64_tr_b16 v[28:29], v13 offset:0
    s_waitcnt lgkmcnt(7)
    v_mfma_f32_16x16x16_bf16 v[64:67], v[14:15], v[36:37], v[64:67]
    s_waitcnt lgkmcnt(6)
    v_mfma_f32_16x16x16_bf16 v[68:71], v[16:17], v[36:37], v[68:71]
    ds_read_b64_tr_b16 v[14:15], v6 offset:256
    s_waitcnt lgkmcnt(6)
    v_mfma_f32_16x16x16_bf16 v[72:75], v[18:19], v[36:37], v[72:75]
    ds_read_b64_tr_b16 v[16:17], v7 offset:256
    s_waitcnt lgkmcnt(6)
    v_mfma_f32_16x16x16_bf16 v[76:79], v[20:21], v[36:37], v[76:79]
    ds_read_b64_tr_b16 v[18:19], v8 offset:256
    s_waitcnt lgkmcnt(6)
    v_mfma_f32_16x16x16_bf16 v[80:83], v[22:23], v[36:37], v[80:83]
    ds_read_b64_tr_b16 v[20:21], v9 offset:256
    s_waitcnt lgkmcnt(6)
    v_mfma_f32_16x16x16_bf16 v[84:87], v[24:25], v[36:37], v[84:87]
    ds_read_b64_tr_b16 v[22:23], v10 offset:256
    s_waitcnt lgkmcnt(6)
    v_mfma_f32_16x16x16_bf16 v[88:91], v[26:27], v[36:37], v[88:91]
    ds_read_b64_tr_b16 v[24:25], v11 offset:256
    s_waitcnt lgkmcnt(6)
    v_mfma_f32_16x16x16_bf16 v[92:95], v[28:29], v[36:37], v[92:95]
    ds_read_b64_tr_b16 v[26:27], v12 offset:256
    s_waitcnt lgkmcnt(6)
    v_mfma_f32_16x16x16_bf16 v[96:99], v[14:15], v[36:37], v[96:99]
    ds_read_b64_tr_b16 v[28:29], v13 offset:256
    s_waitcnt lgkmcnt(6)
    v_mfma_f32_16x16x16_bf16 v[100:103], v[16:17], v[36:37], v[100:103]
    s_waitcnt lgkmcnt(5)
    v_mfma_f32_16x16x16_bf16 v[104:107], v[18:19], v[36:37], v[104:107]
    s_waitcnt lgkmcnt(4)
    v_mfma_f32_16x16x16_bf16 v[108:111], v[20:21], v[36:37], v[108:111]
    s_waitcnt lgkmcnt(3)
    v_mfma_f32_16x16x16_bf16 v[112:115], v[22:23], v[36:37], v[112:115]
    s_waitcnt lgkmcnt(2)
    v_mfma_f32_16x16x16_bf16 v[116:119], v[24:25], v[36:37], v[116:119]
    s_waitcnt lgkmcnt(1)
    v_mfma_f32_16x16x16_bf16 v[120:123], v[26:27], v[36:37], v[120:123]
    s_waitcnt lgkmcnt(0)
    v_mfma_f32_16x16x16_bf16 v[124:127], v[28:29], v[36:37], v[124:127]
    s_add_u32 m0, s56, 0
    s_add_u32 s69, s57, 524288
    buffer_load_dwordx4 v2, s[16:19], s69 offen offset:0 nt lds
    buffer_load_dwordx4 v3, s[16:19], s69 offen offset:1024 nt lds
    buffer_load_dwordx4 v4, s[16:19], s69 offen offset:2048 nt lds
    buffer_load_dwordx4 v5, s[16:19], s69 offen offset:3072 nt lds
    s_add_u32 m0, s56, 4096
    s_add_u32 s69, s69, 4096
    buffer_load_dwordx4 v2, s[16:19], s69 offen offset:0 nt lds
    buffer_load_dwordx4 v3, s[16:19], s69 offen offset:1024 nt lds
    buffer_load_dwordx4 v4, s[16:19], s69 offen offset:2048 nt lds
    buffer_load_dwordx4 v5, s[16:19], s69 offen offset:3072 nt lds
    s_waitcnt vmcnt(8)
    ds_read_b64_tr_b16 v[14:15], v6 offset:8192
    ds_read_b64_tr_b16 v[16:17], v7 offset:8192
    ds_read_b64_tr_b16 v[18:19], v8 offset:8192
    ds_read_b64_tr_b16 v[20:21], v9 offset:8192
    ds_read_b64_tr_b16 v[22:23], v10 offset:8192
    ds_read_b64_tr_b16 v[24:25], v11 offset:8192
    ds_read_b64_tr_b16 v[26:27], v12 offset:8192
    ds_read_b64_tr_b16 v[28:29], v13 offset:8192
    s_waitcnt lgkmcnt(7)
    v_mfma_f32_16x16x16_bf16 v[64:67], v[14:15], v[38:39], v[64:67]
    s_waitcnt lgkmcnt(6)
    v_mfma_f32_16x16x16_bf16 v[68:71], v[16:17], v[38:39], v[68:71]
    ds_read_b64_tr_b16 v[14:15], v6 offset:8448
    s_waitcnt lgkmcnt(6)
    v_mfma_f32_16x16x16_bf16 v[72:75], v[18:19], v[38:39], v[72:75]
    ds_read_b64_tr_b16 v[16:17], v7 offset:8448
    s_waitcnt lgkmcnt(6)
    v_mfma_f32_16x16x16_bf16 v[76:79], v[20:21], v[38:39], v[76:79]
    ds_read_b64_tr_b16 v[18:19], v8 offset:8448
    s_waitcnt lgkmcnt(6)
    v_mfma_f32_16x16x16_bf16 v[80:83], v[22:23], v[38:39], v[80:83]
    ds_read_b64_tr_b16 v[20:21], v9 offset:8448
    s_waitcnt lgkmcnt(6)
    v_mfma_f32_16x16x16_bf16 v[84:87], v[24:25], v[38:39], v[84:87]
    ds_read_b64_tr_b16 v[22:23], v10 offset:8448
    s_waitcnt lgkmcnt(6)
    v_mfma_f32_16x16x16_bf16 v[88:91], v[26:27], v[38:39], v[88:91]
    ds_read_b64_tr_b16 v[24:25], v11 offset:8448
    s_waitcnt lgkmcnt(6)
    v_mfma_f32_16x16x16_bf16 v[92:95], v[28:29], v[38:39], v[92:95]
    ds_read_b64_tr_b16 v[26:27], v12 offset:8448
    s_waitcnt lgkmcnt(6)
    v_mfma_f32_16x16x16_bf16 v[96:99], v[14:15], v[38:39], v[96:99]
    ds_read_b64_tr_b16 v[28:29], v13 offset:8448
    s_waitcnt lgkmcnt(6)
    v_mfma_f32_16x16x16_bf16 v[100:103], v[16:17], v[38:39], v[100:103]
    s_waitcnt lgkmcnt(5)
    v_mfma_f32_16x16x16_bf16 v[104:107], v[18:19], v[38:39], v[104:107]
    s_waitcnt lgkmcnt(4)
    v_mfma_f32_16x16x16_bf16 v[108:111], v[20:21], v[38:39], v[108:111]
    s_waitcnt lgkmcnt(3)
    v_mfma_f32_16x16x16_bf16 v[112:115], v[22:23], v[38:39], v[112:115]
    s_waitcnt lgkmcnt(2)
    v_mfma_f32_16x16x16_bf16 v[116:119], v[24:25], v[38:39], v[116:119]
    s_waitcnt lgkmcnt(1)
    v_mfma_f32_16x16x16_bf16 v[120:123], v[26:27], v[38:39], v[120:123]
    s_waitcnt lgkmcnt(0)
    v_mfma_f32_16x16x16_bf16 v[124:127], v[28:29], v[38:39], v[124:127]
    s_add_u32 m0, s56, 8192
    s_add_u32 s69, s57, 655360
    buffer_load_dwordx4 v2, s[16:19], s69 offen offset:0 nt lds
    buffer_load_dwordx4 v3, s[16:19], s69 offen offset:1024 nt lds
    buffer_load_dwordx4 v4, s[16:19], s69 offen offset:2048 nt lds
    buffer_load_dwordx4 v5, s[16:19], s69 offen offset:3072 nt lds
    s_add_u32 m0, s56, 12288
    s_add_u32 s69, s69, 4096
    buffer_load_dwordx4 v2, s[16:19], s69 offen offset:0 nt lds
    buffer_load_dwordx4 v3, s[16:19], s69 offen offset:1024 nt lds
    buffer_load_dwordx4 v4, s[16:19], s69 offen offset:2048 nt lds
    buffer_load_dwordx4 v5, s[16:19], s69 offen offset:3072 nt lds
    s_waitcnt vmcnt(8)
    ds_read_b64_tr_b16 v[14:15], v6 offset:0
    ds_read_b64_tr_b16 v[16:17], v7 offset:0
    ds_read_b64_tr_b16 v[18:19], v8 offset:0
    ds_read_b64_tr_b16 v[20:21], v9 offset:0
    ds_read_b64_tr_b16 v[22:23], v10 offset:0
    ds_read_b64_tr_b16 v[24:25], v11 offset:0
    ds_read_b64_tr_b16 v[26:27], v12 offset:0
    ds_read_b64_tr_b16 v[28:29], v13 offset:0
    s_waitcnt lgkmcnt(7)
    v_mfma_f32_16x16x16_bf16 v[64:67], v[14:15], v[40:41], v[64:67]
    s_waitcnt lgkmcnt(6)
    v_mfma_f32_16x16x16_bf16 v[68:71], v[16:17], v[40:41], v[68:71]
    ds_read_b64_tr_b16 v[14:15], v6 offset:256
    s_waitcnt lgkmcnt(6)
    v_mfma_f32_16x16x16_bf16 v[72:75], v[18:19], v[40:41], v[72:75]
    ds_read_b64_tr_b16 v[16:17], v7 offset:256
    s_waitcnt lgkmcnt(6)
    v_mfma_f32_16x16x16_bf16 v[76:79], v[20:21], v[40:41], v[76:79]
    ds_read_b64_tr_b16 v[18:19], v8 offset:256
    s_waitcnt lgkmcnt(6)
    v_mfma_f32_16x16x16_bf16 v[80:83], v[22:23], v[40:41], v[80:83]
    ds_read_b64_tr_b16 v[20:21], v9 offset:256
    s_waitcnt lgkmcnt(6)
    v_mfma_f32_16x16x16_bf16 v[84:87], v[24:25], v[40:41], v[84:87]
    ds_read_b64_tr_b16 v[22:23], v10 offset:256
    s_waitcnt lgkmcnt(6)
    v_mfma_f32_16x16x16_bf16 v[88:91], v[26:27], v[40:41], v[88:91]
    ds_read_b64_tr_b16 v[24:25], v11 offset:256
    s_waitcnt lgkmcnt(6)
    v_mfma_f32_16x16x16_bf16 v[92:95], v[28:29], v[40:41], v[92:95]
    ds_read_b64_tr_b16 v[26:27], v12 offset:256
    s_waitcnt lgkmcnt(6)
    v_mfma_f32_16x16x16_bf16 v[96:99], v[14:15], v[40:41], v[96:99]
    ds_read_b64_tr_b16 v[28:29], v13 offset:256
    s_waitcnt lgkmcnt(6)
    v_mfma_f32_16x16x16_bf16 v[100:103], v[16:17], v[40:41], v[100:103]
    s_waitcnt lgkmcnt(5)
    v_mfma_f32_16x16x16_bf16 v[104:107], v[18:19], v[40:41], v[104:107]
    s_waitcnt lgkmcnt(4)
    v_mfma_f32_16x16x16_bf16 v[108:111], v[20:21], v[40:41], v[108:111]
    s_waitcnt lgkmcnt(3)
    v_mfma_f32_16x16x16_bf16 v[112:115], v[22:23], v[40:41], v[112:115]
    s_waitcnt lgkmcnt(2)
    v_mfma_f32_16x16x16_bf16 v[116:119], v[24:25], v[40:41], v[116:119]
    s_waitcnt lgkmcnt(1)
    v_mfma_f32_16x16x16_bf16 v[120:123], v[26:27], v[40:41], v[120:123]
    s_waitcnt lgkmcnt(0)
    v_mfma_f32_16x16x16_bf16 v[124:127], v[28:29], v[40:41], v[124:127]
    s_add_u32 m0, s56, 0
    s_add_u32 s69, s57, 786432
    buffer_load_dwordx4 v2, s[16:19], s69 offen offset:0 nt lds
    buffer_load_dwordx4 v3, s[16:19], s69 offen offset:1024 nt lds
    buffer_load_dwordx4 v4, s[16:19], s69 offen offset:2048 nt lds
    buffer_load_dwordx4 v5, s[16:19], s69 offen offset:3072 nt lds
    s_add_u32 m0, s56, 4096
    s_add_u32 s69, s69, 4096
    buffer_load_dwordx4 v2, s[16:19], s69 offen offset:0 nt lds
    buffer_load_dwordx4 v3, s[16:19], s69 offen offset:1024 nt lds
    buffer_load_dwordx4 v4, s[16:19], s69 offen offset:2048 nt lds
    buffer_load_dwordx4 v5, s[16:19], s69 offen offset:3072 nt lds
    s_waitcnt vmcnt(8)
    ds_read_b64_tr_b16 v[14:15], v6 offset:8192
    ds_read_b64_tr_b16 v[16:17], v7 offset:8192
    ds_read_b64_tr_b16 v[18:19], v8 offset:8192
    ds_read_b64_tr_b16 v[20:21], v9 offset:8192
    ds_read_b64_tr_b16 v[22:23], v10 offset:8192
    ds_read_b64_tr_b16 v[24:25], v11 offset:8192
    ds_read_b64_tr_b16 v[26:27], v12 offset:8192
    ds_read_b64_tr_b16 v[28:29], v13 offset:8192
    s_waitcnt lgkmcnt(7)
    v_mfma_f32_16x16x16_bf16 v[64:67], v[14:15], v[42:43], v[64:67]
    s_waitcnt lgkmcnt(6)
    v_mfma_f32_16x16x16_bf16 v[68:71], v[16:17], v[42:43], v[68:71]
    ds_read_b64_tr_b16 v[14:15], v6 offset:8448
    s_waitcnt lgkmcnt(6)
    v_mfma_f32_16x16x16_bf16 v[72:75], v[18:19], v[42:43], v[72:75]
    ds_read_b64_tr_b16 v[16:17], v7 offset:8448
    s_waitcnt lgkmcnt(6)
    v_mfma_f32_16x16x16_bf16 v[76:79], v[20:21], v[42:43], v[76:79]
    ds_read_b64_tr_b16 v[18:19], v8 offset:8448
    s_waitcnt lgkmcnt(6)
    v_mfma_f32_16x16x16_bf16 v[80:83], v[22:23], v[42:43], v[80:83]
    ds_read_b64_tr_b16 v[20:21], v9 offset:8448
    s_waitcnt lgkmcnt(6)
    v_mfma_f32_16x16x16_bf16 v[84:87], v[24:25], v[42:43], v[84:87]
    ds_read_b64_tr_b16 v[22:23], v10 offset:8448
    s_waitcnt lgkmcnt(6)
    v_mfma_f32_16x16x16_bf16 v[88:91], v[26:27], v[42:43], v[88:91]
    ds_read_b64_tr_b16 v[24:25], v11 offset:8448
    s_waitcnt lgkmcnt(6)
    v_mfma_f32_16x16x16_bf16 v[92:95], v[28:29], v[42:43], v[92:95]
    ds_read_b64_tr_b16 v[26:27], v12 offset:8448
    s_waitcnt lgkmcnt(6)
    v_mfma_f32_16x16x16_bf16 v[96:99], v[14:15], v[42:43], v[96:99]
    ds_read_b64_tr_b16 v[28:29], v13 offset:8448
    s_waitcnt lgkmcnt(6)
    v_mfma_f32_16x16x16_bf16 v[100:103], v[16:17], v[42:43], v[100:103]
    s_waitcnt lgkmcnt(5)
    v_mfma_f32_16x16x16_bf16 v[104:107], v[18:19], v[42:43], v[104:107]
    s_waitcnt lgkmcnt(4)
    v_mfma_f32_16x16x16_bf16 v[108:111], v[20:21], v[42:43], v[108:111]
    s_waitcnt lgkmcnt(3)
    v_mfma_f32_16x16x16_bf16 v[112:115], v[22:23], v[42:43], v[112:115]
    s_waitcnt lgkmcnt(2)
    v_mfma_f32_16x16x16_bf16 v[116:119], v[24:25], v[42:43], v[116:119]
    s_waitcnt lgkmcnt(1)
    v_mfma_f32_16x16x16_bf16 v[120:123], v[26:27], v[42:43], v[120:123]
    s_waitcnt lgkmcnt(0)
    v_mfma_f32_16x16x16_bf16 v[124:127], v[28:29], v[42:43], v[124:127]
    s_add_u32 m0, s56, 8192
    s_add_u32 s69, s57, 917504
    buffer_load_dwordx4 v2, s[16:19], s69 offen offset:0 nt lds
    buffer_load_dwordx4 v3, s[16:19], s69 offen offset:1024 nt lds
    buffer_load_dwordx4 v4, s[16:19], s69 offen offset:2048 nt lds
    buffer_load_dwordx4 v5, s[16:19], s69 offen offset:3072 nt lds
    s_add_u32 m0, s56, 12288
    s_add_u32 s69, s69, 4096
    buffer_load_dwordx4 v2, s[16:19], s69 offen offset:0 nt lds
    buffer_load_dwordx4 v3, s[16:19], s69 offen offset:1024 nt lds
    buffer_load_dwordx4 v4, s[16:19], s69 offen offset:2048 nt lds
    buffer_load_dwordx4 v5, s[16:19], s69 offen offset:3072 nt lds
    s_waitcnt vmcnt(8)
    ds_read_b64_tr_b16 v[14:15], v6 offset:0
    ds_read_b64_tr_b16 v[16:17], v7 offset:0
    ds_read_b64_tr_b16 v[18:19], v8 offset:0
    ds_read_b64_tr_b16 v[20:21], v9 offset:0
    ds_read_b64_tr_b16 v[22:23], v10 offset:0
    ds_read_b64_tr_b16 v[24:25], v11 offset:0
    ds_read_b64_tr_b16 v[26:27], v12 offset:0
    ds_read_b64_tr_b16 v[28:29], v13 offset:0
    s_waitcnt lgkmcnt(7)
    v_mfma_f32_16x16x16_bf16 v[64:67], v[14:15], v[44:45], v[64:67]
    s_waitcnt lgkmcnt(6)
    v_mfma_f32_16x16x16_bf16 v[68:71], v[16:17], v[44:45], v[68:71]
    ds_read_b64_tr_b16 v[14:15], v6 offset:256
    s_waitcnt lgkmcnt(6)
    v_mfma_f32_16x16x16_bf16 v[72:75], v[18:19], v[44:45], v[72:75]
    ds_read_b64_tr_b16 v[16:17], v7 offset:256
    s_waitcnt lgkmcnt(6)
    v_mfma_f32_16x16x16_bf16 v[76:79], v[20:21], v[44:45], v[76:79]
    ds_read_b64_tr_b16 v[18:19], v8 offset:256
    s_waitcnt lgkmcnt(6)
    v_mfma_f32_16x16x16_bf16 v[80:83], v[22:23], v[44:45], v[80:83]
    ds_read_b64_tr_b16 v[20:21], v9 offset:256
    s_waitcnt lgkmcnt(6)
    v_mfma_f32_16x16x16_bf16 v[84:87], v[24:25], v[44:45], v[84:87]
    ds_read_b64_tr_b16 v[22:23], v10 offset:256
    s_waitcnt lgkmcnt(6)
    v_mfma_f32_16x16x16_bf16 v[88:91], v[26:27], v[44:45], v[88:91]
    ds_read_b64_tr_b16 v[24:25], v11 offset:256
    s_waitcnt lgkmcnt(6)
    v_mfma_f32_16x16x16_bf16 v[92:95], v[28:29], v[44:45], v[92:95]
    ds_read_b64_tr_b16 v[26:27], v12 offset:256
    s_waitcnt lgkmcnt(6)
    v_mfma_f32_16x16x16_bf16 v[96:99], v[14:15], v[44:45], v[96:99]
    ds_read_b64_tr_b16 v[28:29], v13 offset:256
    s_waitcnt lgkmcnt(6)
    v_mfma_f32_16x16x16_bf16 v[100:103], v[16:17], v[44:45], v[100:103]
    s_waitcnt lgkmcnt(5)
    v_mfma_f32_16x16x16_bf16 v[104:107], v[18:19], v[44:45], v[104:107]
    s_waitcnt lgkmcnt(4)
    v_mfma_f32_16x16x16_bf16 v[108:111], v[20:21], v[44:45], v[108:111]
    s_waitcnt lgkmcnt(3)
    v_mfma_f32_16x16x16_bf16 v[112:115], v[22:23], v[44:45], v[112:115]
    s_waitcnt lgkmcnt(2)
    v_mfma_f32_16x16x16_bf16 v[116:119], v[24:25], v[44:45], v[116:119]
    s_waitcnt lgkmcnt(1)
    v_mfma_f32_16x16x16_bf16 v[120:123], v[26:27], v[44:45], v[120:123]
    s_waitcnt lgkmcnt(0)
    v_mfma_f32_16x16x16_bf16 v[124:127], v[28:29], v[44:45], v[124:127]
    s_add_u32 m0, s56, 0
    s_add_u32 s69, s57, 1048576
    buffer_load_dwordx4 v2, s[16:19], s69 offen offset:0 nt lds
    buffer_load_dwordx4 v3, s[16:19], s69 offen offset:1024 nt lds
    buffer_load_dwordx4 v4, s[16:19], s69 offen offset:2048 nt lds
    buffer_load_dwordx4 v5, s[16:19], s69 offen offset:3072 nt lds
    s_add_u32 m0, s56, 4096
    s_add_u32 s69, s69, 4096
    buffer_load_dwordx4 v2, s[16:19], s69 offen offset:0 nt lds
    buffer_load_dwordx4 v3, s[16:19], s69 offen offset:1024 nt lds
    buffer_load_dwordx4 v4, s[16:19], s69 offen offset:2048 nt lds
    buffer_load_dwordx4 v5, s[16:19], s69 offen offset:3072 nt lds
    s_waitcnt vmcnt(8)
    ds_read_b64_tr_b16 v[14:15], v6 offset:8192
    ds_read_b64_tr_b16 v[16:17], v7 offset:8192
    ds_read_b64_tr_b16 v[18:19], v8 offset:8192
    ds_read_b64_tr_b16 v[20:21], v9 offset:8192
    ds_read_b64_tr_b16 v[22:23], v10 offset:8192
    ds_read_b64_tr_b16 v[24:25], v11 offset:8192
    ds_read_b64_tr_b16 v[26:27], v12 offset:8192
    ds_read_b64_tr_b16 v[28:29], v13 offset:8192
    s_waitcnt lgkmcnt(7)
    v_mfma_f32_16x16x16_bf16 v[64:67], v[14:15], v[46:47], v[64:67]
    s_waitcnt lgkmcnt(6)
    v_mfma_f32_16x16x16_bf16 v[68:71], v[16:17], v[46:47], v[68:71]
    ds_read_b64_tr_b16 v[14:15], v6 offset:8448
    s_waitcnt lgkmcnt(6)
    v_mfma_f32_16x16x16_bf16 v[72:75], v[18:19], v[46:47], v[72:75]
    ds_read_b64_tr_b16 v[16:17], v7 offset:8448
    s_waitcnt lgkmcnt(6)
    v_mfma_f32_16x16x16_bf16 v[76:79], v[20:21], v[46:47], v[76:79]
    ds_read_b64_tr_b16 v[18:19], v8 offset:8448
    s_waitcnt lgkmcnt(6)
    v_mfma_f32_16x16x16_bf16 v[80:83], v[22:23], v[46:47], v[80:83]
    ds_read_b64_tr_b16 v[20:21], v9 offset:8448
    s_waitcnt lgkmcnt(6)
    v_mfma_f32_16x16x16_bf16 v[84:87], v[24:25], v[46:47], v[84:87]
    ds_read_b64_tr_b16 v[22:23], v10 offset:8448
    s_waitcnt lgkmcnt(6)
    v_mfma_f32_16x16x16_bf16 v[88:91], v[26:27], v[46:47], v[88:91]
    ds_read_b64_tr_b16 v[24:25], v11 offset:8448
    s_waitcnt lgkmcnt(6)
    v_mfma_f32_16x16x16_bf16 v[92:95], v[28:29], v[46:47], v[92:95]
    ds_read_b64_tr_b16 v[26:27], v12 offset:8448
    s_waitcnt lgkmcnt(6)
    v_mfma_f32_16x16x16_bf16 v[96:99], v[14:15], v[46:47], v[96:99]
    ds_read_b64_tr_b16 v[28:29], v13 offset:8448
    s_waitcnt lgkmcnt(6)
    v_mfma_f32_16x16x16_bf16 v[100:103], v[16:17], v[46:47], v[100:103]
    s_waitcnt lgkmcnt(5)
    v_mfma_f32_16x16x16_bf16 v[104:107], v[18:19], v[46:47], v[104:107]
    s_waitcnt lgkmcnt(4)
    v_mfma_f32_16x16x16_bf16 v[108:111], v[20:21], v[46:47], v[108:111]
    s_waitcnt lgkmcnt(3)
    v_mfma_f32_16x16x16_bf16 v[112:115], v[22:23], v[46:47], v[112:115]
    s_waitcnt lgkmcnt(2)
    v_mfma_f32_16x16x16_bf16 v[116:119], v[24:25], v[46:47], v[116:119]
    s_waitcnt lgkmcnt(1)
    v_mfma_f32_16x16x16_bf16 v[120:123], v[26:27], v[46:47], v[120:123]
    s_waitcnt lgkmcnt(0)
    v_mfma_f32_16x16x16_bf16 v[124:127], v[28:29], v[46:47], v[124:127]
    s_add_u32 m0, s56, 8192
    s_add_u32 s69, s57, 1179648
    buffer_load_dwordx4 v2, s[16:19], s69 offen offset:0 nt lds
    buffer_load_dwordx4 v3, s[16:19], s69 offen offset:1024 nt lds
    buffer_load_dwordx4 v4, s[16:19], s69 offen offset:2048 nt lds
    buffer_load_dwordx4 v5, s[16:19], s69 offen offset:3072 nt lds
    s_add_u32 m0, s56, 12288
    s_add_u32 s69, s69, 4096
    buffer_load_dwordx4 v2, s[16:19], s69 offen offset:0 nt lds
    buffer_load_dwordx4 v3, s[16:19], s69 offen offset:1024 nt lds
    buffer_load_dwordx4 v4, s[16:19], s69 offen offset:2048 nt lds
    buffer_load_dwordx4 v5, s[16:19], s69 offen offset:3072 nt lds
    s_waitcnt vmcnt(8)
    ds_read_b64_tr_b16 v[14:15], v6 offset:0
    ds_read_b64_tr_b16 v[16:17], v7 offset:0
    ds_read_b64_tr_b16 v[18:19], v8 offset:0
    ds_read_b64_tr_b16 v[20:21], v9 offset:0
    ds_read_b64_tr_b16 v[22:23], v10 offset:0
    ds_read_b64_tr_b16 v[24:25], v11 offset:0
    ds_read_b64_tr_b16 v[26:27], v12 offset:0
    ds_read_b64_tr_b16 v[28:29], v13 offset:0
    s_waitcnt lgkmcnt(7)
    v_mfma_f32_16x16x16_bf16 v[64:67], v[14:15], v[48:49], v[64:67]
    s_waitcnt lgkmcnt(6)
    v_mfma_f32_16x16x16_bf16 v[68:71], v[16:17], v[48:49], v[68:71]
    ds_read_b64_tr_b16 v[14:15], v6 offset:256
    s_waitcnt lgkmcnt(6)
    v_mfma_f32_16x16x16_bf16 v[72:75], v[18:19], v[48:49], v[72:75]
    ds_read_b64_tr_b16 v[16:17], v7 offset:256
    s_waitcnt lgkmcnt(6)
    v_mfma_f32_16x16x16_bf16 v[76:79], v[20:21], v[48:49], v[76:79]
    ds_read_b64_tr_b16 v[18:19], v8 offset:256
    s_waitcnt lgkmcnt(6)
    v_mfma_f32_16x16x16_bf16 v[80:83], v[22:23], v[48:49], v[80:83]
    ds_read_b64_tr_b16 v[20:21], v9 offset:256
    s_waitcnt lgkmcnt(6)
    v_mfma_f32_16x16x16_bf16 v[84:87], v[24:25], v[48:49], v[84:87]
    ds_read_b64_tr_b16 v[22:23], v10 offset:256
    s_waitcnt lgkmcnt(6)
    v_mfma_f32_16x16x16_bf16 v[88:91], v[26:27], v[48:49], v[88:91]
    ds_read_b64_tr_b16 v[24:25], v11 offset:256
    s_waitcnt lgkmcnt(6)
    v_mfma_f32_16x16x16_bf16 v[92:95], v[28:29], v[48:49], v[92:95]
    ds_read_b64_tr_b16 v[26:27], v12 offset:256
    s_waitcnt lgkmcnt(6)
    v_mfma_f32_16x16x16_bf16 v[96:99], v[14:15], v[48:49], v[96:99]
    ds_read_b64_tr_b16 v[28:29], v13 offset:256
    s_waitcnt lgkmcnt(6)
    v_mfma_f32_16x16x16_bf16 v[100:103], v[16:17], v[48:49], v[100:103]
    s_waitcnt lgkmcnt(5)
    v_mfma_f32_16x16x16_bf16 v[104:107], v[18:19], v[48:49], v[104:107]
    s_waitcnt lgkmcnt(4)
    v_mfma_f32_16x16x16_bf16 v[108:111], v[20:21], v[48:49], v[108:111]
    s_waitcnt lgkmcnt(3)
    v_mfma_f32_16x16x16_bf16 v[112:115], v[22:23], v[48:49], v[112:115]
    s_waitcnt lgkmcnt(2)
    v_mfma_f32_16x16x16_bf16 v[116:119], v[24:25], v[48:49], v[116:119]
    s_waitcnt lgkmcnt(1)
    v_mfma_f32_16x16x16_bf16 v[120:123], v[26:27], v[48:49], v[120:123]
    s_waitcnt lgkmcnt(0)
    v_mfma_f32_16x16x16_bf16 v[124:127], v[28:29], v[48:49], v[124:127]
    s_add_u32 m0, s56, 0
    s_add_u32 s69, s57, 1310720
    buffer_load_dwordx4 v2, s[16:19], s69 offen offset:0 nt lds
    buffer_load_dwordx4 v3, s[16:19], s69 offen offset:1024 nt lds
    buffer_load_dwordx4 v4, s[16:19], s69 offen offset:2048 nt lds
    buffer_load_dwordx4 v5, s[16:19], s69 offen offset:3072 nt lds
    s_add_u32 m0, s56, 4096
    s_add_u32 s69, s69, 4096
    buffer_load_dwordx4 v2, s[16:19], s69 offen offset:0 nt lds
    buffer_load_dwordx4 v3, s[16:19], s69 offen offset:1024 nt lds
    buffer_load_dwordx4 v4, s[16:19], s69 offen offset:2048 nt lds
    buffer_load_dwordx4 v5, s[16:19], s69 offen offset:3072 nt lds
    s_waitcnt vmcnt(8)
    ds_read_b64_tr_b16 v[14:15], v6 offset:8192
    ds_read_b64_tr_b16 v[16:17], v7 offset:8192
    ds_read_b64_tr_b16 v[18:19], v8 offset:8192
    ds_read_b64_tr_b16 v[20:21], v9 offset:8192
    ds_read_b64_tr_b16 v[22:23], v10 offset:8192
    ds_read_b64_tr_b16 v[24:25], v11 offset:8192
    ds_read_b64_tr_b16 v[26:27], v12 offset:8192
    ds_read_b64_tr_b16 v[28:29], v13 offset:8192
    s_waitcnt lgkmcnt(7)
    v_mfma_f32_16x16x16_bf16 v[64:67], v[14:15], v[50:51], v[64:67]
    s_waitcnt lgkmcnt(6)
    v_mfma_f32_16x16x16_bf16 v[68:71], v[16:17], v[50:51], v[68:71]
    ds_read_b64_tr_b16 v[14:15], v6 offset:8448
    s_waitcnt lgkmcnt(6)
    v_mfma_f32_16x16x16_bf16 v[72:75], v[18:19], v[50:51], v[72:75]
    ds_read_b64_tr_b16 v[16:17], v7 offset:8448
    s_waitcnt lgkmcnt(6)
    v_mfma_f32_16x16x16_bf16 v[76:79], v[20:21], v[50:51], v[76:79]
    ds_read_b64_tr_b16 v[18:19], v8 offset:8448
    s_waitcnt lgkmcnt(6)
    v_mfma_f32_16x16x16_bf16 v[80:83], v[22:23], v[50:51], v[80:83]
    ds_read_b64_tr_b16 v[20:21], v9 offset:8448
    s_waitcnt lgkmcnt(6)
    v_mfma_f32_16x16x16_bf16 v[84:87], v[24:25], v[50:51], v[84:87]
    ds_read_b64_tr_b16 v[22:23], v10 offset:8448
    s_waitcnt lgkmcnt(6)
    v_mfma_f32_16x16x16_bf16 v[88:91], v[26:27], v[50:51], v[88:91]
    ds_read_b64_tr_b16 v[24:25], v11 offset:8448
    s_waitcnt lgkmcnt(6)
    v_mfma_f32_16x16x16_bf16 v[92:95], v[28:29], v[50:51], v[92:95]
    ds_read_b64_tr_b16 v[26:27], v12 offset:8448
    s_waitcnt lgkmcnt(6)
    v_mfma_f32_16x16x16_bf16 v[96:99], v[14:15], v[50:51], v[96:99]
    ds_read_b64_tr_b16 v[28:29], v13 offset:8448
    s_waitcnt lgkmcnt(6)
    v_mfma_f32_16x16x16_bf16 v[100:103], v[16:17], v[50:51], v[100:103]
    s_waitcnt lgkmcnt(5)
    v_mfma_f32_16x16x16_bf16 v[104:107], v[18:19], v[50:51], v[104:107]
    s_waitcnt lgkmcnt(4)
    v_mfma_f32_16x16x16_bf16 v[108:111], v[20:21], v[50:51], v[108:111]
    s_waitcnt lgkmcnt(3)
    v_mfma_f32_16x16x16_bf16 v[112:115], v[22:23], v[50:51], v[112:115]
    s_waitcnt lgkmcnt(2)
    v_mfma_f32_16x16x16_bf16 v[116:119], v[24:25], v[50:51], v[116:119]
    s_waitcnt lgkmcnt(1)
    v_mfma_f32_16x16x16_bf16 v[120:123], v[26:27], v[50:51], v[120:123]
    s_waitcnt lgkmcnt(0)
    v_mfma_f32_16x16x16_bf16 v[124:127], v[28:29], v[50:51], v[124:127]
    s_add_u32 m0, s56, 8192
    s_add_u32 s69, s57, 1441792
    buffer_load_dwordx4 v2, s[16:19], s69 offen offset:0 nt lds
    buffer_load_dwordx4 v3, s[16:19], s69 offen offset:1024 nt lds
    buffer_load_dwordx4 v4, s[16:19], s69 offen offset:2048 nt lds
    buffer_load_dwordx4 v5, s[16:19], s69 offen offset:3072 nt lds
    s_add_u32 m0, s56, 12288
    s_add_u32 s69, s69, 4096
    buffer_load_dwordx4 v2, s[16:19], s69 offen offset:0 nt lds
    buffer_load_dwordx4 v3, s[16:19], s69 offen offset:1024 nt lds
    buffer_load_dwordx4 v4, s[16:19], s69 offen offset:2048 nt lds
    buffer_load_dwordx4 v5, s[16:19], s69 offen offset:3072 nt lds
    s_waitcnt vmcnt(8)
    ds_read_b64_tr_b16 v[14:15], v6 offset:0
    ds_read_b64_tr_b16 v[16:17], v7 offset:0
    ds_read_b64_tr_b16 v[18:19], v8 offset:0
    ds_read_b64_tr_b16 v[20:21], v9 offset:0
    ds_read_b64_tr_b16 v[22:23], v10 offset:0
    ds_read_b64_tr_b16 v[24:25], v11 offset:0
    ds_read_b64_tr_b16 v[26:27], v12 offset:0
    ds_read_b64_tr_b16 v[28:29], v13 offset:0
    s_waitcnt lgkmcnt(7)
    v_mfma_f32_16x16x16_bf16 v[64:67], v[14:15], v[52:53], v[64:67]
    s_waitcnt lgkmcnt(6)
    v_mfma_f32_16x16x16_bf16 v[68:71], v[16:17], v[52:53], v[68:71]
    ds_read_b64_tr_b16 v[14:15], v6 offset:256
    s_waitcnt lgkmcnt(6)
    v_mfma_f32_16x16x16_bf16 v[72:75], v[18:19], v[52:53], v[72:75]
    ds_read_b64_tr_b16 v[16:17], v7 offset:256
    s_waitcnt lgkmcnt(6)
    v_mfma_f32_16x16x16_bf16 v[76:79], v[20:21], v[52:53], v[76:79]
    ds_read_b64_tr_b16 v[18:19], v8 offset:256
    s_waitcnt lgkmcnt(6)
    v_mfma_f32_16x16x16_bf16 v[80:83], v[22:23], v[52:53], v[80:83]
    ds_read_b64_tr_b16 v[20:21], v9 offset:256
    s_waitcnt lgkmcnt(6)
    v_mfma_f32_16x16x16_bf16 v[84:87], v[24:25], v[52:53], v[84:87]
    ds_read_b64_tr_b16 v[22:23], v10 offset:256
    s_waitcnt lgkmcnt(6)
    v_mfma_f32_16x16x16_bf16 v[88:91], v[26:27], v[52:53], v[88:91]
    ds_read_b64_tr_b16 v[24:25], v11 offset:256
    s_waitcnt lgkmcnt(6)
    v_mfma_f32_16x16x16_bf16 v[92:95], v[28:29], v[52:53], v[92:95]
    ds_read_b64_tr_b16 v[26:27], v12 offset:256
    s_waitcnt lgkmcnt(6)
    v_mfma_f32_16x16x16_bf16 v[96:99], v[14:15], v[52:53], v[96:99]
    ds_read_b64_tr_b16 v[28:29], v13 offset:256
    s_waitcnt lgkmcnt(6)
    v_mfma_f32_16x16x16_bf16 v[100:103], v[16:17], v[52:53], v[100:103]
    s_waitcnt lgkmcnt(5)
    v_mfma_f32_16x16x16_bf16 v[104:107], v[18:19], v[52:53], v[104:107]
    s_waitcnt lgkmcnt(4)
    v_mfma_f32_16x16x16_bf16 v[108:111], v[20:21], v[52:53], v[108:111]
    s_waitcnt lgkmcnt(3)
    v_mfma_f32_16x16x16_bf16 v[112:115], v[22:23], v[52:53], v[112:115]
    s_waitcnt lgkmcnt(2)
    v_mfma_f32_16x16x16_bf16 v[116:119], v[24:25], v[52:53], v[116:119]
    s_waitcnt lgkmcnt(1)
    v_mfma_f32_16x16x16_bf16 v[120:123], v[26:27], v[52:53], v[120:123]
    s_waitcnt lgkmcnt(0)
    v_mfma_f32_16x16x16_bf16 v[124:127], v[28:29], v[52:53], v[124:127]
    s_add_u32 m0, s56, 0
    s_add_u32 s69, s57, 1572864
    buffer_load_dwordx4 v2, s[16:19], s69 offen offset:0 nt lds
    buffer_load_dwordx4 v3, s[16:19], s69 offen offset:1024 nt lds
    buffer_load_dwordx4 v4, s[16:19], s69 offen offset:2048 nt lds
    buffer_load_dwordx4 v5, s[16:19], s69 offen offset:3072 nt lds
    s_add_u32 m0, s56, 4096
    s_add_u32 s69, s69, 4096
    buffer_load_dwordx4 v2, s[16:19], s69 offen offset:0 nt lds
    buffer_load_dwordx4 v3, s[16:19], s69 offen offset:1024 nt lds
    buffer_load_dwordx4 v4, s[16:19], s69 offen offset:2048 nt lds
    buffer_load_dwordx4 v5, s[16:19], s69 offen offset:3072 nt lds
    s_waitcnt vmcnt(8)
    ds_read_b64_tr_b16 v[14:15], v6 offset:8192
    ds_read_b64_tr_b16 v[16:17], v7 offset:8192
    ds_read_b64_tr_b16 v[18:19], v8 offset:8192
    ds_read_b64_tr_b16 v[20:21], v9 offset:8192
    ds_read_b64_tr_b16 v[22:23], v10 offset:8192
    ds_read_b64_tr_b16 v[24:25], v11 offset:8192
    ds_read_b64_tr_b16 v[26:27], v12 offset:8192
    ds_read_b64_tr_b16 v[28:29], v13 offset:8192
    s_waitcnt lgkmcnt(7)
    v_mfma_f32_16x16x16_bf16 v[64:67], v[14:15], v[54:55], v[64:67]
    s_waitcnt lgkmcnt(6)
    v_mfma_f32_16x16x16_bf16 v[68:71], v[16:17], v[54:55], v[68:71]
    ds_read_b64_tr_b16 v[14:15], v6 offset:8448
    s_waitcnt lgkmcnt(6)
    v_mfma_f32_16x16x16_bf16 v[72:75], v[18:19], v[54:55], v[72:75]
    ds_read_b64_tr_b16 v[16:17], v7 offset:8448
    s_waitcnt lgkmcnt(6)
    v_mfma_f32_16x16x16_bf16 v[76:79], v[20:21], v[54:55], v[76:79]
    ds_read_b64_tr_b16 v[18:19], v8 offset:8448
    s_waitcnt lgkmcnt(6)
    v_mfma_f32_16x16x16_bf16 v[80:83], v[22:23], v[54:55], v[80:83]
    ds_read_b64_tr_b16 v[20:21], v9 offset:8448
    s_waitcnt lgkmcnt(6)
    v_mfma_f32_16x16x16_bf16 v[84:87], v[24:25], v[54:55], v[84:87]
    ds_read_b64_tr_b16 v[22:23], v10 offset:8448
    s_waitcnt lgkmcnt(6)
    v_mfma_f32_16x16x16_bf16 v[88:91], v[26:27], v[54:55], v[88:91]
    ds_read_b64_tr_b16 v[24:25], v11 offset:8448
    s_waitcnt lgkmcnt(6)
    v_mfma_f32_16x16x16_bf16 v[92:95], v[28:29], v[54:55], v[92:95]
    ds_read_b64_tr_b16 v[26:27], v12 offset:8448
    s_waitcnt lgkmcnt(6)
    v_mfma_f32_16x16x16_bf16 v[96:99], v[14:15], v[54:55], v[96:99]
    ds_read_b64_tr_b16 v[28:29], v13 offset:8448
    s_waitcnt lgkmcnt(6)
    v_mfma_f32_16x16x16_bf16 v[100:103], v[16:17], v[54:55], v[100:103]
    s_waitcnt lgkmcnt(5)
    v_mfma_f32_16x16x16_bf16 v[104:107], v[18:19], v[54:55], v[104:107]
    s_waitcnt lgkmcnt(4)
    v_mfma_f32_16x16x16_bf16 v[108:111], v[20:21], v[54:55], v[108:111]
    s_waitcnt lgkmcnt(3)
    v_mfma_f32_16x16x16_bf16 v[112:115], v[22:23], v[54:55], v[112:115]
    s_waitcnt lgkmcnt(2)
    v_mfma_f32_16x16x16_bf16 v[116:119], v[24:25], v[54:55], v[116:119]
    s_waitcnt lgkmcnt(1)
    v_mfma_f32_16x16x16_bf16 v[120:123], v[26:27], v[54:55], v[120:123]
    s_waitcnt lgkmcnt(0)
    v_mfma_f32_16x16x16_bf16 v[124:127], v[28:29], v[54:55], v[124:127]
    s_add_u32 m0, s56, 8192
    s_add_u32 s69, s57, 1703936
    buffer_load_dwordx4 v2, s[16:19], s69 offen offset:0 nt lds
    buffer_load_dwordx4 v3, s[16:19], s69 offen offset:1024 nt lds
    buffer_load_dwordx4 v4, s[16:19], s69 offen offset:2048 nt lds
    buffer_load_dwordx4 v5, s[16:19], s69 offen offset:3072 nt lds
    s_add_u32 m0, s56, 12288
    s_add_u32 s69, s69, 4096
    buffer_load_dwordx4 v2, s[16:19], s69 offen offset:0 nt lds
    buffer_load_dwordx4 v3, s[16:19], s69 offen offset:1024 nt lds
    buffer_load_dwordx4 v4, s[16:19], s69 offen offset:2048 nt lds
    buffer_load_dwordx4 v5, s[16:19], s69 offen offset:3072 nt lds
    s_waitcnt vmcnt(8)
    ds_read_b64_tr_b16 v[14:15], v6 offset:0
    ds_read_b64_tr_b16 v[16:17], v7 offset:0
    ds_read_b64_tr_b16 v[18:19], v8 offset:0
    ds_read_b64_tr_b16 v[20:21], v9 offset:0
    ds_read_b64_tr_b16 v[22:23], v10 offset:0
    ds_read_b64_tr_b16 v[24:25], v11 offset:0
    ds_read_b64_tr_b16 v[26:27], v12 offset:0
    ds_read_b64_tr_b16 v[28:29], v13 offset:0
    s_waitcnt lgkmcnt(7)
    v_mfma_f32_16x16x16_bf16 v[64:67], v[14:15], v[56:57], v[64:67]
    s_waitcnt lgkmcnt(6)
    v_mfma_f32_16x16x16_bf16 v[68:71], v[16:17], v[56:57], v[68:71]
    ds_read_b64_tr_b16 v[14:15], v6 offset:256
    s_waitcnt lgkmcnt(6)
    v_mfma_f32_16x16x16_bf16 v[72:75], v[18:19], v[56:57], v[72:75]
    ds_read_b64_tr_b16 v[16:17], v7 offset:256
    s_waitcnt lgkmcnt(6)
    v_mfma_f32_16x16x16_bf16 v[76:79], v[20:21], v[56:57], v[76:79]
    ds_read_b64_tr_b16 v[18:19], v8 offset:256
    s_waitcnt lgkmcnt(6)
    v_mfma_f32_16x16x16_bf16 v[80:83], v[22:23], v[56:57], v[80:83]
    ds_read_b64_tr_b16 v[20:21], v9 offset:256
    s_waitcnt lgkmcnt(6)
    v_mfma_f32_16x16x16_bf16 v[84:87], v[24:25], v[56:57], v[84:87]
    ds_read_b64_tr_b16 v[22:23], v10 offset:256
    s_waitcnt lgkmcnt(6)
    v_mfma_f32_16x16x16_bf16 v[88:91], v[26:27], v[56:57], v[88:91]
    ds_read_b64_tr_b16 v[24:25], v11 offset:256
    s_waitcnt lgkmcnt(6)
    v_mfma_f32_16x16x16_bf16 v[92:95], v[28:29], v[56:57], v[92:95]
    ds_read_b64_tr_b16 v[26:27], v12 offset:256
    s_waitcnt lgkmcnt(6)
    v_mfma_f32_16x16x16_bf16 v[96:99], v[14:15], v[56:57], v[96:99]
    ds_read_b64_tr_b16 v[28:29], v13 offset:256
    s_waitcnt lgkmcnt(6)
    v_mfma_f32_16x16x16_bf16 v[100:103], v[16:17], v[56:57], v[100:103]
    s_waitcnt lgkmcnt(5)
    v_mfma_f32_16x16x16_bf16 v[104:107], v[18:19], v[56:57], v[104:107]
    s_waitcnt lgkmcnt(4)
    v_mfma_f32_16x16x16_bf16 v[108:111], v[20:21], v[56:57], v[108:111]
    s_waitcnt lgkmcnt(3)
    v_mfma_f32_16x16x16_bf16 v[112:115], v[22:23], v[56:57], v[112:115]
    s_waitcnt lgkmcnt(2)
    v_mfma_f32_16x16x16_bf16 v[116:119], v[24:25], v[56:57], v[116:119]
    s_waitcnt lgkmcnt(1)
    v_mfma_f32_16x16x16_bf16 v[120:123], v[26:27], v[56:57], v[120:123]
    s_waitcnt lgkmcnt(0)
    v_mfma_f32_16x16x16_bf16 v[124:127], v[28:29], v[56:57], v[124:127]
    s_add_u32 m0, s56, 0
    s_add_u32 s69, s57, 1835008
    buffer_load_dwordx4 v2, s[16:19], s69 offen offset:0 nt lds
    buffer_load_dwordx4 v3, s[16:19], s69 offen offset:1024 nt lds
    buffer_load_dwordx4 v4, s[16:19], s69 offen offset:2048 nt lds
    buffer_load_dwordx4 v5, s[16:19], s69 offen offset:3072 nt lds
    s_add_u32 m0, s56, 4096
    s_add_u32 s69, s69, 4096
    buffer_load_dwordx4 v2, s[16:19], s69 offen offset:0 nt lds
    buffer_load_dwordx4 v3, s[16:19], s69 offen offset:1024 nt lds
    buffer_load_dwordx4 v4, s[16:19], s69 offen offset:2048 nt lds
    buffer_load_dwordx4 v5, s[16:19], s69 offen offset:3072 nt lds
    s_waitcnt vmcnt(8)
    ds_read_b64_tr_b16 v[14:15], v6 offset:8192
    ds_read_b64_tr_b16 v[16:17], v7 offset:8192
    ds_read_b64_tr_b16 v[18:19], v8 offset:8192
    ds_read_b64_tr_b16 v[20:21], v9 offset:8192
    ds_read_b64_tr_b16 v[22:23], v10 offset:8192
    ds_read_b64_tr_b16 v[24:25], v11 offset:8192
    ds_read_b64_tr_b16 v[26:27], v12 offset:8192
    ds_read_b64_tr_b16 v[28:29], v13 offset:8192
    s_waitcnt lgkmcnt(7)
    v_mfma_f32_16x16x16_bf16 v[64:67], v[14:15], v[58:59], v[64:67]
    s_waitcnt lgkmcnt(6)
    v_mfma_f32_16x16x16_bf16 v[68:71], v[16:17], v[58:59], v[68:71]
    ds_read_b64_tr_b16 v[14:15], v6 offset:8448
    s_waitcnt lgkmcnt(6)
    v_mfma_f32_16x16x16_bf16 v[72:75], v[18:19], v[58:59], v[72:75]
    ds_read_b64_tr_b16 v[16:17], v7 offset:8448
    s_waitcnt lgkmcnt(6)
    v_mfma_f32_16x16x16_bf16 v[76:79], v[20:21], v[58:59], v[76:79]
    ds_read_b64_tr_b16 v[18:19], v8 offset:8448
    s_waitcnt lgkmcnt(6)
    v_mfma_f32_16x16x16_bf16 v[80:83], v[22:23], v[58:59], v[80:83]
    ds_read_b64_tr_b16 v[20:21], v9 offset:8448
    s_waitcnt lgkmcnt(6)
    v_mfma_f32_16x16x16_bf16 v[84:87], v[24:25], v[58:59], v[84:87]
    ds_read_b64_tr_b16 v[22:23], v10 offset:8448
    s_waitcnt lgkmcnt(6)
    v_mfma_f32_16x16x16_bf16 v[88:91], v[26:27], v[58:59], v[88:91]
    ds_read_b64_tr_b16 v[24:25], v11 offset:8448
    s_waitcnt lgkmcnt(6)
    v_mfma_f32_16x16x16_bf16 v[92:95], v[28:29], v[58:59], v[92:95]
    ds_read_b64_tr_b16 v[26:27], v12 offset:8448
    s_waitcnt lgkmcnt(6)
    v_mfma_f32_16x16x16_bf16 v[96:99], v[14:15], v[58:59], v[96:99]
    ds_read_b64_tr_b16 v[28:29], v13 offset:8448
    s_waitcnt lgkmcnt(6)
    v_mfma_f32_16x16x16_bf16 v[100:103], v[16:17], v[58:59], v[100:103]
    s_waitcnt lgkmcnt(5)
    v_mfma_f32_16x16x16_bf16 v[104:107], v[18:19], v[58:59], v[104:107]
    s_waitcnt lgkmcnt(4)
    v_mfma_f32_16x16x16_bf16 v[108:111], v[20:21], v[58:59], v[108:111]
    s_waitcnt lgkmcnt(3)
    v_mfma_f32_16x16x16_bf16 v[112:115], v[22:23], v[58:59], v[112:115]
    s_waitcnt lgkmcnt(2)
    v_mfma_f32_16x16x16_bf16 v[116:119], v[24:25], v[58:59], v[116:119]
    s_waitcnt lgkmcnt(1)
    v_mfma_f32_16x16x16_bf16 v[120:123], v[26:27], v[58:59], v[120:123]
    s_waitcnt lgkmcnt(0)
    v_mfma_f32_16x16x16_bf16 v[124:127], v[28:29], v[58:59], v[124:127]
    s_add_u32 m0, s56, 8192
    s_add_u32 s69, s57, 1966080
    buffer_load_dwordx4 v2, s[16:19], s69 offen offset:0 nt lds
    buffer_load_dwordx4 v3, s[16:19], s69 offen offset:1024 nt lds
    buffer_load_dwordx4 v4, s[16:19], s69 offen offset:2048 nt lds
    buffer_load_dwordx4 v5, s[16:19], s69 offen offset:3072 nt lds
    s_add_u32 m0, s56, 12288
    s_add_u32 s69, s69, 4096
    buffer_load_dwordx4 v2, s[16:19], s69 offen offset:0 nt lds
    buffer_load_dwordx4 v3, s[16:19], s69 offen offset:1024 nt lds
    buffer_load_dwordx4 v4, s[16:19], s69 offen offset:2048 nt lds
    buffer_load_dwordx4 v5, s[16:19], s69 offen offset:3072 nt lds
    s_waitcnt vmcnt(8)
    ds_read_b64_tr_b16 v[14:15], v6 offset:0
    ds_read_b64_tr_b16 v[16:17], v7 offset:0
    ds_read_b64_tr_b16 v[18:19], v8 offset:0
    ds_read_b64_tr_b16 v[20:21], v9 offset:0
    ds_read_b64_tr_b16 v[22:23], v10 offset:0
    ds_read_b64_tr_b16 v[24:25], v11 offset:0
    ds_read_b64_tr_b16 v[26:27], v12 offset:0
    ds_read_b64_tr_b16 v[28:29], v13 offset:0
    s_waitcnt lgkmcnt(7)
    v_mfma_f32_16x16x16_bf16 v[64:67], v[14:15], v[60:61], v[64:67]
    s_waitcnt lgkmcnt(6)
    v_mfma_f32_16x16x16_bf16 v[68:71], v[16:17], v[60:61], v[68:71]
    ds_read_b64_tr_b16 v[14:15], v6 offset:256
    s_waitcnt lgkmcnt(6)
    v_mfma_f32_16x16x16_bf16 v[72:75], v[18:19], v[60:61], v[72:75]
    ds_read_b64_tr_b16 v[16:17], v7 offset:256
    s_waitcnt lgkmcnt(6)
    v_mfma_f32_16x16x16_bf16 v[76:79], v[20:21], v[60:61], v[76:79]
    ds_read_b64_tr_b16 v[18:19], v8 offset:256
    s_waitcnt lgkmcnt(6)
    v_mfma_f32_16x16x16_bf16 v[80:83], v[22:23], v[60:61], v[80:83]
    ds_read_b64_tr_b16 v[20:21], v9 offset:256
    s_waitcnt lgkmcnt(6)
    v_mfma_f32_16x16x16_bf16 v[84:87], v[24:25], v[60:61], v[84:87]
    ds_read_b64_tr_b16 v[22:23], v10 offset:256
    s_waitcnt lgkmcnt(6)
    v_mfma_f32_16x16x16_bf16 v[88:91], v[26:27], v[60:61], v[88:91]
    ds_read_b64_tr_b16 v[24:25], v11 offset:256
    s_waitcnt lgkmcnt(6)
    v_mfma_f32_16x16x16_bf16 v[92:95], v[28:29], v[60:61], v[92:95]
    ds_read_b64_tr_b16 v[26:27], v12 offset:256
    s_waitcnt lgkmcnt(6)
    v_mfma_f32_16x16x16_bf16 v[96:99], v[14:15], v[60:61], v[96:99]
    ds_read_b64_tr_b16 v[28:29], v13 offset:256
    s_waitcnt lgkmcnt(6)
    v_mfma_f32_16x16x16_bf16 v[100:103], v[16:17], v[60:61], v[100:103]
    s_waitcnt lgkmcnt(5)
    v_mfma_f32_16x16x16_bf16 v[104:107], v[18:19], v[60:61], v[104:107]
    s_waitcnt lgkmcnt(4)
    v_mfma_f32_16x16x16_bf16 v[108:111], v[20:21], v[60:61], v[108:111]
    s_waitcnt lgkmcnt(3)
    v_mfma_f32_16x16x16_bf16 v[112:115], v[22:23], v[60:61], v[112:115]
    s_waitcnt lgkmcnt(2)
    v_mfma_f32_16x16x16_bf16 v[116:119], v[24:25], v[60:61], v[116:119]
    s_waitcnt lgkmcnt(1)
    v_mfma_f32_16x16x16_bf16 v[120:123], v[26:27], v[60:61], v[120:123]
    s_waitcnt lgkmcnt(0)
    v_mfma_f32_16x16x16_bf16 v[124:127], v[28:29], v[60:61], v[124:127]
    s_add_u32 m0, s56, 0
    s_add_u32 s69, s57, 1572864
    buffer_load_dwordx4 v2, s[4:7], s69 offen offset:0 nt lds
    buffer_load_dwordx4 v3, s[4:7], s69 offen offset:1024 nt lds
    buffer_load_dwordx4 v4, s[4:7], s69 offen offset:2048 nt lds
    buffer_load_dwordx4 v5, s[4:7], s69 offen offset:3072 nt lds
    s_add_u32 m0, s56, 4096
    s_add_u32 s69, s69, 4096
    buffer_load_dwordx4 v2, s[4:7], s69 offen offset:0 nt lds
    buffer_load_dwordx4 v3, s[4:7], s69 offen offset:1024 nt lds
    buffer_load_dwordx4 v4, s[4:7], s69 offen offset:2048 nt lds
    buffer_load_dwordx4 v5, s[4:7], s69 offen offset:3072 nt lds
    s_waitcnt vmcnt(8)
    ds_read_b64_tr_b16 v[14:15], v6 offset:8192
    ds_read_b64_tr_b16 v[16:17], v7 offset:8192
    ds_read_b64_tr_b16 v[18:19], v8 offset:8192
    ds_read_b64_tr_b16 v[20:21], v9 offset:8192
    ds_read_b64_tr_b16 v[22:23], v10 offset:8192
    ds_read_b64_tr_b16 v[24:25], v11 offset:8192
    ds_read_b64_tr_b16 v[26:27], v12 offset:8192
    ds_read_b64_tr_b16 v[28:29], v13 offset:8192
    s_waitcnt lgkmcnt(7)
    v_mfma_f32_16x16x16_bf16 v[64:67], v[14:15], v[62:63], v[64:67]
    s_waitcnt lgkmcnt(6)
    v_mfma_f32_16x16x16_bf16 v[68:71], v[16:17], v[62:63], v[68:71]
    ds_read_b64_tr_b16 v[14:15], v6 offset:8448
    s_waitcnt lgkmcnt(6)
    v_mfma_f32_16x16x16_bf16 v[72:75], v[18:19], v[62:63], v[72:75]
    ds_read_b64_tr_b16 v[16:17], v7 offset:8448
    s_waitcnt lgkmcnt(6)
    v_mfma_f32_16x16x16_bf16 v[76:79], v[20:21], v[62:63], v[76:79]
    ds_read_b64_tr_b16 v[18:19], v8 offset:8448
    s_waitcnt lgkmcnt(6)
    v_mfma_f32_16x16x16_bf16 v[80:83], v[22:23], v[62:63], v[80:83]
    ds_read_b64_tr_b16 v[20:21], v9 offset:8448
    s_waitcnt lgkmcnt(6)
    v_mfma_f32_16x16x16_bf16 v[84:87], v[24:25], v[62:63], v[84:87]
    ds_read_b64_tr_b16 v[22:23], v10 offset:8448
    s_waitcnt lgkmcnt(6)
    v_mfma_f32_16x16x16_bf16 v[88:91], v[26:27], v[62:63], v[88:91]
    ds_read_b64_tr_b16 v[24:25], v11 offset:8448
    s_waitcnt lgkmcnt(6)
    v_mfma_f32_16x16x16_bf16 v[92:95], v[28:29], v[62:63], v[92:95]
    ds_read_b64_tr_b16 v[26:27], v12 offset:8448
    s_waitcnt lgkmcnt(6)
    v_mfma_f32_16x16x16_bf16 v[96:99], v[14:15], v[62:63], v[96:99]
    ds_read_b64_tr_b16 v[28:29], v13 offset:8448
    s_waitcnt lgkmcnt(6)
    v_mfma_f32_16x16x16_bf16 v[100:103], v[16:17], v[62:63], v[100:103]
    s_waitcnt lgkmcnt(5)
    v_mfma_f32_16x16x16_bf16 v[104:107], v[18:19], v[62:63], v[104:107]
    s_waitcnt lgkmcnt(4)
    v_mfma_f32_16x16x16_bf16 v[108:111], v[20:21], v[62:63], v[108:111]
    s_waitcnt lgkmcnt(3)
    v_mfma_f32_16x16x16_bf16 v[112:115], v[22:23], v[62:63], v[112:115]
    s_waitcnt lgkmcnt(2)
    v_mfma_f32_16x16x16_bf16 v[116:119], v[24:25], v[62:63], v[116:119]
    s_waitcnt lgkmcnt(1)
    v_mfma_f32_16x16x16_bf16 v[120:123], v[26:27], v[62:63], v[120:123]
    s_waitcnt lgkmcnt(0)
    v_mfma_f32_16x16x16_bf16 v[124:127], v[28:29], v[62:63], v[124:127]
    v_and_b32 v30, 1, v1
    v_lshlrev_b32 v30, 10, v30
    v_lshrrev_b32 v31, 4, v1
    v_lshl_add_u32 v30, v31, 4, v30
    s_lshl_b32 s69, s52, 11
    s_add_u32 s69, s69, 126976
    v_add_u32 v30, s69, v30
    s_nop 7
    s_mov_b64 exec, s[70:71]
    ds_write_b128 v30, v[64:67] offset:0
    ds_write_b128 v30, v[68:71] offset:64
    ds_write_b128 v30, v[72:75] offset:128
    ds_write_b128 v30, v[76:79] offset:192
    ds_write_b128 v30, v[80:83] offset:256
    ds_write_b128 v30, v[84:87] offset:320
    ds_write_b128 v30, v[88:91] offset:384
    ds_write_b128 v30, v[92:95] offset:448
    ds_write_b128 v30, v[96:99] offset:512
    ds_write_b128 v30, v[100:103] offset:576
    ds_write_b128 v30, v[104:107] offset:640
    ds_write_b128 v30, v[108:111] offset:704
    s_waitcnt lgkmcnt(4)
    ds_write_b128 v30, v[112:115] offset:768
    ds_write_b128 v30, v[116:119] offset:832
    ds_write_b128 v30, v[120:123] offset:896
    ds_write_b128 v30, v[124:127] offset:960
    s_mov_b64 exec, -1
    s_waitcnt lgkmcnt(0)
    v_mov_b32 v30, s84
    v_mov_b32 v31, 6
    ds_write_b32 v30, v31
    v_mov_b32 v30, s85
Lps_40:
    ds_read_b32 v31, v30
    s_waitcnt lgkmcnt(0)
    v_cmp_gt_u32 vcc, 6, v31
    s_cbranch_vccz Lpd_41
    s_cmp_eq_u32 s83, 0
    s_cbranch_scc1 Lpd_41
    s_sub_u32 s83, s83, 1
    s_branch Lps_40
Lpd_41:
    s_lshl_b32 s69, s54, 5
    s_lshl_b32 s72, s82, 3
    s_add_u32 s69, s69, s72
    s_add_u32 s69, s69, 135168
    v_mov_b32 v30, s69
    s_mul_i32 s69, s54, 4096
    s_lshl_b32 s72, s82, 10
    s_add_u32 s69, s69, s72
    s_add_u32 s69, s69, 126976
    v_and_b32 v31, 31, v1
    v_lshlrev_b32 v31, 5, v31
    v_add_u32 v31, s69, v31
    ds_read_b64 v[32:33], v30 offset:0
    ds_read_b64 v[34:35], v30 offset:16
    ds_read_b128 v[40:43], v31 offset:0
    ds_read_b128 v[44:47], v31 offset:16
    ds_read_b128 v[48:51], v31 offset:2048
    ds_read_b128 v[52:55], v31 offset:2064
    v_lshlrev_b32 v56, 4, v1
    v_cmp_gt_u32 vcc, 32, v1
    v_mov_b32 v58, 2147483648
    s_nop 0
    v_cndmask_b32 v56, v58, v56, vcc
    v_cmp_eq_u32 vcc, 0, v1
    v_mov_b32 v57, 0
    s_nop 0
    v_cndmask_b32 v57, v58, v57, vcc
    s_waitcnt lgkmcnt(4)
    v_max_f32 v36, v32, v34
    v_sub_f32 v32, v32, v36
    v_sub_f32 v34, v34, v36
    v_exp_f32 v32, v32
    v_exp_f32 v34, v34
    s_nop 0
    v_mul_f32 v37, v32, v33
    v_fmac_f32 v37, v34, v35
    s_waitcnt lgkmcnt(0)
    v_mul_f32 v40, v40, v32
    v_mul_f32 v41, v41, v32
    v_mul_f32 v42, v42, v32
    v_mul_f32 v43, v43, v32
    v_mul_f32 v44, v44, v32
    v_mul_f32 v45, v45, v32
    v_mul_f32 v46, v46, v32
    v_mul_f32 v47, v47, v32
    v_fmac_f32 v40, v48, v34
    v_fmac_f32 v41, v49, v34
    v_fmac_f32 v42, v50, v34
    v_fmac_f32 v43, v51, v34
    v_fmac_f32 v44, v52, v34
    v_fmac_f32 v45, v53, v34
    v_fmac_f32 v46, v54, v34
    v_fmac_f32 v47, v55, v34
    v_cvt_pk_bf16_f32 v48, v40, v41
    v_cvt_pk_bf16_f32 v49, v42, v43
    v_cvt_pk_bf16_f32 v50, v44, v45
    v_cvt_pk_bf16_f32 v51, v46, v47
    v_min_u32 v48, -2, v48
    v_min_u32 v49, -2, v49
    v_min_u32 v50, -2, v50
    v_min_u32 v51, -2, v51
    s_add_u32 s72, s76, 32768
    s_add_u32 s73, s77, 8192
    s_cmp_eq_u32 s100, 0
    s_cbranch_scc1 Lwt_42
    buffer_store_dwordx4 v[48:51], v56, s[36:39], s72 offen
    buffer_store_dwordx2 v[36:37], v57, s[36:39], s73 offen
    s_branch Lwd_43
Lwt_42:
    buffer_store_dwordx4 v[48:51], v56, s[36:39], s72 offen sc1
    buffer_store_dwordx2 v[36:37], v57, s[36:39], s73 offen sc1
Lwd_43:
    s_nop 1
    v_and_b32 v6, 15, v1
    v_lshlrev_b32 v7, 8, v6
    v_lshlrev_b32 v6, 9, v6
    v_lshrrev_b32 v30, 4, v1
    v_lshl_add_u32 v6, v30, 4, v6
    s_lshl_b32 s69, s82, 14
    s_add_u32 s72, s61, 32768
    s_add_u32 s72, s72, s69
    s_add_u32 s73, s62, 8192
    buffer_load_dwordx2 v[22:23], v7, s[36:39], s73 offen offset:0 sc1
    buffer_load_dwordx4 v[32:35], v6, s[36:39], s72 offen offset:0 sc1
    buffer_load_dwordx4 v[36:39], v6, s[36:39], s72 offen offset:64 sc1
    buffer_load_dwordx4 v[40:43], v6, s[36:39], s72 offen offset:128 sc1
    buffer_load_dwordx4 v[44:47], v6, s[36:39], s72 offen offset:192 sc1
    buffer_load_dwordx4 v[48:51], v6, s[36:39], s72 offen offset:256 sc1
    buffer_load_dwordx4 v[52:55], v6, s[36:39], s72 offen offset:320 sc1
    buffer_load_dwordx4 v[56:59], v6, s[36:39], s72 offen offset:384 sc1
    buffer_load_dwordx4 v[60:63], v6, s[36:39], s72 offen offset:448 sc1
    s_add_u32 s79, s73, 4096
    buffer_load_dwordx2 v[24:25], v7, s[36:39], s79 offen sc1
    s_add_u32 s79, s72, 8192
    buffer_load_dwordx4 v[64:67], v6, s[36:39], s79 offen offset:0 sc1
    buffer_load_dwordx4 v[68:71], v6, s[36:39], s79 offen offset:64 sc1
    buffer_load_dwordx4 v[72:75], v6, s[36:39], s79 offen offset:128 sc1
    buffer_load_dwordx4 v[76:79], v6, s[36:39], s79 offen offset:192 sc1
    buffer_load_dwordx4 v[80:83], v6, s[36:39], s79 offen offset:256 sc1
    buffer_load_dwordx4 v[84:87], v6, s[36:39], s79 offen offset:320 sc1
    buffer_load_dwordx4 v[88:91], v6, s[36:39], s79 offen offset:384 sc1
    buffer_load_dwordx4 v[92:95], v6, s[36:39], s79 offen offset:448 sc1
    s_add_u32 m0, s56, 8192
    s_add_u32 s69, s57, 0
    buffer_load_dwordx4 v2, s[4:7], s69 offen offset:0 nt lds
    buffer_load_dwordx4 v3, s[4:7], s69 offen offset:1024 nt lds
    buffer_load_dwordx4 v4, s[4:7], s69 offen offset:2048 nt lds
    buffer_load_dwordx4 v5, s[4:7], s69 offen offset:3072 nt lds
    s_add_u32 m0, s56, 12288
    s_add_u32 s69, s69, 4096
    buffer_load_dwordx4 v2, s[4:7], s69 offen offset:0 nt lds
    buffer_load_dwordx4 v3, s[4:7], s69 offen offset:1024 nt lds
    buffer_load_dwordx4 v4, s[4:7], s69 offen offset:2048 nt lds
    buffer_load_dwordx4 v5, s[4:7], s69 offen offset:3072 nt lds
    v_lshrrev_b32 v8, 4, v1
    v_lshlrev_b32 v8, 8, v8
    v_bfe_u32 v9, v1, 2, 2
    v_lshl_add_u32 v8, v9, 5, v8
    v_and_b32 v9, 3, v1
    v_lshl_add_u32 v8, v9, 3, v8
    s_mul_i32 s69, s82, 8192
    s_add_u32 s69, s69, 81920
    v_add_u32 v8, s69, v8
    ds_read_b64_tr_b16 v[96:97], v8 offset:0
    ds_read_b64_tr_b16 v[98:99], v8 offset:128
    ds_read_b64_tr_b16 v[100:101], v8 offset:1024
    ds_read_b64_tr_b16 v[102:103], v8 offset:1152
    ds_read_b64_tr_b16 v[104:105], v8 offset:2048
    ds_read_b64_tr_b16 v[106:107], v8 offset:2176
    ds_read_b64_tr_b16 v[108:109], v8 offset:3072
    ds_read_b64_tr_b16 v[110:111], v8 offset:3200
    s_waitcnt lgkmcnt(4)
    ds_read_b64_tr_b16 v[112:113], v8 offset:4096
    ds_read_b64_tr_b16 v[114:115], v8 offset:4224
    ds_read_b64_tr_b16 v[116:117], v8 offset:5120
    ds_read_b64_tr_b16 v[118:119], v8 offset:5248
    ds_read_b64_tr_b16 v[120:121], v8 offset:6144
    ds_read_b64_tr_b16 v[122:123], v8 offset:6272
    ds_read_b64_tr_b16 v[124:125], v8 offset:7168
    ds_read_b64_tr_b16 v[126:127], v8 offset:7296
    s_waitcnt lgkmcnt(0)
    s_waitcnt vmcnt(8)
Lpolls1_1_44:
    s_mov_b32 s90, 0
    v_max3_u32 v31, v22, v23, v32
    v_max3_u32 v31, v31, v33, v34
    v_max3_u32 v31, v31, v35, v36
    v_max3_u32 v31, v31, v37, v38
    v_max3_u32 v31, v31, v39, v40
    v_max3_u32 v31, v31, v41, v42
    v_max3_u32 v31, v31, v43, v44
    v_max3_u32 v31, v31, v45, v46
    v_max3_u32 v31, v31, v47, v48
    v_max3_u32 v31, v31, v49, v50
    v_max3_u32 v31, v31, v51, v52
    v_max3_u32 v31, v31, v53, v54
    v_max3_u32 v31, v31, v55, v56
    v_max3_u32 v31, v31, v57, v58
    v_max3_u32 v31, v31, v59, v60
    v_max3_u32 v31, v31, v61, v62
    v_max_u32 v31, v31, v63
    v_cmp_eq_u32 vcc, -1, v31
    s_cbranch_vccz Lsks1_1_46
    s_mov_b64 exec, vcc
    buffer_load_dwordx2 v[22:23], v7, s[36:39], s73 offen offset:0 sc1
    buffer_load_dwordx4 v[32:35], v6, s[36:39], s72 offen offset:0 sc1
    buffer_load_dwordx4 v[36:39], v6, s[36:39], s72 offen offset:64 sc1
    buffer_load_dwordx4 v[40:43], v6, s[36:39], s72 offen offset:128 sc1
    buffer_load_dwordx4 v[44:47], v6, s[36:39], s72 offen offset:192 sc1
    buffer_load_dwordx4 v[48:51], v6, s[36:39], s72 offen offset:256 sc1
    buffer_load_dwordx4 v[52:55], v6, s[36:39], s72 offen offset:320 sc1
    buffer_load_dwordx4 v[56:59], v6, s[36:39], s72 offen offset:384 sc1
    buffer_load_dwordx4 v[60:63], v6, s[36:39], s72 offen offset:448 sc1
    s_mov_b64 exec, -1
    s_mov_b32 s90, 1
Lsks1_1_46:
    v_max3_u32 v31, v24, v25, v64
    v_max3_u32 v31, v31, v65, v66
    v_max3_u32 v31, v31, v67, v68
    v_max3_u32 v31, v31, v69, v70
    v_max3_u32 v31, v31, v71, v72
    v_max3_u32 v31, v31, v73, v74
    v_max3_u32 v31, v31, v75, v76
    v_max3_u32 v31, v31, v77, v78
    v_max3_u32 v31, v31, v79, v80
    v_max3_u32 v31, v31, v81, v82
    v_max3_u32 v31, v31, v83, v84
    v_max3_u32 v31, v31, v85, v86
    v_max3_u32 v31, v31, v87, v88
    v_max3_u32 v31, v31, v89, v90
    v_max3_u32 v31, v31, v91, v92
    v_max3_u32 v31, v31, v93, v94
    v_max_u32 v31, v31, v95
    v_cmp_eq_u32 vcc, -1, v31
    s_cbranch_vccz Lsks1_1_47
    s_mov_b64 exec, vcc
    s_add_u32 s79, s73, 4096
    buffer_load_dwordx2 v[24:25], v7, s[36:39], s79 offen sc1
    s_add_u32 s79, s72, 8192
    buffer_load_dwordx4 v[64:67], v6, s[36:39], s79 offen offset:0 sc1
    buffer_load_dwordx4 v[68:71], v6, s[36:39], s79 offen offset:64 sc1
    buffer_load_dwordx4 v[72:75], v6, s[36:39], s79 offen offset:128 sc1
    buffer_load_dwordx4 v[76:79], v6, s[36:39], s79 offen offset:192 sc1
    buffer_load_dwordx4 v[80:83], v6, s[36:39], s79 offen offset:256 sc1
    buffer_load_dwordx4 v[84:87], v6, s[36:39], s79 offen offset:320 sc1
    buffer_load_dwordx4 v[88:91], v6, s[36:39], s79 offen offset:384 sc1
    buffer_load_dwordx4 v[92:95], v6, s[36:39], s79 offen offset:448 sc1
    s_mov_b64 exec, -1
    s_mov_b32 s90, 1
Lsks1_1_47:
    s_cmp_eq_u32 s90, 0
    s_cbranch_scc1 Ldones1_1_45
    s_waitcnt vmcnt(0)
    s_cmp_eq_u32 s65, 0
    s_cbranch_scc1 Ldones1_1_45
    s_sub_u32 s65, s65, 1
    s_sleep 1
    s_branch Lpolls1_1_44
Ldones1_1_45:
    v_mfma_f32_16x16x32_bf16 v[14:17], v[96:99], v[32:35], 0
    v_mfma_f32_16x16x32_bf16 v[18:21], v[96:99], v[64:67], 0
    v_mfma_f32_16x16x32_bf16 v[14:17], v[100:103], v[36:39], v[14:17]
    v_mfma_f32_16x16x32_bf16 v[18:21], v[100:103], v[68:71], v[18:21]
    v_mfma_f32_16x16x32_bf16 v[14:17], v[104:107], v[40:43], v[14:17]
    v_mfma_f32_16x16x32_bf16 v[18:21], v[104:107], v[72:75], v[18:21]
    v_mfma_f32_16x16x32_bf16 v[14:17], v[108:111], v[44:47], v[14:17]
    v_mfma_f32_16x16x32_bf16 v[18:21], v[108:111], v[76:79], v[18:21]
    v_mfma_f32_16x16x32_bf16 v[14:17], v[112:115], v[48:51], v[14:17]
    v_mfma_f32_16x16x32_bf16 v[18:21], v[112:115], v[80:83], v[18:21]
    v_mfma_f32_16x16x32_bf16 v[14:17], v[116:119], v[52:55], v[14:17]
    v_mfma_f32_16x16x32_bf16 v[18:21], v[116:119], v[84:87], v[18:21]
    v_mfma_f32_16x16x32_bf16 v[14:17], v[120:123], v[56:59], v[14:17]
    v_mfma_f32_16x16x32_bf16 v[18:21], v[120:123], v[88:91], v[18:21]
    v_mfma_f32_16x16x32_bf16 v[14:17], v[124:127], v[60:63], v[14:17]
    v_mfma_f32_16x16x32_bf16 v[18:21], v[124:127], v[92:95], v[18:21]
    v_mov_b32 v26, v22
    v_mov_b32 v27, v24
    s_nop 0
    v_max_f32_dpp v26, v26, v26 quad_perm:[1,0,3,2] row_mask:0xf bank_mask:0xf
    v_max_f32_dpp v27, v27, v27 quad_perm:[1,0,3,2] row_mask:0xf bank_mask:0xf
    s_nop 0
    v_max_f32_dpp v26, v26, v26 quad_perm:[2,3,0,1] row_mask:0xf bank_mask:0xf
    v_max_f32_dpp v27, v27, v27 quad_perm:[2,3,0,1] row_mask:0xf bank_mask:0xf
    s_nop 0
    v_max_f32_dpp v26, v26, v26 row_half_mirror row_mask:0xf bank_mask:0xf
    v_max_f32_dpp v27, v27, v27 row_half_mirror row_mask:0xf bank_mask:0xf
    v_sub_f32 v26, v22, v26
    v_sub_f32 v27, v24, v27
    v_exp_f32 v26, v26
    v_exp_f32 v27, v27
    s_nop 0
    v_mul_f32 v28, v26, v23
    v_mul_f32 v29, v27, v25
    s_nop 0
    v_add_f32_dpp v28, v28, v28 quad_perm:[1,0,3,2] row_mask:0xf bank_mask:0xf
    v_add_f32_dpp v29, v29, v29 quad_perm:[1,0,3,2] row_mask:0xf bank_mask:0xf
    s_nop 0
    v_add_f32_dpp v28, v28, v28 quad_perm:[2,3,0,1] row_mask:0xf bank_mask:0xf
    v_add_f32_dpp v29, v29, v29 quad_perm:[2,3,0,1] row_mask:0xf bank_mask:0xf
    s_nop 0
    v_add_f32_dpp v28, v28, v28 row_half_mirror row_mask:0xf bank_mask:0xf
    v_add_f32_dpp v29, v29, v29 row_half_mirror row_mask:0xf bank_mask:0xf
    v_rcp_f32 v28, v28
    v_rcp_f32 v29, v29
    s_nop 0
    v_mul_f32 v26, v26, v28
    v_mul_f32 v27, v27, v29
    v_bfe_u32 v30, v1, 3, 1
    v_lshlrev_b32 v30, 6, v30
    v_lshrrev_b32 v31, 4, v1
    v_lshl_add_u32 v30, v31, 4, v30
    s_lshl_b32 s69, s52, 8
    s_add_u32 s69, s69, 135424
    v_add_u32 v30, s69, v30
    s_nop 3
    v_mul_f32 v14, v14, v26
    v_mul_f32 v18, v18, v27
    v_mul_f32 v15, v15, v26
    v_mul_f32 v19, v19, v27
    v_mul_f32 v16, v16, v26
    v_mul_f32 v20, v20, v27
    v_mul_f32 v17, v17, v26
    v_mul_f32 v21, v21, v27
    v_add_f32_dpp v14, v14, v14 quad_perm:[1,0,3,2] row_mask:0xf bank_mask:0xf
    v_add_f32_dpp v15, v15, v15 quad_perm:[1,0,3,2] row_mask:0xf bank_mask:0xf
    v_add_f32_dpp v16, v16, v16 quad_perm:[1,0,3,2] row_mask:0xf bank_mask:0xf
    v_add_f32_dpp v17, v17, v17 quad_perm:[1,0,3,2] row_mask:0xf bank_mask:0xf
    v_add_f32_dpp v18, v18, v18 quad_perm:[1,0,3,2] row_mask:0xf bank_mask:0xf
    v_add_f32_dpp v19, v19, v19 quad_perm:[1,0,3,2] row_mask:0xf bank_mask:0xf
    v_add_f32_dpp v20, v20, v20 quad_perm:[1,0,3,2] row_mask:0xf bank_mask:0xf
    v_add_f32_dpp v21, v21, v21 quad_perm:[1,0,3,2] row_mask:0xf bank_mask:0xf
    v_add_f32_dpp v14, v14, v14 quad_perm:[2,3,0,1] row_mask:0xf bank_mask:0xf
    v_add_f32_dpp v15, v15, v15 quad_perm:[2,3,0,1] row_mask:0xf bank_mask:0xf
    v_add_f32_dpp v16, v16, v16 quad_perm:[2,3,0,1] row_mask:0xf bank_mask:0xf
    v_add_f32_dpp v17, v17, v17 quad_perm:[2,3,0,1] row_mask:0xf bank_mask:0xf
    v_add_f32_dpp v18, v18, v18 quad_perm:[2,3,0,1] row_mask:0xf bank_mask:0xf
    v_add_f32_dpp v19, v19, v19 quad_perm:[2,3,0,1] row_mask:0xf bank_mask:0xf
    v_add_f32_dpp v20, v20, v20 quad_perm:[2,3,0,1] row_mask:0xf bank_mask:0xf
    v_add_f32_dpp v21, v21, v21 quad_perm:[2,3,0,1] row_mask:0xf bank_mask:0xf
    v_add_f32_dpp v14, v14, v14 row_half_mirror row_mask:0xf bank_mask:0xf
    v_add_f32_dpp v15, v15, v15 row_half_mirror row_mask:0xf bank_mask:0xf
    v_add_f32_dpp v16, v16, v16 row_half_mirror row_mask:0xf bank_mask:0xf
    v_add_f32_dpp v17, v17, v17 row_half_mirror row_mask:0xf bank_mask:0xf
    v_add_f32_dpp v18, v18, v18 row_half_mirror row_mask:0xf bank_mask:0xf
    v_add_f32_dpp v19, v19, v19 row_half_mirror row_mask:0xf bank_mask:0xf
    v_add_f32_dpp v20, v20, v20 row_half_mirror row_mask:0xf bank_mask:0xf
    v_add_f32_dpp v21, v21, v21 row_half_mirror row_mask:0xf bank_mask:0xf
    ds_write_b128 v30, v[14:17]
    ds_write_b128 v30, v[18:21] offset:128
    s_waitcnt lgkmcnt(0)
    v_mov_b32 v30, s84
    v_mov_b32 v31, 7
    ds_write_b32 v30, v31
    v_mov_b32 v30, s85
Lps_48:
    ds_read_b32 v31, v30
    s_waitcnt lgkmcnt(0)
    v_cmp_gt_u32 vcc, 7, v31
    s_cbranch_vccz Lpd_49
    s_cmp_eq_u32 s83, 0
    s_cbranch_scc1 Lpd_49
    s_sub_u32 s83, s83, 1
    s_branch Lps_48
Lpd_49:
    s_add_u32 s72, s63, 3584
    s_lshl_b32 s69, s54, 9
    s_add_u32 s69, s69, 135424
    v_and_b32 v30, 7, v1
    v_lshlrev_b32 v30, 5, v30
    v_add_u32 v30, s69, v30
    ds_read_b128 v[64:67], v30 offset:0
    ds_read_b128 v[68:71], v30 offset:16
    ds_read_b128 v[72:75], v30 offset:256
    ds_read_b128 v[76:79], v30 offset:272
    v_lshlrev_b32 v31, 4, v1
    s_cmp_eq_u32 s82, 0
    s_cselect_b32 s69, 8, 0
    s_cmp_lt_u32 s55, 28
    s_cselect_b32 s69, s69, 0
    v_cmp_gt_u32 vcc, s69, v1
    v_mov_b32 v80, 2147483648
    s_nop 0
    v_cndmask_b32 v31, v80, v31, vcc
    s_waitcnt lgkmcnt(0)
    v_add_f32 v64, v64, v72
    v_add_f32 v65, v65, v73
    v_add_f32 v66, v66, v74
    v_add_f32 v67, v67, v75
    v_add_f32 v68, v68, v76
    v_add_f32 v69, v69, v77
    v_add_f32 v70, v70, v78
    v_add_f32 v71, v71, v79
    v_cvt_pk_bf16_f32 v72, v64, v65
    v_cvt_pk_bf16_f32 v73, v66, v67
    v_cvt_pk_bf16_f32 v74, v68, v69
    v_cvt_pk_bf16_f32 v75, v70, v71
    v_min_u32 v72, -2, v72
    v_min_u32 v73, -2, v73
    v_min_u32 v74, -2, v74
    v_min_u32 v75, -2, v75
    buffer_store_dwordx4 v[72:75], v31, s[36:39], s72 offen sc1
    s_cmp_lg_u32 s82, 0
    s_cbranch_scc1 Lxs_50
    s_cmp_ge_u32 s55, 28
    s_cbranch_scc1 Lxs_50
    v_lshrrev_b32 v30, 3, v1
    v_mul_u32_u24 v30, 196608, v30
    v_and_b32 v31, 7, v1
    v_lshl_add_u32 v30, v31, 4, v30
    s_lshl_b32 s72, s55, 7
    s_add_u32 s72, s72, s60
    s_add_u32 s72, s72, 138752
    buffer_load_dwordx4 v[32:35], v30, s[36:39], s72 offen sc1
    s_waitcnt vmcnt(0)
Lpollxs_1_51:
    v_max3_u32 v31, v32, v33, v34
    v_max_u32 v31, v31, v35
    v_cmp_eq_u32 vcc, -1, v31
    s_cbranch_vccz Ldonexs_1_52
Lhsxs_1_53:
    s_add_u32 s3, s72, 786432
    s_buffer_load_dword s92, s[36:39], s72 offset:124 glc
    s_buffer_load_dword s93, s[36:39], s72 offset:196732 glc
    s_buffer_load_dword s94, s[36:39], s72 offset:393340 glc
    s_buffer_load_dword s95, s[36:39], s72 offset:589948 glc
    s_buffer_load_dword s96, s[36:39], s3 offset:124 glc
    s_buffer_load_dword s97, s[36:39], s3 offset:196732 glc
    s_buffer_load_dword s98, s[36:39], s3 offset:393340 glc
    s_buffer_load_dword s99, s[36:39], s3 offset:589948 glc
    s_waitcnt lgkmcnt(0)
    s_max_u32 s92, s92, s93
    s_max_u32 s92, s92, s94
    s_max_u32 s92, s92, s95
    s_max_u32 s92, s92, s96
    s_max_u32 s92, s92, s97
    s_max_u32 s92, s92, s98
    s_max_u32 s92, s92, s99
    s_cmp_lg_u32 s92, -1
    s_cbranch_scc1 Lhrxs_1_54
    s_cmp_eq_u32 s65, 0
    s_cbranch_scc1 Ldonexs_1_52
    s_sub_u32 s65, s65, 1
    s_sleep 2
    s_branch Lhsxs_1_53
Lhrxs_1_54:
    s_cbranch_vccz Ldonexs_1_52
    s_mov_b64 exec, vcc
    buffer_load_dwordx4 v[32:35], v30, s[36:39], s72 offen sc1
    s_mov_b64 exec, -1
    s_waitcnt vmcnt(0)
    s_cmp_eq_u32 s65, 0
    s_cbranch_scc1 Ldonexs_1_52
    s_sub_u32 s65, s65, 1
    s_branch Lpollxs_1_51
Ldonexs_1_52:
    v_lshlrev_b32 v40, 16, v32
    v_and_b32 v41, 0xffff0000, v32
    v_lshlrev_b32 v42, 16, v33
    v_and_b32 v43, 0xffff0000, v33
    v_lshlrev_b32 v44, 16, v34
    v_and_b32 v45, 0xffff0000, v34
    v_lshlrev_b32 v46, 16, v35
    v_and_b32 v47, 0xffff0000, v35
    v_add_f32_dpp v40, v40, v40 row_ror:8 row_mask:0xf bank_mask:0xf
    v_add_f32_dpp v41, v41, v41 row_ror:8 row_mask:0xf bank_mask:0xf
    v_add_f32_dpp v42, v42, v42 row_ror:8 row_mask:0xf bank_mask:0xf
    v_add_f32_dpp v43, v43, v43 row_ror:8 row_mask:0xf bank_mask:0xf
    v_add_f32_dpp v44, v44, v44 row_ror:8 row_mask:0xf bank_mask:0xf
    v_add_f32_dpp v45, v45, v45 row_ror:8 row_mask:0xf bank_mask:0xf
    v_add_f32_dpp v46, v46, v46 row_ror:8 row_mask:0xf bank_mask:0xf
    v_add_f32_dpp v47, v47, v47 row_ror:8 row_mask:0xf bank_mask:0xf
    s_nop 0
    v_mov_b32 v48, v40
    v_mov_b32 v49, v41
    v_mov_b32 v50, v42
    v_mov_b32 v51, v43
    v_mov_b32 v52, v44
    v_mov_b32 v53, v45
    v_mov_b32 v54, v46
    v_mov_b32 v55, v47
    s_nop 0
    v_permlane32_swap_b32 v48, v40
    v_permlane32_swap_b32 v49, v41
    v_permlane32_swap_b32 v50, v42
    v_permlane32_swap_b32 v51, v43
    v_permlane32_swap_b32 v52, v44
    v_permlane32_swap_b32 v53, v45
    v_permlane32_swap_b32 v54, v46
    v_permlane32_swap_b32 v55, v47
    s_nop 0
    v_add_f32 v40, v40, v48
    v_add_f32 v41, v41, v49
    v_add_f32 v42, v42, v50
    v_add_f32 v43, v43, v51
    v_add_f32 v44, v44, v52
    v_add_f32 v45, v45, v53
    v_add_f32 v46, v46, v54
    v_add_f32 v47, v47, v55
    v_mov_b32 v48, v40
    v_mov_b32 v49, v41
    v_mov_b32 v50, v42
    v_mov_b32 v51, v43
    v_mov_b32 v52, v44
    v_mov_b32 v53, v45
    v_mov_b32 v54, v46
    v_mov_b32 v55, v47
    s_nop 0
    v_permlane16_swap_b32 v48, v40
    v_permlane16_swap_b32 v49, v41
    v_permlane16_swap_b32 v50, v42
    v_permlane16_swap_b32 v51, v43
    v_permlane16_swap_b32 v52, v44
    v_permlane16_swap_b32 v53, v45
    v_permlane16_swap_b32 v54, v46
    v_permlane16_swap_b32 v55, v47
    s_nop 0
    v_add_f32 v40, v40, v48
    v_add_f32 v41, v41, v49
    v_add_f32 v42, v42, v50
    v_add_f32 v43, v43, v51
    v_add_f32 v44, v44, v52
    v_add_f32 v45, v45, v53
    v_add_f32 v46, v46, v54
    v_add_f32 v47, v47, v55
    v_cvt_pk_bf16_f32 v32, v40, v41
    v_cvt_pk_bf16_f32 v33, v42, v43
    v_cvt_pk_bf16_f32 v34, v44, v45
    v_cvt_pk_bf16_f32 v35, v46, v47
    v_min_u32 v32, -2, v32
    v_min_u32 v33, -2, v33
    v_min_u32 v34, -2, v34
    v_min_u32 v35, -2, v35
    v_lshlrev_b32 v30, 4, v1
    s_lshl_b32 s72, s55, 7
    s_add_u32 s72, s72, s101
    s_add_u32 s72, s72, 4096
    v_cmp_gt_u32 vcc, 8, v1
    v_mov_b32 v31, 2147483648
    s_nop 0
    v_cndmask_b32 v30, v31, v30, vcc
    s_cmp_eq_u32 s100, 0
    s_cbranch_scc1 Lwt_55
    buffer_store_dwordx4 v[32:35], v30, s[36:39], s72 offen
    s_branch Lwd_56
Lwt_55:
    buffer_store_dwordx4 v[32:35], v30, s[36:39], s72 offen sc1
Lwd_56:
    s_nop 1
Lxs_50:
    s_nop 1
    s_lshl_b32 s69, s82, 6
    v_lshrrev_b32 v30, 1, v1
    v_lshlrev_b32 v30, 7, v30
    v_and_b32 v31, 1, v1
    v_lshl_add_u32 v30, v31, 4, v30
    v_add_u32 v30, s69, v30
    v_mov_b32 v31, 2147483648
    v_cndmask_b32 v30, v31, v30, s[66:67]
    s_add_u32 s72, s60, 138752
    s_add_u32 s72, s101, 4096
    buffer_load_dwordx4 v[60:63], v30, s[36:39], s72 offen sc1
    buffer_load_dwordx4 v[124:127], v30, s[36:39], s72 offen offset:32 sc1
    s_lshl_b32 s69, s54, 1
    s_add_u32 s69, s69, s82
    s_mul_i32 s69, s69, 3584
    s_add_u32 s69, s69, 148224
    v_lshlrev_b32 v31, 5, v1
    v_add_u32 v31, s69, v31
    v_mov_b32 v14, 0
    v_mov_b32 v15, 0
    v_mov_b32 v16, 0
    v_mov_b32 v17, 0
    v_mov_b32 v18, 0
    v_mov_b32 v19, 0
    v_mov_b32 v20, 0
    v_mov_b32 v21, 0
    v_mov_b32 v22, 0
    v_mov_b32 v23, 0
    v_mov_b32 v24, 0
    v_mov_b32 v25, 0
    v_mov_b32 v26, 0
    v_mov_b32 v27, 0
    v_mov_b32 v28, 0
    v_mov_b32 v29, 0
    s_mov_b64 exec, s[66:67]
    ds_read_b128 v[14:17], v31 offset:0
    ds_read_b128 v[18:21], v31 offset:16
    ds_read_b128 v[22:25], v31 offset:1792
    ds_read_b128 v[26:29], v31 offset:1808
    s_mov_b64 exec, -1
    v_lshrrev_b32 v84, 4, v1
    v_lshlrev_b32 v84, 8, v84
    v_bfe_u32 v85, v1, 2, 2
    v_lshl_add_u32 v84, v85, 5, v84
    v_and_b32 v85, 3, v1
    v_lshl_add_u32 v84, v85, 3, v84
    s_mul_i32 s69, s82, 7168
    s_add_u32 s69, s69, 98304
    v_add_u32 v84, s69, v84
    ds_read_b64_tr_b16 v[96:97], v84 offset:0
    ds_read_b64_tr_b16 v[98:99], v84 offset:128
    ds_read_b64_tr_b16 v[100:101], v84 offset:1024
    ds_read_b64_tr_b16 v[102:103], v84 offset:1152
    ds_read_b64_tr_b16 v[104:105], v84 offset:2048
    ds_read_b64_tr_b16 v[106:107], v84 offset:2176
    ds_read_b64_tr_b16 v[108:109], v84 offset:3072
    ds_read_b64_tr_b16 v[110:111], v84 offset:3200
    s_waitcnt lgkmcnt(4)
    ds_read_b64_tr_b16 v[112:113], v84 offset:4096
    ds_read_b64_tr_b16 v[114:115], v84 offset:4224
    ds_read_b64_tr_b16 v[116:117], v84 offset:5120
    ds_read_b64_tr_b16 v[118:119], v84 offset:5248
    ds_read_b64_tr_b16 v[120:121], v84 offset:6144
    ds_read_b64_tr_b16 v[122:123], v84 offset:6272
    s_waitcnt lgkmcnt(0)
    s_waitcnt vmcnt(0)
    v_max3_u32 v31, v60, v61, v62
    v_max3_u32 v31, v31, v63, v124
    v_max3_u32 v31, v31, v125, v126
    v_max_u32 v31, v31, v127
    v_cmp_eq_u32 vcc, -1, v31
    s_or_b64 s[92:93], vcc, 1
    s_cbranch_vccz Ldones2_1_59
    s_mov_b64 exec, s[92:93]
    buffer_load_dwordx4 v[60:63], v30, s[36:39], s72 offen sc1
    buffer_load_dwordx4 v[124:127], v30, s[36:39], s72 offen offset:32 sc1
    s_mov_b64 exec, -1
    s_sleep 8
Lpolls2_1_58:
    s_mov_b64 exec, s[92:93]
    buffer_load_dwordx4 v[60:63], v30, s[36:39], s72 offen sc1
    buffer_load_dwordx4 v[124:127], v30, s[36:39], s72 offen offset:32 sc1
    s_mov_b64 exec, -1
    s_waitcnt vmcnt(2)
    s_cmp_eq_u32 s65, 0
    s_cbranch_scc1 Ldones2_1_59
    s_sub_u32 s65, s65, 1
    v_max3_u32 v31, v60, v61, v62
    v_max3_u32 v31, v31, v63, v124
    v_max3_u32 v31, v31, v125, v126
    v_max_u32 v31, v31, v127
    v_cmp_eq_u32 vcc, -1, v31
    s_or_b64 s[92:93], vcc, 1
    s_cbranch_vccz Ldones2_1_59
    s_branch Lpolls2_1_58
Ldones2_1_59:
    v_dot2c_f32_bf16 v14, s86, v60
    v_dot2c_f32_bf16 v15, s87, v60
    v_dot2c_f32_bf16 v16, s86, v61
    v_dot2c_f32_bf16 v17, s87, v61
    v_dot2c_f32_bf16 v18, s86, v62
    v_dot2c_f32_bf16 v19, s87, v62
    v_dot2c_f32_bf16 v20, s86, v63
    v_dot2c_f32_bf16 v21, s87, v63
    v_dot2c_f32_bf16 v22, s86, v124
    v_dot2c_f32_bf16 v23, s87, v124
    v_dot2c_f32_bf16 v24, s86, v125
    v_dot2c_f32_bf16 v25, s87, v125
    v_dot2c_f32_bf16 v26, s86, v126
    v_dot2c_f32_bf16 v27, s87, v126
    v_dot2c_f32_bf16 v28, s86, v127
    v_dot2c_f32_bf16 v29, s87, v127
    s_lshl_b32 s69, s54, 1
    s_add_u32 s69, s69, s82
    s_mul_i32 s69, s69, 3584
    s_add_u32 s69, s69, 148224
    v_lshlrev_b32 v31, 5, v1
    v_add_u32 v31, s69, v31
    s_mov_b64 exec, s[66:67]
    ds_write_b128 v31, v[14:17] offset:0
    ds_write_b128 v31, v[18:21] offset:16
    ds_write_b128 v31, v[22:25] offset:1792
    ds_write_b128 v31, v[26:29] offset:1808
    s_mov_b64 exec, -1
    v_add_f32 v80, v14, v15
    v_add_f32 v80, v80, v16
    v_add_f32 v80, v80, v17
    v_add_f32 v80, v80, v18
    v_add_f32 v80, v80, v19
    v_add_f32 v80, v80, v20
    v_add_f32 v80, v80, v21
    v_add_f32 v81, v22, v23
    v_add_f32 v81, v81, v24
    v_add_f32 v81, v81, v25
    v_add_f32 v81, v81, v26
    v_add_f32 v81, v81, v27
    v_add_f32 v81, v81, v28
    v_add_f32 v81, v81, v29
    s_nop 0
    v_add_f32_dpp v80, v80, v80 row_ror:8 row_mask:0xf bank_mask:0xf
    v_add_f32_dpp v81, v81, v81 row_ror:8 row_mask:0xf bank_mask:0xf
    s_nop 0
    v_add_f32_dpp v80, v80, v80 row_ror:4 row_mask:0xf bank_mask:0xf
    v_add_f32_dpp v81, v81, v81 row_ror:4 row_mask:0xf bank_mask:0xf
    s_nop 0
    v_add_f32_dpp v80, v80, v80 row_ror:2 row_mask:0xf bank_mask:0xf
    v_add_f32_dpp v81, v81, v81 row_ror:2 row_mask:0xf bank_mask:0xf
    s_nop 0
    v_add_f32_dpp v80, v80, v80 row_ror:1 row_mask:0xf bank_mask:0xf
    v_add_f32_dpp v81, v81, v81 row_ror:1 row_mask:0xf bank_mask:0xf
    s_nop 0
    v_mov_b32 v82, v80
    v_mov_b32 v83, v81
    s_nop 0
    v_permlane32_swap_b32 v82, v80
    v_permlane32_swap_b32 v83, v81
    s_nop 0
    v_add_f32 v80, v80, v82
    v_add_f32 v81, v81, v83
    v_mov_b32 v82, v80
    v_mov_b32 v83, v81
    s_nop 0
    v_permlane16_swap_b32 v82, v80
    v_permlane16_swap_b32 v83, v81
    s_nop 0
    v_add_f32 v80, v80, v82
    v_add_f32 v81, v81, v83
    v_mul_f32 v80, 0x3b124925, v80
    v_mul_f32 v81, 0x3b124925, v81
    v_sub_f32 v64, v14, v80
    v_sub_f32 v65, v15, v80
    v_sub_f32 v66, v16, v80
    v_sub_f32 v67, v17, v80
    v_sub_f32 v68, v18, v80
    v_sub_f32 v69, v19, v80
    v_sub_f32 v70, v20, v80
    v_sub_f32 v71, v21, v80
    v_sub_f32 v72, v22, v81
    v_sub_f32 v73, v23, v81
    v_sub_f32 v74, v24, v81
    v_sub_f32 v75, v25, v81
    v_sub_f32 v76, v26, v81
    v_sub_f32 v77, v27, v81
    v_sub_f32 v78, v28, v81
    v_sub_f32 v79, v29, v81
    v_mul_f32 v80, v64, v64
    v_fmac_f32 v80, v65, v65
    v_fmac_f32 v80, v66, v66
    v_fmac_f32 v80, v67, v67
    v_fmac_f32 v80, v68, v68
    v_fmac_f32 v80, v69, v69
    v_fmac_f32 v80, v70, v70
    v_fmac_f32 v80, v71, v71
    v_mul_f32 v81, v72, v72
    v_fmac_f32 v81, v73, v73
    v_fmac_f32 v81, v74, v74
    v_fmac_f32 v81, v75, v75
    v_fmac_f32 v81, v76, v76
    v_fmac_f32 v81, v77, v77
    v_fmac_f32 v81, v78, v78
    v_fmac_f32 v81, v79, v79
    v_cndmask_b32 v80, 0, v80, s[66:67]
    v_cndmask_b32 v81, 0, v81, s[66:67]
    s_nop 0
    v_add_f32_dpp v80, v80, v80 row_ror:8 row_mask:0xf bank_mask:0xf
    v_add_f32_dpp v81, v81, v81 row_ror:8 row_mask:0xf bank_mask:0xf
    s_nop 0
    v_add_f32_dpp v80, v80, v80 row_ror:4 row_mask:0xf bank_mask:0xf
    v_add_f32_dpp v81, v81, v81 row_ror:4 row_mask:0xf bank_mask:0xf
    s_nop 0
    v_add_f32_dpp v80, v80, v80 row_ror:2 row_mask:0xf bank_mask:0xf
    v_add_f32_dpp v81, v81, v81 row_ror:2 row_mask:0xf bank_mask:0xf
    s_nop 0
    v_add_f32_dpp v80, v80, v80 row_ror:1 row_mask:0xf bank_mask:0xf
    v_add_f32_dpp v81, v81, v81 row_ror:1 row_mask:0xf bank_mask:0xf
    s_nop 0
    v_mov_b32 v82, v80
    v_mov_b32 v83, v81
    s_nop 0
    v_permlane32_swap_b32 v82, v80
    v_permlane32_swap_b32 v83, v81
    s_nop 0
    v_add_f32 v80, v80, v82
    v_add_f32 v81, v81, v83
    v_mov_b32 v82, v80
    v_mov_b32 v83, v81
    s_nop 0
    v_permlane16_swap_b32 v82, v80
    v_permlane16_swap_b32 v83, v81
    s_nop 0
    v_add_f32 v80, v80, v82
    v_add_f32 v81, v81, v83
    v_mov_b32 v82, 0x3727c5ac
    v_mov_b32 v83, 0x3727c5ac
    v_fmac_f32 v82, 0x3b124925, v80
    v_fmac_f32 v83, 0x3b124925, v81
    v_rsq_f32 v82, v82
    v_rsq_f32 v83, v83
    s_nop 0
    v_mul_f32 v64, v64, v82
    v_mul_f32 v65, v65, v82
    v_mul_f32 v66, v66, v82
    v_mul_f32 v67, v67, v82
    v_mul_f32 v68, v68, v82
    v_mul_f32 v69, v69, v82
    v_mul_f32 v70, v70, v82
    v_mul_f32 v71, v71, v82
    v_mul_f32 v72, v72, v83
    v_mul_f32 v73, v73, v83
    v_mul_f32 v74, v74, v83
    v_mul_f32 v75, v75, v83
    v_mul_f32 v76, v76, v83
    v_mul_f32 v77, v77, v83
    v_mul_f32 v78, v78, v83
    v_mul_f32 v79, v79, v83
    v_cvt_pk_bf16_f32 v84, v64, v65
    v_cvt_pk_bf16_f32 v85, v66, v67
    v_cvt_pk_bf16_f32 v86, v68, v69
    v_cvt_pk_bf16_f32 v87, v70, v71
    v_cvt_pk_bf16_f32 v88, v72, v73
    v_cvt_pk_bf16_f32 v89, v74, v75
    v_cvt_pk_bf16_f32 v90, v76, v77
    v_cvt_pk_bf16_f32 v91, v78, v79
    s_lshl_b32 s69, s52, 11
    s_add_u32 s69, s69, 137472
    v_lshlrev_b32 v30, 4, v1
    v_add_u32 v30, s69, v30
    ds_write_b128 v30, v[84:87]
    ds_write_b128 v30, v[88:91] offset:1024
    s_waitcnt lgkmcnt(0)
    v_mov_b32 v30, s84
    v_mov_b32 v31, 8
    ds_write_b32 v30, v31
    v_mov_b32 v30, s85
Lps_60:
    ds_read_b32 v31, v30
    s_waitcnt lgkmcnt(0)
    v_cmp_gt_u32 vcc, 8, v31
    s_cbranch_vccz Lpd_61
    s_cmp_eq_u32 s83, 0
    s_cbranch_scc1 Lpd_61
    s_sub_u32 s83, s83, 1
    s_branch Lps_60
Lpd_61:
    v_and_b32 v30, 3, v1
    v_lshlrev_b32 v30, 10, v30
    s_lshl_b32 s69, s54, 12
    s_add_u32 s69, s69, 137472
    v_lshrrev_b32 v31, 4, v1
    v_lshl_add_u32 v30, v31, 4, v30
    s_mul_i32 s72, s82, 448
    s_add_u32 s69, s69, s72
    v_add_u32 v30, s69, v30
    ds_read_b128 v[32:35], v30 offset:0
    ds_read_b128 v[36:39], v30 offset:64
    ds_read_b128 v[40:43], v30 offset:128
    ds_read_b128 v[44:47], v30 offset:192
    ds_read_b128 v[48:51], v30 offset:256
    ds_read_b128 v[52:55], v30 offset:320
    ds_read_b128 v[56:59], v30 offset:384
    s_waitcnt lgkmcnt(6)
    v_mfma_f32_16x16x32_bf16 v[92:95], v[96:99], v[32:35], 0
    s_waitcnt lgkmcnt(5)
    v_mfma_f32_16x16x32_bf16 v[92:95], v[100:103], v[36:39], v[92:95]
    s_waitcnt lgkmcnt(4)
    v_mfma_f32_16x16x32_bf16 v[92:95], v[104:107], v[40:43], v[92:95]
    s_waitcnt lgkmcnt(3)
    v_mfma_f32_16x16x32_bf16 v[92:95], v[108:111], v[44:47], v[92:95]
    s_waitcnt lgkmcnt(2)
    v_mfma_f32_16x16x32_bf16 v[92:95], v[112:115], v[48:51], v[92:95]
    s_waitcnt lgkmcnt(1)
    v_mfma_f32_16x16x32_bf16 v[92:95], v[116:119], v[52:55], v[92:95]
    s_waitcnt lgkmcnt(0)
    v_mfma_f32_16x16x32_bf16 v[92:95], v[120:123], v[56:59], v[92:95]
    v_and_b32 v30, 3, v1
    v_lshlrev_b32 v30, 6, v30
    v_lshrrev_b32 v31, 4, v1
    v_lshl_add_u32 v30, v31, 4, v30
    s_lshl_b32 s69, s52, 8
    s_add_u32 s69, s69, 136448
    v_add_u32 v30, s69, v30
    s_nop 7
    ds_write_b128 v30, v[92:95]
    s_waitcnt lgkmcnt(0)
    v_mov_b32 v30, s84
    v_mov_b32 v31, 9
    ds_write_b32 v30, v31
    v_mov_b32 v30, s85
Lps_62:
    ds_read_b32 v31, v30
    s_waitcnt lgkmcnt(0)
    v_cmp_gt_u32 vcc, 9, v31
    s_cbranch_vccz Lpd_63
    s_cmp_eq_u32 s83, 0
    s_cbranch_scc1 Lpd_63
    s_sub_u32 s83, s83, 1
    s_branch Lps_62
Lpd_63:
    s_add_u32 s72, s61, 155648
    s_add_u32 s72, s72, s75
    s_lshl_b32 s69, s54, 9
    s_add_u32 s69, s69, 136448
    v_and_b32 v30, 7, v1
    v_lshlrev_b32 v30, 5, v30
    v_add_u32 v30, s69, v30
    ds_read_b128 v[64:67], v30 offset:0
    ds_read_b128 v[68:71], v30 offset:16
    ds_read_b128 v[72:75], v30 offset:256
    ds_read_b128 v[76:79], v30 offset:272
    v_lshlrev_b32 v31, 4, v1
    s_cmp_eq_u32 s82, 0
    s_cselect_b32 s69, 8, 0
    v_cmp_gt_u32 vcc, s69, v1
    v_mov_b32 v80, 2147483648
    s_nop 0
    v_cndmask_b32 v31, v80, v31, vcc
    s_waitcnt lgkmcnt(0)
    v_add_f32 v64, v64, v72
    v_add_f32 v65, v65, v73
    v_add_f32 v66, v66, v74
    v_add_f32 v67, v67, v75
    v_add_f32 v68, v68, v76
    v_add_f32 v69, v69, v77
    v_add_f32 v70, v70, v78
    v_add_f32 v71, v71, v79
    v_cvt_pk_bf16_f32 v72, v64, v65
    v_cvt_pk_bf16_f32 v73, v66, v67
    v_cvt_pk_bf16_f32 v74, v68, v69
    v_cvt_pk_bf16_f32 v75, v70, v71
    v_min_u32 v72, -2, v72
    v_min_u32 v73, -2, v73
    v_min_u32 v74, -2, v74
    v_min_u32 v75, -2, v75
    s_cmp_eq_u32 s100, 0
    s_cbranch_scc1 Lwt_64
    buffer_store_dwordx4 v[72:75], v31, s[36:39], s72 offen
    s_branch Lwd_65
Lwt_64:
    buffer_store_dwordx4 v[72:75], v31, s[36:39], s72 offen sc1
Lwd_65:
    s_nop 1
    s_add_u32 s72, s61, 155648
    s_add_u32 s72, s72, s64
    v_lshrrev_b32 v30, 1, v1
    v_lshlrev_b32 v30, 7, v30
    v_and_b32 v31, 1, v1
    v_lshl_add_u32 v30, v31, 4, v30
    buffer_load_dwordx4 v[84:87], v30, s[36:39], s72 offen sc1
    s_waitcnt vmcnt(0)
    v_max3_u32 v31, v84, v85, v86
    v_max_u32 v31, v31, v87
    v_cmp_eq_u32 vcc, -1, v31
    s_or_b64 s[92:93], vcc, 1
    s_cbranch_vccz Ldoneq2_68
    s_mov_b64 exec, s[92:93]
    buffer_load_dwordx4 v[84:87], v30, s[36:39], s72 offen sc1
    s_mov_b64 exec, -1
    s_sleep 8
Lpollq2_67:
    s_mov_b64 exec, s[92:93]
    buffer_load_dwordx4 v[84:87], v30, s[36:39], s72 offen sc1
    s_mov_b64 exec, -1
    s_waitcnt vmcnt(1)
    s_cmp_eq_u32 s65, 0
    s_cbranch_scc1 Ldoneq2_68
    s_sub_u32 s65, s65, 1
    v_max3_u32 v31, v84, v85, v86
    v_max_u32 v31, v31, v87
    v_cmp_eq_u32 vcc, -1, v31
    s_or_b64 s[92:93], vcc, 1
    s_cbranch_vccz Ldoneq2_68
    s_branch Lpollq2_67
Ldoneq2_68:
    s_lshl_b32 s69, s54, 10
    s_add_u32 s69, s69, 145664
    v_lshlrev_b32 v30, 4, v1
    v_add_u32 v30, s69, v30
    ds_write_b128 v30, v[84:87]
    v_and_b32 v31, 1, v1
    v_lshlrev_b32 v31, 9, v31
    v_bfe_u32 v30, v1, 4, 1
    v_lshl_add_u32 v31, v30, 4, v31
    v_lshrrev_b32 v30, 5, v1
    v_lshl_add_u32 v31, v30, 8, v31
    v_add_u32 v31, s69, v31
    s_waitcnt lgkmcnt(0)
    ds_read_b128 v[32:35], v31 offset:0
    ds_read_b128 v[36:39], v31 offset:32
    ds_read_b128 v[40:43], v31 offset:64
    ds_read_b128 v[44:47], v31 offset:96
    ds_read_b128 v[48:51], v31 offset:128
    ds_read_b128 v[52:55], v31 offset:160
    ds_read_b128 v[56:59], v31 offset:192
    ds_read_b128 v[60:63], v31 offset:224
    s_waitcnt lgkmcnt(0)
    v_mfma_f32_16x16x32_bf16 v[88:91], a[0:3], v[32:35], 0
    v_mfma_f32_16x16x32_bf16 v[88:91], a[4:7], v[36:39], v[88:91]
    v_mfma_f32_16x16x32_bf16 v[88:91], a[8:11], v[40:43], v[88:91]
    v_mfma_f32_16x16x32_bf16 v[88:91], a[12:15], v[44:47], v[88:91]
    v_mfma_f32_16x16x32_bf16 v[88:91], a[16:19], v[48:51], v[88:91]
    v_mfma_f32_16x16x32_bf16 v[88:91], a[20:23], v[52:55], v[88:91]
    v_mfma_f32_16x16x32_bf16 v[88:91], a[24:27], v[56:59], v[88:91]
    v_mfma_f32_16x16x32_bf16 v[88:91], a[28:31], v[60:63], v[88:91]
    v_mfma_f32_16x16x32_bf16 v[92:95], a[32:35], v[32:35], 0
    v_mfma_f32_16x16x32_bf16 v[92:95], a[36:39], v[36:39], v[92:95]
    v_mfma_f32_16x16x32_bf16 v[92:95], a[40:43], v[40:43], v[92:95]
    v_mfma_f32_16x16x32_bf16 v[92:95], a[44:47], v[44:47], v[92:95]
    v_mfma_f32_16x16x32_bf16 v[92:95], a[48:51], v[48:51], v[92:95]
    v_mfma_f32_16x16x32_bf16 v[92:95], a[52:55], v[52:55], v[92:95]
    v_mfma_f32_16x16x32_bf16 v[92:95], a[56:59], v[56:59], v[92:95]
    v_mfma_f32_16x16x32_bf16 v[92:95], a[60:63], v[60:63], v[92:95]
    v_mfma_f32_16x16x32_bf16 v[96:99], a[64:67], v[32:35], 0
    v_mfma_f32_16x16x32_bf16 v[96:99], a[68:71], v[36:39], v[96:99]
    v_mfma_f32_16x16x32_bf16 v[96:99], a[72:75], v[40:43], v[96:99]
    v_mfma_f32_16x16x32_bf16 v[96:99], a[76:79], v[44:47], v[96:99]
    v_mfma_f32_16x16x32_bf16 v[96:99], a[80:83], v[48:51], v[96:99]
    v_mfma_f32_16x16x32_bf16 v[96:99], a[84:87], v[52:55], v[96:99]
    v_mfma_f32_16x16x32_bf16 v[96:99], a[88:91], v[56:59], v[96:99]
    v_mfma_f32_16x16x32_bf16 v[96:99], a[92:95], v[60:63], v[96:99]
    v_mfma_f32_16x16x32_bf16 v[100:103], a[96:99], v[32:35], 0
    v_mfma_f32_16x16x32_bf16 v[100:103], a[100:103], v[36:39], v[100:103]
    v_mfma_f32_16x16x32_bf16 v[100:103], a[104:107], v[40:43], v[100:103]
    v_mfma_f32_16x16x32_bf16 v[100:103], a[108:111], v[44:47], v[100:103]
    v_mfma_f32_16x16x32_bf16 v[100:103], a[112:115], v[48:51], v[100:103]
    v_mfma_f32_16x16x32_bf16 v[100:103], a[116:119], v[52:55], v[100:103]
    v_mfma_f32_16x16x32_bf16 v[100:103], a[120:123], v[56:59], v[100:103]
    v_mfma_f32_16x16x32_bf16 v[100:103], a[124:127], v[60:63], v[100:103]
    v_mfma_f32_16x16x32_bf16 v[104:107], a[128:131], v[32:35], 0
    v_mfma_f32_16x16x32_bf16 v[104:107], a[132:135], v[36:39], v[104:107]
    v_mfma_f32_16x16x32_bf16 v[104:107], a[136:139], v[40:43], v[104:107]
    v_mfma_f32_16x16x32_bf16 v[104:107], a[140:143], v[44:47], v[104:107]
    v_mfma_f32_16x16x32_bf16 v[104:107], a[144:147], v[48:51], v[104:107]
    v_mfma_f32_16x16x32_bf16 v[104:107], a[148:151], v[52:55], v[104:107]
    v_mfma_f32_16x16x32_bf16 v[104:107], a[152:155], v[56:59], v[104:107]
    v_mfma_f32_16x16x32_bf16 v[104:107], a[156:159], v[60:63], v[104:107]
    v_mfma_f32_16x16x32_bf16 v[108:111], a[160:163], v[32:35], 0
    v_mfma_f32_16x16x32_bf16 v[108:111], a[164:167], v[36:39], v[108:111]
    v_mfma_f32_16x16x32_bf16 v[108:111], a[168:171], v[40:43], v[108:111]
    v_mfma_f32_16x16x32_bf16 v[108:111], a[172:175], v[44:47], v[108:111]
    v_mfma_f32_16x16x32_bf16 v[108:111], a[176:179], v[48:51], v[108:111]
    v_mfma_f32_16x16x32_bf16 v[108:111], a[180:183], v[52:55], v[108:111]
    v_mfma_f32_16x16x32_bf16 v[108:111], a[184:187], v[56:59], v[108:111]
    v_mfma_f32_16x16x32_bf16 v[108:111], a[188:191], v[60:63], v[108:111]
    v_and_b32 v7, 15, v1
    v_lshlrev_b32 v6, 9, v7
    v_and_b32 v7, 7, v7
    v_lshl_add_u32 v6, v7, 5, v6
    v_lshrrev_b32 v7, 5, v1
    v_lshl_add_u32 v6, v7, 8, v6
    v_bfe_u32 v7, v1, 4, 1
    v_lshl_add_u32 v6, v7, 4, v6
    v_add_u32 v6, s56, v6
    v_xor_b32 v7, 32, v6
    v_xor_b32 v8, 64, v6
    v_xor_b32 v9, 96, v6
    v_xor_b32 v10, 128, v6
    v_xor_b32 v11, 160, v6
    v_xor_b32 v12, 192, v6
    v_xor_b32 v13, 224, v6
    ds_read_b128 v[14:17], v6 offset:0
    ds_read_b128 v[18:21], v7 offset:0
    ds_read_b128 v[22:25], v8 offset:0
    ds_read_b128 v[26:29], v9 offset:0
    s_waitcnt lgkmcnt(3)
    v_mfma_f32_16x16x32_bf16 v[112:115], v[14:17], v[32:35], 0
    s_waitcnt lgkmcnt(2)
    v_mfma_f32_16x16x32_bf16 v[112:115], v[18:21], v[36:39], v[112:115]
    ds_read_b128 v[14:17], v10 offset:0
    s_waitcnt lgkmcnt(2)
    v_mfma_f32_16x16x32_bf16 v[112:115], v[22:25], v[40:43], v[112:115]
    ds_read_b128 v[18:21], v11 offset:0
    s_waitcnt lgkmcnt(2)
    v_mfma_f32_16x16x32_bf16 v[112:115], v[26:29], v[44:47], v[112:115]
    ds_read_b128 v[22:25], v12 offset:0
    s_waitcnt lgkmcnt(2)
    v_mfma_f32_16x16x32_bf16 v[112:115], v[14:17], v[48:51], v[112:115]
    ds_read_b128 v[26:29], v13 offset:0
    s_waitcnt lgkmcnt(2)
    v_mfma_f32_16x16x32_bf16 v[112:115], v[18:21], v[52:55], v[112:115]
    s_waitcnt lgkmcnt(1)
    v_mfma_f32_16x16x32_bf16 v[112:115], v[22:25], v[56:59], v[112:115]
    s_waitcnt lgkmcnt(0)
    v_mfma_f32_16x16x32_bf16 v[112:115], v[26:29], v[60:63], v[112:115]
    s_add_u32 m0, s56, 0
    s_add_u32 s69, s57, 1703936
    buffer_load_dwordx4 v2, s[4:7], s69 offen offset:0 nt lds
    buffer_load_dwordx4 v3, s[4:7], s69 offen offset:1024 nt lds
    buffer_load_dwordx4 v4, s[4:7], s69 offen offset:2048 nt lds
    buffer_load_dwordx4 v5, s[4:7], s69 offen offset:3072 nt lds
    s_add_u32 m0, s56, 4096
    s_add_u32 s69, s69, 4096
    buffer_load_dwordx4 v2, s[4:7], s69 offen offset:0 nt lds
    buffer_load_dwordx4 v3, s[4:7], s69 offen offset:1024 nt lds
    buffer_load_dwordx4 v4, s[4:7], s69 offen offset:2048 nt lds
    buffer_load_dwordx4 v5, s[4:7], s69 offen offset:3072 nt lds
    ds_read_b128 v[14:17], v6 offset:8192
    ds_read_b128 v[18:21], v7 offset:8192
    ds_read_b128 v[22:25], v8 offset:8192
    ds_read_b128 v[26:29], v9 offset:8192
    s_waitcnt lgkmcnt(3)
    v_mfma_f32_16x16x32_bf16 v[64:67], v[14:17], v[32:35], 0
    s_waitcnt lgkmcnt(2)
    v_mfma_f32_16x16x32_bf16 v[64:67], v[18:21], v[36:39], v[64:67]
    ds_read_b128 v[14:17], v10 offset:8192
    s_waitcnt lgkmcnt(2)
    v_mfma_f32_16x16x32_bf16 v[64:67], v[22:25], v[40:43], v[64:67]
    ds_read_b128 v[18:21], v11 offset:8192
    s_waitcnt lgkmcnt(2)
    v_mfma_f32_16x16x32_bf16 v[64:67], v[26:29], v[44:47], v[64:67]
    ds_read_b128 v[22:25], v12 offset:8192
    s_waitcnt lgkmcnt(2)
    v_mfma_f32_16x16x32_bf16 v[64:67], v[14:17], v[48:51], v[64:67]
    ds_read_b128 v[26:29], v13 offset:8192
    s_waitcnt lgkmcnt(2)
    v_mfma_f32_16x16x32_bf16 v[64:67], v[18:21], v[52:55], v[64:67]
    s_waitcnt lgkmcnt(1)
    v_mfma_f32_16x16x32_bf16 v[64:67], v[22:25], v[56:59], v[64:67]
    s_waitcnt lgkmcnt(0)
    v_mfma_f32_16x16x32_bf16 v[64:67], v[26:29], v[60:63], v[64:67]
    s_add_u32 m0, s56, 8192
    s_add_u32 s69, s57, 131072
    buffer_load_dwordx4 v2, s[4:7], s69 offen offset:0 nt lds
    buffer_load_dwordx4 v3, s[4:7], s69 offen offset:1024 nt lds
    buffer_load_dwordx4 v4, s[4:7], s69 offen offset:2048 nt lds
    buffer_load_dwordx4 v5, s[4:7], s69 offen offset:3072 nt lds
    s_add_u32 m0, s56, 12288
    s_add_u32 s69, s69, 4096
    buffer_load_dwordx4 v2, s[4:7], s69 offen offset:0 nt lds
    buffer_load_dwordx4 v3, s[4:7], s69 offen offset:1024 nt lds
    buffer_load_dwordx4 v4, s[4:7], s69 offen offset:2048 nt lds
    buffer_load_dwordx4 v5, s[4:7], s69 offen offset:3072 nt lds
    s_waitcnt vmcnt(8)
    ds_read_b128 v[14:17], v6 offset:0
    ds_read_b128 v[18:21], v7 offset:0
    ds_read_b128 v[22:25], v8 offset:0
    ds_read_b128 v[26:29], v9 offset:0
    s_waitcnt lgkmcnt(3)
    v_mfma_f32_16x16x32_bf16 v[116:119], v[14:17], v[32:35], 0
    s_waitcnt lgkmcnt(2)
    v_mfma_f32_16x16x32_bf16 v[116:119], v[18:21], v[36:39], v[116:119]
    ds_read_b128 v[14:17], v10 offset:0
    s_waitcnt lgkmcnt(2)
    v_mfma_f32_16x16x32_bf16 v[116:119], v[22:25], v[40:43], v[116:119]
    ds_read_b128 v[18:21], v11 offset:0
    s_waitcnt lgkmcnt(2)
    v_mfma_f32_16x16x32_bf16 v[116:119], v[26:29], v[44:47], v[116:119]
    ds_read_b128 v[22:25], v12 offset:0
    s_waitcnt lgkmcnt(2)
    v_mfma_f32_16x16x32_bf16 v[116:119], v[14:17], v[48:51], v[116:119]
    ds_read_b128 v[26:29], v13 offset:0
    s_waitcnt lgkmcnt(2)
    v_mfma_f32_16x16x32_bf16 v[116:119], v[18:21], v[52:55], v[116:119]
    s_waitcnt lgkmcnt(1)
    v_mfma_f32_16x16x32_bf16 v[116:119], v[22:25], v[56:59], v[116:119]
    s_waitcnt lgkmcnt(0)
    v_mfma_f32_16x16x32_bf16 v[116:119], v[26:29], v[60:63], v[116:119]
    s_add_u32 m0, s56, 0
    s_add_u32 s69, s57, 1835008
    buffer_load_dwordx4 v2, s[4:7], s69 offen offset:0 nt lds
    buffer_load_dwordx4 v3, s[4:7], s69 offen offset:1024 nt lds
    buffer_load_dwordx4 v4, s[4:7], s69 offen offset:2048 nt lds
    buffer_load_dwordx4 v5, s[4:7], s69 offen offset:3072 nt lds
    s_add_u32 m0, s56, 4096
    s_add_u32 s69, s69, 4096
    buffer_load_dwordx4 v2, s[4:7], s69 offen offset:0 nt lds
    buffer_load_dwordx4 v3, s[4:7], s69 offen offset:1024 nt lds
    buffer_load_dwordx4 v4, s[4:7], s69 offen offset:2048 nt lds
    buffer_load_dwordx4 v5, s[4:7], s69 offen offset:3072 nt lds
    s_waitcnt vmcnt(8)
    ds_read_b128 v[14:17], v6 offset:8192
    ds_read_b128 v[18:21], v7 offset:8192
    ds_read_b128 v[22:25], v8 offset:8192
    ds_read_b128 v[26:29], v9 offset:8192
    s_waitcnt lgkmcnt(3)
    v_mfma_f32_16x16x32_bf16 v[68:71], v[14:17], v[32:35], 0
    s_waitcnt lgkmcnt(2)
    v_mfma_f32_16x16x32_bf16 v[68:71], v[18:21], v[36:39], v[68:71]
    ds_read_b128 v[14:17], v10 offset:8192
    s_waitcnt lgkmcnt(2)
    v_mfma_f32_16x16x32_bf16 v[68:71], v[22:25], v[40:43], v[68:71]
    ds_read_b128 v[18:21], v11 offset:8192
    s_waitcnt lgkmcnt(2)
    v_mfma_f32_16x16x32_bf16 v[68:71], v[26:29], v[44:47], v[68:71]
    ds_read_b128 v[22:25], v12 offset:8192
    s_waitcnt lgkmcnt(2)
    v_mfma_f32_16x16x32_bf16 v[68:71], v[14:17], v[48:51], v[68:71]
    ds_read_b128 v[26:29], v13 offset:8192
    s_waitcnt lgkmcnt(2)
    v_mfma_f32_16x16x32_bf16 v[68:71], v[18:21], v[52:55], v[68:71]
    s_waitcnt lgkmcnt(1)
    v_mfma_f32_16x16x32_bf16 v[68:71], v[22:25], v[56:59], v[68:71]
    s_waitcnt lgkmcnt(0)
    v_mfma_f32_16x16x32_bf16 v[68:71], v[26:29], v[60:63], v[68:71]
    s_add_u32 m0, s56, 8192
    s_add_u32 s69, s57, 262144
    buffer_load_dwordx4 v2, s[4:7], s69 offen offset:0 nt lds
    buffer_load_dwordx4 v3, s[4:7], s69 offen offset:1024 nt lds
    buffer_load_dwordx4 v4, s[4:7], s69 offen offset:2048 nt lds
    buffer_load_dwordx4 v5, s[4:7], s69 offen offset:3072 nt lds
    s_add_u32 m0, s56, 12288
    s_add_u32 s69, s69, 4096
    buffer_load_dwordx4 v2, s[4:7], s69 offen offset:0 nt lds
    buffer_load_dwordx4 v3, s[4:7], s69 offen offset:1024 nt lds
    buffer_load_dwordx4 v4, s[4:7], s69 offen offset:2048 nt lds
    buffer_load_dwordx4 v5, s[4:7], s69 offen offset:3072 nt lds
    s_waitcnt vmcnt(8)
    ds_read_b128 v[14:17], v6 offset:0
    ds_read_b128 v[18:21], v7 offset:0
    ds_read_b128 v[22:25], v8 offset:0
    ds_read_b128 v[26:29], v9 offset:0
    s_waitcnt lgkmcnt(3)
    v_mfma_f32_16x16x32_bf16 v[120:123], v[14:17], v[32:35], 0
    s_waitcnt lgkmcnt(2)
    v_mfma_f32_16x16x32_bf16 v[120:123], v[18:21], v[36:39], v[120:123]
    ds_read_b128 v[14:17], v10 offset:0
    s_waitcnt lgkmcnt(2)
    v_mfma_f32_16x16x32_bf16 v[120:123], v[22:25], v[40:43], v[120:123]
    ds_read_b128 v[18:21], v11 offset:0
    s_waitcnt lgkmcnt(2)
    v_mfma_f32_16x16x32_bf16 v[120:123], v[26:29], v[44:47], v[120:123]
    ds_read_b128 v[22:25], v12 offset:0
    s_waitcnt lgkmcnt(2)
    v_mfma_f32_16x16x32_bf16 v[120:123], v[14:17], v[48:51], v[120:123]
    ds_read_b128 v[26:29], v13 offset:0
    s_waitcnt lgkmcnt(2)
    v_mfma_f32_16x16x32_bf16 v[120:123], v[18:21], v[52:55], v[120:123]
    s_waitcnt lgkmcnt(1)
    v_mfma_f32_16x16x32_bf16 v[120:123], v[22:25], v[56:59], v[120:123]
    s_waitcnt lgkmcnt(0)
    v_mfma_f32_16x16x32_bf16 v[120:123], v[26:29], v[60:63], v[120:123]
    s_add_u32 m0, s56, 0
    s_add_u32 s69, s57, 1966080
    buffer_load_dwordx4 v2, s[4:7], s69 offen offset:0 nt lds
    buffer_load_dwordx4 v3, s[4:7], s69 offen offset:1024 nt lds
    buffer_load_dwordx4 v4, s[4:7], s69 offen offset:2048 nt lds
    buffer_load_dwordx4 v5, s[4:7], s69 offen offset:3072 nt lds
    s_add_u32 m0, s56, 4096
    s_add_u32 s69, s69, 4096
    buffer_load_dwordx4 v2, s[4:7], s69 offen offset:0 nt lds
    buffer_load_dwordx4 v3, s[4:7], s69 offen offset:1024 nt lds
    buffer_load_dwordx4 v4, s[4:7], s69 offen offset:2048 nt lds
    buffer_load_dwordx4 v5, s[4:7], s69 offen offset:3072 nt lds
    s_waitcnt vmcnt(8)
    ds_read_b128 v[14:17], v6 offset:8192
    ds_read_b128 v[18:21], v7 offset:8192
    ds_read_b128 v[22:25], v8 offset:8192
    ds_read_b128 v[26:29], v9 offset:8192
    s_waitcnt lgkmcnt(3)
    v_mfma_f32_16x16x32_bf16 v[72:75], v[14:17], v[32:35], 0
    s_waitcnt lgkmcnt(2)
    v_mfma_f32_16x16x32_bf16 v[72:75], v[18:21], v[36:39], v[72:75]
    ds_read_b128 v[14:17], v10 offset:8192
    s_waitcnt lgkmcnt(2)
    v_mfma_f32_16x16x32_bf16 v[72:75], v[22:25], v[40:43], v[72:75]
    ds_read_b128 v[18:21], v11 offset:8192
    s_waitcnt lgkmcnt(2)
    v_mfma_f32_16x16x32_bf16 v[72:75], v[26:29], v[44:47], v[72:75]
    ds_read_b128 v[22:25], v12 offset:8192
    s_waitcnt lgkmcnt(2)
    v_mfma_f32_16x16x32_bf16 v[72:75], v[14:17], v[48:51], v[72:75]
    ds_read_b128 v[26:29], v13 offset:8192
    s_waitcnt lgkmcnt(2)
    v_mfma_f32_16x16x32_bf16 v[72:75], v[18:21], v[52:55], v[72:75]
    s_waitcnt lgkmcnt(1)
    v_mfma_f32_16x16x32_bf16 v[72:75], v[22:25], v[56:59], v[72:75]
    s_waitcnt lgkmcnt(0)
    v_mfma_f32_16x16x32_bf16 v[72:75], v[26:29], v[60:63], v[72:75]
    s_add_u32 m0, s56, 8192
    s_add_u32 s69, s57, 393216
    buffer_load_dwordx4 v2, s[4:7], s69 offen offset:0 nt lds
    buffer_load_dwordx4 v3, s[4:7], s69 offen offset:1024 nt lds
    buffer_load_dwordx4 v4, s[4:7], s69 offen offset:2048 nt lds
    buffer_load_dwordx4 v5, s[4:7], s69 offen offset:3072 nt lds
    s_add_u32 m0, s56, 12288
    s_add_u32 s69, s69, 4096
    buffer_load_dwordx4 v2, s[4:7], s69 offen offset:0 nt lds
    buffer_load_dwordx4 v3, s[4:7], s69 offen offset:1024 nt lds
    buffer_load_dwordx4 v4, s[4:7], s69 offen offset:2048 nt lds
    buffer_load_dwordx4 v5, s[4:7], s69 offen offset:3072 nt lds
    s_waitcnt vmcnt(8)
    ds_read_b128 v[14:17], v6 offset:0
    ds_read_b128 v[18:21], v7 offset:0
    ds_read_b128 v[22:25], v8 offset:0
    ds_read_b128 v[26:29], v9 offset:0
    s_waitcnt lgkmcnt(3)
    v_mfma_f32_16x16x32_bf16 v[124:127], v[14:17], v[32:35], 0
    s_waitcnt lgkmcnt(2)
    v_mfma_f32_16x16x32_bf16 v[124:127], v[18:21], v[36:39], v[124:127]
    ds_read_b128 v[14:17], v10 offset:0
    s_waitcnt lgkmcnt(2)
    v_mfma_f32_16x16x32_bf16 v[124:127], v[22:25], v[40:43], v[124:127]
    ds_read_b128 v[18:21], v11 offset:0
    s_waitcnt lgkmcnt(2)
    v_mfma_f32_16x16x32_bf16 v[124:127], v[26:29], v[44:47], v[124:127]
    ds_read_b128 v[22:25], v12 offset:0
    s_waitcnt lgkmcnt(2)
    v_mfma_f32_16x16x32_bf16 v[124:127], v[14:17], v[48:51], v[124:127]
    ds_read_b128 v[26:29], v13 offset:0
    s_waitcnt lgkmcnt(2)
    v_mfma_f32_16x16x32_bf16 v[124:127], v[18:21], v[52:55], v[124:127]
    s_waitcnt lgkmcnt(1)
    v_mfma_f32_16x16x32_bf16 v[124:127], v[22:25], v[56:59], v[124:127]
    s_waitcnt lgkmcnt(0)
    v_mfma_f32_16x16x32_bf16 v[124:127], v[26:29], v[60:63], v[124:127]
    s_add_u32 m0, s56, 0
    s_add_u32 s69, s57, 524288
    buffer_load_dwordx4 v2, s[4:7], s69 offen offset:0 nt lds
    buffer_load_dwordx4 v3, s[4:7], s69 offen offset:1024 nt lds
    buffer_load_dwordx4 v4, s[4:7], s69 offen offset:2048 nt lds
    buffer_load_dwordx4 v5, s[4:7], s69 offen offset:3072 nt lds
    s_add_u32 m0, s56, 4096
    s_add_u32 s69, s69, 4096
    buffer_load_dwordx4 v2, s[4:7], s69 offen offset:0 nt lds
    buffer_load_dwordx4 v3, s[4:7], s69 offen offset:1024 nt lds
    buffer_load_dwordx4 v4, s[4:7], s69 offen offset:2048 nt lds
    buffer_load_dwordx4 v5, s[4:7], s69 offen offset:3072 nt lds
    s_waitcnt vmcnt(8)
    ds_read_b128 v[14:17], v6 offset:8192
    ds_read_b128 v[18:21], v7 offset:8192
    ds_read_b128 v[22:25], v8 offset:8192
    ds_read_b128 v[26:29], v9 offset:8192
    s_waitcnt lgkmcnt(3)
    v_mfma_f32_16x16x32_bf16 v[76:79], v[14:17], v[32:35], 0
    s_waitcnt lgkmcnt(2)
    v_mfma_f32_16x16x32_bf16 v[76:79], v[18:21], v[36:39], v[76:79]
    ds_read_b128 v[14:17], v10 offset:8192
    s_waitcnt lgkmcnt(2)
    v_mfma_f32_16x16x32_bf16 v[76:79], v[22:25], v[40:43], v[76:79]
    ds_read_b128 v[18:21], v11 offset:8192
    s_waitcnt lgkmcnt(2)
    v_mfma_f32_16x16x32_bf16 v[76:79], v[26:29], v[44:47], v[76:79]
    ds_read_b128 v[22:25], v12 offset:8192
    s_waitcnt lgkmcnt(2)
    v_mfma_f32_16x16x32_bf16 v[76:79], v[14:17], v[48:51], v[76:79]
    ds_read_b128 v[26:29], v13 offset:8192
    s_waitcnt lgkmcnt(2)
    v_mfma_f32_16x16x32_bf16 v[76:79], v[18:21], v[52:55], v[76:79]
    s_waitcnt lgkmcnt(1)
    v_mfma_f32_16x16x32_bf16 v[76:79], v[22:25], v[56:59], v[76:79]
    s_waitcnt lgkmcnt(0)
    v_mfma_f32_16x16x32_bf16 v[76:79], v[26:29], v[60:63], v[76:79]
    s_add_u32 m0, s56, 8192
    s_add_u32 s69, s57, 655360
    buffer_load_dwordx4 v2, s[4:7], s69 offen offset:0 nt lds
    buffer_load_dwordx4 v3, s[4:7], s69 offen offset:1024 nt lds
    buffer_load_dwordx4 v4, s[4:7], s69 offen offset:2048 nt lds
    buffer_load_dwordx4 v5, s[4:7], s69 offen offset:3072 nt lds
    s_add_u32 m0, s56, 12288
    s_add_u32 s69, s69, 4096
    buffer_load_dwordx4 v2, s[4:7], s69 offen offset:0 nt lds
    buffer_load_dwordx4 v3, s[4:7], s69 offen offset:1024 nt lds
    buffer_load_dwordx4 v4, s[4:7], s69 offen offset:2048 nt lds
    buffer_load_dwordx4 v5, s[4:7], s69 offen offset:3072 nt lds
    s_waitcnt vmcnt(8)
    ds_read_b128 v[14:17], v6 offset:0
    ds_read_b128 v[18:21], v7 offset:0
    ds_read_b128 v[22:25], v8 offset:0
    ds_read_b128 v[26:29], v9 offset:0
    s_waitcnt lgkmcnt(3)
    v_mfma_f32_16x16x32_bf16 v[80:83], v[14:17], v[32:35], 0
    s_waitcnt lgkmcnt(2)
    v_mfma_f32_16x16x32_bf16 v[80:83], v[18:21], v[36:39], v[80:83]
    ds_read_b128 v[14:17], v10 offset:0
    s_waitcnt lgkmcnt(2)
    v_mfma_f32_16x16x32_bf16 v[80:83], v[22:25], v[40:43], v[80:83]
    ds_read_b128 v[18:21], v11 offset:0
    s_waitcnt lgkmcnt(2)
    v_mfma_f32_16x16x32_bf16 v[80:83], v[26:29], v[44:47], v[80:83]
    ds_read_b128 v[22:25], v12 offset:0
    s_waitcnt lgkmcnt(2)
    v_mfma_f32_16x16x32_bf16 v[80:83], v[14:17], v[48:51], v[80:83]
    ds_read_b128 v[26:29], v13 offset:0
    s_waitcnt lgkmcnt(2)
    v_mfma_f32_16x16x32_bf16 v[80:83], v[18:21], v[52:55], v[80:83]
    s_waitcnt lgkmcnt(1)
    v_mfma_f32_16x16x32_bf16 v[80:83], v[22:25], v[56:59], v[80:83]
    s_waitcnt lgkmcnt(0)
    v_mfma_f32_16x16x32_bf16 v[80:83], v[26:29], v[60:63], v[80:83]
    s_add_u32 m0, s56, 0
    s_add_u32 s69, s57, 0
    buffer_load_dwordx4 v2, s[8:11], s69 offen offset:0 nt lds
    buffer_load_dwordx4 v3, s[8:11], s69 offen offset:1024 nt lds
    buffer_load_dwordx4 v4, s[8:11], s69 offen offset:2048 nt lds
    buffer_load_dwordx4 v5, s[8:11], s69 offen offset:3072 nt lds
    s_add_u32 m0, s56, 4096
    s_add_u32 s69, s69, 4096
    buffer_load_dwordx4 v2, s[8:11], s69 offen offset:0 nt lds
    buffer_load_dwordx4 v3, s[8:11], s69 offen offset:1024 nt lds
    buffer_load_dwordx4 v4, s[8:11], s69 offen offset:2048 nt lds
    buffer_load_dwordx4 v5, s[8:11], s69 offen offset:3072 nt lds
    s_waitcnt vmcnt(8)
    ds_read_b128 v[14:17], v6 offset:8192
    ds_read_b128 v[18:21], v7 offset:8192
    ds_read_b128 v[22:25], v8 offset:8192
    ds_read_b128 v[26:29], v9 offset:8192
    s_waitcnt lgkmcnt(3)
    v_mfma_f32_16x16x32_bf16 v[84:87], v[14:17], v[32:35], 0
    s_waitcnt lgkmcnt(2)
    v_mfma_f32_16x16x32_bf16 v[84:87], v[18:21], v[36:39], v[84:87]
    ds_read_b128 v[14:17], v10 offset:8192
    s_waitcnt lgkmcnt(2)
    v_mfma_f32_16x16x32_bf16 v[84:87], v[22:25], v[40:43], v[84:87]
    ds_read_b128 v[18:21], v11 offset:8192
    s_waitcnt lgkmcnt(2)
    v_mfma_f32_16x16x32_bf16 v[84:87], v[26:29], v[44:47], v[84:87]
    ds_read_b128 v[22:25], v12 offset:8192
    s_waitcnt lgkmcnt(2)
    v_mfma_f32_16x16x32_bf16 v[84:87], v[14:17], v[48:51], v[84:87]
    ds_read_b128 v[26:29], v13 offset:8192
    s_waitcnt lgkmcnt(2)
    v_mfma_f32_16x16x32_bf16 v[84:87], v[18:21], v[52:55], v[84:87]
    s_waitcnt lgkmcnt(1)
    v_mfma_f32_16x16x32_bf16 v[84:87], v[22:25], v[56:59], v[84:87]
    s_waitcnt lgkmcnt(0)
    v_mfma_f32_16x16x32_bf16 v[84:87], v[26:29], v[60:63], v[84:87]
    s_add_u32 m0, s56, 8192
    s_add_u32 s69, s57, 131072
    buffer_load_dwordx4 v2, s[8:11], s69 offen offset:0 nt lds
    buffer_load_dwordx4 v3, s[8:11], s69 offen offset:1024 nt lds
    buffer_load_dwordx4 v4, s[8:11], s69 offen offset:2048 nt lds
    buffer_load_dwordx4 v5, s[8:11], s69 offen offset:3072 nt lds
    s_add_u32 m0, s56, 12288
    s_add_u32 s69, s69, 4096
    buffer_load_dwordx4 v2, s[8:11], s69 offen offset:0 nt lds
    buffer_load_dwordx4 v3, s[8:11], s69 offen offset:1024 nt lds
    buffer_load_dwordx4 v4, s[8:11], s69 offen offset:2048 nt lds
    buffer_load_dwordx4 v5, s[8:11], s69 offen offset:3072 nt lds
    s_nop 7
    v_max3_f32 v14, v64, v65, v66
    v_max3_f32 v15, v67, v68, v69
    v_max3_f32 v14, v14, v70, v71
    v_max3_f32 v15, v15, v72, v73
    v_max3_f32 v14, v14, v74, v75
    v_max3_f32 v15, v15, v76, v77
    v_max3_f32 v14, v14, v78, v79
    v_max3_f32 v15, v15, v80, v81
    v_max3_f32 v14, v14, v82, v83
    v_max3_f32 v15, v15, v84, v85
    v_max3_f32 v14, v14, v86, v87
    v_max3_f32 v15, v15, v88, v89
    v_max3_f32 v14, v14, v90, v91
    v_max3_f32 v15, v15, v92, v93
    v_max3_f32 v14, v14, v94, v95
    v_max3_f32 v15, v15, v96, v97
    v_max3_f32 v14, v14, v98, v99
    v_max3_f32 v15, v15, v100, v101
    v_max3_f32 v14, v14, v102, v103
    v_max3_f32 v15, v15, v104, v105
    v_max3_f32 v14, v14, v106, v107
    v_max3_f32 v15, v15, v108, v109
    v_max3_f32 v14, v14, v110, v111
    v_max3_f32 v15, v15, v112, v113
    v_max3_f32 v14, v14, v114, v115
    v_max3_f32 v15, v15, v116, v117
    v_max3_f32 v14, v14, v118, v119
    v_max3_f32 v15, v15, v120, v121
    v_max3_f32 v14, v14, v122, v123
    v_max3_f32 v15, v15, v124, v125
    v_max3_f32 v14, v14, v126, v127
    v_max_f32 v14, v14, v15
    v_mov_b32 v15, v14
    s_nop 1
    v_permlane32_swap_b32 v15, v14
    s_nop 1
    v_max_f32 v14, v14, v15
    v_mov_b32 v15, v14
    s_nop 1
    v_permlane16_swap_b32 v15, v14
    s_nop 1
    v_max_f32 v14, v14, v15
    v_mul_f32 v14, s68, v14
    v_mov_b32 v16, 0
    v_mov_b32 v17, 0
    v_fma_f32 v64, v64, s68, -v14
    v_fma_f32 v65, v65, s68, -v14
    v_fma_f32 v66, v66, s68, -v14
    v_fma_f32 v67, v67, s68, -v14
    v_exp_f32 v64, v64
    v_exp_f32 v65, v65
    v_exp_f32 v66, v66
    v_exp_f32 v67, v67
    v_cvt_pk_bf16_f32 v32, v64, v65
    v_add_f32 v16, v16, v64
    v_add_f32 v17, v17, v65
    v_cvt_pk_bf16_f32 v33, v66, v67
    v_add_f32 v16, v16, v66
    v_add_f32 v17, v17, v67
    v_fma_f32 v68, v68, s68, -v14
    v_fma_f32 v69, v69, s68, -v14
    v_fma_f32 v70, v70, s68, -v14
    v_fma_f32 v71, v71, s68, -v14
    v_exp_f32 v68, v68
    v_exp_f32 v69, v69
    v_exp_f32 v70, v70
    v_exp_f32 v71, v71
    v_cvt_pk_bf16_f32 v34, v68, v69
    v_add_f32 v16, v16, v68
    v_add_f32 v17, v17, v69
    v_cvt_pk_bf16_f32 v35, v70, v71
    v_add_f32 v16, v16, v70
    v_add_f32 v17, v17, v71
    v_fma_f32 v72, v72, s68, -v14
    v_fma_f32 v73, v73, s68, -v14
    v_fma_f32 v74, v74, s68, -v14
    v_fma_f32 v75, v75, s68, -v14
    v_exp_f32 v72, v72
    v_exp_f32 v73, v73
    v_exp_f32 v74, v74
    v_exp_f32 v75, v75
    v_cvt_pk_bf16_f32 v36, v72, v73
    v_add_f32 v16, v16, v72
    v_add_f32 v17, v17, v73
    v_cvt_pk_bf16_f32 v37, v74, v75
    v_add_f32 v16, v16, v74
    v_add_f32 v17, v17, v75
    v_fma_f32 v76, v76, s68, -v14
    v_fma_f32 v77, v77, s68, -v14
    v_fma_f32 v78, v78, s68, -v14
    v_fma_f32 v79, v79, s68, -v14
    v_exp_f32 v76, v76
    v_exp_f32 v77, v77
    v_exp_f32 v78, v78
    v_exp_f32 v79, v79
    v_cvt_pk_bf16_f32 v38, v76, v77
    v_add_f32 v16, v16, v76
    v_add_f32 v17, v17, v77
    v_cvt_pk_bf16_f32 v39, v78, v79
    v_add_f32 v16, v16, v78
    v_add_f32 v17, v17, v79
    v_fma_f32 v80, v80, s68, -v14
    v_fma_f32 v81, v81, s68, -v14
    v_fma_f32 v82, v82, s68, -v14
    v_fma_f32 v83, v83, s68, -v14
    v_exp_f32 v80, v80
    v_exp_f32 v81, v81
    v_exp_f32 v82, v82
    v_exp_f32 v83, v83
    v_cvt_pk_bf16_f32 v40, v80, v81
    v_add_f32 v16, v16, v80
    v_add_f32 v17, v17, v81
    v_cvt_pk_bf16_f32 v41, v82, v83
    v_add_f32 v16, v16, v82
    v_add_f32 v17, v17, v83
    v_fma_f32 v84, v84, s68, -v14
    v_fma_f32 v85, v85, s68, -v14
    v_fma_f32 v86, v86, s68, -v14
    v_fma_f32 v87, v87, s68, -v14
    v_exp_f32 v84, v84
    v_exp_f32 v85, v85
    v_exp_f32 v86, v86
    v_exp_f32 v87, v87
    v_cvt_pk_bf16_f32 v42, v84, v85
    v_add_f32 v16, v16, v84
    v_add_f32 v17, v17, v85
    v_cvt_pk_bf16_f32 v43, v86, v87
    v_add_f32 v16, v16, v86
    v_add_f32 v17, v17, v87
    v_fma_f32 v88, v88, s68, -v14
    v_fma_f32 v89, v89, s68, -v14
    v_fma_f32 v90, v90, s68, -v14
    v_fma_f32 v91, v91, s68, -v14
    v_exp_f32 v88, v88
    v_exp_f32 v89, v89
    v_exp_f32 v90, v90
    v_exp_f32 v91, v91
    v_cvt_pk_bf16_f32 v44, v88, v89
    v_add_f32 v16, v16, v88
    v_add_f32 v17, v17, v89
    v_cvt_pk_bf16_f32 v45, v90, v91
    v_add_f32 v16, v16, v90
    v_add_f32 v17, v17, v91
    v_fma_f32 v92, v92, s68, -v14
    v_fma_f32 v93, v93, s68, -v14
    v_fma_f32 v94, v94, s68, -v14
    v_fma_f32 v95, v95, s68, -v14
    v_exp_f32 v92, v92
    v_exp_f32 v93, v93
    v_exp_f32 v94, v94
    v_exp_f32 v95, v95
    v_cvt_pk_bf16_f32 v46, v92, v93
    v_add_f32 v16, v16, v92
    v_add_f32 v17, v17, v93
    v_cvt_pk_bf16_f32 v47, v94, v95
    v_add_f32 v16, v16, v94
    v_add_f32 v17, v17, v95
    v_fma_f32 v96, v96, s68, -v14
    v_fma_f32 v97, v97, s68, -v14
    v_fma_f32 v98, v98, s68, -v14
    v_fma_f32 v99, v99, s68, -v14
    v_exp_f32 v96, v96
    v_exp_f32 v97, v97
    v_exp_f32 v98, v98
    v_exp_f32 v99, v99
    v_cvt_pk_bf16_f32 v48, v96, v97
    v_add_f32 v16, v16, v96
    v_add_f32 v17, v17, v97
    v_cvt_pk_bf16_f32 v49, v98, v99
    v_add_f32 v16, v16, v98
    v_add_f32 v17, v17, v99
    v_fma_f32 v100, v100, s68, -v14
    v_fma_f32 v101, v101, s68, -v14
    v_fma_f32 v102, v102, s68, -v14
    v_fma_f32 v103, v103, s68, -v14
    v_exp_f32 v100, v100
    v_exp_f32 v101, v101
    v_exp_f32 v102, v102
    v_exp_f32 v103, v103
    v_cvt_pk_bf16_f32 v50, v100, v101
    v_add_f32 v16, v16, v100
    v_add_f32 v17, v17, v101
    v_cvt_pk_bf16_f32 v51, v102, v103
    v_add_f32 v16, v16, v102
    v_add_f32 v17, v17, v103
    v_fma_f32 v104, v104, s68, -v14
    v_fma_f32 v105, v105, s68, -v14
    v_fma_f32 v106, v106, s68, -v14
    v_fma_f32 v107, v107, s68, -v14
    v_exp_f32 v104, v104
    v_exp_f32 v105, v105
    v_exp_f32 v106, v106
    v_exp_f32 v107, v107
    v_cvt_pk_bf16_f32 v52, v104, v105
    v_add_f32 v16, v16, v104
    v_add_f32 v17, v17, v105
    v_cvt_pk_bf16_f32 v53, v106, v107
    v_add_f32 v16, v16, v106
    v_add_f32 v17, v17, v107
    v_fma_f32 v108, v108, s68, -v14
    v_fma_f32 v109, v109, s68, -v14
    v_fma_f32 v110, v110, s68, -v14
    v_fma_f32 v111, v111, s68, -v14
    v_exp_f32 v108, v108
    v_exp_f32 v109, v109
    v_exp_f32 v110, v110
    v_exp_f32 v111, v111
    v_cvt_pk_bf16_f32 v54, v108, v109
    v_add_f32 v16, v16, v108
    v_add_f32 v17, v17, v109
    v_cvt_pk_bf16_f32 v55, v110, v111
    v_add_f32 v16, v16, v110
    v_add_f32 v17, v17, v111
    v_fma_f32 v112, v112, s68, -v14
    v_fma_f32 v113, v113, s68, -v14
    v_fma_f32 v114, v114, s68, -v14
    v_fma_f32 v115, v115, s68, -v14
    v_exp_f32 v112, v112
    v_exp_f32 v113, v113
    v_exp_f32 v114, v114
    v_exp_f32 v115, v115
    v_cvt_pk_bf16_f32 v56, v112, v113
    v_add_f32 v16, v16, v112
    v_add_f32 v17, v17, v113
    v_cvt_pk_bf16_f32 v57, v114, v115
    v_add_f32 v16, v16, v114
    v_add_f32 v17, v17, v115
    v_fma_f32 v116, v116, s68, -v14
    v_fma_f32 v117, v117, s68, -v14
    v_fma_f32 v118, v118, s68, -v14
    v_fma_f32 v119, v119, s68, -v14
    v_exp_f32 v116, v116
    v_exp_f32 v117, v117
    v_exp_f32 v118, v118
    v_exp_f32 v119, v119
    v_cvt_pk_bf16_f32 v58, v116, v117
    v_add_f32 v16, v16, v116
    v_add_f32 v17, v17, v117
    v_cvt_pk_bf16_f32 v59, v118, v119
    v_add_f32 v16, v16, v118
    v_add_f32 v17, v17, v119
    v_fma_f32 v120, v120, s68, -v14
    v_fma_f32 v121, v121, s68, -v14
    v_fma_f32 v122, v122, s68, -v14
    v_fma_f32 v123, v123, s68, -v14
    v_exp_f32 v120, v120
    v_exp_f32 v121, v121
    v_exp_f32 v122, v122
    v_exp_f32 v123, v123
    v_cvt_pk_bf16_f32 v60, v120, v121
    v_add_f32 v16, v16, v120
    v_add_f32 v17, v17, v121
    v_cvt_pk_bf16_f32 v61, v122, v123
    v_add_f32 v16, v16, v122
    v_add_f32 v17, v17, v123
    v_fma_f32 v124, v124, s68, -v14
    v_fma_f32 v125, v125, s68, -v14
    v_fma_f32 v126, v126, s68, -v14
    v_fma_f32 v127, v127, s68, -v14
    v_exp_f32 v124, v124
    v_exp_f32 v125, v125
    v_exp_f32 v126, v126
    v_exp_f32 v127, v127
    v_cvt_pk_bf16_f32 v62, v124, v125
    v_add_f32 v16, v16, v124
    v_add_f32 v17, v17, v125
    v_cvt_pk_bf16_f32 v63, v126, v127
    v_add_f32 v16, v16, v126
    v_add_f32 v17, v17, v127
    v_add_f32 v16, v16, v17
    v_mov_b32 v15, v16
    s_nop 1
    v_permlane32_swap_b32 v15, v16
    s_nop 1
    v_add_f32 v16, v16, v15
    v_mov_b32 v15, v16
    s_nop 1
    v_permlane16_swap_b32 v15, v16
    s_nop 1
    v_add_f32 v16, v16, v15
    v_mov_b32 v15, v16
    v_and_b32 v17, 1, v1
    v_lshlrev_b32 v17, 3, v17
    s_lshl_b32 s69, s52, 4
    s_add_u32 s69, s69, 135168
    v_add_u32 v17, s69, v17
    ds_write_b64 v17, v[14:15]
    s_waitcnt lgkmcnt(0)
    v_lshrrev_b32 v7, 2, v1
    v_lshlrev_b32 v6, 9, v7
    v_and_b32 v7, 7, v7
    v_lshl_add_u32 v6, v7, 5, v6
    v_and_b32 v7, 3, v1
    v_lshl_add_u32 v6, v7, 3, v6
    v_add_u32 v6, s56, v6
    v_xor_b32 v7, 32, v6
    v_xor_b32 v8, 64, v6
    v_xor_b32 v9, 96, v6
    v_xor_b32 v10, 128, v6
    v_xor_b32 v11, 160, v6
    v_xor_b32 v12, 192, v6
    v_xor_b32 v13, 224, v6
    s_waitcnt vmcnt(8)
    ds_read_b64_tr_b16 v[14:15], v6 offset:0
    ds_read_b64_tr_b16 v[16:17], v7 offset:0
    ds_read_b64_tr_b16 v[18:19], v8 offset:0
    ds_read_b64_tr_b16 v[20:21], v9 offset:0
    ds_read_b64_tr_b16 v[22:23], v10 offset:0
    ds_read_b64_tr_b16 v[24:25], v11 offset:0
    ds_read_b64_tr_b16 v[26:27], v12 offset:0
    ds_read_b64_tr_b16 v[28:29], v13 offset:0
    s_waitcnt lgkmcnt(7)
    v_mfma_f32_16x16x16_bf16 v[64:67], v[14:15], v[32:33], 0
    s_waitcnt lgkmcnt(6)
    v_mfma_f32_16x16x16_bf16 v[68:71], v[16:17], v[32:33], 0
    ds_read_b64_tr_b16 v[14:15], v6 offset:256
    s_waitcnt lgkmcnt(6)
    v_mfma_f32_16x16x16_bf16 v[72:75], v[18:19], v[32:33], 0
    ds_read_b64_tr_b16 v[16:17], v7 offset:256
    s_waitcnt lgkmcnt(6)
    v_mfma_f32_16x16x16_bf16 v[76:79], v[20:21], v[32:33], 0
    ds_read_b64_tr_b16 v[18:19], v8 offset:256
    s_waitcnt lgkmcnt(6)
    v_mfma_f32_16x16x16_bf16 v[80:83], v[22:23], v[32:33], 0
    ds_read_b64_tr_b16 v[20:21], v9 offset:256
    s_waitcnt lgkmcnt(6)
    v_mfma_f32_16x16x16_bf16 v[84:87], v[24:25], v[32:33], 0
    ds_read_b64_tr_b16 v[22:23], v10 offset:256
    s_waitcnt lgkmcnt(6)
    v_mfma_f32_16x16x16_bf16 v[88:91], v[26:27], v[32:33], 0
    ds_read_b64_tr_b16 v[24:25], v11 offset:256
    s_waitcnt lgkmcnt(6)
    v_mfma_f32_16x16x16_bf16 v[92:95], v[28:29], v[32:33], 0
    ds_read_b64_tr_b16 v[26:27], v12 offset:256
    s_waitcnt lgkmcnt(6)
    v_mfma_f32_16x16x16_bf16 v[96:99], v[14:15], v[32:33], 0
    ds_read_b64_tr_b16 v[28:29], v13 offset:256
    s_waitcnt lgkmcnt(6)
    v_mfma_f32_16x16x16_bf16 v[100:103], v[16:17], v[32:33], 0
    s_waitcnt lgkmcnt(5)
    v_mfma_f32_16x16x16_bf16 v[104:107], v[18:19], v[32:33], 0
    s_waitcnt lgkmcnt(4)
    v_mfma_f32_16x16x16_bf16 v[108:111], v[20:21], v[32:33], 0
    s_waitcnt lgkmcnt(3)
    v_mfma_f32_16x16x16_bf16 v[112:115], v[22:23], v[32:33], 0
    s_waitcnt lgkmcnt(2)
    v_mfma_f32_16x16x16_bf16 v[116:119], v[24:25], v[32:33], 0
    s_waitcnt lgkmcnt(1)
    v_mfma_f32_16x16x16_bf16 v[120:123], v[26:27], v[32:33], 0
    s_waitcnt lgkmcnt(0)
    v_mfma_f32_16x16x16_bf16 v[124:127], v[28:29], v[32:33], 0
    s_add_u32 m0, s56, 0
    s_add_u32 s69, s57, 262144
    buffer_load_dwordx4 v2, s[8:11], s69 offen offset:0 nt lds
    buffer_load_dwordx4 v3, s[8:11], s69 offen offset:1024 nt lds
    buffer_load_dwordx4 v4, s[8:11], s69 offen offset:2048 nt lds
    buffer_load_dwordx4 v5, s[8:11], s69 offen offset:3072 nt lds
    s_add_u32 m0, s56, 4096
    s_add_u32 s69, s69, 4096
    buffer_load_dwordx4 v2, s[8:11], s69 offen offset:0 nt lds
    buffer_load_dwordx4 v3, s[8:11], s69 offen offset:1024 nt lds
    buffer_load_dwordx4 v4, s[8:11], s69 offen offset:2048 nt lds
    buffer_load_dwordx4 v5, s[8:11], s69 offen offset:3072 nt lds
    s_waitcnt vmcnt(8)
    ds_read_b64_tr_b16 v[14:15], v6 offset:8192
    ds_read_b64_tr_b16 v[16:17], v7 offset:8192
    ds_read_b64_tr_b16 v[18:19], v8 offset:8192
    ds_read_b64_tr_b16 v[20:21], v9 offset:8192
    ds_read_b64_tr_b16 v[22:23], v10 offset:8192
    ds_read_b64_tr_b16 v[24:25], v11 offset:8192
    ds_read_b64_tr_b16 v[26:27], v12 offset:8192
    ds_read_b64_tr_b16 v[28:29], v13 offset:8192
    s_waitcnt lgkmcnt(7)
    v_mfma_f32_16x16x16_bf16 v[64:67], v[14:15], v[34:35], v[64:67]
    s_waitcnt lgkmcnt(6)
    v_mfma_f32_16x16x16_bf16 v[68:71], v[16:17], v[34:35], v[68:71]
    ds_read_b64_tr_b16 v[14:15], v6 offset:8448
    s_waitcnt lgkmcnt(6)
    v_mfma_f32_16x16x16_bf16 v[72:75], v[18:19], v[34:35], v[72:75]
    ds_read_b64_tr_b16 v[16:17], v7 offset:8448
    s_waitcnt lgkmcnt(6)
    v_mfma_f32_16x16x16_bf16 v[76:79], v[20:21], v[34:35], v[76:79]
    ds_read_b64_tr_b16 v[18:19], v8 offset:8448
    s_waitcnt lgkmcnt(6)
    v_mfma_f32_16x16x16_bf16 v[80:83], v[22:23], v[34:35], v[80:83]
    ds_read_b64_tr_b16 v[20:21], v9 offset:8448
    s_waitcnt lgkmcnt(6)
    v_mfma_f32_16x16x16_bf16 v[84:87], v[24:25], v[34:35], v[84:87]
    ds_read_b64_tr_b16 v[22:23], v10 offset:8448
    s_waitcnt lgkmcnt(6)
    v_mfma_f32_16x16x16_bf16 v[88:91], v[26:27], v[34:35], v[88:91]
    ds_read_b64_tr_b16 v[24:25], v11 offset:8448
    s_waitcnt lgkmcnt(6)
    v_mfma_f32_16x16x16_bf16 v[92:95], v[28:29], v[34:35], v[92:95]
    ds_read_b64_tr_b16 v[26:27], v12 offset:8448
    s_waitcnt lgkmcnt(6)
    v_mfma_f32_16x16x16_bf16 v[96:99], v[14:15], v[34:35], v[96:99]
    ds_read_b64_tr_b16 v[28:29], v13 offset:8448
    s_waitcnt lgkmcnt(6)
    v_mfma_f32_16x16x16_bf16 v[100:103], v[16:17], v[34:35], v[100:103]
    s_waitcnt lgkmcnt(5)
    v_mfma_f32_16x16x16_bf16 v[104:107], v[18:19], v[34:35], v[104:107]
    s_waitcnt lgkmcnt(4)
    v_mfma_f32_16x16x16_bf16 v[108:111], v[20:21], v[34:35], v[108:111]
    s_waitcnt lgkmcnt(3)
    v_mfma_f32_16x16x16_bf16 v[112:115], v[22:23], v[34:35], v[112:115]
    s_waitcnt lgkmcnt(2)
    v_mfma_f32_16x16x16_bf16 v[116:119], v[24:25], v[34:35], v[116:119]
    s_waitcnt lgkmcnt(1)
    v_mfma_f32_16x16x16_bf16 v[120:123], v[26:27], v[34:35], v[120:123]
    s_waitcnt lgkmcnt(0)
    v_mfma_f32_16x16x16_bf16 v[124:127], v[28:29], v[34:35], v[124:127]
    s_add_u32 m0, s56, 8192
    s_add_u32 s69, s57, 393216
    buffer_load_dwordx4 v2, s[8:11], s69 offen offset:0 nt lds
    buffer_load_dwordx4 v3, s[8:11], s69 offen offset:1024 nt lds
    buffer_load_dwordx4 v4, s[8:11], s69 offen offset:2048 nt lds
    buffer_load_dwordx4 v5, s[8:11], s69 offen offset:3072 nt lds
    s_add_u32 m0, s56, 12288
    s_add_u32 s69, s69, 4096
    buffer_load_dwordx4 v2, s[8:11], s69 offen offset:0 nt lds
    buffer_load_dwordx4 v3, s[8:11], s69 offen offset:1024 nt lds
    buffer_load_dwordx4 v4, s[8:11], s69 offen offset:2048 nt lds
    buffer_load_dwordx4 v5, s[8:11], s69 offen offset:3072 nt lds
    s_waitcnt vmcnt(8)
    ds_read_b64_tr_b16 v[14:15], v6 offset:0
    ds_read_b64_tr_b16 v[16:17], v7 offset:0
    ds_read_b64_tr_b16 v[18:19], v8 offset:0
    ds_read_b64_tr_b16 v[20:21], v9 offset:0
    ds_read_b64_tr_b16 v[22:23], v10 offset:0
    ds_read_b64_tr_b16 v[24:25], v11 offset:0
    ds_read_b64_tr_b16 v[26:27], v12 offset:0
    ds_read_b64_tr_b16 v[28:29], v13 offset:0
    s_waitcnt lgkmcnt(7)
    v_mfma_f32_16x16x16_bf16 v[64:67], v[14:15], v[36:37], v[64:67]
    s_waitcnt lgkmcnt(6)
    v_mfma_f32_16x16x16_bf16 v[68:71], v[16:17], v[36:37], v[68:71]
    ds_read_b64_tr_b16 v[14:15], v6 offset:256
    s_waitcnt lgkmcnt(6)
    v_mfma_f32_16x16x16_bf16 v[72:75], v[18:19], v[36:37], v[72:75]
    ds_read_b64_tr_b16 v[16:17], v7 offset:256
    s_waitcnt lgkmcnt(6)
    v_mfma_f32_16x16x16_bf16 v[76:79], v[20:21], v[36:37], v[76:79]
    ds_read_b64_tr_b16 v[18:19], v8 offset:256
    s_waitcnt lgkmcnt(6)
    v_mfma_f32_16x16x16_bf16 v[80:83], v[22:23], v[36:37], v[80:83]
    ds_read_b64_tr_b16 v[20:21], v9 offset:256
    s_waitcnt lgkmcnt(6)
    v_mfma_f32_16x16x16_bf16 v[84:87], v[24:25], v[36:37], v[84:87]
    ds_read_b64_tr_b16 v[22:23], v10 offset:256
    s_waitcnt lgkmcnt(6)
    v_mfma_f32_16x16x16_bf16 v[88:91], v[26:27], v[36:37], v[88:91]
    ds_read_b64_tr_b16 v[24:25], v11 offset:256
    s_waitcnt lgkmcnt(6)
    v_mfma_f32_16x16x16_bf16 v[92:95], v[28:29], v[36:37], v[92:95]
    ds_read_b64_tr_b16 v[26:27], v12 offset:256
    s_waitcnt lgkmcnt(6)
    v_mfma_f32_16x16x16_bf16 v[96:99], v[14:15], v[36:37], v[96:99]
    ds_read_b64_tr_b16 v[28:29], v13 offset:256
    s_waitcnt lgkmcnt(6)
    v_mfma_f32_16x16x16_bf16 v[100:103], v[16:17], v[36:37], v[100:103]
    s_waitcnt lgkmcnt(5)
    v_mfma_f32_16x16x16_bf16 v[104:107], v[18:19], v[36:37], v[104:107]
    s_waitcnt lgkmcnt(4)
    v_mfma_f32_16x16x16_bf16 v[108:111], v[20:21], v[36:37], v[108:111]
    s_waitcnt lgkmcnt(3)
    v_mfma_f32_16x16x16_bf16 v[112:115], v[22:23], v[36:37], v[112:115]
    s_waitcnt lgkmcnt(2)
    v_mfma_f32_16x16x16_bf16 v[116:119], v[24:25], v[36:37], v[116:119]
    s_waitcnt lgkmcnt(1)
    v_mfma_f32_16x16x16_bf16 v[120:123], v[26:27], v[36:37], v[120:123]
    s_waitcnt lgkmcnt(0)
    v_mfma_f32_16x16x16_bf16 v[124:127], v[28:29], v[36:37], v[124:127]
    s_add_u32 m0, s56, 0
    s_add_u32 s69, s57, 524288
    buffer_load_dwordx4 v2, s[8:11], s69 offen offset:0 nt lds
    buffer_load_dwordx4 v3, s[8:11], s69 offen offset:1024 nt lds
    buffer_load_dwordx4 v4, s[8:11], s69 offen offset:2048 nt lds
    buffer_load_dwordx4 v5, s[8:11], s69 offen offset:3072 nt lds
    s_add_u32 m0, s56, 4096
    s_add_u32 s69, s69, 4096
    buffer_load_dwordx4 v2, s[8:11], s69 offen offset:0 nt lds
    buffer_load_dwordx4 v3, s[8:11], s69 offen offset:1024 nt lds
    buffer_load_dwordx4 v4, s[8:11], s69 offen offset:2048 nt lds
    buffer_load_dwordx4 v5, s[8:11], s69 offen offset:3072 nt lds
    s_waitcnt vmcnt(8)
    ds_read_b64_tr_b16 v[14:15], v6 offset:8192
    ds_read_b64_tr_b16 v[16:17], v7 offset:8192
    ds_read_b64_tr_b16 v[18:19], v8 offset:8192
    ds_read_b64_tr_b16 v[20:21], v9 offset:8192
    ds_read_b64_tr_b16 v[22:23], v10 offset:8192
    ds_read_b64_tr_b16 v[24:25], v11 offset:8192
    ds_read_b64_tr_b16 v[26:27], v12 offset:8192
    ds_read_b64_tr_b16 v[28:29], v13 offset:8192
    s_waitcnt lgkmcnt(7)
    v_mfma_f32_16x16x16_bf16 v[64:67], v[14:15], v[38:39], v[64:67]
    s_waitcnt lgkmcnt(6)
    v_mfma_f32_16x16x16_bf16 v[68:71], v[16:17], v[38:39], v[68:71]
    ds_read_b64_tr_b16 v[14:15], v6 offset:8448
    s_waitcnt lgkmcnt(6)
    v_mfma_f32_16x16x16_bf16 v[72:75], v[18:19], v[38:39], v[72:75]
    ds_read_b64_tr_b16 v[16:17], v7 offset:8448
    s_waitcnt lgkmcnt(6)
    v_mfma_f32_16x16x16_bf16 v[76:79], v[20:21], v[38:39], v[76:79]
    ds_read_b64_tr_b16 v[18:19], v8 offset:8448
    s_waitcnt lgkmcnt(6)
    v_mfma_f32_16x16x16_bf16 v[80:83], v[22:23], v[38:39], v[80:83]
    ds_read_b64_tr_b16 v[20:21], v9 offset:8448
    s_waitcnt lgkmcnt(6)
    v_mfma_f32_16x16x16_bf16 v[84:87], v[24:25], v[38:39], v[84:87]
    ds_read_b64_tr_b16 v[22:23], v10 offset:8448
    s_waitcnt lgkmcnt(6)
    v_mfma_f32_16x16x16_bf16 v[88:91], v[26:27], v[38:39], v[88:91]
    ds_read_b64_tr_b16 v[24:25], v11 offset:8448
    s_waitcnt lgkmcnt(6)
    v_mfma_f32_16x16x16_bf16 v[92:95], v[28:29], v[38:39], v[92:95]
    ds_read_b64_tr_b16 v[26:27], v12 offset:8448
    s_waitcnt lgkmcnt(6)
    v_mfma_f32_16x16x16_bf16 v[96:99], v[14:15], v[38:39], v[96:99]
    ds_read_b64_tr_b16 v[28:29], v13 offset:8448
    s_waitcnt lgkmcnt(6)
    v_mfma_f32_16x16x16_bf16 v[100:103], v[16:17], v[38:39], v[100:103]
    s_waitcnt lgkmcnt(5)
    v_mfma_f32_16x16x16_bf16 v[104:107], v[18:19], v[38:39], v[104:107]
    s_waitcnt lgkmcnt(4)
    v_mfma_f32_16x16x16_bf16 v[108:111], v[20:21], v[38:39], v[108:111]
    s_waitcnt lgkmcnt(3)
    v_mfma_f32_16x16x16_bf16 v[112:115], v[22:23], v[38:39], v[112:115]
    s_waitcnt lgkmcnt(2)
    v_mfma_f32_16x16x16_bf16 v[116:119], v[24:25], v[38:39], v[116:119]
    s_waitcnt lgkmcnt(1)
    v_mfma_f32_16x16x16_bf16 v[120:123], v[26:27], v[38:39], v[120:123]
    s_waitcnt lgkmcnt(0)
    v_mfma_f32_16x16x16_bf16 v[124:127], v[28:29], v[38:39], v[124:127]
    s_add_u32 m0, s56, 8192
    s_add_u32 s69, s57, 655360
    buffer_load_dwordx4 v2, s[8:11], s69 offen offset:0 nt lds
    buffer_load_dwordx4 v3, s[8:11], s69 offen offset:1024 nt lds
    buffer_load_dwordx4 v4, s[8:11], s69 offen offset:2048 nt lds
    buffer_load_dwordx4 v5, s[8:11], s69 offen offset:3072 nt lds
    s_add_u32 m0, s56, 12288
    s_add_u32 s69, s69, 4096
    buffer_load_dwordx4 v2, s[8:11], s69 offen offset:0 nt lds
    buffer_load_dwordx4 v3, s[8:11], s69 offen offset:1024 nt lds
    buffer_load_dwordx4 v4, s[8:11], s69 offen offset:2048 nt lds
    buffer_load_dwordx4 v5, s[8:11], s69 offen offset:3072 nt lds
    s_waitcnt vmcnt(8)
    ds_read_b64_tr_b16 v[14:15], v6 offset:0
    ds_read_b64_tr_b16 v[16:17], v7 offset:0
    ds_read_b64_tr_b16 v[18:19], v8 offset:0
    ds_read_b64_tr_b16 v[20:21], v9 offset:0
    ds_read_b64_tr_b16 v[22:23], v10 offset:0
    ds_read_b64_tr_b16 v[24:25], v11 offset:0
    ds_read_b64_tr_b16 v[26:27], v12 offset:0
    ds_read_b64_tr_b16 v[28:29], v13 offset:0
    s_waitcnt lgkmcnt(7)
    v_mfma_f32_16x16x16_bf16 v[64:67], v[14:15], v[40:41], v[64:67]
    s_waitcnt lgkmcnt(6)
    v_mfma_f32_16x16x16_bf16 v[68:71], v[16:17], v[40:41], v[68:71]
    ds_read_b64_tr_b16 v[14:15], v6 offset:256
    s_waitcnt lgkmcnt(6)
    v_mfma_f32_16x16x16_bf16 v[72:75], v[18:19], v[40:41], v[72:75]
    ds_read_b64_tr_b16 v[16:17], v7 offset:256
    s_waitcnt lgkmcnt(6)
    v_mfma_f32_16x16x16_bf16 v[76:79], v[20:21], v[40:41], v[76:79]
    ds_read_b64_tr_b16 v[18:19], v8 offset:256
    s_waitcnt lgkmcnt(6)
    v_mfma_f32_16x16x16_bf16 v[80:83], v[22:23], v[40:41], v[80:83]
    ds_read_b64_tr_b16 v[20:21], v9 offset:256
    s_waitcnt lgkmcnt(6)
    v_mfma_f32_16x16x16_bf16 v[84:87], v[24:25], v[40:41], v[84:87]
    ds_read_b64_tr_b16 v[22:23], v10 offset:256
    s_waitcnt lgkmcnt(6)
    v_mfma_f32_16x16x16_bf16 v[88:91], v[26:27], v[40:41], v[88:91]
    ds_read_b64_tr_b16 v[24:25], v11 offset:256
    s_waitcnt lgkmcnt(6)
    v_mfma_f32_16x16x16_bf16 v[92:95], v[28:29], v[40:41], v[92:95]
    ds_read_b64_tr_b16 v[26:27], v12 offset:256
    s_waitcnt lgkmcnt(6)
    v_mfma_f32_16x16x16_bf16 v[96:99], v[14:15], v[40:41], v[96:99]
    ds_read_b64_tr_b16 v[28:29], v13 offset:256
    s_waitcnt lgkmcnt(6)
    v_mfma_f32_16x16x16_bf16 v[100:103], v[16:17], v[40:41], v[100:103]
    s_waitcnt lgkmcnt(5)
    v_mfma_f32_16x16x16_bf16 v[104:107], v[18:19], v[40:41], v[104:107]
    s_waitcnt lgkmcnt(4)
    v_mfma_f32_16x16x16_bf16 v[108:111], v[20:21], v[40:41], v[108:111]
    s_waitcnt lgkmcnt(3)
    v_mfma_f32_16x16x16_bf16 v[112:115], v[22:23], v[40:41], v[112:115]
    s_waitcnt lgkmcnt(2)
    v_mfma_f32_16x16x16_bf16 v[116:119], v[24:25], v[40:41], v[116:119]
    s_waitcnt lgkmcnt(1)
    v_mfma_f32_16x16x16_bf16 v[120:123], v[26:27], v[40:41], v[120:123]
    s_waitcnt lgkmcnt(0)
    v_mfma_f32_16x16x16_bf16 v[124:127], v[28:29], v[40:41], v[124:127]
    s_add_u32 m0, s56, 0
    s_add_u32 s69, s57, 786432
    buffer_load_dwordx4 v2, s[8:11], s69 offen offset:0 nt lds
    buffer_load_dwordx4 v3, s[8:11], s69 offen offset:1024 nt lds
    buffer_load_dwordx4 v4, s[8:11], s69 offen offset:2048 nt lds
    buffer_load_dwordx4 v5, s[8:11], s69 offen offset:3072 nt lds
    s_add_u32 m0, s56, 4096
    s_add_u32 s69, s69, 4096
    buffer_load_dwordx4 v2, s[8:11], s69 offen offset:0 nt lds
    buffer_load_dwordx4 v3, s[8:11], s69 offen offset:1024 nt lds
    buffer_load_dwordx4 v4, s[8:11], s69 offen offset:2048 nt lds
    buffer_load_dwordx4 v5, s[8:11], s69 offen offset:3072 nt lds
    s_waitcnt vmcnt(8)
    ds_read_b64_tr_b16 v[14:15], v6 offset:8192
    ds_read_b64_tr_b16 v[16:17], v7 offset:8192
    ds_read_b64_tr_b16 v[18:19], v8 offset:8192
    ds_read_b64_tr_b16 v[20:21], v9 offset:8192
    ds_read_b64_tr_b16 v[22:23], v10 offset:8192
    ds_read_b64_tr_b16 v[24:25], v11 offset:8192
    ds_read_b64_tr_b16 v[26:27], v12 offset:8192
    ds_read_b64_tr_b16 v[28:29], v13 offset:8192
    s_waitcnt lgkmcnt(7)
    v_mfma_f32_16x16x16_bf16 v[64:67], v[14:15], v[42:43], v[64:67]
    s_waitcnt lgkmcnt(6)
    v_mfma_f32_16x16x16_bf16 v[68:71], v[16:17], v[42:43], v[68:71]
    ds_read_b64_tr_b16 v[14:15], v6 offset:8448
    s_waitcnt lgkmcnt(6)
    v_mfma_f32_16x16x16_bf16 v[72:75], v[18:19], v[42:43], v[72:75]
    ds_read_b64_tr_b16 v[16:17], v7 offset:8448
    s_waitcnt lgkmcnt(6)
    v_mfma_f32_16x16x16_bf16 v[76:79], v[20:21], v[42:43], v[76:79]
    ds_read_b64_tr_b16 v[18:19], v8 offset:8448
    s_waitcnt lgkmcnt(6)
    v_mfma_f32_16x16x16_bf16 v[80:83], v[22:23], v[42:43], v[80:83]
    ds_read_b64_tr_b16 v[20:21], v9 offset:8448
    s_waitcnt lgkmcnt(6)
    v_mfma_f32_16x16x16_bf16 v[84:87], v[24:25], v[42:43], v[84:87]
    ds_read_b64_tr_b16 v[22:23], v10 offset:8448
    s_waitcnt lgkmcnt(6)
    v_mfma_f32_16x16x16_bf16 v[88:91], v[26:27], v[42:43], v[88:91]
    ds_read_b64_tr_b16 v[24:25], v11 offset:8448
    s_waitcnt lgkmcnt(6)
    v_mfma_f32_16x16x16_bf16 v[92:95], v[28:29], v[42:43], v[92:95]
    ds_read_b64_tr_b16 v[26:27], v12 offset:8448
    s_waitcnt lgkmcnt(6)
    v_mfma_f32_16x16x16_bf16 v[96:99], v[14:15], v[42:43], v[96:99]
    ds_read_b64_tr_b16 v[28:29], v13 offset:8448
    s_waitcnt lgkmcnt(6)
    v_mfma_f32_16x16x16_bf16 v[100:103], v[16:17], v[42:43], v[100:103]
    s_waitcnt lgkmcnt(5)
    v_mfma_f32_16x16x16_bf16 v[104:107], v[18:19], v[42:43], v[104:107]
    s_waitcnt lgkmcnt(4)
    v_mfma_f32_16x16x16_bf16 v[108:111], v[20:21], v[42:43], v[108:111]
    s_waitcnt lgkmcnt(3)
    v_mfma_f32_16x16x16_bf16 v[112:115], v[22:23], v[42:43], v[112:115]
    s_waitcnt lgkmcnt(2)
    v_mfma_f32_16x16x16_bf16 v[116:119], v[24:25], v[42:43], v[116:119]
    s_waitcnt lgkmcnt(1)
    v_mfma_f32_16x16x16_bf16 v[120:123], v[26:27], v[42:43], v[120:123]
    s_waitcnt lgkmcnt(0)
    v_mfma_f32_16x16x16_bf16 v[124:127], v[28:29], v[42:43], v[124:127]
    s_add_u32 m0, s56, 8192
    s_add_u32 s69, s57, 917504
    buffer_load_dwordx4 v2, s[8:11], s69 offen offset:0 nt lds
    buffer_load_dwordx4 v3, s[8:11], s69 offen offset:1024 nt lds
    buffer_load_dwordx4 v4, s[8:11], s69 offen offset:2048 nt lds
    buffer_load_dwordx4 v5, s[8:11], s69 offen offset:3072 nt lds
    s_add_u32 m0, s56, 12288
    s_add_u32 s69, s69, 4096
    buffer_load_dwordx4 v2, s[8:11], s69 offen offset:0 nt lds
    buffer_load_dwordx4 v3, s[8:11], s69 offen offset:1024 nt lds
    buffer_load_dwordx4 v4, s[8:11], s69 offen offset:2048 nt lds
    buffer_load_dwordx4 v5, s[8:11], s69 offen offset:3072 nt lds
    s_waitcnt vmcnt(8)
    ds_read_b64_tr_b16 v[14:15], v6 offset:0
    ds_read_b64_tr_b16 v[16:17], v7 offset:0
    ds_read_b64_tr_b16 v[18:19], v8 offset:0
    ds_read_b64_tr_b16 v[20:21], v9 offset:0
    ds_read_b64_tr_b16 v[22:23], v10 offset:0
    ds_read_b64_tr_b16 v[24:25], v11 offset:0
    ds_read_b64_tr_b16 v[26:27], v12 offset:0
    ds_read_b64_tr_b16 v[28:29], v13 offset:0
    s_waitcnt lgkmcnt(7)
    v_mfma_f32_16x16x16_bf16 v[64:67], v[14:15], v[44:45], v[64:67]
    s_waitcnt lgkmcnt(6)
    v_mfma_f32_16x16x16_bf16 v[68:71], v[16:17], v[44:45], v[68:71]
    ds_read_b64_tr_b16 v[14:15], v6 offset:256
    s_waitcnt lgkmcnt(6)
    v_mfma_f32_16x16x16_bf16 v[72:75], v[18:19], v[44:45], v[72:75]
    ds_read_b64_tr_b16 v[16:17], v7 offset:256
    s_waitcnt lgkmcnt(6)
    v_mfma_f32_16x16x16_bf16 v[76:79], v[20:21], v[44:45], v[76:79]
    ds_read_b64_tr_b16 v[18:19], v8 offset:256
    s_waitcnt lgkmcnt(6)
    v_mfma_f32_16x16x16_bf16 v[80:83], v[22:23], v[44:45], v[80:83]
    ds_read_b64_tr_b16 v[20:21], v9 offset:256
    s_waitcnt lgkmcnt(6)
    v_mfma_f32_16x16x16_bf16 v[84:87], v[24:25], v[44:45], v[84:87]
    ds_read_b64_tr_b16 v[22:23], v10 offset:256
    s_waitcnt lgkmcnt(6)
    v_mfma_f32_16x16x16_bf16 v[88:91], v[26:27], v[44:45], v[88:91]
    ds_read_b64_tr_b16 v[24:25], v11 offset:256
    s_waitcnt lgkmcnt(6)
    v_mfma_f32_16x16x16_bf16 v[92:95], v[28:29], v[44:45], v[92:95]
    ds_read_b64_tr_b16 v[26:27], v12 offset:256
    s_waitcnt lgkmcnt(6)
    v_mfma_f32_16x16x16_bf16 v[96:99], v[14:15], v[44:45], v[96:99]
    ds_read_b64_tr_b16 v[28:29], v13 offset:256
    s_waitcnt lgkmcnt(6)
    v_mfma_f32_16x16x16_bf16 v[100:103], v[16:17], v[44:45], v[100:103]
    s_waitcnt lgkmcnt(5)
    v_mfma_f32_16x16x16_bf16 v[104:107], v[18:19], v[44:45], v[104:107]
    s_waitcnt lgkmcnt(4)
    v_mfma_f32_16x16x16_bf16 v[108:111], v[20:21], v[44:45], v[108:111]
    s_waitcnt lgkmcnt(3)
    v_mfma_f32_16x16x16_bf16 v[112:115], v[22:23], v[44:45], v[112:115]
    s_waitcnt lgkmcnt(2)
    v_mfma_f32_16x16x16_bf16 v[116:119], v[24:25], v[44:45], v[116:119]
    s_waitcnt lgkmcnt(1)
    v_mfma_f32_16x16x16_bf16 v[120:123], v[26:27], v[44:45], v[120:123]
    s_waitcnt lgkmcnt(0)
    v_mfma_f32_16x16x16_bf16 v[124:127], v[28:29], v[44:45], v[124:127]
    s_add_u32 m0, s56, 0
    s_add_u32 s69, s57, 1048576
    buffer_load_dwordx4 v2, s[8:11], s69 offen offset:0 nt lds
    buffer_load_dwordx4 v3, s[8:11], s69 offen offset:1024 nt lds
    buffer_load_dwordx4 v4, s[8:11], s69 offen offset:2048 nt lds
    buffer_load_dwordx4 v5, s[8:11], s69 offen offset:3072 nt lds
    s_add_u32 m0, s56, 4096
    s_add_u32 s69, s69, 4096
    buffer_load_dwordx4 v2, s[8:11], s69 offen offset:0 nt lds
    buffer_load_dwordx4 v3, s[8:11], s69 offen offset:1024 nt lds
    buffer_load_dwordx4 v4, s[8:11], s69 offen offset:2048 nt lds
    buffer_load_dwordx4 v5, s[8:11], s69 offen offset:3072 nt lds
    s_waitcnt vmcnt(8)
    ds_read_b64_tr_b16 v[14:15], v6 offset:8192
    ds_read_b64_tr_b16 v[16:17], v7 offset:8192
    ds_read_b64_tr_b16 v[18:19], v8 offset:8192
    ds_read_b64_tr_b16 v[20:21], v9 offset:8192
    ds_read_b64_tr_b16 v[22:23], v10 offset:8192
    ds_read_b64_tr_b16 v[24:25], v11 offset:8192
    ds_read_b64_tr_b16 v[26:27], v12 offset:8192
    ds_read_b64_tr_b16 v[28:29], v13 offset:8192
    s_waitcnt lgkmcnt(7)
    v_mfma_f32_16x16x16_bf16 v[64:67], v[14:15], v[46:47], v[64:67]
    s_waitcnt lgkmcnt(6)
    v_mfma_f32_16x16x16_bf16 v[68:71], v[16:17], v[46:47], v[68:71]
    ds_read_b64_tr_b16 v[14:15], v6 offset:8448
    s_waitcnt lgkmcnt(6)
    v_mfma_f32_16x16x16_bf16 v[72:75], v[18:19], v[46:47], v[72:75]
    ds_read_b64_tr_b16 v[16:17], v7 offset:8448
    s_waitcnt lgkmcnt(6)
    v_mfma_f32_16x16x16_bf16 v[76:79], v[20:21], v[46:47], v[76:79]
    ds_read_b64_tr_b16 v[18:19], v8 offset:8448
    s_waitcnt lgkmcnt(6)
    v_mfma_f32_16x16x16_bf16 v[80:83], v[22:23], v[46:47], v[80:83]
    ds_read_b64_tr_b16 v[20:21], v9 offset:8448
    s_waitcnt lgkmcnt(6)
    v_mfma_f32_16x16x16_bf16 v[84:87], v[24:25], v[46:47], v[84:87]
    ds_read_b64_tr_b16 v[22:23], v10 offset:8448
    s_waitcnt lgkmcnt(6)
    v_mfma_f32_16x16x16_bf16 v[88:91], v[26:27], v[46:47], v[88:91]
    ds_read_b64_tr_b16 v[24:25], v11 offset:8448
    s_waitcnt lgkmcnt(6)
    v_mfma_f32_16x16x16_bf16 v[92:95], v[28:29], v[46:47], v[92:95]
    ds_read_b64_tr_b16 v[26:27], v12 offset:8448
    s_waitcnt lgkmcnt(6)
    v_mfma_f32_16x16x16_bf16 v[96:99], v[14:15], v[46:47], v[96:99]
    ds_read_b64_tr_b16 v[28:29], v13 offset:8448
    s_waitcnt lgkmcnt(6)
    v_mfma_f32_16x16x16_bf16 v[100:103], v[16:17], v[46:47], v[100:103]
    s_waitcnt lgkmcnt(5)
    v_mfma_f32_16x16x16_bf16 v[104:107], v[18:19], v[46:47], v[104:107]
    s_waitcnt lgkmcnt(4)
    v_mfma_f32_16x16x16_bf16 v[108:111], v[20:21], v[46:47], v[108:111]
    s_waitcnt lgkmcnt(3)
    v_mfma_f32_16x16x16_bf16 v[112:115], v[22:23], v[46:47], v[112:115]
    s_waitcnt lgkmcnt(2)
    v_mfma_f32_16x16x16_bf16 v[116:119], v[24:25], v[46:47], v[116:119]
    s_waitcnt lgkmcnt(1)
    v_mfma_f32_16x16x16_bf16 v[120:123], v[26:27], v[46:47], v[120:123]
    s_waitcnt lgkmcnt(0)
    v_mfma_f32_16x16x16_bf16 v[124:127], v[28:29], v[46:47], v[124:127]
    s_add_u32 m0, s56, 8192
    s_add_u32 s69, s57, 1179648
    buffer_load_dwordx4 v2, s[8:11], s69 offen offset:0 nt lds
    buffer_load_dwordx4 v3, s[8:11], s69 offen offset:1024 nt lds
    buffer_load_dwordx4 v4, s[8:11], s69 offen offset:2048 nt lds
    buffer_load_dwordx4 v5, s[8:11], s69 offen offset:3072 nt lds
    s_add_u32 m0, s56, 12288
    s_add_u32 s69, s69, 4096
    buffer_load_dwordx4 v2, s[8:11], s69 offen offset:0 nt lds
    buffer_load_dwordx4 v3, s[8:11], s69 offen offset:1024 nt lds
    buffer_load_dwordx4 v4, s[8:11], s69 offen offset:2048 nt lds
    buffer_load_dwordx4 v5, s[8:11], s69 offen offset:3072 nt lds
    s_waitcnt vmcnt(8)
    ds_read_b64_tr_b16 v[14:15], v6 offset:0
    ds_read_b64_tr_b16 v[16:17], v7 offset:0
    ds_read_b64_tr_b16 v[18:19], v8 offset:0
    ds_read_b64_tr_b16 v[20:21], v9 offset:0
    ds_read_b64_tr_b16 v[22:23], v10 offset:0
    ds_read_b64_tr_b16 v[24:25], v11 offset:0
    ds_read_b64_tr_b16 v[26:27], v12 offset:0
    ds_read_b64_tr_b16 v[28:29], v13 offset:0
    s_waitcnt lgkmcnt(7)
    v_mfma_f32_16x16x16_bf16 v[64:67], v[14:15], v[48:49], v[64:67]
    s_waitcnt lgkmcnt(6)
    v_mfma_f32_16x16x16_bf16 v[68:71], v[16:17], v[48:49], v[68:71]
    ds_read_b64_tr_b16 v[14:15], v6 offset:256
    s_waitcnt lgkmcnt(6)
    v_mfma_f32_16x16x16_bf16 v[72:75], v[18:19], v[48:49], v[72:75]
    ds_read_b64_tr_b16 v[16:17], v7 offset:256
    s_waitcnt lgkmcnt(6)
    v_mfma_f32_16x16x16_bf16 v[76:79], v[20:21], v[48:49], v[76:79]
    ds_read_b64_tr_b16 v[18:19], v8 offset:256
    s_waitcnt lgkmcnt(6)
    v_mfma_f32_16x16x16_bf16 v[80:83], v[22:23], v[48:49], v[80:83]
    ds_read_b64_tr_b16 v[20:21], v9 offset:256
    s_waitcnt lgkmcnt(6)
    v_mfma_f32_16x16x16_bf16 v[84:87], v[24:25], v[48:49], v[84:87]
    ds_read_b64_tr_b16 v[22:23], v10 offset:256
    s_waitcnt lgkmcnt(6)
    v_mfma_f32_16x16x16_bf16 v[88:91], v[26:27], v[48:49], v[88:91]
    ds_read_b64_tr_b16 v[24:25], v11 offset:256
    s_waitcnt lgkmcnt(6)
    v_mfma_f32_16x16x16_bf16 v[92:95], v[28:29], v[48:49], v[92:95]
    ds_read_b64_tr_b16 v[26:27], v12 offset:256
    s_waitcnt lgkmcnt(6)
    v_mfma_f32_16x16x16_bf16 v[96:99], v[14:15], v[48:49], v[96:99]
    ds_read_b64_tr_b16 v[28:29], v13 offset:256
    s_waitcnt lgkmcnt(6)
    v_mfma_f32_16x16x16_bf16 v[100:103], v[16:17], v[48:49], v[100:103]
    s_waitcnt lgkmcnt(5)
    v_mfma_f32_16x16x16_bf16 v[104:107], v[18:19], v[48:49], v[104:107]
    s_waitcnt lgkmcnt(4)
    v_mfma_f32_16x16x16_bf16 v[108:111], v[20:21], v[48:49], v[108:111]
    s_waitcnt lgkmcnt(3)
    v_mfma_f32_16x16x16_bf16 v[112:115], v[22:23], v[48:49], v[112:115]
    s_waitcnt lgkmcnt(2)
    v_mfma_f32_16x16x16_bf16 v[116:119], v[24:25], v[48:49], v[116:119]
    s_waitcnt lgkmcnt(1)
    v_mfma_f32_16x16x16_bf16 v[120:123], v[26:27], v[48:49], v[120:123]
    s_waitcnt lgkmcnt(0)
    v_mfma_f32_16x16x16_bf16 v[124:127], v[28:29], v[48:49], v[124:127]
    s_add_u32 m0, s56, 0
    s_add_u32 s69, s57, 1310720
    buffer_load_dwordx4 v2, s[8:11], s69 offen offset:0 nt lds
    buffer_load_dwordx4 v3, s[8:11], s69 offen offset:1024 nt lds
    buffer_load_dwordx4 v4, s[8:11], s69 offen offset:2048 nt lds
    buffer_load_dwordx4 v5, s[8:11], s69 offen offset:3072 nt lds
    s_add_u32 m0, s56, 4096
    s_add_u32 s69, s69, 4096
    buffer_load_dwordx4 v2, s[8:11], s69 offen offset:0 nt lds
    buffer_load_dwordx4 v3, s[8:11], s69 offen offset:1024 nt lds
    buffer_load_dwordx4 v4, s[8:11], s69 offen offset:2048 nt lds
    buffer_load_dwordx4 v5, s[8:11], s69 offen offset:3072 nt lds
    s_waitcnt vmcnt(8)
    ds_read_b64_tr_b16 v[14:15], v6 offset:8192
    ds_read_b64_tr_b16 v[16:17], v7 offset:8192
    ds_read_b64_tr_b16 v[18:19], v8 offset:8192
    ds_read_b64_tr_b16 v[20:21], v9 offset:8192
    ds_read_b64_tr_b16 v[22:23], v10 offset:8192
    ds_read_b64_tr_b16 v[24:25], v11 offset:8192
    ds_read_b64_tr_b16 v[26:27], v12 offset:8192
    ds_read_b64_tr_b16 v[28:29], v13 offset:8192
    s_waitcnt lgkmcnt(7)
    v_mfma_f32_16x16x16_bf16 v[64:67], v[14:15], v[50:51], v[64:67]
    s_waitcnt lgkmcnt(6)
    v_mfma_f32_16x16x16_bf16 v[68:71], v[16:17], v[50:51], v[68:71]
    ds_read_b64_tr_b16 v[14:15], v6 offset:8448
    s_waitcnt lgkmcnt(6)
    v_mfma_f32_16x16x16_bf16 v[72:75], v[18:19], v[50:51], v[72:75]
    ds_read_b64_tr_b16 v[16:17], v7 offset:8448
    s_waitcnt lgkmcnt(6)
    v_mfma_f32_16x16x16_bf16 v[76:79], v[20:21], v[50:51], v[76:79]
    ds_read_b64_tr_b16 v[18:19], v8 offset:8448
    s_waitcnt lgkmcnt(6)
    v_mfma_f32_16x16x16_bf16 v[80:83], v[22:23], v[50:51], v[80:83]
    ds_read_b64_tr_b16 v[20:21], v9 offset:8448
    s_waitcnt lgkmcnt(6)
    v_mfma_f32_16x16x16_bf16 v[84:87], v[24:25], v[50:51], v[84:87]
    ds_read_b64_tr_b16 v[22:23], v10 offset:8448
    s_waitcnt lgkmcnt(6)
    v_mfma_f32_16x16x16_bf16 v[88:91], v[26:27], v[50:51], v[88:91]
    ds_read_b64_tr_b16 v[24:25], v11 offset:8448
    s_waitcnt lgkmcnt(6)
    v_mfma_f32_16x16x16_bf16 v[92:95], v[28:29], v[50:51], v[92:95]
    ds_read_b64_tr_b16 v[26:27], v12 offset:8448
    s_waitcnt lgkmcnt(6)
    v_mfma_f32_16x16x16_bf16 v[96:99], v[14:15], v[50:51], v[96:99]
    ds_read_b64_tr_b16 v[28:29], v13 offset:8448
    s_waitcnt lgkmcnt(6)
    v_mfma_f32_16x16x16_bf16 v[100:103], v[16:17], v[50:51], v[100:103]
    s_waitcnt lgkmcnt(5)
    v_mfma_f32_16x16x16_bf16 v[104:107], v[18:19], v[50:51], v[104:107]
    s_waitcnt lgkmcnt(4)
    v_mfma_f32_16x16x16_bf16 v[108:111], v[20:21], v[50:51], v[108:111]
    s_waitcnt lgkmcnt(3)
    v_mfma_f32_16x16x16_bf16 v[112:115], v[22:23], v[50:51], v[112:115]
    s_waitcnt lgkmcnt(2)
    v_mfma_f32_16x16x16_bf16 v[116:119], v[24:25], v[50:51], v[116:119]
    s_waitcnt lgkmcnt(1)
    v_mfma_f32_16x16x16_bf16 v[120:123], v[26:27], v[50:51], v[120:123]
    s_waitcnt lgkmcnt(0)
    v_mfma_f32_16x16x16_bf16 v[124:127], v[28:29], v[50:51], v[124:127]
    s_add_u32 m0, s56, 8192
    s_add_u32 s69, s57, 1441792
    buffer_load_dwordx4 v2, s[8:11], s69 offen offset:0 nt lds
    buffer_load_dwordx4 v3, s[8:11], s69 offen offset:1024 nt lds
    buffer_load_dwordx4 v4, s[8:11], s69 offen offset:2048 nt lds
    buffer_load_dwordx4 v5, s[8:11], s69 offen offset:3072 nt lds
    s_add_u32 m0, s56, 12288
    s_add_u32 s69, s69, 4096
    buffer_load_dwordx4 v2, s[8:11], s69 offen offset:0 nt lds
    buffer_load_dwordx4 v3, s[8:11], s69 offen offset:1024 nt lds
    buffer_load_dwordx4 v4, s[8:11], s69 offen offset:2048 nt lds
    buffer_load_dwordx4 v5, s[8:11], s69 offen offset:3072 nt lds
    s_waitcnt vmcnt(8)
    ds_read_b64_tr_b16 v[14:15], v6 offset:0
    ds_read_b64_tr_b16 v[16:17], v7 offset:0
    ds_read_b64_tr_b16 v[18:19], v8 offset:0
    ds_read_b64_tr_b16 v[20:21], v9 offset:0
    ds_read_b64_tr_b16 v[22:23], v10 offset:0
    ds_read_b64_tr_b16 v[24:25], v11 offset:0
    ds_read_b64_tr_b16 v[26:27], v12 offset:0
    ds_read_b64_tr_b16 v[28:29], v13 offset:0
    s_waitcnt lgkmcnt(7)
    v_mfma_f32_16x16x16_bf16 v[64:67], v[14:15], v[52:53], v[64:67]
    s_waitcnt lgkmcnt(6)
    v_mfma_f32_16x16x16_bf16 v[68:71], v[16:17], v[52:53], v[68:71]
    ds_read_b64_tr_b16 v[14:15], v6 offset:256
    s_waitcnt lgkmcnt(6)
    v_mfma_f32_16x16x16_bf16 v[72:75], v[18:19], v[52:53], v[72:75]
    ds_read_b64_tr_b16 v[16:17], v7 offset:256
    s_waitcnt lgkmcnt(6)
    v_mfma_f32_16x16x16_bf16 v[76:79], v[20:21], v[52:53], v[76:79]
    ds_read_b64_tr_b16 v[18:19], v8 offset:256
    s_waitcnt lgkmcnt(6)
    v_mfma_f32_16x16x16_bf16 v[80:83], v[22:23], v[52:53], v[80:83]
    ds_read_b64_tr_b16 v[20:21], v9 offset:256
    s_waitcnt lgkmcnt(6)
    v_mfma_f32_16x16x16_bf16 v[84:87], v[24:25], v[52:53], v[84:87]
    ds_read_b64_tr_b16 v[22:23], v10 offset:256
    s_waitcnt lgkmcnt(6)
    v_mfma_f32_16x16x16_bf16 v[88:91], v[26:27], v[52:53], v[88:91]
    ds_read_b64_tr_b16 v[24:25], v11 offset:256
    s_waitcnt lgkmcnt(6)
    v_mfma_f32_16x16x16_bf16 v[92:95], v[28:29], v[52:53], v[92:95]
    ds_read_b64_tr_b16 v[26:27], v12 offset:256
    s_waitcnt lgkmcnt(6)
    v_mfma_f32_16x16x16_bf16 v[96:99], v[14:15], v[52:53], v[96:99]
    ds_read_b64_tr_b16 v[28:29], v13 offset:256
    s_waitcnt lgkmcnt(6)
    v_mfma_f32_16x16x16_bf16 v[100:103], v[16:17], v[52:53], v[100:103]
    s_waitcnt lgkmcnt(5)
    v_mfma_f32_16x16x16_bf16 v[104:107], v[18:19], v[52:53], v[104:107]
    s_waitcnt lgkmcnt(4)
    v_mfma_f32_16x16x16_bf16 v[108:111], v[20:21], v[52:53], v[108:111]
    s_waitcnt lgkmcnt(3)
    v_mfma_f32_16x16x16_bf16 v[112:115], v[22:23], v[52:53], v[112:115]
    s_waitcnt lgkmcnt(2)
    v_mfma_f32_16x16x16_bf16 v[116:119], v[24:25], v[52:53], v[116:119]
    s_waitcnt lgkmcnt(1)
    v_mfma_f32_16x16x16_bf16 v[120:123], v[26:27], v[52:53], v[120:123]
    s_waitcnt lgkmcnt(0)
    v_mfma_f32_16x16x16_bf16 v[124:127], v[28:29], v[52:53], v[124:127]
    s_add_u32 m0, s56, 0
    s_add_u32 s69, s57, 1572864
    buffer_load_dwordx4 v2, s[8:11], s69 offen offset:0 nt lds
    buffer_load_dwordx4 v3, s[8:11], s69 offen offset:1024 nt lds
    buffer_load_dwordx4 v4, s[8:11], s69 offen offset:2048 nt lds
    buffer_load_dwordx4 v5, s[8:11], s69 offen offset:3072 nt lds
    s_add_u32 m0, s56, 4096
    s_add_u32 s69, s69, 4096
    buffer_load_dwordx4 v2, s[8:11], s69 offen offset:0 nt lds
    buffer_load_dwordx4 v3, s[8:11], s69 offen offset:1024 nt lds
    buffer_load_dwordx4 v4, s[8:11], s69 offen offset:2048 nt lds
    buffer_load_dwordx4 v5, s[8:11], s69 offen offset:3072 nt lds
    s_waitcnt vmcnt(8)
    ds_read_b64_tr_b16 v[14:15], v6 offset:8192
    ds_read_b64_tr_b16 v[16:17], v7 offset:8192
    ds_read_b64_tr_b16 v[18:19], v8 offset:8192
    ds_read_b64_tr_b16 v[20:21], v9 offset:8192
    ds_read_b64_tr_b16 v[22:23], v10 offset:8192
    ds_read_b64_tr_b16 v[24:25], v11 offset:8192
    ds_read_b64_tr_b16 v[26:27], v12 offset:8192
    ds_read_b64_tr_b16 v[28:29], v13 offset:8192
    s_waitcnt lgkmcnt(7)
    v_mfma_f32_16x16x16_bf16 v[64:67], v[14:15], v[54:55], v[64:67]
    s_waitcnt lgkmcnt(6)
    v_mfma_f32_16x16x16_bf16 v[68:71], v[16:17], v[54:55], v[68:71]
    ds_read_b64_tr_b16 v[14:15], v6 offset:8448
    s_waitcnt lgkmcnt(6)
    v_mfma_f32_16x16x16_bf16 v[72:75], v[18:19], v[54:55], v[72:75]
    ds_read_b64_tr_b16 v[16:17], v7 offset:8448
    s_waitcnt lgkmcnt(6)
    v_mfma_f32_16x16x16_bf16 v[76:79], v[20:21], v[54:55], v[76:79]
    ds_read_b64_tr_b16 v[18:19], v8 offset:8448
    s_waitcnt lgkmcnt(6)
    v_mfma_f32_16x16x16_bf16 v[80:83], v[22:23], v[54:55], v[80:83]
    ds_read_b64_tr_b16 v[20:21], v9 offset:8448
    s_waitcnt lgkmcnt(6)
    v_mfma_f32_16x16x16_bf16 v[84:87], v[24:25], v[54:55], v[84:87]
    ds_read_b64_tr_b16 v[22:23], v10 offset:8448
    s_waitcnt lgkmcnt(6)
    v_mfma_f32_16x16x16_bf16 v[88:91], v[26:27], v[54:55], v[88:91]
    ds_read_b64_tr_b16 v[24:25], v11 offset:8448
    s_waitcnt lgkmcnt(6)
    v_mfma_f32_16x16x16_bf16 v[92:95], v[28:29], v[54:55], v[92:95]
    ds_read_b64_tr_b16 v[26:27], v12 offset:8448
    s_waitcnt lgkmcnt(6)
    v_mfma_f32_16x16x16_bf16 v[96:99], v[14:15], v[54:55], v[96:99]
    ds_read_b64_tr_b16 v[28:29], v13 offset:8448
    s_waitcnt lgkmcnt(6)
    v_mfma_f32_16x16x16_bf16 v[100:103], v[16:17], v[54:55], v[100:103]
    s_waitcnt lgkmcnt(5)
    v_mfma_f32_16x16x16_bf16 v[104:107], v[18:19], v[54:55], v[104:107]
    s_waitcnt lgkmcnt(4)
    v_mfma_f32_16x16x16_bf16 v[108:111], v[20:21], v[54:55], v[108:111]
    s_waitcnt lgkmcnt(3)
    v_mfma_f32_16x16x16_bf16 v[112:115], v[22:23], v[54:55], v[112:115]
    s_waitcnt lgkmcnt(2)
    v_mfma_f32_16x16x16_bf16 v[116:119], v[24:25], v[54:55], v[116:119]
    s_waitcnt lgkmcnt(1)
    v_mfma_f32_16x16x16_bf16 v[120:123], v[26:27], v[54:55], v[120:123]
    s_waitcnt lgkmcnt(0)
    v_mfma_f32_16x16x16_bf16 v[124:127], v[28:29], v[54:55], v[124:127]
    s_add_u32 m0, s56, 8192
    s_add_u32 s69, s57, 1703936
    buffer_load_dwordx4 v2, s[8:11], s69 offen offset:0 nt lds
    buffer_load_dwordx4 v3, s[8:11], s69 offen offset:1024 nt lds
    buffer_load_dwordx4 v4, s[8:11], s69 offen offset:2048 nt lds
    buffer_load_dwordx4 v5, s[8:11], s69 offen offset:3072 nt lds
    s_add_u32 m0, s56, 12288
    s_add_u32 s69, s69, 4096
    buffer_load_dwordx4 v2, s[8:11], s69 offen offset:0 nt lds
    buffer_load_dwordx4 v3, s[8:11], s69 offen offset:1024 nt lds
    buffer_load_dwordx4 v4, s[8:11], s69 offen offset:2048 nt lds
    buffer_load_dwordx4 v5, s[8:11], s69 offen offset:3072 nt lds
    s_waitcnt vmcnt(8)
    ds_read_b64_tr_b16 v[14:15], v6 offset:0
    ds_read_b64_tr_b16 v[16:17], v7 offset:0
    ds_read_b64_tr_b16 v[18:19], v8 offset:0
    ds_read_b64_tr_b16 v[20:21], v9 offset:0
    ds_read_b64_tr_b16 v[22:23], v10 offset:0
    ds_read_b64_tr_b16 v[24:25], v11 offset:0
    ds_read_b64_tr_b16 v[26:27], v12 offset:0
    ds_read_b64_tr_b16 v[28:29], v13 offset:0
    s_waitcnt lgkmcnt(7)
    v_mfma_f32_16x16x16_bf16 v[64:67], v[14:15], v[56:57], v[64:67]
    s_waitcnt lgkmcnt(6)
    v_mfma_f32_16x16x16_bf16 v[68:71], v[16:17], v[56:57], v[68:71]
    ds_read_b64_tr_b16 v[14:15], v6 offset:256
    s_waitcnt lgkmcnt(6)
    v_mfma_f32_16x16x16_bf16 v[72:75], v[18:19], v[56:57], v[72:75]
    ds_read_b64_tr_b16 v[16:17], v7 offset:256
    s_waitcnt lgkmcnt(6)
    v_mfma_f32_16x16x16_bf16 v[76:79], v[20:21], v[56:57], v[76:79]
    ds_read_b64_tr_b16 v[18:19], v8 offset:256
    s_waitcnt lgkmcnt(6)
    v_mfma_f32_16x16x16_bf16 v[80:83], v[22:23], v[56:57], v[80:83]
    ds_read_b64_tr_b16 v[20:21], v9 offset:256
    s_waitcnt lgkmcnt(6)
    v_mfma_f32_16x16x16_bf16 v[84:87], v[24:25], v[56:57], v[84:87]
    ds_read_b64_tr_b16 v[22:23], v10 offset:256
    s_waitcnt lgkmcnt(6)
    v_mfma_f32_16x16x16_bf16 v[88:91], v[26:27], v[56:57], v[88:91]
    ds_read_b64_tr_b16 v[24:25], v11 offset:256
    s_waitcnt lgkmcnt(6)
    v_mfma_f32_16x16x16_bf16 v[92:95], v[28:29], v[56:57], v[92:95]
    ds_read_b64_tr_b16 v[26:27], v12 offset:256
    s_waitcnt lgkmcnt(6)
    v_mfma_f32_16x16x16_bf16 v[96:99], v[14:15], v[56:57], v[96:99]
    ds_read_b64_tr_b16 v[28:29], v13 offset:256
    s_waitcnt lgkmcnt(6)
    v_mfma_f32_16x16x16_bf16 v[100:103], v[16:17], v[56:57], v[100:103]
    s_waitcnt lgkmcnt(5)
    v_mfma_f32_16x16x16_bf16 v[104:107], v[18:19], v[56:57], v[104:107]
    s_waitcnt lgkmcnt(4)
    v_mfma_f32_16x16x16_bf16 v[108:111], v[20:21], v[56:57], v[108:111]
    s_waitcnt lgkmcnt(3)
    v_mfma_f32_16x16x16_bf16 v[112:115], v[22:23], v[56:57], v[112:115]
    s_waitcnt lgkmcnt(2)
    v_mfma_f32_16x16x16_bf16 v[116:119], v[24:25], v[56:57], v[116:119]
    s_waitcnt lgkmcnt(1)
    v_mfma_f32_16x16x16_bf16 v[120:123], v[26:27], v[56:57], v[120:123]
    s_waitcnt lgkmcnt(0)
    v_mfma_f32_16x16x16_bf16 v[124:127], v[28:29], v[56:57], v[124:127]
    s_add_u32 m0, s56, 0
    s_add_u32 s69, s57, 1835008
    buffer_load_dwordx4 v2, s[8:11], s69 offen offset:0 nt lds
    buffer_load_dwordx4 v3, s[8:11], s69 offen offset:1024 nt lds
    buffer_load_dwordx4 v4, s[8:11], s69 offen offset:2048 nt lds
    buffer_load_dwordx4 v5, s[8:11], s69 offen offset:3072 nt lds
    s_add_u32 m0, s56, 4096
    s_add_u32 s69, s69, 4096
    buffer_load_dwordx4 v2, s[8:11], s69 offen offset:0 nt lds
    buffer_load_dwordx4 v3, s[8:11], s69 offen offset:1024 nt lds
    buffer_load_dwordx4 v4, s[8:11], s69 offen offset:2048 nt lds
    buffer_load_dwordx4 v5, s[8:11], s69 offen offset:3072 nt lds
    s_waitcnt vmcnt(8)
    ds_read_b64_tr_b16 v[14:15], v6 offset:8192
    ds_read_b64_tr_b16 v[16:17], v7 offset:8192
    ds_read_b64_tr_b16 v[18:19], v8 offset:8192
    ds_read_b64_tr_b16 v[20:21], v9 offset:8192
    ds_read_b64_tr_b16 v[22:23], v10 offset:8192
    ds_read_b64_tr_b16 v[24:25], v11 offset:8192
    ds_read_b64_tr_b16 v[26:27], v12 offset:8192
    ds_read_b64_tr_b16 v[28:29], v13 offset:8192
    s_waitcnt lgkmcnt(7)
    v_mfma_f32_16x16x16_bf16 v[64:67], v[14:15], v[58:59], v[64:67]
    s_waitcnt lgkmcnt(6)
    v_mfma_f32_16x16x16_bf16 v[68:71], v[16:17], v[58:59], v[68:71]
    ds_read_b64_tr_b16 v[14:15], v6 offset:8448
    s_waitcnt lgkmcnt(6)
    v_mfma_f32_16x16x16_bf16 v[72:75], v[18:19], v[58:59], v[72:75]
    ds_read_b64_tr_b16 v[16:17], v7 offset:8448
    s_waitcnt lgkmcnt(6)
    v_mfma_f32_16x16x16_bf16 v[76:79], v[20:21], v[58:59], v[76:79]
    ds_read_b64_tr_b16 v[18:19], v8 offset:8448
    s_waitcnt lgkmcnt(6)
    v_mfma_f32_16x16x16_bf16 v[80:83], v[22:23], v[58:59], v[80:83]
    ds_read_b64_tr_b16 v[20:21], v9 offset:8448
    s_waitcnt lgkmcnt(6)
    v_mfma_f32_16x16x16_bf16 v[84:87], v[24:25], v[58:59], v[84:87]
    ds_read_b64_tr_b16 v[22:23], v10 offset:8448
    s_waitcnt lgkmcnt(6)
    v_mfma_f32_16x16x16_bf16 v[88:91], v[26:27], v[58:59], v[88:91]
    ds_read_b64_tr_b16 v[24:25], v11 offset:8448
    s_waitcnt lgkmcnt(6)
    v_mfma_f32_16x16x16_bf16 v[92:95], v[28:29], v[58:59], v[92:95]
    ds_read_b64_tr_b16 v[26:27], v12 offset:8448
    s_waitcnt lgkmcnt(6)
    v_mfma_f32_16x16x16_bf16 v[96:99], v[14:15], v[58:59], v[96:99]
    ds_read_b64_tr_b16 v[28:29], v13 offset:8448
    s_waitcnt lgkmcnt(6)
    v_mfma_f32_16x16x16_bf16 v[100:103], v[16:17], v[58:59], v[100:103]
    s_waitcnt lgkmcnt(5)
    v_mfma_f32_16x16x16_bf16 v[104:107], v[18:19], v[58:59], v[104:107]
    s_waitcnt lgkmcnt(4)
    v_mfma_f32_16x16x16_bf16 v[108:111], v[20:21], v[58:59], v[108:111]
    s_waitcnt lgkmcnt(3)
    v_mfma_f32_16x16x16_bf16 v[112:115], v[22:23], v[58:59], v[112:115]
    s_waitcnt lgkmcnt(2)
    v_mfma_f32_16x16x16_bf16 v[116:119], v[24:25], v[58:59], v[116:119]
    s_waitcnt lgkmcnt(1)
    v_mfma_f32_16x16x16_bf16 v[120:123], v[26:27], v[58:59], v[120:123]
    s_waitcnt lgkmcnt(0)
    v_mfma_f32_16x16x16_bf16 v[124:127], v[28:29], v[58:59], v[124:127]
    s_add_u32 m0, s56, 8192
    s_add_u32 s69, s57, 1966080
    buffer_load_dwordx4 v2, s[8:11], s69 offen offset:0 nt lds
    buffer_load_dwordx4 v3, s[8:11], s69 offen offset:1024 nt lds
    buffer_load_dwordx4 v4, s[8:11], s69 offen offset:2048 nt lds
    buffer_load_dwordx4 v5, s[8:11], s69 offen offset:3072 nt lds
    s_add_u32 m0, s56, 12288
    s_add_u32 s69, s69, 4096
    buffer_load_dwordx4 v2, s[8:11], s69 offen offset:0 nt lds
    buffer_load_dwordx4 v3, s[8:11], s69 offen offset:1024 nt lds
    buffer_load_dwordx4 v4, s[8:11], s69 offen offset:2048 nt lds
    buffer_load_dwordx4 v5, s[8:11], s69 offen offset:3072 nt lds
    s_waitcnt vmcnt(8)
    ds_read_b64_tr_b16 v[14:15], v6 offset:0
    ds_read_b64_tr_b16 v[16:17], v7 offset:0
    ds_read_b64_tr_b16 v[18:19], v8 offset:0
    ds_read_b64_tr_b16 v[20:21], v9 offset:0
    ds_read_b64_tr_b16 v[22:23], v10 offset:0
    ds_read_b64_tr_b16 v[24:25], v11 offset:0
    ds_read_b64_tr_b16 v[26:27], v12 offset:0
    ds_read_b64_tr_b16 v[28:29], v13 offset:0
    s_waitcnt lgkmcnt(7)
    v_mfma_f32_16x16x16_bf16 v[64:67], v[14:15], v[60:61], v[64:67]
    s_waitcnt lgkmcnt(6)
    v_mfma_f32_16x16x16_bf16 v[68:71], v[16:17], v[60:61], v[68:71]
    ds_read_b64_tr_b16 v[14:15], v6 offset:256
    s_waitcnt lgkmcnt(6)
    v_mfma_f32_16x16x16_bf16 v[72:75], v[18:19], v[60:61], v[72:75]
    ds_read_b64_tr_b16 v[16:17], v7 offset:256
    s_waitcnt lgkmcnt(6)
    v_mfma_f32_16x16x16_bf16 v[76:79], v[20:21], v[60:61], v[76:79]
    ds_read_b64_tr_b16 v[18:19], v8 offset:256
    s_waitcnt lgkmcnt(6)
    v_mfma_f32_16x16x16_bf16 v[80:83], v[22:23], v[60:61], v[80:83]
    ds_read_b64_tr_b16 v[20:21], v9 offset:256
    s_waitcnt lgkmcnt(6)
    v_mfma_f32_16x16x16_bf16 v[84:87], v[24:25], v[60:61], v[84:87]
    ds_read_b64_tr_b16 v[22:23], v10 offset:256
    s_waitcnt lgkmcnt(6)
    v_mfma_f32_16x16x16_bf16 v[88:91], v[26:27], v[60:61], v[88:91]
    ds_read_b64_tr_b16 v[24:25], v11 offset:256
    s_waitcnt lgkmcnt(6)
    v_mfma_f32_16x16x16_bf16 v[92:95], v[28:29], v[60:61], v[92:95]
    ds_read_b64_tr_b16 v[26:27], v12 offset:256
    s_waitcnt lgkmcnt(6)
    v_mfma_f32_16x16x16_bf16 v[96:99], v[14:15], v[60:61], v[96:99]
    ds_read_b64_tr_b16 v[28:29], v13 offset:256
    s_waitcnt lgkmcnt(6)
    v_mfma_f32_16x16x16_bf16 v[100:103], v[16:17], v[60:61], v[100:103]
    s_waitcnt lgkmcnt(5)
    v_mfma_f32_16x16x16_bf16 v[104:107], v[18:19], v[60:61], v[104:107]
    s_waitcnt lgkmcnt(4)
    v_mfma_f32_16x16x16_bf16 v[108:111], v[20:21], v[60:61], v[108:111]
    s_waitcnt lgkmcnt(3)
    v_mfma_f32_16x16x16_bf16 v[112:115], v[22:23], v[60:61], v[112:115]
    s_waitcnt lgkmcnt(2)
    v_mfma_f32_16x16x16_bf16 v[116:119], v[24:25], v[60:61], v[116:119]
    s_waitcnt lgkmcnt(1)
    v_mfma_f32_16x16x16_bf16 v[120:123], v[26:27], v[60:61], v[120:123]
    s_waitcnt lgkmcnt(0)
    v_mfma_f32_16x16x16_bf16 v[124:127], v[28:29], v[60:61], v[124:127]
    s_add_u32 m0, s56, 0
    s_add_u32 s69, s57, 1441792
    buffer_load_dwordx4 v2, s[12:15], s69 offen offset:0 nt lds
    buffer_load_dwordx4 v3, s[12:15], s69 offen offset:1024 nt lds
    buffer_load_dwordx4 v4, s[12:15], s69 offen offset:2048 nt lds
    buffer_load_dwordx4 v5, s[12:15], s69 offen offset:3072 nt lds
    s_add_u32 m0, s56, 4096
    s_add_u32 s69, s69, 4096
    buffer_load_dwordx4 v2, s[12:15], s69 offen offset:0 nt lds
    buffer_load_dwordx4 v3, s[12:15], s69 offen offset:1024 nt lds
    buffer_load_dwordx4 v4, s[12:15], s69 offen offset:2048 nt lds
    buffer_load_dwordx4 v5, s[12:15], s69 offen offset:3072 nt lds
    s_waitcnt vmcnt(8)
    ds_read_b64_tr_b16 v[14:15], v6 offset:8192
    ds_read_b64_tr_b16 v[16:17], v7 offset:8192
    ds_read_b64_tr_b16 v[18:19], v8 offset:8192
    ds_read_b64_tr_b16 v[20:21], v9 offset:8192
    ds_read_b64_tr_b16 v[22:23], v10 offset:8192
    ds_read_b64_tr_b16 v[24:25], v11 offset:8192
    ds_read_b64_tr_b16 v[26:27], v12 offset:8192
    ds_read_b64_tr_b16 v[28:29], v13 offset:8192
    s_waitcnt lgkmcnt(7)
    v_mfma_f32_16x16x16_bf16 v[64:67], v[14:15], v[62:63], v[64:67]
    s_waitcnt lgkmcnt(6)
    v_mfma_f32_16x16x16_bf16 v[68:71], v[16:17], v[62:63], v[68:71]
    ds_read_b64_tr_b16 v[14:15], v6 offset:8448
    s_waitcnt lgkmcnt(6)
    v_mfma_f32_16x16x16_bf16 v[72:75], v[18:19], v[62:63], v[72:75]
    ds_read_b64_tr_b16 v[16:17], v7 offset:8448
    s_waitcnt lgkmcnt(6)
    v_mfma_f32_16x16x16_bf16 v[76:79], v[20:21], v[62:63], v[76:79]
    ds_read_b64_tr_b16 v[18:19], v8 offset:8448
    s_waitcnt lgkmcnt(6)
    v_mfma_f32_16x16x16_bf16 v[80:83], v[22:23], v[62:63], v[80:83]
    ds_read_b64_tr_b16 v[20:21], v9 offset:8448
    s_waitcnt lgkmcnt(6)
    v_mfma_f32_16x16x16_bf16 v[84:87], v[24:25], v[62:63], v[84:87]
    ds_read_b64_tr_b16 v[22:23], v10 offset:8448
    s_waitcnt lgkmcnt(6)
    v_mfma_f32_16x16x16_bf16 v[88:91], v[26:27], v[62:63], v[88:91]
    ds_read_b64_tr_b16 v[24:25], v11 offset:8448
    s_waitcnt lgkmcnt(6)
    v_mfma_f32_16x16x16_bf16 v[92:95], v[28:29], v[62:63], v[92:95]
    ds_read_b64_tr_b16 v[26:27], v12 offset:8448
    s_waitcnt lgkmcnt(6)
    v_mfma_f32_16x16x16_bf16 v[96:99], v[14:15], v[62:63], v[96:99]
    ds_read_b64_tr_b16 v[28:29], v13 offset:8448
    s_waitcnt lgkmcnt(6)
    v_mfma_f32_16x16x16_bf16 v[100:103], v[16:17], v[62:63], v[100:103]
    s_waitcnt lgkmcnt(5)
    v_mfma_f32_16x16x16_bf16 v[104:107], v[18:19], v[62:63], v[104:107]
    s_waitcnt lgkmcnt(4)
    v_mfma_f32_16x16x16_bf16 v[108:111], v[20:21], v[62:63], v[108:111]
    s_waitcnt lgkmcnt(3)
    v_mfma_f32_16x16x16_bf16 v[112:115], v[22:23], v[62:63], v[112:115]
    s_waitcnt lgkmcnt(2)
    v_mfma_f32_16x16x16_bf16 v[116:119], v[24:25], v[62:63], v[116:119]
    s_waitcnt lgkmcnt(1)
    v_mfma_f32_16x16x16_bf16 v[120:123], v[26:27], v[62:63], v[120:123]
    s_waitcnt lgkmcnt(0)
    v_mfma_f32_16x16x16_bf16 v[124:127], v[28:29], v[62:63], v[124:127]
    v_and_b32 v30, 1, v1
    v_lshlrev_b32 v30, 10, v30
    v_lshrrev_b32 v31, 4, v1
    v_lshl_add_u32 v30, v31, 4, v30
    s_lshl_b32 s69, s52, 11
    s_add_u32 s69, s69, 126976
    v_add_u32 v30, s69, v30
    s_nop 7
    s_mov_b64 exec, s[70:71]
    ds_write_b128 v30, v[64:67] offset:0
    ds_write_b128 v30, v[68:71] offset:64
    ds_write_b128 v30, v[72:75] offset:128
    ds_write_b128 v30, v[76:79] offset:192
    ds_write_b128 v30, v[80:83] offset:256
    ds_write_b128 v30, v[84:87] offset:320
    ds_write_b128 v30, v[88:91] offset:384
    ds_write_b128 v30, v[92:95] offset:448
    ds_write_b128 v30, v[96:99] offset:512
    ds_write_b128 v30, v[100:103] offset:576
    ds_write_b128 v30, v[104:107] offset:640
    ds_write_b128 v30, v[108:111] offset:704
    s_waitcnt lgkmcnt(4)
    ds_write_b128 v30, v[112:115] offset:768
    ds_write_b128 v30, v[116:119] offset:832
    ds_write_b128 v30, v[120:123] offset:896
    ds_write_b128 v30, v[124:127] offset:960
    s_mov_b64 exec, -1
    s_waitcnt lgkmcnt(0)
    v_mov_b32 v30, s84
    v_mov_b32 v31, 10
    ds_write_b32 v30, v31
    v_mov_b32 v30, s85
Lps_69:
    ds_read_b32 v31, v30
    s_waitcnt lgkmcnt(0)
    v_cmp_gt_u32 vcc, 10, v31
    s_cbranch_vccz Lpd_70
    s_cmp_eq_u32 s83, 0
    s_cbranch_scc1 Lpd_70
    s_sub_u32 s83, s83, 1
    s_branch Lps_69
Lpd_70:
    s_lshl_b32 s69, s54, 5
    s_lshl_b32 s72, s82, 3
    s_add_u32 s69, s69, s72
    s_add_u32 s69, s69, 135168
    v_mov_b32 v30, s69
    s_mul_i32 s69, s54, 4096
    s_lshl_b32 s72, s82, 10
    s_add_u32 s69, s69, s72
    s_add_u32 s69, s69, 126976
    v_and_b32 v31, 31, v1
    v_lshlrev_b32 v31, 5, v31
    v_add_u32 v31, s69, v31
    ds_read_b64 v[32:33], v30 offset:0
    ds_read_b64 v[34:35], v30 offset:16
    ds_read_b128 v[40:43], v31 offset:0
    ds_read_b128 v[44:47], v31 offset:16
    ds_read_b128 v[48:51], v31 offset:2048
    ds_read_b128 v[52:55], v31 offset:2064
    v_lshlrev_b32 v56, 4, v1
    v_cmp_gt_u32 vcc, 32, v1
    v_mov_b32 v58, 2147483648
    s_nop 0
    v_cndmask_b32 v56, v58, v56, vcc
    v_cmp_eq_u32 vcc, 0, v1
    v_mov_b32 v57, 0
    s_nop 0
    v_cndmask_b32 v57, v58, v57, vcc
    s_waitcnt lgkmcnt(4)
    v_max_f32 v36, v32, v34
    v_sub_f32 v32, v32, v36
    v_sub_f32 v34, v34, v36
    v_exp_f32 v32, v32
    v_exp_f32 v34, v34
    s_nop 0
    v_mul_f32 v37, v32, v33
    v_fmac_f32 v37, v34, v35
    s_waitcnt lgkmcnt(0)
    v_mul_f32 v40, v40, v32
    v_mul_f32 v41, v41, v32
    v_mul_f32 v42, v42, v32
    v_mul_f32 v43, v43, v32
    v_mul_f32 v44, v44, v32
    v_mul_f32 v45, v45, v32
    v_mul_f32 v46, v46, v32
    v_mul_f32 v47, v47, v32
    v_fmac_f32 v40, v48, v34
    v_fmac_f32 v41, v49, v34
    v_fmac_f32 v42, v50, v34
    v_fmac_f32 v43, v51, v34
    v_fmac_f32 v44, v52, v34
    v_fmac_f32 v45, v53, v34
    v_fmac_f32 v46, v54, v34
    v_fmac_f32 v47, v55, v34
    v_cvt_pk_bf16_f32 v48, v40, v41
    v_cvt_pk_bf16_f32 v49, v42, v43
    v_cvt_pk_bf16_f32 v50, v44, v45
    v_cvt_pk_bf16_f32 v51, v46, v47
    v_min_u32 v48, -2, v48
    v_min_u32 v49, -2, v49
    v_min_u32 v50, -2, v50
    v_min_u32 v51, -2, v51
    s_add_u32 s72, s76, 65536
    s_add_u32 s73, s77, 16384
    s_cmp_eq_u32 s100, 0
    s_cbranch_scc1 Lwt_71
    buffer_store_dwordx4 v[48:51], v56, s[36:39], s72 offen
    buffer_store_dwordx2 v[36:37], v57, s[36:39], s73 offen
    s_branch Lwd_72
Lwt_71:
    buffer_store_dwordx4 v[48:51], v56, s[36:39], s72 offen sc1
    buffer_store_dwordx2 v[36:37], v57, s[36:39], s73 offen sc1
Lwd_72:
    s_nop 1
    v_and_b32 v6, 15, v1
    v_lshlrev_b32 v7, 8, v6
    v_lshlrev_b32 v6, 9, v6
    v_lshrrev_b32 v30, 4, v1
    v_lshl_add_u32 v6, v30, 4, v6
    s_lshl_b32 s69, s82, 14
    s_add_u32 s72, s61, 65536
    s_add_u32 s72, s72, s69
    s_add_u32 s73, s62, 16384
    buffer_load_dwordx2 v[22:23], v7, s[36:39], s73 offen offset:0 sc1
    buffer_load_dwordx4 v[32:35], v6, s[36:39], s72 offen offset:0 sc1
    buffer_load_dwordx4 v[36:39], v6, s[36:39], s72 offen offset:64 sc1
    buffer_load_dwordx4 v[40:43], v6, s[36:39], s72 offen offset:128 sc1
    buffer_load_dwordx4 v[44:47], v6, s[36:39], s72 offen offset:192 sc1
    buffer_load_dwordx4 v[48:51], v6, s[36:39], s72 offen offset:256 sc1
    buffer_load_dwordx4 v[52:55], v6, s[36:39], s72 offen offset:320 sc1
    buffer_load_dwordx4 v[56:59], v6, s[36:39], s72 offen offset:384 sc1
    buffer_load_dwordx4 v[60:63], v6, s[36:39], s72 offen offset:448 sc1
    s_add_u32 s79, s73, 4096
    buffer_load_dwordx2 v[24:25], v7, s[36:39], s79 offen sc1
    s_add_u32 s79, s72, 8192
    buffer_load_dwordx4 v[64:67], v6, s[36:39], s79 offen offset:0 sc1
    buffer_load_dwordx4 v[68:71], v6, s[36:39], s79 offen offset:64 sc1
    buffer_load_dwordx4 v[72:75], v6, s[36:39], s79 offen offset:128 sc1
    buffer_load_dwordx4 v[76:79], v6, s[36:39], s79 offen offset:192 sc1
    buffer_load_dwordx4 v[80:83], v6, s[36:39], s79 offen offset:256 sc1
    buffer_load_dwordx4 v[84:87], v6, s[36:39], s79 offen offset:320 sc1
    buffer_load_dwordx4 v[88:91], v6, s[36:39], s79 offen offset:384 sc1
    buffer_load_dwordx4 v[92:95], v6, s[36:39], s79 offen offset:448 sc1
    s_add_u32 m0, s56, 8192
    s_add_u32 s69, s57, 0
    buffer_load_dwordx4 v2, s[12:15], s69 offen offset:0 nt lds
    buffer_load_dwordx4 v3, s[12:15], s69 offen offset:1024 nt lds
    buffer_load_dwordx4 v4, s[12:15], s69 offen offset:2048 nt lds
    buffer_load_dwordx4 v5, s[12:15], s69 offen offset:3072 nt lds
    s_add_u32 m0, s56, 12288
    s_add_u32 s69, s69, 4096
    buffer_load_dwordx4 v2, s[12:15], s69 offen offset:0 nt lds
    buffer_load_dwordx4 v3, s[12:15], s69 offen offset:1024 nt lds
    buffer_load_dwordx4 v4, s[12:15], s69 offen offset:2048 nt lds
    buffer_load_dwordx4 v5, s[12:15], s69 offen offset:3072 nt lds
    v_lshrrev_b32 v8, 4, v1
    v_lshlrev_b32 v8, 8, v8
    v_bfe_u32 v9, v1, 2, 2
    v_lshl_add_u32 v8, v9, 5, v8
    v_and_b32 v9, 3, v1
    v_lshl_add_u32 v8, v9, 3, v8
    s_mul_i32 s69, s82, 8192
    s_add_u32 s69, s69, 65536
    v_add_u32 v8, s69, v8
    ds_read_b64_tr_b16 v[96:97], v8 offset:0
    ds_read_b64_tr_b16 v[98:99], v8 offset:128
    ds_read_b64_tr_b16 v[100:101], v8 offset:1024
    ds_read_b64_tr_b16 v[102:103], v8 offset:1152
    ds_read_b64_tr_b16 v[104:105], v8 offset:2048
    ds_read_b64_tr_b16 v[106:107], v8 offset:2176
    ds_read_b64_tr_b16 v[108:109], v8 offset:3072
    ds_read_b64_tr_b16 v[110:111], v8 offset:3200
    s_waitcnt lgkmcnt(4)
    ds_read_b64_tr_b16 v[112:113], v8 offset:4096
    ds_read_b64_tr_b16 v[114:115], v8 offset:4224
    ds_read_b64_tr_b16 v[116:117], v8 offset:5120
    ds_read_b64_tr_b16 v[118:119], v8 offset:5248
    ds_read_b64_tr_b16 v[120:121], v8 offset:6144
    ds_read_b64_tr_b16 v[122:123], v8 offset:6272
    ds_read_b64_tr_b16 v[124:125], v8 offset:7168
    ds_read_b64_tr_b16 v[126:127], v8 offset:7296
    s_waitcnt lgkmcnt(0)
    s_waitcnt vmcnt(8)
Lpolls1_2_73:
    s_mov_b32 s90, 0
    v_max3_u32 v31, v22, v23, v32
    v_max3_u32 v31, v31, v33, v34
    v_max3_u32 v31, v31, v35, v36
    v_max3_u32 v31, v31, v37, v38
    v_max3_u32 v31, v31, v39, v40
    v_max3_u32 v31, v31, v41, v42
    v_max3_u32 v31, v31, v43, v44
    v_max3_u32 v31, v31, v45, v46
    v_max3_u32 v31, v31, v47, v48
    v_max3_u32 v31, v31, v49, v50
    v_max3_u32 v31, v31, v51, v52
    v_max3_u32 v31, v31, v53, v54
    v_max3_u32 v31, v31, v55, v56
    v_max3_u32 v31, v31, v57, v58
    v_max3_u32 v31, v31, v59, v60
    v_max3_u32 v31, v31, v61, v62
    v_max_u32 v31, v31, v63
    v_cmp_eq_u32 vcc, -1, v31
    s_cbranch_vccz Lsks1_2_75
    s_mov_b64 exec, vcc
    buffer_load_dwordx2 v[22:23], v7, s[36:39], s73 offen offset:0 sc1
    buffer_load_dwordx4 v[32:35], v6, s[36:39], s72 offen offset:0 sc1
    buffer_load_dwordx4 v[36:39], v6, s[36:39], s72 offen offset:64 sc1
    buffer_load_dwordx4 v[40:43], v6, s[36:39], s72 offen offset:128 sc1
    buffer_load_dwordx4 v[44:47], v6, s[36:39], s72 offen offset:192 sc1
    buffer_load_dwordx4 v[48:51], v6, s[36:39], s72 offen offset:256 sc1
    buffer_load_dwordx4 v[52:55], v6, s[36:39], s72 offen offset:320 sc1
    buffer_load_dwordx4 v[56:59], v6, s[36:39], s72 offen offset:384 sc1
    buffer_load_dwordx4 v[60:63], v6, s[36:39], s72 offen offset:448 sc1
    s_mov_b64 exec, -1
    s_mov_b32 s90, 1
Lsks1_2_75:
    v_max3_u32 v31, v24, v25, v64
    v_max3_u32 v31, v31, v65, v66
    v_max3_u32 v31, v31, v67, v68
    v_max3_u32 v31, v31, v69, v70
    v_max3_u32 v31, v31, v71, v72
    v_max3_u32 v31, v31, v73, v74
    v_max3_u32 v31, v31, v75, v76
    v_max3_u32 v31, v31, v77, v78
    v_max3_u32 v31, v31, v79, v80
    v_max3_u32 v31, v31, v81, v82
    v_max3_u32 v31, v31, v83, v84
    v_max3_u32 v31, v31, v85, v86
    v_max3_u32 v31, v31, v87, v88
    v_max3_u32 v31, v31, v89, v90
    v_max3_u32 v31, v31, v91, v92
    v_max3_u32 v31, v31, v93, v94
    v_max_u32 v31, v31, v95
    v_cmp_eq_u32 vcc, -1, v31
    s_cbranch_vccz Lsks1_2_76
    s_mov_b64 exec, vcc
    s_add_u32 s79, s73, 4096
    buffer_load_dwordx2 v[24:25], v7, s[36:39], s79 offen sc1
    s_add_u32 s79, s72, 8192
    buffer_load_dwordx4 v[64:67], v6, s[36:39], s79 offen offset:0 sc1
    buffer_load_dwordx4 v[68:71], v6, s[36:39], s79 offen offset:64 sc1
    buffer_load_dwordx4 v[72:75], v6, s[36:39], s79 offen offset:128 sc1
    buffer_load_dwordx4 v[76:79], v6, s[36:39], s79 offen offset:192 sc1
    buffer_load_dwordx4 v[80:83], v6, s[36:39], s79 offen offset:256 sc1
    buffer_load_dwordx4 v[84:87], v6, s[36:39], s79 offen offset:320 sc1
    buffer_load_dwordx4 v[88:91], v6, s[36:39], s79 offen offset:384 sc1
    buffer_load_dwordx4 v[92:95], v6, s[36:39], s79 offen offset:448 sc1
    s_mov_b64 exec, -1
    s_mov_b32 s90, 1
Lsks1_2_76:
    s_cmp_eq_u32 s90, 0
    s_cbranch_scc1 Ldones1_2_74
    s_waitcnt vmcnt(0)
    s_cmp_eq_u32 s65, 0
    s_cbranch_scc1 Ldones1_2_74
    s_sub_u32 s65, s65, 1
    s_sleep 1
    s_branch Lpolls1_2_73
Ldones1_2_74:
    v_mfma_f32_16x16x32_bf16 v[14:17], v[96:99], v[32:35], 0
    v_mfma_f32_16x16x32_bf16 v[18:21], v[96:99], v[64:67], 0
    v_mfma_f32_16x16x32_bf16 v[14:17], v[100:103], v[36:39], v[14:17]
    v_mfma_f32_16x16x32_bf16 v[18:21], v[100:103], v[68:71], v[18:21]
    v_mfma_f32_16x16x32_bf16 v[14:17], v[104:107], v[40:43], v[14:17]
    v_mfma_f32_16x16x32_bf16 v[18:21], v[104:107], v[72:75], v[18:21]
    v_mfma_f32_16x16x32_bf16 v[14:17], v[108:111], v[44:47], v[14:17]
    v_mfma_f32_16x16x32_bf16 v[18:21], v[108:111], v[76:79], v[18:21]
    v_mfma_f32_16x16x32_bf16 v[14:17], v[112:115], v[48:51], v[14:17]
    v_mfma_f32_16x16x32_bf16 v[18:21], v[112:115], v[80:83], v[18:21]
    v_mfma_f32_16x16x32_bf16 v[14:17], v[116:119], v[52:55], v[14:17]
    v_mfma_f32_16x16x32_bf16 v[18:21], v[116:119], v[84:87], v[18:21]
    v_mfma_f32_16x16x32_bf16 v[14:17], v[120:123], v[56:59], v[14:17]
    v_mfma_f32_16x16x32_bf16 v[18:21], v[120:123], v[88:91], v[18:21]
    v_mfma_f32_16x16x32_bf16 v[14:17], v[124:127], v[60:63], v[14:17]
    v_mfma_f32_16x16x32_bf16 v[18:21], v[124:127], v[92:95], v[18:21]
    v_mov_b32 v26, v22
    v_mov_b32 v27, v24
    s_nop 0
    v_max_f32_dpp v26, v26, v26 quad_perm:[1,0,3,2] row_mask:0xf bank_mask:0xf
    v_max_f32_dpp v27, v27, v27 quad_perm:[1,0,3,2] row_mask:0xf bank_mask:0xf
    s_nop 0
    v_max_f32_dpp v26, v26, v26 quad_perm:[2,3,0,1] row_mask:0xf bank_mask:0xf
    v_max_f32_dpp v27, v27, v27 quad_perm:[2,3,0,1] row_mask:0xf bank_mask:0xf
    s_nop 0
    v_max_f32_dpp v26, v26, v26 row_half_mirror row_mask:0xf bank_mask:0xf
    v_max_f32_dpp v27, v27, v27 row_half_mirror row_mask:0xf bank_mask:0xf
    v_sub_f32 v26, v22, v26
    v_sub_f32 v27, v24, v27
    v_exp_f32 v26, v26
    v_exp_f32 v27, v27
    s_nop 0
    v_mul_f32 v28, v26, v23
    v_mul_f32 v29, v27, v25
    s_nop 0
    v_add_f32_dpp v28, v28, v28 quad_perm:[1,0,3,2] row_mask:0xf bank_mask:0xf
    v_add_f32_dpp v29, v29, v29 quad_perm:[1,0,3,2] row_mask:0xf bank_mask:0xf
    s_nop 0
    v_add_f32_dpp v28, v28, v28 quad_perm:[2,3,0,1] row_mask:0xf bank_mask:0xf
    v_add_f32_dpp v29, v29, v29 quad_perm:[2,3,0,1] row_mask:0xf bank_mask:0xf
    s_nop 0
    v_add_f32_dpp v28, v28, v28 row_half_mirror row_mask:0xf bank_mask:0xf
    v_add_f32_dpp v29, v29, v29 row_half_mirror row_mask:0xf bank_mask:0xf
    v_rcp_f32 v28, v28
    v_rcp_f32 v29, v29
    s_nop 0
    v_mul_f32 v26, v26, v28
    v_mul_f32 v27, v27, v29
    v_bfe_u32 v30, v1, 3, 1
    v_lshlrev_b32 v30, 6, v30
    v_lshrrev_b32 v31, 4, v1
    v_lshl_add_u32 v30, v31, 4, v30
    s_lshl_b32 s69, s52, 8
    s_add_u32 s69, s69, 135424
    v_add_u32 v30, s69, v30
    s_nop 3
    v_mul_f32 v14, v14, v26
    v_mul_f32 v18, v18, v27
    v_mul_f32 v15, v15, v26
    v_mul_f32 v19, v19, v27
    v_mul_f32 v16, v16, v26
    v_mul_f32 v20, v20, v27
    v_mul_f32 v17, v17, v26
    v_mul_f32 v21, v21, v27
    v_add_f32_dpp v14, v14, v14 quad_perm:[1,0,3,2] row_mask:0xf bank_mask:0xf
    v_add_f32_dpp v15, v15, v15 quad_perm:[1,0,3,2] row_mask:0xf bank_mask:0xf
    v_add_f32_dpp v16, v16, v16 quad_perm:[1,0,3,2] row_mask:0xf bank_mask:0xf
    v_add_f32_dpp v17, v17, v17 quad_perm:[1,0,3,2] row_mask:0xf bank_mask:0xf
    v_add_f32_dpp v18, v18, v18 quad_perm:[1,0,3,2] row_mask:0xf bank_mask:0xf
    v_add_f32_dpp v19, v19, v19 quad_perm:[1,0,3,2] row_mask:0xf bank_mask:0xf
    v_add_f32_dpp v20, v20, v20 quad_perm:[1,0,3,2] row_mask:0xf bank_mask:0xf
    v_add_f32_dpp v21, v21, v21 quad_perm:[1,0,3,2] row_mask:0xf bank_mask:0xf
    v_add_f32_dpp v14, v14, v14 quad_perm:[2,3,0,1] row_mask:0xf bank_mask:0xf
    v_add_f32_dpp v15, v15, v15 quad_perm:[2,3,0,1] row_mask:0xf bank_mask:0xf
    v_add_f32_dpp v16, v16, v16 quad_perm:[2,3,0,1] row_mask:0xf bank_mask:0xf
    v_add_f32_dpp v17, v17, v17 quad_perm:[2,3,0,1] row_mask:0xf bank_mask:0xf
    v_add_f32_dpp v18, v18, v18 quad_perm:[2,3,0,1] row_mask:0xf bank_mask:0xf
    v_add_f32_dpp v19, v19, v19 quad_perm:[2,3,0,1] row_mask:0xf bank_mask:0xf
    v_add_f32_dpp v20, v20, v20 quad_perm:[2,3,0,1] row_mask:0xf bank_mask:0xf
    v_add_f32_dpp v21, v21, v21 quad_perm:[2,3,0,1] row_mask:0xf bank_mask:0xf
    v_add_f32_dpp v14, v14, v14 row_half_mirror row_mask:0xf bank_mask:0xf
    v_add_f32_dpp v15, v15, v15 row_half_mirror row_mask:0xf bank_mask:0xf
    v_add_f32_dpp v16, v16, v16 row_half_mirror row_mask:0xf bank_mask:0xf
    v_add_f32_dpp v17, v17, v17 row_half_mirror row_mask:0xf bank_mask:0xf
    v_add_f32_dpp v18, v18, v18 row_half_mirror row_mask:0xf bank_mask:0xf
    v_add_f32_dpp v19, v19, v19 row_half_mirror row_mask:0xf bank_mask:0xf
    v_add_f32_dpp v20, v20, v20 row_half_mirror row_mask:0xf bank_mask:0xf
    v_add_f32_dpp v21, v21, v21 row_half_mirror row_mask:0xf bank_mask:0xf
    ds_write_b128 v30, v[14:17]
    ds_write_b128 v30, v[18:21] offset:128
    s_waitcnt lgkmcnt(0)
    v_mov_b32 v30, s84
    v_mov_b32 v31, 11
    ds_write_b32 v30, v31
    v_mov_b32 v30, s85
Lps_77:
    ds_read_b32 v31, v30
    s_waitcnt lgkmcnt(0)
    v_cmp_gt_u32 vcc, 11, v31
    s_cbranch_vccz Lpd_78
    s_cmp_eq_u32 s83, 0
    s_cbranch_scc1 Lpd_78
    s_sub_u32 s83, s83, 1
    s_branch Lps_77
Lpd_78:
    s_add_u32 s72, s63, 7168
    s_lshl_b32 s69, s54, 9
    s_add_u32 s69, s69, 135424
    v_and_b32 v30, 7, v1
    v_lshlrev_b32 v30, 5, v30
    v_add_u32 v30, s69, v30
    ds_read_b128 v[64:67], v30 offset:0
    ds_read_b128 v[68:71], v30 offset:16
    ds_read_b128 v[72:75], v30 offset:256
    ds_read_b128 v[76:79], v30 offset:272
    v_lshlrev_b32 v31, 4, v1
    s_cmp_eq_u32 s82, 0
    s_cselect_b32 s69, 8, 0
    s_cmp_lt_u32 s55, 28
    s_cselect_b32 s69, s69, 0
    v_cmp_gt_u32 vcc, s69, v1
    v_mov_b32 v80, 2147483648
    s_nop 0
    v_cndmask_b32 v31, v80, v31, vcc
    s_waitcnt lgkmcnt(0)
    v_add_f32 v64, v64, v72
    v_add_f32 v65, v65, v73
    v_add_f32 v66, v66, v74
    v_add_f32 v67, v67, v75
    v_add_f32 v68, v68, v76
    v_add_f32 v69, v69, v77
    v_add_f32 v70, v70, v78
    v_add_f32 v71, v71, v79
    v_cvt_pk_bf16_f32 v72, v64, v65
    v_cvt_pk_bf16_f32 v73, v66, v67
    v_cvt_pk_bf16_f32 v74, v68, v69
    v_cvt_pk_bf16_f32 v75, v70, v71
    v_min_u32 v72, -2, v72
    v_min_u32 v73, -2, v73
    v_min_u32 v74, -2, v74
    v_min_u32 v75, -2, v75
    buffer_store_dwordx4 v[72:75], v31, s[36:39], s72 offen sc1
    s_cmp_lg_u32 s82, 0
    s_cbranch_scc1 Lxs_79
    s_cmp_ge_u32 s55, 28
    s_cbranch_scc1 Lxs_79
    v_lshrrev_b32 v30, 3, v1
    v_mul_u32_u24 v30, 196608, v30
    v_and_b32 v31, 7, v1
    v_lshl_add_u32 v30, v31, 4, v30
    s_lshl_b32 s72, s55, 7
    s_add_u32 s72, s72, s60
    s_add_u32 s72, s72, 142336
    buffer_load_dwordx4 v[32:35], v30, s[36:39], s72 offen sc1
    s_waitcnt vmcnt(0)
Lpollxs_2_80:
    v_max3_u32 v31, v32, v33, v34
    v_max_u32 v31, v31, v35
    v_cmp_eq_u32 vcc, -1, v31
    s_cbranch_vccz Ldonexs_2_81
Lhsxs_2_82:
    s_add_u32 s3, s72, 786432
    s_buffer_load_dword s92, s[36:39], s72 offset:124 glc
    s_buffer_load_dword s93, s[36:39], s72 offset:196732 glc
    s_buffer_load_dword s94, s[36:39], s72 offset:393340 glc
    s_buffer_load_dword s95, s[36:39], s72 offset:589948 glc
    s_buffer_load_dword s96, s[36:39], s3 offset:124 glc
    s_buffer_load_dword s97, s[36:39], s3 offset:196732 glc
    s_buffer_load_dword s98, s[36:39], s3 offset:393340 glc
    s_buffer_load_dword s99, s[36:39], s3 offset:589948 glc
    s_waitcnt lgkmcnt(0)
    s_max_u32 s92, s92, s93
    s_max_u32 s92, s92, s94
    s_max_u32 s92, s92, s95
    s_max_u32 s92, s92, s96
    s_max_u32 s92, s92, s97
    s_max_u32 s92, s92, s98
    s_max_u32 s92, s92, s99
    s_cmp_lg_u32 s92, -1
    s_cbranch_scc1 Lhrxs_2_83
    s_cmp_eq_u32 s65, 0
    s_cbranch_scc1 Ldonexs_2_81
    s_sub_u32 s65, s65, 1
    s_sleep 2
    s_branch Lhsxs_2_82
Lhrxs_2_83:
    s_cbranch_vccz Ldonexs_2_81
    s_mov_b64 exec, vcc
    buffer_load_dwordx4 v[32:35], v30, s[36:39], s72 offen sc1
    s_mov_b64 exec, -1
    s_waitcnt vmcnt(0)
    s_cmp_eq_u32 s65, 0
    s_cbranch_scc1 Ldonexs_2_81
    s_sub_u32 s65, s65, 1
    s_branch Lpollxs_2_80
Ldonexs_2_81:
    v_lshlrev_b32 v40, 16, v32
    v_and_b32 v41, 0xffff0000, v32
    v_lshlrev_b32 v42, 16, v33
    v_and_b32 v43, 0xffff0000, v33
    v_lshlrev_b32 v44, 16, v34
    v_and_b32 v45, 0xffff0000, v34
    v_lshlrev_b32 v46, 16, v35
    v_and_b32 v47, 0xffff0000, v35
    v_add_f32_dpp v40, v40, v40 row_ror:8 row_mask:0xf bank_mask:0xf
    v_add_f32_dpp v41, v41, v41 row_ror:8 row_mask:0xf bank_mask:0xf
    v_add_f32_dpp v42, v42, v42 row_ror:8 row_mask:0xf bank_mask:0xf
    v_add_f32_dpp v43, v43, v43 row_ror:8 row_mask:0xf bank_mask:0xf
    v_add_f32_dpp v44, v44, v44 row_ror:8 row_mask:0xf bank_mask:0xf
    v_add_f32_dpp v45, v45, v45 row_ror:8 row_mask:0xf bank_mask:0xf
    v_add_f32_dpp v46, v46, v46 row_ror:8 row_mask:0xf bank_mask:0xf
    v_add_f32_dpp v47, v47, v47 row_ror:8 row_mask:0xf bank_mask:0xf
    s_nop 0
    v_mov_b32 v48, v40
    v_mov_b32 v49, v41
    v_mov_b32 v50, v42
    v_mov_b32 v51, v43
    v_mov_b32 v52, v44
    v_mov_b32 v53, v45
    v_mov_b32 v54, v46
    v_mov_b32 v55, v47
    s_nop 0
    v_permlane32_swap_b32 v48, v40
    v_permlane32_swap_b32 v49, v41
    v_permlane32_swap_b32 v50, v42
    v_permlane32_swap_b32 v51, v43
    v_permlane32_swap_b32 v52, v44
    v_permlane32_swap_b32 v53, v45
    v_permlane32_swap_b32 v54, v46
    v_permlane32_swap_b32 v55, v47
    s_nop 0
    v_add_f32 v40, v40, v48
    v_add_f32 v41, v41, v49
    v_add_f32 v42, v42, v50
    v_add_f32 v43, v43, v51
    v_add_f32 v44, v44, v52
    v_add_f32 v45, v45, v53
    v_add_f32 v46, v46, v54
    v_add_f32 v47, v47, v55
    v_mov_b32 v48, v40
    v_mov_b32 v49, v41
    v_mov_b32 v50, v42
    v_mov_b32 v51, v43
    v_mov_b32 v52, v44
    v_mov_b32 v53, v45
    v_mov_b32 v54, v46
    v_mov_b32 v55, v47
    s_nop 0
    v_permlane16_swap_b32 v48, v40
    v_permlane16_swap_b32 v49, v41
    v_permlane16_swap_b32 v50, v42
    v_permlane16_swap_b32 v51, v43
    v_permlane16_swap_b32 v52, v44
    v_permlane16_swap_b32 v53, v45
    v_permlane16_swap_b32 v54, v46
    v_permlane16_swap_b32 v55, v47
    s_nop 0
    v_add_f32 v40, v40, v48
    v_add_f32 v41, v41, v49
    v_add_f32 v42, v42, v50
    v_add_f32 v43, v43, v51
    v_add_f32 v44, v44, v52
    v_add_f32 v45, v45, v53
    v_add_f32 v46, v46, v54
    v_add_f32 v47, v47, v55
    v_cvt_pk_bf16_f32 v32, v40, v41
    v_cvt_pk_bf16_f32 v33, v42, v43
    v_cvt_pk_bf16_f32 v34, v44, v45
    v_cvt_pk_bf16_f32 v35, v46, v47
    v_min_u32 v32, -2, v32
    v_min_u32 v33, -2, v33
    v_min_u32 v34, -2, v34
    v_min_u32 v35, -2, v35
    v_lshlrev_b32 v30, 4, v1
    s_lshl_b32 s72, s55, 7
    s_add_u32 s72, s72, s101
    s_add_u32 s72, s72, 8192
    v_cmp_gt_u32 vcc, 8, v1
    v_mov_b32 v31, 2147483648
    s_nop 0
    v_cndmask_b32 v30, v31, v30, vcc
    s_cmp_eq_u32 s100, 0
    s_cbranch_scc1 Lwt_84
    buffer_store_dwordx4 v[32:35], v30, s[36:39], s72 offen
    s_branch Lwd_85
Lwt_84:
    buffer_store_dwordx4 v[32:35], v30, s[36:39], s72 offen sc1
Lwd_85:
    s_nop 1
Lxs_79:
    s_nop 1
    s_lshl_b32 s69, s82, 6
    v_lshrrev_b32 v30, 1, v1
    v_lshlrev_b32 v30, 7, v30
    v_and_b32 v31, 1, v1
    v_lshl_add_u32 v30, v31, 4, v30
    v_add_u32 v30, s69, v30
    v_mov_b32 v31, 2147483648
    v_cndmask_b32 v30, v31, v30, s[66:67]
    s_add_u32 s72, s60, 142336
    s_add_u32 s72, s101, 8192
    buffer_load_dwordx4 v[60:63], v30, s[36:39], s72 offen sc1
    buffer_load_dwordx4 v[124:127], v30, s[36:39], s72 offen offset:32 sc1
    s_lshl_b32 s69, s54, 1
    s_add_u32 s69, s69, s82
    s_mul_i32 s69, s69, 3584
    s_add_u32 s69, s69, 148224
    v_lshlrev_b32 v31, 5, v1
    v_add_u32 v31, s69, v31
    v_mov_b32 v14, 0
    v_mov_b32 v15, 0
    v_mov_b32 v16, 0
    v_mov_b32 v17, 0
    v_mov_b32 v18, 0
    v_mov_b32 v19, 0
    v_mov_b32 v20, 0
    v_mov_b32 v21, 0
    v_mov_b32 v22, 0
    v_mov_b32 v23, 0
    v_mov_b32 v24, 0
    v_mov_b32 v25, 0
    v_mov_b32 v26, 0
    v_mov_b32 v27, 0
    v_mov_b32 v28, 0
    v_mov_b32 v29, 0
    s_mov_b64 exec, s[66:67]
    ds_read_b128 v[14:17], v31 offset:0
    ds_read_b128 v[18:21], v31 offset:16
    ds_read_b128 v[22:25], v31 offset:1792
    ds_read_b128 v[26:29], v31 offset:1808
    s_mov_b64 exec, -1
    v_lshrrev_b32 v84, 4, v1
    v_lshlrev_b32 v84, 8, v84
    v_bfe_u32 v85, v1, 2, 2
    v_lshl_add_u32 v84, v85, 5, v84
    v_and_b32 v85, 3, v1
    v_lshl_add_u32 v84, v85, 3, v84
    s_mul_i32 s69, s82, 7168
    s_add_u32 s69, s69, 112640
    v_add_u32 v84, s69, v84
    ds_read_b64_tr_b16 v[96:97], v84 offset:0
    ds_read_b64_tr_b16 v[98:99], v84 offset:128
    ds_read_b64_tr_b16 v[100:101], v84 offset:1024
    ds_read_b64_tr_b16 v[102:103], v84 offset:1152
    ds_read_b64_tr_b16 v[104:105], v84 offset:2048
    ds_read_b64_tr_b16 v[106:107], v84 offset:2176
    ds_read_b64_tr_b16 v[108:109], v84 offset:3072
    ds_read_b64_tr_b16 v[110:111], v84 offset:3200
    s_waitcnt lgkmcnt(4)
    ds_read_b64_tr_b16 v[112:113], v84 offset:4096
    ds_read_b64_tr_b16 v[114:115], v84 offset:4224
    ds_read_b64_tr_b16 v[116:117], v84 offset:5120
    ds_read_b64_tr_b16 v[118:119], v84 offset:5248
    ds_read_b64_tr_b16 v[120:121], v84 offset:6144
    ds_read_b64_tr_b16 v[122:123], v84 offset:6272
    s_waitcnt lgkmcnt(0)
    s_waitcnt vmcnt(0)
    v_max3_u32 v31, v60, v61, v62
    v_max3_u32 v31, v31, v63, v124
    v_max3_u32 v31, v31, v125, v126
    v_max_u32 v31, v31, v127
    v_cmp_eq_u32 vcc, -1, v31
    s_or_b64 s[92:93], vcc, 1
    s_cbranch_vccz Ldones2_2_88
    s_mov_b64 exec, s[92:93]
    buffer_load_dwordx4 v[60:63], v30, s[36:39], s72 offen sc1
    buffer_load_dwordx4 v[124:127], v30, s[36:39], s72 offen offset:32 sc1
    s_mov_b64 exec, -1
    s_sleep 8
Lpolls2_2_87:
    s_mov_b64 exec, s[92:93]
    buffer_load_dwordx4 v[60:63], v30, s[36:39], s72 offen sc1
    buffer_load_dwordx4 v[124:127], v30, s[36:39], s72 offen offset:32 sc1
    s_mov_b64 exec, -1
    s_waitcnt vmcnt(2)
    s_cmp_eq_u32 s65, 0
    s_cbranch_scc1 Ldones2_2_88
    s_sub_u32 s65, s65, 1
    v_max3_u32 v31, v60, v61, v62
    v_max3_u32 v31, v31, v63, v124
    v_max3_u32 v31, v31, v125, v126
    v_max_u32 v31, v31, v127
    v_cmp_eq_u32 vcc, -1, v31
    s_or_b64 s[92:93], vcc, 1
    s_cbranch_vccz Ldones2_2_88
    s_branch Lpolls2_2_87
Ldones2_2_88:
    v_dot2c_f32_bf16 v14, s86, v60
    v_dot2c_f32_bf16 v15, s87, v60
    v_dot2c_f32_bf16 v16, s86, v61
    v_dot2c_f32_bf16 v17, s87, v61
    v_dot2c_f32_bf16 v18, s86, v62
    v_dot2c_f32_bf16 v19, s87, v62
    v_dot2c_f32_bf16 v20, s86, v63
    v_dot2c_f32_bf16 v21, s87, v63
    v_dot2c_f32_bf16 v22, s86, v124
    v_dot2c_f32_bf16 v23, s87, v124
    v_dot2c_f32_bf16 v24, s86, v125
    v_dot2c_f32_bf16 v25, s87, v125
    v_dot2c_f32_bf16 v26, s86, v126
    v_dot2c_f32_bf16 v27, s87, v126
    v_dot2c_f32_bf16 v28, s86, v127
    v_dot2c_f32_bf16 v29, s87, v127
    s_lshl_b32 s69, s54, 1
    s_add_u32 s69, s69, s82
    s_mul_i32 s69, s69, 3584
    s_add_u32 s69, s69, 148224
    v_lshlrev_b32 v31, 5, v1
    v_add_u32 v31, s69, v31
    s_mov_b64 exec, s[66:67]
    ds_write_b128 v31, v[14:17] offset:0
    ds_write_b128 v31, v[18:21] offset:16
    ds_write_b128 v31, v[22:25] offset:1792
    ds_write_b128 v31, v[26:29] offset:1808
    s_mov_b64 exec, -1
    v_add_f32 v80, v14, v15
    v_add_f32 v80, v80, v16
    v_add_f32 v80, v80, v17
    v_add_f32 v80, v80, v18
    v_add_f32 v80, v80, v19
    v_add_f32 v80, v80, v20
    v_add_f32 v80, v80, v21
    v_add_f32 v81, v22, v23
    v_add_f32 v81, v81, v24
    v_add_f32 v81, v81, v25
    v_add_f32 v81, v81, v26
    v_add_f32 v81, v81, v27
    v_add_f32 v81, v81, v28
    v_add_f32 v81, v81, v29
    s_nop 0
    v_add_f32_dpp v80, v80, v80 row_ror:8 row_mask:0xf bank_mask:0xf
    v_add_f32_dpp v81, v81, v81 row_ror:8 row_mask:0xf bank_mask:0xf
    s_nop 0
    v_add_f32_dpp v80, v80, v80 row_ror:4 row_mask:0xf bank_mask:0xf
    v_add_f32_dpp v81, v81, v81 row_ror:4 row_mask:0xf bank_mask:0xf
    s_nop 0
    v_add_f32_dpp v80, v80, v80 row_ror:2 row_mask:0xf bank_mask:0xf
    v_add_f32_dpp v81, v81, v81 row_ror:2 row_mask:0xf bank_mask:0xf
    s_nop 0
    v_add_f32_dpp v80, v80, v80 row_ror:1 row_mask:0xf bank_mask:0xf
    v_add_f32_dpp v81, v81, v81 row_ror:1 row_mask:0xf bank_mask:0xf
    s_nop 0
    v_mov_b32 v82, v80
    v_mov_b32 v83, v81
    s_nop 0
    v_permlane32_swap_b32 v82, v80
    v_permlane32_swap_b32 v83, v81
    s_nop 0
    v_add_f32 v80, v80, v82
    v_add_f32 v81, v81, v83
    v_mov_b32 v82, v80
    v_mov_b32 v83, v81
    s_nop 0
    v_permlane16_swap_b32 v82, v80
    v_permlane16_swap_b32 v83, v81
    s_nop 0
    v_add_f32 v80, v80, v82
    v_add_f32 v81, v81, v83
    v_mul_f32 v80, 0x3b124925, v80
    v_mul_f32 v81, 0x3b124925, v81
    v_sub_f32 v64, v14, v80
    v_sub_f32 v65, v15, v80
    v_sub_f32 v66, v16, v80
    v_sub_f32 v67, v17, v80
    v_sub_f32 v68, v18, v80
    v_sub_f32 v69, v19, v80
    v_sub_f32 v70, v20, v80
    v_sub_f32 v71, v21, v80
    v_sub_f32 v72, v22, v81
    v_sub_f32 v73, v23, v81
    v_sub_f32 v74, v24, v81
    v_sub_f32 v75, v25, v81
    v_sub_f32 v76, v26, v81
    v_sub_f32 v77, v27, v81
    v_sub_f32 v78, v28, v81
    v_sub_f32 v79, v29, v81
    v_mul_f32 v80, v64, v64
    v_fmac_f32 v80, v65, v65
    v_fmac_f32 v80, v66, v66
    v_fmac_f32 v80, v67, v67
    v_fmac_f32 v80, v68, v68
    v_fmac_f32 v80, v69, v69
    v_fmac_f32 v80, v70, v70
    v_fmac_f32 v80, v71, v71
    v_mul_f32 v81, v72, v72
    v_fmac_f32 v81, v73, v73
    v_fmac_f32 v81, v74, v74
    v_fmac_f32 v81, v75, v75
    v_fmac_f32 v81, v76, v76
    v_fmac_f32 v81, v77, v77
    v_fmac_f32 v81, v78, v78
    v_fmac_f32 v81, v79, v79
    v_cndmask_b32 v80, 0, v80, s[66:67]
    v_cndmask_b32 v81, 0, v81, s[66:67]
    s_nop 0
    v_add_f32_dpp v80, v80, v80 row_ror:8 row_mask:0xf bank_mask:0xf
    v_add_f32_dpp v81, v81, v81 row_ror:8 row_mask:0xf bank_mask:0xf
    s_nop 0
    v_add_f32_dpp v80, v80, v80 row_ror:4 row_mask:0xf bank_mask:0xf
    v_add_f32_dpp v81, v81, v81 row_ror:4 row_mask:0xf bank_mask:0xf
    s_nop 0
    v_add_f32_dpp v80, v80, v80 row_ror:2 row_mask:0xf bank_mask:0xf
    v_add_f32_dpp v81, v81, v81 row_ror:2 row_mask:0xf bank_mask:0xf
    s_nop 0
    v_add_f32_dpp v80, v80, v80 row_ror:1 row_mask:0xf bank_mask:0xf
    v_add_f32_dpp v81, v81, v81 row_ror:1 row_mask:0xf bank_mask:0xf
    s_nop 0
    v_mov_b32 v82, v80
    v_mov_b32 v83, v81
    s_nop 0
    v_permlane32_swap_b32 v82, v80
    v_permlane32_swap_b32 v83, v81
    s_nop 0
    v_add_f32 v80, v80, v82
    v_add_f32 v81, v81, v83
    v_mov_b32 v82, v80
    v_mov_b32 v83, v81
    s_nop 0
    v_permlane16_swap_b32 v82, v80
    v_permlane16_swap_b32 v83, v81
    s_nop 0
    v_add_f32 v80, v80, v82
    v_add_f32 v81, v81, v83
    v_mov_b32 v82, 0x3727c5ac
    v_mov_b32 v83, 0x3727c5ac
    v_fmac_f32 v82, 0x3b124925, v80
    v_fmac_f32 v83, 0x3b124925, v81
    v_rsq_f32 v82, v82
    v_rsq_f32 v83, v83
    s_nop 0
    v_mul_f32 v64, v64, v82
    v_mul_f32 v65, v65, v82
    v_mul_f32 v66, v66, v82
    v_mul_f32 v67, v67, v82
    v_mul_f32 v68, v68, v82
    v_mul_f32 v69, v69, v82
    v_mul_f32 v70, v70, v82
    v_mul_f32 v71, v71, v82
    v_mul_f32 v72, v72, v83
    v_mul_f32 v73, v73, v83
    v_mul_f32 v74, v74, v83
    v_mul_f32 v75, v75, v83
    v_mul_f32 v76, v76, v83
    v_mul_f32 v77, v77, v83
    v_mul_f32 v78, v78, v83
    v_mul_f32 v79, v79, v83
    v_cvt_pk_bf16_f32 v84, v64, v65
    v_cvt_pk_bf16_f32 v85, v66, v67
    v_cvt_pk_bf16_f32 v86, v68, v69
    v_cvt_pk_bf16_f32 v87, v70, v71
    v_cvt_pk_bf16_f32 v88, v72, v73
    v_cvt_pk_bf16_f32 v89, v74, v75
    v_cvt_pk_bf16_f32 v90, v76, v77
    v_cvt_pk_bf16_f32 v91, v78, v79
    s_lshl_b32 s69, s52, 11
    s_add_u32 s69, s69, 137472
    v_lshlrev_b32 v30, 4, v1
    v_add_u32 v30, s69, v30
    ds_write_b128 v30, v[84:87]
    ds_write_b128 v30, v[88:91] offset:1024
    s_waitcnt lgkmcnt(0)
    v_mov_b32 v30, s84
    v_mov_b32 v31, 12
    ds_write_b32 v30, v31
    v_mov_b32 v30, s85
Lps_89:
    ds_read_b32 v31, v30
    s_waitcnt lgkmcnt(0)
    v_cmp_gt_u32 vcc, 12, v31
    s_cbranch_vccz Lpd_90
    s_cmp_eq_u32 s83, 0
    s_cbranch_scc1 Lpd_90
    s_sub_u32 s83, s83, 1
    s_branch Lps_89
Lpd_90:
    v_and_b32 v30, 3, v1
    v_lshlrev_b32 v30, 10, v30
    s_lshl_b32 s69, s54, 12
    s_add_u32 s69, s69, 137472
    v_lshrrev_b32 v31, 4, v1
    v_lshl_add_u32 v30, v31, 4, v30
    s_mul_i32 s72, s82, 448
    s_add_u32 s69, s69, s72
    v_add_u32 v30, s69, v30
    ds_read_b128 v[32:35], v30 offset:0
    ds_read_b128 v[36:39], v30 offset:64
    ds_read_b128 v[40:43], v30 offset:128
    ds_read_b128 v[44:47], v30 offset:192
    ds_read_b128 v[48:51], v30 offset:256
    ds_read_b128 v[52:55], v30 offset:320
    ds_read_b128 v[56:59], v30 offset:384
    s_waitcnt lgkmcnt(6)
    v_mfma_f32_16x16x32_bf16 v[92:95], v[96:99], v[32:35], 0
    s_waitcnt lgkmcnt(5)
    v_mfma_f32_16x16x32_bf16 v[92:95], v[100:103], v[36:39], v[92:95]
    s_waitcnt lgkmcnt(4)
    v_mfma_f32_16x16x32_bf16 v[92:95], v[104:107], v[40:43], v[92:95]
    s_waitcnt lgkmcnt(3)
    v_mfma_f32_16x16x32_bf16 v[92:95], v[108:111], v[44:47], v[92:95]
    s_waitcnt lgkmcnt(2)
    v_mfma_f32_16x16x32_bf16 v[92:95], v[112:115], v[48:51], v[92:95]
    s_waitcnt lgkmcnt(1)
    v_mfma_f32_16x16x32_bf16 v[92:95], v[116:119], v[52:55], v[92:95]
    s_waitcnt lgkmcnt(0)
    v_mfma_f32_16x16x32_bf16 v[92:95], v[120:123], v[56:59], v[92:95]
    v_and_b32 v30, 3, v1
    v_lshlrev_b32 v30, 6, v30
    v_lshrrev_b32 v31, 4, v1
    v_lshl_add_u32 v30, v31, 4, v30
    s_lshl_b32 s69, s52, 8
    s_add_u32 s69, s69, 136448
    v_add_u32 v30, s69, v30
    s_nop 7
    ds_write_b128 v30, v[92:95]
    s_waitcnt lgkmcnt(0)
    v_mov_b32 v30, s84
    v_mov_b32 v31, 13
    ds_write_b32 v30, v31
    v_mov_b32 v30, s85
Lps_91:
    ds_read_b32 v31, v30
    s_waitcnt lgkmcnt(0)
    v_cmp_gt_u32 vcc, 13, v31
    s_cbranch_vccz Lpd_92
    s_cmp_eq_u32 s83, 0
    s_cbranch_scc1 Lpd_92
    s_sub_u32 s83, s83, 1
    s_branch Lps_91
Lpd_92:
    s_add_u32 s72, s61, 159744
    s_add_u32 s72, s72, s75
    s_lshl_b32 s69, s54, 9
    s_add_u32 s69, s69, 136448
    v_and_b32 v30, 7, v1
    v_lshlrev_b32 v30, 5, v30
    v_add_u32 v30, s69, v30
    ds_read_b128 v[64:67], v30 offset:0
    ds_read_b128 v[68:71], v30 offset:16
    ds_read_b128 v[72:75], v30 offset:256
    ds_read_b128 v[76:79], v30 offset:272
    v_lshlrev_b32 v31, 4, v1
    s_cmp_eq_u32 s82, 0
    s_cselect_b32 s69, 8, 0
    v_cmp_gt_u32 vcc, s69, v1
    v_mov_b32 v80, 2147483648
    s_nop 0
    v_cndmask_b32 v31, v80, v31, vcc
    s_waitcnt lgkmcnt(0)
    v_add_f32 v64, v64, v72
    v_add_f32 v65, v65, v73
    v_add_f32 v66, v66, v74
    v_add_f32 v67, v67, v75
    v_add_f32 v68, v68, v76
    v_add_f32 v69, v69, v77
    v_add_f32 v70, v70, v78
    v_add_f32 v71, v71, v79
    v_cvt_pk_bf16_f32 v72, v64, v65
    v_cvt_pk_bf16_f32 v73, v66, v67
    v_cvt_pk_bf16_f32 v74, v68, v69
    v_cvt_pk_bf16_f32 v75, v70, v71
    v_min_u32 v72, -2, v72
    v_min_u32 v73, -2, v73
    v_min_u32 v74, -2, v74
    v_min_u32 v75, -2, v75
    s_cmp_eq_u32 s100, 0
    s_cbranch_scc1 Lwt_93
    buffer_store_dwordx4 v[72:75], v31, s[36:39], s72 offen
    s_branch Lwd_94
Lwt_93:
    buffer_store_dwordx4 v[72:75], v31, s[36:39], s72 offen sc1
Lwd_94:
    s_nop 1
    s_add_u32 s72, s61, 159744
    s_add_u32 s72, s72, s64
    v_lshrrev_b32 v30, 1, v1
    v_lshlrev_b32 v30, 7, v30
    v_and_b32 v31, 1, v1
    v_lshl_add_u32 v30, v31, 4, v30
    buffer_load_dwordx4 v[80:83], v30, s[36:39], s72 offen sc1
    s_waitcnt vmcnt(0)
    v_max3_u32 v31, v80, v81, v82
    v_max_u32 v31, v31, v83
    v_cmp_eq_u32 vcc, -1, v31
    s_or_b64 s[92:93], vcc, 1
    s_cbranch_vccz Ldoneq3_97
    s_mov_b64 exec, s[92:93]
    buffer_load_dwordx4 v[80:83], v30, s[36:39], s72 offen sc1
    s_mov_b64 exec, -1
    s_sleep 8
Lpollq3_96:
    s_mov_b64 exec, s[92:93]
    buffer_load_dwordx4 v[80:83], v30, s[36:39], s72 offen sc1
    s_mov_b64 exec, -1
    s_waitcnt vmcnt(1)
    s_cmp_eq_u32 s65, 0
    s_cbranch_scc1 Ldoneq3_97
    s_sub_u32 s65, s65, 1
    v_max3_u32 v31, v80, v81, v82
    v_max_u32 v31, v31, v83
    v_cmp_eq_u32 vcc, -1, v31
    s_or_b64 s[92:93], vcc, 1
    s_cbranch_vccz Ldoneq3_97
    s_branch Lpollq3_96
Ldoneq3_97:
    s_lshl_b32 s69, s54, 10
    s_add_u32 s69, s69, 145664
    v_lshlrev_b32 v30, 4, v1
    v_add_u32 v30, s69, v30
    ds_write_b128 v30, v[80:83]
    v_and_b32 v31, 1, v1
    v_lshlrev_b32 v31, 9, v31
    v_bfe_u32 v30, v1, 4, 1
    v_lshl_add_u32 v31, v30, 4, v31
    v_lshrrev_b32 v30, 5, v1
    v_lshl_add_u32 v31, v30, 8, v31
    v_add_u32 v31, s69, v31
    s_waitcnt lgkmcnt(0)
    ds_read_b128 v[32:35], v31 offset:0
    ds_read_b128 v[36:39], v31 offset:32
    ds_read_b128 v[40:43], v31 offset:64
    ds_read_b128 v[44:47], v31 offset:96
    ds_read_b128 v[48:51], v31 offset:128
    ds_read_b128 v[52:55], v31 offset:160
    ds_read_b128 v[56:59], v31 offset:192
    ds_read_b128 v[60:63], v31 offset:224
    s_waitcnt lgkmcnt(0)
    v_mfma_f32_16x16x32_bf16 v[84:87], a[192:195], v[32:35], 0
    v_mfma_f32_16x16x32_bf16 v[84:87], a[196:199], v[36:39], v[84:87]
    v_mfma_f32_16x16x32_bf16 v[84:87], a[200:203], v[40:43], v[84:87]
    v_mfma_f32_16x16x32_bf16 v[84:87], a[204:207], v[44:47], v[84:87]
    v_mfma_f32_16x16x32_bf16 v[84:87], a[208:211], v[48:51], v[84:87]
    v_mfma_f32_16x16x32_bf16 v[84:87], a[212:215], v[52:55], v[84:87]
    v_mfma_f32_16x16x32_bf16 v[84:87], a[216:219], v[56:59], v[84:87]
    v_mfma_f32_16x16x32_bf16 v[84:87], a[220:223], v[60:63], v[84:87]
    v_mfma_f32_16x16x32_bf16 v[88:91], a[224:227], v[32:35], 0
    v_mfma_f32_16x16x32_bf16 v[88:91], a[228:231], v[36:39], v[88:91]
    v_mfma_f32_16x16x32_bf16 v[88:91], a[232:235], v[40:43], v[88:91]
    v_mfma_f32_16x16x32_bf16 v[88:91], a[236:239], v[44:47], v[88:91]
    v_mfma_f32_16x16x32_bf16 v[88:91], a[240:243], v[48:51], v[88:91]
    v_mfma_f32_16x16x32_bf16 v[88:91], a[244:247], v[52:55], v[88:91]
    v_mfma_f32_16x16x32_bf16 v[88:91], a[248:251], v[56:59], v[88:91]
    v_mfma_f32_16x16x32_bf16 v[88:91], a[252:255], v[60:63], v[88:91]
    v_mfma_f32_16x16x32_bf16 v[92:95], v[160:163], v[32:35], 0
    v_mfma_f32_16x16x32_bf16 v[92:95], v[164:167], v[36:39], v[92:95]
    v_mfma_f32_16x16x32_bf16 v[92:95], v[168:171], v[40:43], v[92:95]
    v_mfma_f32_16x16x32_bf16 v[92:95], v[172:175], v[44:47], v[92:95]
    v_mfma_f32_16x16x32_bf16 v[92:95], v[176:179], v[48:51], v[92:95]
    v_mfma_f32_16x16x32_bf16 v[92:95], v[180:183], v[52:55], v[92:95]
    v_mfma_f32_16x16x32_bf16 v[92:95], v[184:187], v[56:59], v[92:95]
    v_mfma_f32_16x16x32_bf16 v[92:95], v[188:191], v[60:63], v[92:95]
    v_mfma_f32_16x16x32_bf16 v[96:99], v[192:195], v[32:35], 0
    v_mfma_f32_16x16x32_bf16 v[96:99], v[196:199], v[36:39], v[96:99]
    v_mfma_f32_16x16x32_bf16 v[96:99], v[200:203], v[40:43], v[96:99]
    v_mfma_f32_16x16x32_bf16 v[96:99], v[204:207], v[44:47], v[96:99]
    v_mfma_f32_16x16x32_bf16 v[96:99], v[208:211], v[48:51], v[96:99]
    v_mfma_f32_16x16x32_bf16 v[96:99], v[212:215], v[52:55], v[96:99]
    v_mfma_f32_16x16x32_bf16 v[96:99], v[216:219], v[56:59], v[96:99]
    v_mfma_f32_16x16x32_bf16 v[96:99], v[220:223], v[60:63], v[96:99]
    v_mfma_f32_16x16x32_bf16 v[100:103], v[224:227], v[32:35], 0
    v_mfma_f32_16x16x32_bf16 v[100:103], v[228:231], v[36:39], v[100:103]
    v_mfma_f32_16x16x32_bf16 v[100:103], v[232:235], v[40:43], v[100:103]
    v_mfma_f32_16x16x32_bf16 v[100:103], v[236:239], v[44:47], v[100:103]
    v_mfma_f32_16x16x32_bf16 v[100:103], v[240:243], v[48:51], v[100:103]
    v_mfma_f32_16x16x32_bf16 v[100:103], v[244:247], v[52:55], v[100:103]
    v_mfma_f32_16x16x32_bf16 v[100:103], v[248:251], v[56:59], v[100:103]
    v_mfma_f32_16x16x32_bf16 v[100:103], v[252:255], v[60:63], v[100:103]
    v_mfma_f32_16x16x32_bf16 v[104:107], v[128:131], v[32:35], 0
    v_mfma_f32_16x16x32_bf16 v[104:107], v[132:135], v[36:39], v[104:107]
    v_mfma_f32_16x16x32_bf16 v[104:107], v[136:139], v[40:43], v[104:107]
    v_mfma_f32_16x16x32_bf16 v[104:107], v[140:143], v[44:47], v[104:107]
    v_mfma_f32_16x16x32_bf16 v[104:107], v[144:147], v[48:51], v[104:107]
    v_mfma_f32_16x16x32_bf16 v[104:107], v[148:151], v[52:55], v[104:107]
    v_mfma_f32_16x16x32_bf16 v[104:107], v[152:155], v[56:59], v[104:107]
    v_mfma_f32_16x16x32_bf16 v[104:107], v[156:159], v[60:63], v[104:107]
    v_and_b32 v7, 15, v1
    v_lshlrev_b32 v6, 9, v7
    v_and_b32 v7, 7, v7
    v_lshl_add_u32 v6, v7, 5, v6
    v_lshrrev_b32 v7, 5, v1
    v_lshl_add_u32 v6, v7, 8, v6
    v_bfe_u32 v7, v1, 4, 1
    v_lshl_add_u32 v6, v7, 4, v6
    v_add_u32 v6, s56, v6
    v_xor_b32 v7, 32, v6
    v_xor_b32 v8, 64, v6
    v_xor_b32 v9, 96, v6
    v_xor_b32 v10, 128, v6
    v_xor_b32 v11, 160, v6
    v_xor_b32 v12, 192, v6
    v_xor_b32 v13, 224, v6
    ds_read_b128 v[14:17], v6 offset:0
    ds_read_b128 v[18:21], v7 offset:0
    ds_read_b128 v[22:25], v8 offset:0
    ds_read_b128 v[26:29], v9 offset:0
    s_waitcnt lgkmcnt(3)
    v_mfma_f32_16x16x32_bf16 v[108:111], v[14:17], v[32:35], 0
    s_waitcnt lgkmcnt(2)
    v_mfma_f32_16x16x32_bf16 v[108:111], v[18:21], v[36:39], v[108:111]
    ds_read_b128 v[14:17], v10 offset:0
    s_waitcnt lgkmcnt(2)
    v_mfma_f32_16x16x32_bf16 v[108:111], v[22:25], v[40:43], v[108:111]
    ds_read_b128 v[18:21], v11 offset:0
    s_waitcnt lgkmcnt(2)
    v_mfma_f32_16x16x32_bf16 v[108:111], v[26:29], v[44:47], v[108:111]
    ds_read_b128 v[22:25], v12 offset:0
    s_waitcnt lgkmcnt(2)
    v_mfma_f32_16x16x32_bf16 v[108:111], v[14:17], v[48:51], v[108:111]
    ds_read_b128 v[26:29], v13 offset:0
    s_waitcnt lgkmcnt(2)
    v_mfma_f32_16x16x32_bf16 v[108:111], v[18:21], v[52:55], v[108:111]
    s_waitcnt lgkmcnt(1)
    v_mfma_f32_16x16x32_bf16 v[108:111], v[22:25], v[56:59], v[108:111]
    s_waitcnt lgkmcnt(0)
    v_mfma_f32_16x16x32_bf16 v[108:111], v[26:29], v[60:63], v[108:111]
    s_add_u32 m0, s56, 0
    s_add_u32 s69, s57, 1572864
    buffer_load_dwordx4 v2, s[12:15], s69 offen offset:0 nt lds
    buffer_load_dwordx4 v3, s[12:15], s69 offen offset:1024 nt lds
    buffer_load_dwordx4 v4, s[12:15], s69 offen offset:2048 nt lds
    buffer_load_dwordx4 v5, s[12:15], s69 offen offset:3072 nt lds
    s_add_u32 m0, s56, 4096
    s_add_u32 s69, s69, 4096
    buffer_load_dwordx4 v2, s[12:15], s69 offen offset:0 nt lds
    buffer_load_dwordx4 v3, s[12:15], s69 offen offset:1024 nt lds
    buffer_load_dwordx4 v4, s[12:15], s69 offen offset:2048 nt lds
    buffer_load_dwordx4 v5, s[12:15], s69 offen offset:3072 nt lds
    ds_read_b128 v[14:17], v6 offset:8192
    ds_read_b128 v[18:21], v7 offset:8192
    ds_read_b128 v[22:25], v8 offset:8192
    ds_read_b128 v[26:29], v9 offset:8192
    s_waitcnt lgkmcnt(3)
    v_mfma_f32_16x16x32_bf16 v[64:67], v[14:17], v[32:35], 0
    s_waitcnt lgkmcnt(2)
    v_mfma_f32_16x16x32_bf16 v[64:67], v[18:21], v[36:39], v[64:67]
    ds_read_b128 v[14:17], v10 offset:8192
    s_waitcnt lgkmcnt(2)
    v_mfma_f32_16x16x32_bf16 v[64:67], v[22:25], v[40:43], v[64:67]
    ds_read_b128 v[18:21], v11 offset:8192
    s_waitcnt lgkmcnt(2)
    v_mfma_f32_16x16x32_bf16 v[64:67], v[26:29], v[44:47], v[64:67]
    ds_read_b128 v[22:25], v12 offset:8192
    s_waitcnt lgkmcnt(2)
    v_mfma_f32_16x16x32_bf16 v[64:67], v[14:17], v[48:51], v[64:67]
    ds_read_b128 v[26:29], v13 offset:8192
    s_waitcnt lgkmcnt(2)
    v_mfma_f32_16x16x32_bf16 v[64:67], v[18:21], v[52:55], v[64:67]
    s_waitcnt lgkmcnt(1)
    v_mfma_f32_16x16x32_bf16 v[64:67], v[22:25], v[56:59], v[64:67]
    s_waitcnt lgkmcnt(0)
    v_mfma_f32_16x16x32_bf16 v[64:67], v[26:29], v[60:63], v[64:67]
    s_add_u32 m0, s56, 8192
    s_add_u32 s69, s57, 131072
    buffer_load_dwordx4 v2, s[12:15], s69 offen offset:0 nt lds
    buffer_load_dwordx4 v3, s[12:15], s69 offen offset:1024 nt lds
    buffer_load_dwordx4 v4, s[12:15], s69 offen offset:2048 nt lds
    buffer_load_dwordx4 v5, s[12:15], s69 offen offset:3072 nt lds
    s_add_u32 m0, s56, 12288
    s_add_u32 s69, s69, 4096
    buffer_load_dwordx4 v2, s[12:15], s69 offen offset:0 nt lds
    buffer_load_dwordx4 v3, s[12:15], s69 offen offset:1024 nt lds
    buffer_load_dwordx4 v4, s[12:15], s69 offen offset:2048 nt lds
    buffer_load_dwordx4 v5, s[12:15], s69 offen offset:3072 nt lds
    s_waitcnt vmcnt(8)
    ds_read_b128 v[14:17], v6 offset:0
    ds_read_b128 v[18:21], v7 offset:0
    ds_read_b128 v[22:25], v8 offset:0
    ds_read_b128 v[26:29], v9 offset:0
    s_waitcnt lgkmcnt(3)
    v_mfma_f32_16x16x32_bf16 v[112:115], v[14:17], v[32:35], 0
    s_waitcnt lgkmcnt(2)
    v_mfma_f32_16x16x32_bf16 v[112:115], v[18:21], v[36:39], v[112:115]
    ds_read_b128 v[14:17], v10 offset:0
    s_waitcnt lgkmcnt(2)
    v_mfma_f32_16x16x32_bf16 v[112:115], v[22:25], v[40:43], v[112:115]
    ds_read_b128 v[18:21], v11 offset:0
    s_waitcnt lgkmcnt(2)
    v_mfma_f32_16x16x32_bf16 v[112:115], v[26:29], v[44:47], v[112:115]
    ds_read_b128 v[22:25], v12 offset:0
    s_waitcnt lgkmcnt(2)
    v_mfma_f32_16x16x32_bf16 v[112:115], v[14:17], v[48:51], v[112:115]
    ds_read_b128 v[26:29], v13 offset:0
    s_waitcnt lgkmcnt(2)
    v_mfma_f32_16x16x32_bf16 v[112:115], v[18:21], v[52:55], v[112:115]
    s_waitcnt lgkmcnt(1)
    v_mfma_f32_16x16x32_bf16 v[112:115], v[22:25], v[56:59], v[112:115]
    s_waitcnt lgkmcnt(0)
    v_mfma_f32_16x16x32_bf16 v[112:115], v[26:29], v[60:63], v[112:115]
    s_add_u32 m0, s56, 0
    s_add_u32 s69, s57, 1703936
    buffer_load_dwordx4 v2, s[12:15], s69 offen offset:0 nt lds
    buffer_load_dwordx4 v3, s[12:15], s69 offen offset:1024 nt lds
    buffer_load_dwordx4 v4, s[12:15], s69 offen offset:2048 nt lds
    buffer_load_dwordx4 v5, s[12:15], s69 offen offset:3072 nt lds
    s_add_u32 m0, s56, 4096
    s_add_u32 s69, s69, 4096
    buffer_load_dwordx4 v2, s[12:15], s69 offen offset:0 nt lds
    buffer_load_dwordx4 v3, s[12:15], s69 offen offset:1024 nt lds
    buffer_load_dwordx4 v4, s[12:15], s69 offen offset:2048 nt lds
    buffer_load_dwordx4 v5, s[12:15], s69 offen offset:3072 nt lds
    s_waitcnt vmcnt(8)
    ds_read_b128 v[14:17], v6 offset:8192
    ds_read_b128 v[18:21], v7 offset:8192
    ds_read_b128 v[22:25], v8 offset:8192
    ds_read_b128 v[26:29], v9 offset:8192
    s_waitcnt lgkmcnt(3)
    v_mfma_f32_16x16x32_bf16 v[68:71], v[14:17], v[32:35], 0
    s_waitcnt lgkmcnt(2)
    v_mfma_f32_16x16x32_bf16 v[68:71], v[18:21], v[36:39], v[68:71]
    ds_read_b128 v[14:17], v10 offset:8192
    s_waitcnt lgkmcnt(2)
    v_mfma_f32_16x16x32_bf16 v[68:71], v[22:25], v[40:43], v[68:71]
    ds_read_b128 v[18:21], v11 offset:8192
    s_waitcnt lgkmcnt(2)
    v_mfma_f32_16x16x32_bf16 v[68:71], v[26:29], v[44:47], v[68:71]
    ds_read_b128 v[22:25], v12 offset:8192
    s_waitcnt lgkmcnt(2)
    v_mfma_f32_16x16x32_bf16 v[68:71], v[14:17], v[48:51], v[68:71]
    ds_read_b128 v[26:29], v13 offset:8192
    s_waitcnt lgkmcnt(2)
    v_mfma_f32_16x16x32_bf16 v[68:71], v[18:21], v[52:55], v[68:71]
    s_waitcnt lgkmcnt(1)
    v_mfma_f32_16x16x32_bf16 v[68:71], v[22:25], v[56:59], v[68:71]
    s_waitcnt lgkmcnt(0)
    v_mfma_f32_16x16x32_bf16 v[68:71], v[26:29], v[60:63], v[68:71]
    s_add_u32 m0, s56, 8192
    s_add_u32 s69, s57, 262144
    buffer_load_dwordx4 v2, s[12:15], s69 offen offset:0 nt lds
    buffer_load_dwordx4 v3, s[12:15], s69 offen offset:1024 nt lds
    buffer_load_dwordx4 v4, s[12:15], s69 offen offset:2048 nt lds
    buffer_load_dwordx4 v5, s[12:15], s69 offen offset:3072 nt lds
    s_add_u32 m0, s56, 12288
    s_add_u32 s69, s69, 4096
    buffer_load_dwordx4 v2, s[12:15], s69 offen offset:0 nt lds
    buffer_load_dwordx4 v3, s[12:15], s69 offen offset:1024 nt lds
    buffer_load_dwordx4 v4, s[12:15], s69 offen offset:2048 nt lds
    buffer_load_dwordx4 v5, s[12:15], s69 offen offset:3072 nt lds
    s_waitcnt vmcnt(8)
    ds_read_b128 v[14:17], v6 offset:0
    ds_read_b128 v[18:21], v7 offset:0
    ds_read_b128 v[22:25], v8 offset:0
    ds_read_b128 v[26:29], v9 offset:0
    s_waitcnt lgkmcnt(3)
    v_mfma_f32_16x16x32_bf16 v[116:119], v[14:17], v[32:35], 0
    s_waitcnt lgkmcnt(2)
    v_mfma_f32_16x16x32_bf16 v[116:119], v[18:21], v[36:39], v[116:119]
    ds_read_b128 v[14:17], v10 offset:0
    s_waitcnt lgkmcnt(2)
    v_mfma_f32_16x16x32_bf16 v[116:119], v[22:25], v[40:43], v[116:119]
    ds_read_b128 v[18:21], v11 offset:0
    s_waitcnt lgkmcnt(2)
    v_mfma_f32_16x16x32_bf16 v[116:119], v[26:29], v[44:47], v[116:119]
    ds_read_b128 v[22:25], v12 offset:0
    s_waitcnt lgkmcnt(2)
    v_mfma_f32_16x16x32_bf16 v[116:119], v[14:17], v[48:51], v[116:119]
    ds_read_b128 v[26:29], v13 offset:0
    s_waitcnt lgkmcnt(2)
    v_mfma_f32_16x16x32_bf16 v[116:119], v[18:21], v[52:55], v[116:119]
    s_waitcnt lgkmcnt(1)
    v_mfma_f32_16x16x32_bf16 v[116:119], v[22:25], v[56:59], v[116:119]
    s_waitcnt lgkmcnt(0)
    v_mfma_f32_16x16x32_bf16 v[116:119], v[26:29], v[60:63], v[116:119]
    s_add_u32 m0, s56, 0
    s_add_u32 s69, s57, 1835008
    buffer_load_dwordx4 v2, s[12:15], s69 offen offset:0 nt lds
    buffer_load_dwordx4 v3, s[12:15], s69 offen offset:1024 nt lds
    buffer_load_dwordx4 v4, s[12:15], s69 offen offset:2048 nt lds
    buffer_load_dwordx4 v5, s[12:15], s69 offen offset:3072 nt lds
    s_add_u32 m0, s56, 4096
    s_add_u32 s69, s69, 4096
    buffer_load_dwordx4 v2, s[12:15], s69 offen offset:0 nt lds
    buffer_load_dwordx4 v3, s[12:15], s69 offen offset:1024 nt lds
    buffer_load_dwordx4 v4, s[12:15], s69 offen offset:2048 nt lds
    buffer_load_dwordx4 v5, s[12:15], s69 offen offset:3072 nt lds
    s_waitcnt vmcnt(8)
    ds_read_b128 v[14:17], v6 offset:8192
    ds_read_b128 v[18:21], v7 offset:8192
    ds_read_b128 v[22:25], v8 offset:8192
    ds_read_b128 v[26:29], v9 offset:8192
    s_waitcnt lgkmcnt(3)
    v_mfma_f32_16x16x32_bf16 v[72:75], v[14:17], v[32:35], 0
    s_waitcnt lgkmcnt(2)
    v_mfma_f32_16x16x32_bf16 v[72:75], v[18:21], v[36:39], v[72:75]
    ds_read_b128 v[14:17], v10 offset:8192
    s_waitcnt lgkmcnt(2)
    v_mfma_f32_16x16x32_bf16 v[72:75], v[22:25], v[40:43], v[72:75]
    ds_read_b128 v[18:21], v11 offset:8192
    s_waitcnt lgkmcnt(2)
    v_mfma_f32_16x16x32_bf16 v[72:75], v[26:29], v[44:47], v[72:75]
    ds_read_b128 v[22:25], v12 offset:8192
    s_waitcnt lgkmcnt(2)
    v_mfma_f32_16x16x32_bf16 v[72:75], v[14:17], v[48:51], v[72:75]
    ds_read_b128 v[26:29], v13 offset:8192
    s_waitcnt lgkmcnt(2)
    v_mfma_f32_16x16x32_bf16 v[72:75], v[18:21], v[52:55], v[72:75]
    s_waitcnt lgkmcnt(1)
    v_mfma_f32_16x16x32_bf16 v[72:75], v[22:25], v[56:59], v[72:75]
    s_waitcnt lgkmcnt(0)
    v_mfma_f32_16x16x32_bf16 v[72:75], v[26:29], v[60:63], v[72:75]
    s_add_u32 m0, s56, 8192
    s_add_u32 s69, s57, 393216
    buffer_load_dwordx4 v2, s[12:15], s69 offen offset:0 nt lds
    buffer_load_dwordx4 v3, s[12:15], s69 offen offset:1024 nt lds
    buffer_load_dwordx4 v4, s[12:15], s69 offen offset:2048 nt lds
    buffer_load_dwordx4 v5, s[12:15], s69 offen offset:3072 nt lds
    s_add_u32 m0, s56, 12288
    s_add_u32 s69, s69, 4096
    buffer_load_dwordx4 v2, s[12:15], s69 offen offset:0 nt lds
    buffer_load_dwordx4 v3, s[12:15], s69 offen offset:1024 nt lds
    buffer_load_dwordx4 v4, s[12:15], s69 offen offset:2048 nt lds
    buffer_load_dwordx4 v5, s[12:15], s69 offen offset:3072 nt lds
    s_waitcnt vmcnt(8)
    ds_read_b128 v[14:17], v6 offset:0
    ds_read_b128 v[18:21], v7 offset:0
    ds_read_b128 v[22:25], v8 offset:0
    ds_read_b128 v[26:29], v9 offset:0
    s_waitcnt lgkmcnt(3)
    v_mfma_f32_16x16x32_bf16 v[120:123], v[14:17], v[32:35], 0
    s_waitcnt lgkmcnt(2)
    v_mfma_f32_16x16x32_bf16 v[120:123], v[18:21], v[36:39], v[120:123]
    ds_read_b128 v[14:17], v10 offset:0
    s_waitcnt lgkmcnt(2)
    v_mfma_f32_16x16x32_bf16 v[120:123], v[22:25], v[40:43], v[120:123]
    ds_read_b128 v[18:21], v11 offset:0
    s_waitcnt lgkmcnt(2)
    v_mfma_f32_16x16x32_bf16 v[120:123], v[26:29], v[44:47], v[120:123]
    ds_read_b128 v[22:25], v12 offset:0
    s_waitcnt lgkmcnt(2)
    v_mfma_f32_16x16x32_bf16 v[120:123], v[14:17], v[48:51], v[120:123]
    ds_read_b128 v[26:29], v13 offset:0
    s_waitcnt lgkmcnt(2)
    v_mfma_f32_16x16x32_bf16 v[120:123], v[18:21], v[52:55], v[120:123]
    s_waitcnt lgkmcnt(1)
    v_mfma_f32_16x16x32_bf16 v[120:123], v[22:25], v[56:59], v[120:123]
    s_waitcnt lgkmcnt(0)
    v_mfma_f32_16x16x32_bf16 v[120:123], v[26:29], v[60:63], v[120:123]
    s_add_u32 m0, s56, 0
    s_add_u32 s69, s57, 1966080
    buffer_load_dwordx4 v2, s[12:15], s69 offen offset:0 nt lds
    buffer_load_dwordx4 v3, s[12:15], s69 offen offset:1024 nt lds
    buffer_load_dwordx4 v4, s[12:15], s69 offen offset:2048 nt lds
    buffer_load_dwordx4 v5, s[12:15], s69 offen offset:3072 nt lds
    s_add_u32 m0, s56, 4096
    s_add_u32 s69, s69, 4096
    buffer_load_dwordx4 v2, s[12:15], s69 offen offset:0 nt lds
    buffer_load_dwordx4 v3, s[12:15], s69 offen offset:1024 nt lds
    buffer_load_dwordx4 v4, s[12:15], s69 offen offset:2048 nt lds
    buffer_load_dwordx4 v5, s[12:15], s69 offen offset:3072 nt lds
    s_waitcnt vmcnt(8)
    ds_read_b128 v[14:17], v6 offset:8192
    ds_read_b128 v[18:21], v7 offset:8192
    ds_read_b128 v[22:25], v8 offset:8192
    ds_read_b128 v[26:29], v9 offset:8192
    s_waitcnt lgkmcnt(3)
    v_mfma_f32_16x16x32_bf16 v[76:79], v[14:17], v[32:35], 0
    s_waitcnt lgkmcnt(2)
    v_mfma_f32_16x16x32_bf16 v[76:79], v[18:21], v[36:39], v[76:79]
    ds_read_b128 v[14:17], v10 offset:8192
    s_waitcnt lgkmcnt(2)
    v_mfma_f32_16x16x32_bf16 v[76:79], v[22:25], v[40:43], v[76:79]
    ds_read_b128 v[18:21], v11 offset:8192
    s_waitcnt lgkmcnt(2)
    v_mfma_f32_16x16x32_bf16 v[76:79], v[26:29], v[44:47], v[76:79]
    ds_read_b128 v[22:25], v12 offset:8192
    s_waitcnt lgkmcnt(2)
    v_mfma_f32_16x16x32_bf16 v[76:79], v[14:17], v[48:51], v[76:79]
    ds_read_b128 v[26:29], v13 offset:8192
    s_waitcnt lgkmcnt(2)
    v_mfma_f32_16x16x32_bf16 v[76:79], v[18:21], v[52:55], v[76:79]
    s_waitcnt lgkmcnt(1)
    v_mfma_f32_16x16x32_bf16 v[76:79], v[22:25], v[56:59], v[76:79]
    s_waitcnt lgkmcnt(0)
    v_mfma_f32_16x16x32_bf16 v[76:79], v[26:29], v[60:63], v[76:79]
    s_add_u32 m0, s56, 8192
    s_add_u32 s69, s57, 524288
    buffer_load_dwordx4 v2, s[12:15], s69 offen offset:0 nt lds
    buffer_load_dwordx4 v3, s[12:15], s69 offen offset:1024 nt lds
    buffer_load_dwordx4 v4, s[12:15], s69 offen offset:2048 nt lds
    buffer_load_dwordx4 v5, s[12:15], s69 offen offset:3072 nt lds
    s_add_u32 m0, s56, 12288
    s_add_u32 s69, s69, 4096
    buffer_load_dwordx4 v2, s[12:15], s69 offen offset:0 nt lds
    buffer_load_dwordx4 v3, s[12:15], s69 offen offset:1024 nt lds
    buffer_load_dwordx4 v4, s[12:15], s69 offen offset:2048 nt lds
    buffer_load_dwordx4 v5, s[12:15], s69 offen offset:3072 nt lds
    s_waitcnt vmcnt(8)
    ds_read_b128 v[14:17], v6 offset:0
    ds_read_b128 v[18:21], v7 offset:0
    ds_read_b128 v[22:25], v8 offset:0
    ds_read_b128 v[26:29], v9 offset:0
    s_waitcnt lgkmcnt(3)
    v_mfma_f32_16x16x32_bf16 v[124:127], v[14:17], v[32:35], 0
    s_waitcnt lgkmcnt(2)
    v_mfma_f32_16x16x32_bf16 v[124:127], v[18:21], v[36:39], v[124:127]
    ds_read_b128 v[14:17], v10 offset:0
    s_waitcnt lgkmcnt(2)
    v_mfma_f32_16x16x32_bf16 v[124:127], v[22:25], v[40:43], v[124:127]
    ds_read_b128 v[18:21], v11 offset:0
    s_waitcnt lgkmcnt(2)
    v_mfma_f32_16x16x32_bf16 v[124:127], v[26:29], v[44:47], v[124:127]
    ds_read_b128 v[22:25], v12 offset:0
    s_waitcnt lgkmcnt(2)
    v_mfma_f32_16x16x32_bf16 v[124:127], v[14:17], v[48:51], v[124:127]
    ds_read_b128 v[26:29], v13 offset:0
    s_waitcnt lgkmcnt(2)
    v_mfma_f32_16x16x32_bf16 v[124:127], v[18:21], v[52:55], v[124:127]
    s_waitcnt lgkmcnt(1)
    v_mfma_f32_16x16x32_bf16 v[124:127], v[22:25], v[56:59], v[124:127]
    s_waitcnt lgkmcnt(0)
    v_mfma_f32_16x16x32_bf16 v[124:127], v[26:29], v[60:63], v[124:127]
    s_add_u32 m0, s56, 0
    s_add_u32 s69, s57, 0
    buffer_load_dwordx4 v2, s[16:19], s69 offen offset:0 nt lds
    buffer_load_dwordx4 v3, s[16:19], s69 offen offset:1024 nt lds
    buffer_load_dwordx4 v4, s[16:19], s69 offen offset:2048 nt lds
    buffer_load_dwordx4 v5, s[16:19], s69 offen offset:3072 nt lds
    s_add_u32 m0, s56, 4096
    s_add_u32 s69, s69, 4096
    buffer_load_dwordx4 v2, s[16:19], s69 offen offset:0 nt lds
    buffer_load_dwordx4 v3, s[16:19], s69 offen offset:1024 nt lds
    buffer_load_dwordx4 v4, s[16:19], s69 offen offset:2048 nt lds
    buffer_load_dwordx4 v5, s[16:19], s69 offen offset:3072 nt lds
    s_waitcnt vmcnt(8)
    ds_read_b128 v[14:17], v6 offset:8192
    ds_read_b128 v[18:21], v7 offset:8192
    ds_read_b128 v[22:25], v8 offset:8192
    ds_read_b128 v[26:29], v9 offset:8192
    s_waitcnt lgkmcnt(3)
    v_mfma_f32_16x16x32_bf16 v[80:83], v[14:17], v[32:35], 0
    s_waitcnt lgkmcnt(2)
    v_mfma_f32_16x16x32_bf16 v[80:83], v[18:21], v[36:39], v[80:83]
    ds_read_b128 v[14:17], v10 offset:8192
    s_waitcnt lgkmcnt(2)
    v_mfma_f32_16x16x32_bf16 v[80:83], v[22:25], v[40:43], v[80:83]
    ds_read_b128 v[18:21], v11 offset:8192
    s_waitcnt lgkmcnt(2)
    v_mfma_f32_16x16x32_bf16 v[80:83], v[26:29], v[44:47], v[80:83]
    ds_read_b128 v[22:25], v12 offset:8192
    s_waitcnt lgkmcnt(2)
    v_mfma_f32_16x16x32_bf16 v[80:83], v[14:17], v[48:51], v[80:83]
    ds_read_b128 v[26:29], v13 offset:8192
    s_waitcnt lgkmcnt(2)
    v_mfma_f32_16x16x32_bf16 v[80:83], v[18:21], v[52:55], v[80:83]
    s_waitcnt lgkmcnt(1)
    v_mfma_f32_16x16x32_bf16 v[80:83], v[22:25], v[56:59], v[80:83]
    s_waitcnt lgkmcnt(0)
    v_mfma_f32_16x16x32_bf16 v[80:83], v[26:29], v[60:63], v[80:83]
    s_add_u32 m0, s56, 8192
    s_add_u32 s69, s57, 131072
    buffer_load_dwordx4 v2, s[16:19], s69 offen offset:0 nt lds
    buffer_load_dwordx4 v3, s[16:19], s69 offen offset:1024 nt lds
    buffer_load_dwordx4 v4, s[16:19], s69 offen offset:2048 nt lds
    buffer_load_dwordx4 v5, s[16:19], s69 offen offset:3072 nt lds
    s_add_u32 m0, s56, 12288
    s_add_u32 s69, s69, 4096
    buffer_load_dwordx4 v2, s[16:19], s69 offen offset:0 nt lds
    buffer_load_dwordx4 v3, s[16:19], s69 offen offset:1024 nt lds
    buffer_load_dwordx4 v4, s[16:19], s69 offen offset:2048 nt lds
    buffer_load_dwordx4 v5, s[16:19], s69 offen offset:3072 nt lds
    s_nop 7
    v_max3_f32 v14, v64, v65, v66
    v_max3_f32 v15, v67, v68, v69
    v_max3_f32 v14, v14, v70, v71
    v_max3_f32 v15, v15, v72, v73
    v_max3_f32 v14, v14, v74, v75
    v_max3_f32 v15, v15, v76, v77
    v_max3_f32 v14, v14, v78, v79
    v_max3_f32 v15, v15, v80, v81
    v_max3_f32 v14, v14, v82, v83
    v_max3_f32 v15, v15, v84, v85
    v_max3_f32 v14, v14, v86, v87
    v_max3_f32 v15, v15, v88, v89
    v_max3_f32 v14, v14, v90, v91
    v_max3_f32 v15, v15, v92, v93
    v_max3_f32 v14, v14, v94, v95
    v_max3_f32 v15, v15, v96, v97
    v_max3_f32 v14, v14, v98, v99
    v_max3_f32 v15, v15, v100, v101
    v_max3_f32 v14, v14, v102, v103
    v_max3_f32 v15, v15, v104, v105
    v_max3_f32 v14, v14, v106, v107
    v_max3_f32 v15, v15, v108, v109
    v_max3_f32 v14, v14, v110, v111
    v_max3_f32 v15, v15, v112, v113
    v_max3_f32 v14, v14, v114, v115
    v_max3_f32 v15, v15, v116, v117
    v_max3_f32 v14, v14, v118, v119
    v_max3_f32 v15, v15, v120, v121
    v_max3_f32 v14, v14, v122, v123
    v_max3_f32 v15, v15, v124, v125
    v_max3_f32 v14, v14, v126, v127
    v_max_f32 v14, v14, v15
    v_mov_b32 v15, v14
    s_nop 1
    v_permlane32_swap_b32 v15, v14
    s_nop 1
    v_max_f32 v14, v14, v15
    v_mov_b32 v15, v14
    s_nop 1
    v_permlane16_swap_b32 v15, v14
    s_nop 1
    v_max_f32 v14, v14, v15
    v_mul_f32 v14, s68, v14
    v_mov_b32 v16, 0
    v_mov_b32 v17, 0
    v_fma_f32 v64, v64, s68, -v14
    v_fma_f32 v65, v65, s68, -v14
    v_fma_f32 v66, v66, s68, -v14
    v_fma_f32 v67, v67, s68, -v14
    v_exp_f32 v64, v64
    v_exp_f32 v65, v65
    v_exp_f32 v66, v66
    v_exp_f32 v67, v67
    v_cvt_pk_bf16_f32 v32, v64, v65
    v_add_f32 v16, v16, v64
    v_add_f32 v17, v17, v65
    v_cvt_pk_bf16_f32 v33, v66, v67
    v_add_f32 v16, v16, v66
    v_add_f32 v17, v17, v67
    v_fma_f32 v68, v68, s68, -v14
    v_fma_f32 v69, v69, s68, -v14
    v_fma_f32 v70, v70, s68, -v14
    v_fma_f32 v71, v71, s68, -v14
    v_exp_f32 v68, v68
    v_exp_f32 v69, v69
    v_exp_f32 v70, v70
    v_exp_f32 v71, v71
    v_cvt_pk_bf16_f32 v34, v68, v69
    v_add_f32 v16, v16, v68
    v_add_f32 v17, v17, v69
    v_cvt_pk_bf16_f32 v35, v70, v71
    v_add_f32 v16, v16, v70
    v_add_f32 v17, v17, v71
    v_fma_f32 v72, v72, s68, -v14
    v_fma_f32 v73, v73, s68, -v14
    v_fma_f32 v74, v74, s68, -v14
    v_fma_f32 v75, v75, s68, -v14
    v_exp_f32 v72, v72
    v_exp_f32 v73, v73
    v_exp_f32 v74, v74
    v_exp_f32 v75, v75
    v_cvt_pk_bf16_f32 v36, v72, v73
    v_add_f32 v16, v16, v72
    v_add_f32 v17, v17, v73
    v_cvt_pk_bf16_f32 v37, v74, v75
    v_add_f32 v16, v16, v74
    v_add_f32 v17, v17, v75
    v_fma_f32 v76, v76, s68, -v14
    v_fma_f32 v77, v77, s68, -v14
    v_fma_f32 v78, v78, s68, -v14
    v_fma_f32 v79, v79, s68, -v14
    v_exp_f32 v76, v76
    v_exp_f32 v77, v77
    v_exp_f32 v78, v78
    v_exp_f32 v79, v79
    v_cvt_pk_bf16_f32 v38, v76, v77
    v_add_f32 v16, v16, v76
    v_add_f32 v17, v17, v77
    v_cvt_pk_bf16_f32 v39, v78, v79
    v_add_f32 v16, v16, v78
    v_add_f32 v17, v17, v79
    v_fma_f32 v80, v80, s68, -v14
    v_fma_f32 v81, v81, s68, -v14
    v_fma_f32 v82, v82, s68, -v14
    v_fma_f32 v83, v83, s68, -v14
    v_exp_f32 v80, v80
    v_exp_f32 v81, v81
    v_exp_f32 v82, v82
    v_exp_f32 v83, v83
    v_cvt_pk_bf16_f32 v40, v80, v81
    v_add_f32 v16, v16, v80
    v_add_f32 v17, v17, v81
    v_cvt_pk_bf16_f32 v41, v82, v83
    v_add_f32 v16, v16, v82
    v_add_f32 v17, v17, v83
    v_fma_f32 v84, v84, s68, -v14
    v_fma_f32 v85, v85, s68, -v14
    v_fma_f32 v86, v86, s68, -v14
    v_fma_f32 v87, v87, s68, -v14
    v_exp_f32 v84, v84
    v_exp_f32 v85, v85
    v_exp_f32 v86, v86
    v_exp_f32 v87, v87
    v_cvt_pk_bf16_f32 v42, v84, v85
    v_add_f32 v16, v16, v84
    v_add_f32 v17, v17, v85
    v_cvt_pk_bf16_f32 v43, v86, v87
    v_add_f32 v16, v16, v86
    v_add_f32 v17, v17, v87
    v_fma_f32 v88, v88, s68, -v14
    v_fma_f32 v89, v89, s68, -v14
    v_fma_f32 v90, v90, s68, -v14
    v_fma_f32 v91, v91, s68, -v14
    v_exp_f32 v88, v88
    v_exp_f32 v89, v89
    v_exp_f32 v90, v90
    v_exp_f32 v91, v91
    v_cvt_pk_bf16_f32 v44, v88, v89
    v_add_f32 v16, v16, v88
    v_add_f32 v17, v17, v89
    v_cvt_pk_bf16_f32 v45, v90, v91
    v_add_f32 v16, v16, v90
    v_add_f32 v17, v17, v91
    v_fma_f32 v92, v92, s68, -v14
    v_fma_f32 v93, v93, s68, -v14
    v_fma_f32 v94, v94, s68, -v14
    v_fma_f32 v95, v95, s68, -v14
    v_exp_f32 v92, v92
    v_exp_f32 v93, v93
    v_exp_f32 v94, v94
    v_exp_f32 v95, v95
    v_cvt_pk_bf16_f32 v46, v92, v93
    v_add_f32 v16, v16, v92
    v_add_f32 v17, v17, v93
    v_cvt_pk_bf16_f32 v47, v94, v95
    v_add_f32 v16, v16, v94
    v_add_f32 v17, v17, v95
    v_fma_f32 v96, v96, s68, -v14
    v_fma_f32 v97, v97, s68, -v14
    v_fma_f32 v98, v98, s68, -v14
    v_fma_f32 v99, v99, s68, -v14
    v_exp_f32 v96, v96
    v_exp_f32 v97, v97
    v_exp_f32 v98, v98
    v_exp_f32 v99, v99
    v_cvt_pk_bf16_f32 v48, v96, v97
    v_add_f32 v16, v16, v96
    v_add_f32 v17, v17, v97
    v_cvt_pk_bf16_f32 v49, v98, v99
    v_add_f32 v16, v16, v98
    v_add_f32 v17, v17, v99
    v_fma_f32 v100, v100, s68, -v14
    v_fma_f32 v101, v101, s68, -v14
    v_fma_f32 v102, v102, s68, -v14
    v_fma_f32 v103, v103, s68, -v14
    v_exp_f32 v100, v100
    v_exp_f32 v101, v101
    v_exp_f32 v102, v102
    v_exp_f32 v103, v103
    v_cvt_pk_bf16_f32 v50, v100, v101
    v_add_f32 v16, v16, v100
    v_add_f32 v17, v17, v101
    v_cvt_pk_bf16_f32 v51, v102, v103
    v_add_f32 v16, v16, v102
    v_add_f32 v17, v17, v103
    v_fma_f32 v104, v104, s68, -v14
    v_fma_f32 v105, v105, s68, -v14
    v_fma_f32 v106, v106, s68, -v14
    v_fma_f32 v107, v107, s68, -v14
    v_exp_f32 v104, v104
    v_exp_f32 v105, v105
    v_exp_f32 v106, v106
    v_exp_f32 v107, v107
    v_cvt_pk_bf16_f32 v52, v104, v105
    v_add_f32 v16, v16, v104
    v_add_f32 v17, v17, v105
    v_cvt_pk_bf16_f32 v53, v106, v107
    v_add_f32 v16, v16, v106
    v_add_f32 v17, v17, v107
    v_fma_f32 v108, v108, s68, -v14
    v_fma_f32 v109, v109, s68, -v14
    v_fma_f32 v110, v110, s68, -v14
    v_fma_f32 v111, v111, s68, -v14
    v_exp_f32 v108, v108
    v_exp_f32 v109, v109
    v_exp_f32 v110, v110
    v_exp_f32 v111, v111
    v_cvt_pk_bf16_f32 v54, v108, v109
    v_add_f32 v16, v16, v108
    v_add_f32 v17, v17, v109
    v_cvt_pk_bf16_f32 v55, v110, v111
    v_add_f32 v16, v16, v110
    v_add_f32 v17, v17, v111
    v_fma_f32 v112, v112, s68, -v14
    v_fma_f32 v113, v113, s68, -v14
    v_fma_f32 v114, v114, s68, -v14
    v_fma_f32 v115, v115, s68, -v14
    v_exp_f32 v112, v112
    v_exp_f32 v113, v113
    v_exp_f32 v114, v114
    v_exp_f32 v115, v115
    v_cvt_pk_bf16_f32 v56, v112, v113
    v_add_f32 v16, v16, v112
    v_add_f32 v17, v17, v113
    v_cvt_pk_bf16_f32 v57, v114, v115
    v_add_f32 v16, v16, v114
    v_add_f32 v17, v17, v115
    v_fma_f32 v116, v116, s68, -v14
    v_fma_f32 v117, v117, s68, -v14
    v_fma_f32 v118, v118, s68, -v14
    v_fma_f32 v119, v119, s68, -v14
    v_exp_f32 v116, v116
    v_exp_f32 v117, v117
    v_exp_f32 v118, v118
    v_exp_f32 v119, v119
    v_cvt_pk_bf16_f32 v58, v116, v117
    v_add_f32 v16, v16, v116
    v_add_f32 v17, v17, v117
    v_cvt_pk_bf16_f32 v59, v118, v119
    v_add_f32 v16, v16, v118
    v_add_f32 v17, v17, v119
    v_fma_f32 v120, v120, s68, -v14
    v_fma_f32 v121, v121, s68, -v14
    v_fma_f32 v122, v122, s68, -v14
    v_fma_f32 v123, v123, s68, -v14
    v_exp_f32 v120, v120
    v_exp_f32 v121, v121
    v_exp_f32 v122, v122
    v_exp_f32 v123, v123
    v_cvt_pk_bf16_f32 v60, v120, v121
    v_add_f32 v16, v16, v120
    v_add_f32 v17, v17, v121
    v_cvt_pk_bf16_f32 v61, v122, v123
    v_add_f32 v16, v16, v122
    v_add_f32 v17, v17, v123
    v_fma_f32 v124, v124, s68, -v14
    v_fma_f32 v125, v125, s68, -v14
    v_fma_f32 v126, v126, s68, -v14
    v_fma_f32 v127, v127, s68, -v14
    v_exp_f32 v124, v124
    v_exp_f32 v125, v125
    v_exp_f32 v126, v126
    v_exp_f32 v127, v127
    v_cvt_pk_bf16_f32 v62, v124, v125
    v_add_f32 v16, v16, v124
    v_add_f32 v17, v17, v125
    v_cvt_pk_bf16_f32 v63, v126, v127
    v_add_f32 v16, v16, v126
    v_add_f32 v17, v17, v127
    v_add_f32 v16, v16, v17
    v_mov_b32 v15, v16
    s_nop 1
    v_permlane32_swap_b32 v15, v16
    s_nop 1
    v_add_f32 v16, v16, v15
    v_mov_b32 v15, v16
    s_nop 1
    v_permlane16_swap_b32 v15, v16
    s_nop 1
    v_add_f32 v16, v16, v15
    v_mov_b32 v15, v16
    v_and_b32 v17, 1, v1
    v_lshlrev_b32 v17, 3, v17
    s_lshl_b32 s69, s52, 4
    s_add_u32 s69, s69, 135168
    v_add_u32 v17, s69, v17
    ds_write_b64 v17, v[14:15]
    s_waitcnt lgkmcnt(0)
    v_lshrrev_b32 v7, 2, v1
    v_lshlrev_b32 v6, 9, v7
    v_and_b32 v7, 7, v7
    v_lshl_add_u32 v6, v7, 5, v6
    v_and_b32 v7, 3, v1
    v_lshl_add_u32 v6, v7, 3, v6
    v_add_u32 v6, s56, v6
    v_xor_b32 v7, 32, v6
    v_xor_b32 v8, 64, v6
    v_xor_b32 v9, 96, v6
    v_xor_b32 v10, 128, v6
    v_xor_b32 v11, 160, v6
    v_xor_b32 v12, 192, v6
    v_xor_b32 v13, 224, v6
    s_waitcnt vmcnt(8)
    ds_read_b64_tr_b16 v[14:15], v6 offset:0
    ds_read_b64_tr_b16 v[16:17], v7 offset:0
    ds_read_b64_tr_b16 v[18:19], v8 offset:0
    ds_read_b64_tr_b16 v[20:21], v9 offset:0
    ds_read_b64_tr_b16 v[22:23], v10 offset:0
    ds_read_b64_tr_b16 v[24:25], v11 offset:0
    ds_read_b64_tr_b16 v[26:27], v12 offset:0
    ds_read_b64_tr_b16 v[28:29], v13 offset:0
    s_waitcnt lgkmcnt(7)
    v_mfma_f32_16x16x16_bf16 v[64:67], v[14:15], v[32:33], 0
    s_waitcnt lgkmcnt(6)
    v_mfma_f32_16x16x16_bf16 v[68:71], v[16:17], v[32:33], 0
    ds_read_b64_tr_b16 v[14:15], v6 offset:256
    s_waitcnt lgkmcnt(6)
    v_mfma_f32_16x16x16_bf16 v[72:75], v[18:19], v[32:33], 0
    ds_read_b64_tr_b16 v[16:17], v7 offset:256
    s_waitcnt lgkmcnt(6)
    v_mfma_f32_16x16x16_bf16 v[76:79], v[20:21], v[32:33], 0
    ds_read_b64_tr_b16 v[18:19], v8 offset:256
    s_waitcnt lgkmcnt(6)
    v_mfma_f32_16x16x16_bf16 v[80:83], v[22:23], v[32:33], 0
    ds_read_b64_tr_b16 v[20:21], v9 offset:256
    s_waitcnt lgkmcnt(6)
    v_mfma_f32_16x16x16_bf16 v[84:87], v[24:25], v[32:33], 0
    ds_read_b64_tr_b16 v[22:23], v10 offset:256
    s_waitcnt lgkmcnt(6)
    v_mfma_f32_16x16x16_bf16 v[88:91], v[26:27], v[32:33], 0
    ds_read_b64_tr_b16 v[24:25], v11 offset:256
    s_waitcnt lgkmcnt(6)
    v_mfma_f32_16x16x16_bf16 v[92:95], v[28:29], v[32:33], 0
    ds_read_b64_tr_b16 v[26:27], v12 offset:256
    s_waitcnt lgkmcnt(6)
    v_mfma_f32_16x16x16_bf16 v[96:99], v[14:15], v[32:33], 0
    ds_read_b64_tr_b16 v[28:29], v13 offset:256
    s_waitcnt lgkmcnt(6)
    v_mfma_f32_16x16x16_bf16 v[100:103], v[16:17], v[32:33], 0
    s_waitcnt lgkmcnt(5)
    v_mfma_f32_16x16x16_bf16 v[104:107], v[18:19], v[32:33], 0
    s_waitcnt lgkmcnt(4)
    v_mfma_f32_16x16x16_bf16 v[108:111], v[20:21], v[32:33], 0
    s_waitcnt lgkmcnt(3)
    v_mfma_f32_16x16x16_bf16 v[112:115], v[22:23], v[32:33], 0
    s_waitcnt lgkmcnt(2)
    v_mfma_f32_16x16x16_bf16 v[116:119], v[24:25], v[32:33], 0
    s_waitcnt lgkmcnt(1)
    v_mfma_f32_16x16x16_bf16 v[120:123], v[26:27], v[32:33], 0
    s_waitcnt lgkmcnt(0)
    v_mfma_f32_16x16x16_bf16 v[124:127], v[28:29], v[32:33], 0
    s_add_u32 m0, s56, 0
    s_add_u32 s69, s57, 262144
    buffer_load_dwordx4 v2, s[16:19], s69 offen offset:0 nt lds
    buffer_load_dwordx4 v3, s[16:19], s69 offen offset:1024 nt lds
    buffer_load_dwordx4 v4, s[16:19], s69 offen offset:2048 nt lds
    buffer_load_dwordx4 v5, s[16:19], s69 offen offset:3072 nt lds
    s_add_u32 m0, s56, 4096
    s_add_u32 s69, s69, 4096
    buffer_load_dwordx4 v2, s[16:19], s69 offen offset:0 nt lds
    buffer_load_dwordx4 v3, s[16:19], s69 offen offset:1024 nt lds
    buffer_load_dwordx4 v4, s[16:19], s69 offen offset:2048 nt lds
    buffer_load_dwordx4 v5, s[16:19], s69 offen offset:3072 nt lds
    s_waitcnt vmcnt(8)
    ds_read_b64_tr_b16 v[14:15], v6 offset:8192
    ds_read_b64_tr_b16 v[16:17], v7 offset:8192
    ds_read_b64_tr_b16 v[18:19], v8 offset:8192
    ds_read_b64_tr_b16 v[20:21], v9 offset:8192
    ds_read_b64_tr_b16 v[22:23], v10 offset:8192
    ds_read_b64_tr_b16 v[24:25], v11 offset:8192
    ds_read_b64_tr_b16 v[26:27], v12 offset:8192
    ds_read_b64_tr_b16 v[28:29], v13 offset:8192
    s_waitcnt lgkmcnt(7)
    v_mfma_f32_16x16x16_bf16 v[64:67], v[14:15], v[34:35], v[64:67]
    s_waitcnt lgkmcnt(6)
    v_mfma_f32_16x16x16_bf16 v[68:71], v[16:17], v[34:35], v[68:71]
    ds_read_b64_tr_b16 v[14:15], v6 offset:8448
    s_waitcnt lgkmcnt(6)
    v_mfma_f32_16x16x16_bf16 v[72:75], v[18:19], v[34:35], v[72:75]
    ds_read_b64_tr_b16 v[16:17], v7 offset:8448
    s_waitcnt lgkmcnt(6)
    v_mfma_f32_16x16x16_bf16 v[76:79], v[20:21], v[34:35], v[76:79]
    ds_read_b64_tr_b16 v[18:19], v8 offset:8448
    s_waitcnt lgkmcnt(6)
    v_mfma_f32_16x16x16_bf16 v[80:83], v[22:23], v[34:35], v[80:83]
    ds_read_b64_tr_b16 v[20:21], v9 offset:8448
    s_waitcnt lgkmcnt(6)
    v_mfma_f32_16x16x16_bf16 v[84:87], v[24:25], v[34:35], v[84:87]
    ds_read_b64_tr_b16 v[22:23], v10 offset:8448
    s_waitcnt lgkmcnt(6)
    v_mfma_f32_16x16x16_bf16 v[88:91], v[26:27], v[34:35], v[88:91]
    ds_read_b64_tr_b16 v[24:25], v11 offset:8448
    s_waitcnt lgkmcnt(6)
    v_mfma_f32_16x16x16_bf16 v[92:95], v[28:29], v[34:35], v[92:95]
    ds_read_b64_tr_b16 v[26:27], v12 offset:8448
    s_waitcnt lgkmcnt(6)
    v_mfma_f32_16x16x16_bf16 v[96:99], v[14:15], v[34:35], v[96:99]
    ds_read_b64_tr_b16 v[28:29], v13 offset:8448
    s_waitcnt lgkmcnt(6)
    v_mfma_f32_16x16x16_bf16 v[100:103], v[16:17], v[34:35], v[100:103]
    s_waitcnt lgkmcnt(5)
    v_mfma_f32_16x16x16_bf16 v[104:107], v[18:19], v[34:35], v[104:107]
    s_waitcnt lgkmcnt(4)
    v_mfma_f32_16x16x16_bf16 v[108:111], v[20:21], v[34:35], v[108:111]
    s_waitcnt lgkmcnt(3)
    v_mfma_f32_16x16x16_bf16 v[112:115], v[22:23], v[34:35], v[112:115]
    s_waitcnt lgkmcnt(2)
    v_mfma_f32_16x16x16_bf16 v[116:119], v[24:25], v[34:35], v[116:119]
    s_waitcnt lgkmcnt(1)
    v_mfma_f32_16x16x16_bf16 v[120:123], v[26:27], v[34:35], v[120:123]
    s_waitcnt lgkmcnt(0)
    v_mfma_f32_16x16x16_bf16 v[124:127], v[28:29], v[34:35], v[124:127]
    s_add_u32 m0, s56, 8192
    s_add_u32 s69, s57, 393216
    buffer_load_dwordx4 v2, s[16:19], s69 offen offset:0 nt lds
    buffer_load_dwordx4 v3, s[16:19], s69 offen offset:1024 nt lds
    buffer_load_dwordx4 v4, s[16:19], s69 offen offset:2048 nt lds
    buffer_load_dwordx4 v5, s[16:19], s69 offen offset:3072 nt lds
    s_add_u32 m0, s56, 12288
    s_add_u32 s69, s69, 4096
    buffer_load_dwordx4 v2, s[16:19], s69 offen offset:0 nt lds
    buffer_load_dwordx4 v3, s[16:19], s69 offen offset:1024 nt lds
    buffer_load_dwordx4 v4, s[16:19], s69 offen offset:2048 nt lds
    buffer_load_dwordx4 v5, s[16:19], s69 offen offset:3072 nt lds
    s_waitcnt vmcnt(8)
    ds_read_b64_tr_b16 v[14:15], v6 offset:0
    ds_read_b64_tr_b16 v[16:17], v7 offset:0
    ds_read_b64_tr_b16 v[18:19], v8 offset:0
    ds_read_b64_tr_b16 v[20:21], v9 offset:0
    ds_read_b64_tr_b16 v[22:23], v10 offset:0
    ds_read_b64_tr_b16 v[24:25], v11 offset:0
    ds_read_b64_tr_b16 v[26:27], v12 offset:0
    ds_read_b64_tr_b16 v[28:29], v13 offset:0
    s_waitcnt lgkmcnt(7)
    v_mfma_f32_16x16x16_bf16 v[64:67], v[14:15], v[36:37], v[64:67]
    s_waitcnt lgkmcnt(6)
    v_mfma_f32_16x16x16_bf16 v[68:71], v[16:17], v[36:37], v[68:71]
    ds_read_b64_tr_b16 v[14:15], v6 offset:256
    s_waitcnt lgkmcnt(6)
    v_mfma_f32_16x16x16_bf16 v[72:75], v[18:19], v[36:37], v[72:75]
    ds_read_b64_tr_b16 v[16:17], v7 offset:256
    s_waitcnt lgkmcnt(6)
    v_mfma_f32_16x16x16_bf16 v[76:79], v[20:21], v[36:37], v[76:79]
    ds_read_b64_tr_b16 v[18:19], v8 offset:256
    s_waitcnt lgkmcnt(6)
    v_mfma_f32_16x16x16_bf16 v[80:83], v[22:23], v[36:37], v[80:83]
    ds_read_b64_tr_b16 v[20:21], v9 offset:256
    s_waitcnt lgkmcnt(6)
    v_mfma_f32_16x16x16_bf16 v[84:87], v[24:25], v[36:37], v[84:87]
    ds_read_b64_tr_b16 v[22:23], v10 offset:256
    s_waitcnt lgkmcnt(6)
    v_mfma_f32_16x16x16_bf16 v[88:91], v[26:27], v[36:37], v[88:91]
    ds_read_b64_tr_b16 v[24:25], v11 offset:256
    s_waitcnt lgkmcnt(6)
    v_mfma_f32_16x16x16_bf16 v[92:95], v[28:29], v[36:37], v[92:95]
    ds_read_b64_tr_b16 v[26:27], v12 offset:256
    s_waitcnt lgkmcnt(6)
    v_mfma_f32_16x16x16_bf16 v[96:99], v[14:15], v[36:37], v[96:99]
    ds_read_b64_tr_b16 v[28:29], v13 offset:256
    s_waitcnt lgkmcnt(6)
    v_mfma_f32_16x16x16_bf16 v[100:103], v[16:17], v[36:37], v[100:103]
    s_waitcnt lgkmcnt(5)
    v_mfma_f32_16x16x16_bf16 v[104:107], v[18:19], v[36:37], v[104:107]
    s_waitcnt lgkmcnt(4)
    v_mfma_f32_16x16x16_bf16 v[108:111], v[20:21], v[36:37], v[108:111]
    s_waitcnt lgkmcnt(3)
    v_mfma_f32_16x16x16_bf16 v[112:115], v[22:23], v[36:37], v[112:115]
    s_waitcnt lgkmcnt(2)
    v_mfma_f32_16x16x16_bf16 v[116:119], v[24:25], v[36:37], v[116:119]
    s_waitcnt lgkmcnt(1)
    v_mfma_f32_16x16x16_bf16 v[120:123], v[26:27], v[36:37], v[120:123]
    s_waitcnt lgkmcnt(0)
    v_mfma_f32_16x16x16_bf16 v[124:127], v[28:29], v[36:37], v[124:127]
    s_add_u32 m0, s56, 0
    s_add_u32 s69, s57, 524288
    buffer_load_dwordx4 v2, s[16:19], s69 offen offset:0 nt lds
    buffer_load_dwordx4 v3, s[16:19], s69 offen offset:1024 nt lds
    buffer_load_dwordx4 v4, s[16:19], s69 offen offset:2048 nt lds
    buffer_load_dwordx4 v5, s[16:19], s69 offen offset:3072 nt lds
    s_add_u32 m0, s56, 4096
    s_add_u32 s69, s69, 4096
    buffer_load_dwordx4 v2, s[16:19], s69 offen offset:0 nt lds
    buffer_load_dwordx4 v3, s[16:19], s69 offen offset:1024 nt lds
    buffer_load_dwordx4 v4, s[16:19], s69 offen offset:2048 nt lds
    buffer_load_dwordx4 v5, s[16:19], s69 offen offset:3072 nt lds
    s_waitcnt vmcnt(8)
    ds_read_b64_tr_b16 v[14:15], v6 offset:8192
    ds_read_b64_tr_b16 v[16:17], v7 offset:8192
    ds_read_b64_tr_b16 v[18:19], v8 offset:8192
    ds_read_b64_tr_b16 v[20:21], v9 offset:8192
    ds_read_b64_tr_b16 v[22:23], v10 offset:8192
    ds_read_b64_tr_b16 v[24:25], v11 offset:8192
    ds_read_b64_tr_b16 v[26:27], v12 offset:8192
    ds_read_b64_tr_b16 v[28:29], v13 offset:8192
    s_waitcnt lgkmcnt(7)
    v_mfma_f32_16x16x16_bf16 v[64:67], v[14:15], v[38:39], v[64:67]
    s_waitcnt lgkmcnt(6)
    v_mfma_f32_16x16x16_bf16 v[68:71], v[16:17], v[38:39], v[68:71]
    ds_read_b64_tr_b16 v[14:15], v6 offset:8448
    s_waitcnt lgkmcnt(6)
    v_mfma_f32_16x16x16_bf16 v[72:75], v[18:19], v[38:39], v[72:75]
    ds_read_b64_tr_b16 v[16:17], v7 offset:8448
    s_waitcnt lgkmcnt(6)
    v_mfma_f32_16x16x16_bf16 v[76:79], v[20:21], v[38:39], v[76:79]
    ds_read_b64_tr_b16 v[18:19], v8 offset:8448
    s_waitcnt lgkmcnt(6)
    v_mfma_f32_16x16x16_bf16 v[80:83], v[22:23], v[38:39], v[80:83]
    ds_read_b64_tr_b16 v[20:21], v9 offset:8448
    s_waitcnt lgkmcnt(6)
    v_mfma_f32_16x16x16_bf16 v[84:87], v[24:25], v[38:39], v[84:87]
    ds_read_b64_tr_b16 v[22:23], v10 offset:8448
    s_waitcnt lgkmcnt(6)
    v_mfma_f32_16x16x16_bf16 v[88:91], v[26:27], v[38:39], v[88:91]
    ds_read_b64_tr_b16 v[24:25], v11 offset:8448
    s_waitcnt lgkmcnt(6)
    v_mfma_f32_16x16x16_bf16 v[92:95], v[28:29], v[38:39], v[92:95]
    ds_read_b64_tr_b16 v[26:27], v12 offset:8448
    s_waitcnt lgkmcnt(6)
    v_mfma_f32_16x16x16_bf16 v[96:99], v[14:15], v[38:39], v[96:99]
    ds_read_b64_tr_b16 v[28:29], v13 offset:8448
    s_waitcnt lgkmcnt(6)
    v_mfma_f32_16x16x16_bf16 v[100:103], v[16:17], v[38:39], v[100:103]
    s_waitcnt lgkmcnt(5)
    v_mfma_f32_16x16x16_bf16 v[104:107], v[18:19], v[38:39], v[104:107]
    s_waitcnt lgkmcnt(4)
    v_mfma_f32_16x16x16_bf16 v[108:111], v[20:21], v[38:39], v[108:111]
    s_waitcnt lgkmcnt(3)
    v_mfma_f32_16x16x16_bf16 v[112:115], v[22:23], v[38:39], v[112:115]
    s_waitcnt lgkmcnt(2)
    v_mfma_f32_16x16x16_bf16 v[116:119], v[24:25], v[38:39], v[116:119]
    s_waitcnt lgkmcnt(1)
    v_mfma_f32_16x16x16_bf16 v[120:123], v[26:27], v[38:39], v[120:123]
    s_waitcnt lgkmcnt(0)
    v_mfma_f32_16x16x16_bf16 v[124:127], v[28:29], v[38:39], v[124:127]
    s_add_u32 m0, s56, 8192
    s_add_u32 s69, s57, 655360
    buffer_load_dwordx4 v2, s[16:19], s69 offen offset:0 nt lds
    buffer_load_dwordx4 v3, s[16:19], s69 offen offset:1024 nt lds
    buffer_load_dwordx4 v4, s[16:19], s69 offen offset:2048 nt lds
    buffer_load_dwordx4 v5, s[16:19], s69 offen offset:3072 nt lds
    s_add_u32 m0, s56, 12288
    s_add_u32 s69, s69, 4096
    buffer_load_dwordx4 v2, s[16:19], s69 offen offset:0 nt lds
    buffer_load_dwordx4 v3, s[16:19], s69 offen offset:1024 nt lds
    buffer_load_dwordx4 v4, s[16:19], s69 offen offset:2048 nt lds
    buffer_load_dwordx4 v5, s[16:19], s69 offen offset:3072 nt lds
    s_waitcnt vmcnt(8)
    ds_read_b64_tr_b16 v[14:15], v6 offset:0
    ds_read_b64_tr_b16 v[16:17], v7 offset:0
    ds_read_b64_tr_b16 v[18:19], v8 offset:0
    ds_read_b64_tr_b16 v[20:21], v9 offset:0
    ds_read_b64_tr_b16 v[22:23], v10 offset:0
    ds_read_b64_tr_b16 v[24:25], v11 offset:0
    ds_read_b64_tr_b16 v[26:27], v12 offset:0
    ds_read_b64_tr_b16 v[28:29], v13 offset:0
    s_waitcnt lgkmcnt(7)
    v_mfma_f32_16x16x16_bf16 v[64:67], v[14:15], v[40:41], v[64:67]
    s_waitcnt lgkmcnt(6)
    v_mfma_f32_16x16x16_bf16 v[68:71], v[16:17], v[40:41], v[68:71]
    ds_read_b64_tr_b16 v[14:15], v6 offset:256
    s_waitcnt lgkmcnt(6)
    v_mfma_f32_16x16x16_bf16 v[72:75], v[18:19], v[40:41], v[72:75]
    ds_read_b64_tr_b16 v[16:17], v7 offset:256
    s_waitcnt lgkmcnt(6)
    v_mfma_f32_16x16x16_bf16 v[76:79], v[20:21], v[40:41], v[76:79]
    ds_read_b64_tr_b16 v[18:19], v8 offset:256
    s_waitcnt lgkmcnt(6)
    v_mfma_f32_16x16x16_bf16 v[80:83], v[22:23], v[40:41], v[80:83]
    ds_read_b64_tr_b16 v[20:21], v9 offset:256
    s_waitcnt lgkmcnt(6)
    v_mfma_f32_16x16x16_bf16 v[84:87], v[24:25], v[40:41], v[84:87]
    ds_read_b64_tr_b16 v[22:23], v10 offset:256
    s_waitcnt lgkmcnt(6)
    v_mfma_f32_16x16x16_bf16 v[88:91], v[26:27], v[40:41], v[88:91]
    ds_read_b64_tr_b16 v[24:25], v11 offset:256
    s_waitcnt lgkmcnt(6)
    v_mfma_f32_16x16x16_bf16 v[92:95], v[28:29], v[40:41], v[92:95]
    ds_read_b64_tr_b16 v[26:27], v12 offset:256
    s_waitcnt lgkmcnt(6)
    v_mfma_f32_16x16x16_bf16 v[96:99], v[14:15], v[40:41], v[96:99]
    ds_read_b64_tr_b16 v[28:29], v13 offset:256
    s_waitcnt lgkmcnt(6)
    v_mfma_f32_16x16x16_bf16 v[100:103], v[16:17], v[40:41], v[100:103]
    s_waitcnt lgkmcnt(5)
    v_mfma_f32_16x16x16_bf16 v[104:107], v[18:19], v[40:41], v[104:107]
    s_waitcnt lgkmcnt(4)
    v_mfma_f32_16x16x16_bf16 v[108:111], v[20:21], v[40:41], v[108:111]
    s_waitcnt lgkmcnt(3)
    v_mfma_f32_16x16x16_bf16 v[112:115], v[22:23], v[40:41], v[112:115]
    s_waitcnt lgkmcnt(2)
    v_mfma_f32_16x16x16_bf16 v[116:119], v[24:25], v[40:41], v[116:119]
    s_waitcnt lgkmcnt(1)
    v_mfma_f32_16x16x16_bf16 v[120:123], v[26:27], v[40:41], v[120:123]
    s_waitcnt lgkmcnt(0)
    v_mfma_f32_16x16x16_bf16 v[124:127], v[28:29], v[40:41], v[124:127]
    s_add_u32 m0, s56, 0
    s_add_u32 s69, s57, 786432
    buffer_load_dwordx4 v2, s[16:19], s69 offen offset:0 nt lds
    buffer_load_dwordx4 v3, s[16:19], s69 offen offset:1024 nt lds
    buffer_load_dwordx4 v4, s[16:19], s69 offen offset:2048 nt lds
    buffer_load_dwordx4 v5, s[16:19], s69 offen offset:3072 nt lds
    s_add_u32 m0, s56, 4096
    s_add_u32 s69, s69, 4096
    buffer_load_dwordx4 v2, s[16:19], s69 offen offset:0 nt lds
    buffer_load_dwordx4 v3, s[16:19], s69 offen offset:1024 nt lds
    buffer_load_dwordx4 v4, s[16:19], s69 offen offset:2048 nt lds
    buffer_load_dwordx4 v5, s[16:19], s69 offen offset:3072 nt lds
    s_waitcnt vmcnt(8)
    ds_read_b64_tr_b16 v[14:15], v6 offset:8192
    ds_read_b64_tr_b16 v[16:17], v7 offset:8192
    ds_read_b64_tr_b16 v[18:19], v8 offset:8192
    ds_read_b64_tr_b16 v[20:21], v9 offset:8192
    ds_read_b64_tr_b16 v[22:23], v10 offset:8192
    ds_read_b64_tr_b16 v[24:25], v11 offset:8192
    ds_read_b64_tr_b16 v[26:27], v12 offset:8192
    ds_read_b64_tr_b16 v[28:29], v13 offset:8192
    s_waitcnt lgkmcnt(7)
    v_mfma_f32_16x16x16_bf16 v[64:67], v[14:15], v[42:43], v[64:67]
    s_waitcnt lgkmcnt(6)
    v_mfma_f32_16x16x16_bf16 v[68:71], v[16:17], v[42:43], v[68:71]
    ds_read_b64_tr_b16 v[14:15], v6 offset:8448
    s_waitcnt lgkmcnt(6)
    v_mfma_f32_16x16x16_bf16 v[72:75], v[18:19], v[42:43], v[72:75]
    ds_read_b64_tr_b16 v[16:17], v7 offset:8448
    s_waitcnt lgkmcnt(6)
    v_mfma_f32_16x16x16_bf16 v[76:79], v[20:21], v[42:43], v[76:79]
    ds_read_b64_tr_b16 v[18:19], v8 offset:8448
    s_waitcnt lgkmcnt(6)
    v_mfma_f32_16x16x16_bf16 v[80:83], v[22:23], v[42:43], v[80:83]
    ds_read_b64_tr_b16 v[20:21], v9 offset:8448
    s_waitcnt lgkmcnt(6)
    v_mfma_f32_16x16x16_bf16 v[84:87], v[24:25], v[42:43], v[84:87]
    ds_read_b64_tr_b16 v[22:23], v10 offset:8448
    s_waitcnt lgkmcnt(6)
    v_mfma_f32_16x16x16_bf16 v[88:91], v[26:27], v[42:43], v[88:91]
    ds_read_b64_tr_b16 v[24:25], v11 offset:8448
    s_waitcnt lgkmcnt(6)
    v_mfma_f32_16x16x16_bf16 v[92:95], v[28:29], v[42:43], v[92:95]
    ds_read_b64_tr_b16 v[26:27], v12 offset:8448
    s_waitcnt lgkmcnt(6)
    v_mfma_f32_16x16x16_bf16 v[96:99], v[14:15], v[42:43], v[96:99]
    ds_read_b64_tr_b16 v[28:29], v13 offset:8448
    s_waitcnt lgkmcnt(6)
    v_mfma_f32_16x16x16_bf16 v[100:103], v[16:17], v[42:43], v[100:103]
    s_waitcnt lgkmcnt(5)
    v_mfma_f32_16x16x16_bf16 v[104:107], v[18:19], v[42:43], v[104:107]
    s_waitcnt lgkmcnt(4)
    v_mfma_f32_16x16x16_bf16 v[108:111], v[20:21], v[42:43], v[108:111]
    s_waitcnt lgkmcnt(3)
    v_mfma_f32_16x16x16_bf16 v[112:115], v[22:23], v[42:43], v[112:115]
    s_waitcnt lgkmcnt(2)
    v_mfma_f32_16x16x16_bf16 v[116:119], v[24:25], v[42:43], v[116:119]
    s_waitcnt lgkmcnt(1)
    v_mfma_f32_16x16x16_bf16 v[120:123], v[26:27], v[42:43], v[120:123]
    s_waitcnt lgkmcnt(0)
    v_mfma_f32_16x16x16_bf16 v[124:127], v[28:29], v[42:43], v[124:127]
    s_add_u32 m0, s56, 8192
    s_add_u32 s69, s57, 917504
    buffer_load_dwordx4 v2, s[16:19], s69 offen offset:0 nt lds
    buffer_load_dwordx4 v3, s[16:19], s69 offen offset:1024 nt lds
    buffer_load_dwordx4 v4, s[16:19], s69 offen offset:2048 nt lds
    buffer_load_dwordx4 v5, s[16:19], s69 offen offset:3072 nt lds
    s_add_u32 m0, s56, 12288
    s_add_u32 s69, s69, 4096
    buffer_load_dwordx4 v2, s[16:19], s69 offen offset:0 nt lds
    buffer_load_dwordx4 v3, s[16:19], s69 offen offset:1024 nt lds
    buffer_load_dwordx4 v4, s[16:19], s69 offen offset:2048 nt lds
    buffer_load_dwordx4 v5, s[16:19], s69 offen offset:3072 nt lds
    s_waitcnt vmcnt(8)
    ds_read_b64_tr_b16 v[14:15], v6 offset:0
    ds_read_b64_tr_b16 v[16:17], v7 offset:0
    ds_read_b64_tr_b16 v[18:19], v8 offset:0
    ds_read_b64_tr_b16 v[20:21], v9 offset:0
    ds_read_b64_tr_b16 v[22:23], v10 offset:0
    ds_read_b64_tr_b16 v[24:25], v11 offset:0
    ds_read_b64_tr_b16 v[26:27], v12 offset:0
    ds_read_b64_tr_b16 v[28:29], v13 offset:0
    s_waitcnt lgkmcnt(7)
    v_mfma_f32_16x16x16_bf16 v[64:67], v[14:15], v[44:45], v[64:67]
    s_waitcnt lgkmcnt(6)
    v_mfma_f32_16x16x16_bf16 v[68:71], v[16:17], v[44:45], v[68:71]
    ds_read_b64_tr_b16 v[14:15], v6 offset:256
    s_waitcnt lgkmcnt(6)
    v_mfma_f32_16x16x16_bf16 v[72:75], v[18:19], v[44:45], v[72:75]
    ds_read_b64_tr_b16 v[16:17], v7 offset:256
    s_waitcnt lgkmcnt(6)
    v_mfma_f32_16x16x16_bf16 v[76:79], v[20:21], v[44:45], v[76:79]
    ds_read_b64_tr_b16 v[18:19], v8 offset:256
    s_waitcnt lgkmcnt(6)
    v_mfma_f32_16x16x16_bf16 v[80:83], v[22:23], v[44:45], v[80:83]
    ds_read_b64_tr_b16 v[20:21], v9 offset:256
    s_waitcnt lgkmcnt(6)
    v_mfma_f32_16x16x16_bf16 v[84:87], v[24:25], v[44:45], v[84:87]
    ds_read_b64_tr_b16 v[22:23], v10 offset:256
    s_waitcnt lgkmcnt(6)
    v_mfma_f32_16x16x16_bf16 v[88:91], v[26:27], v[44:45], v[88:91]
    ds_read_b64_tr_b16 v[24:25], v11 offset:256
    s_waitcnt lgkmcnt(6)
    v_mfma_f32_16x16x16_bf16 v[92:95], v[28:29], v[44:45], v[92:95]
    ds_read_b64_tr_b16 v[26:27], v12 offset:256
    s_waitcnt lgkmcnt(6)
    v_mfma_f32_16x16x16_bf16 v[96:99], v[14:15], v[44:45], v[96:99]
    ds_read_b64_tr_b16 v[28:29], v13 offset:256
    s_waitcnt lgkmcnt(6)
    v_mfma_f32_16x16x16_bf16 v[100:103], v[16:17], v[44:45], v[100:103]
    s_waitcnt lgkmcnt(5)
    v_mfma_f32_16x16x16_bf16 v[104:107], v[18:19], v[44:45], v[104:107]
    s_waitcnt lgkmcnt(4)
    v_mfma_f32_16x16x16_bf16 v[108:111], v[20:21], v[44:45], v[108:111]
    s_waitcnt lgkmcnt(3)
    v_mfma_f32_16x16x16_bf16 v[112:115], v[22:23], v[44:45], v[112:115]
    s_waitcnt lgkmcnt(2)
    v_mfma_f32_16x16x16_bf16 v[116:119], v[24:25], v[44:45], v[116:119]
    s_waitcnt lgkmcnt(1)
    v_mfma_f32_16x16x16_bf16 v[120:123], v[26:27], v[44:45], v[120:123]
    s_waitcnt lgkmcnt(0)
    v_mfma_f32_16x16x16_bf16 v[124:127], v[28:29], v[44:45], v[124:127]
    s_add_u32 m0, s56, 0
    s_add_u32 s69, s57, 1048576
    buffer_load_dwordx4 v2, s[16:19], s69 offen offset:0 nt lds
    buffer_load_dwordx4 v3, s[16:19], s69 offen offset:1024 nt lds
    buffer_load_dwordx4 v4, s[16:19], s69 offen offset:2048 nt lds
    buffer_load_dwordx4 v5, s[16:19], s69 offen offset:3072 nt lds
    s_add_u32 m0, s56, 4096
    s_add_u32 s69, s69, 4096
    buffer_load_dwordx4 v2, s[16:19], s69 offen offset:0 nt lds
    buffer_load_dwordx4 v3, s[16:19], s69 offen offset:1024 nt lds
    buffer_load_dwordx4 v4, s[16:19], s69 offen offset:2048 nt lds
    buffer_load_dwordx4 v5, s[16:19], s69 offen offset:3072 nt lds
    s_waitcnt vmcnt(8)
    ds_read_b64_tr_b16 v[14:15], v6 offset:8192
    ds_read_b64_tr_b16 v[16:17], v7 offset:8192
    ds_read_b64_tr_b16 v[18:19], v8 offset:8192
    ds_read_b64_tr_b16 v[20:21], v9 offset:8192
    ds_read_b64_tr_b16 v[22:23], v10 offset:8192
    ds_read_b64_tr_b16 v[24:25], v11 offset:8192
    ds_read_b64_tr_b16 v[26:27], v12 offset:8192
    ds_read_b64_tr_b16 v[28:29], v13 offset:8192
    s_waitcnt lgkmcnt(7)
    v_mfma_f32_16x16x16_bf16 v[64:67], v[14:15], v[46:47], v[64:67]
    s_waitcnt lgkmcnt(6)
    v_mfma_f32_16x16x16_bf16 v[68:71], v[16:17], v[46:47], v[68:71]
    ds_read_b64_tr_b16 v[14:15], v6 offset:8448
    s_waitcnt lgkmcnt(6)
    v_mfma_f32_16x16x16_bf16 v[72:75], v[18:19], v[46:47], v[72:75]
    ds_read_b64_tr_b16 v[16:17], v7 offset:8448
    s_waitcnt lgkmcnt(6)
    v_mfma_f32_16x16x16_bf16 v[76:79], v[20:21], v[46:47], v[76:79]
    ds_read_b64_tr_b16 v[18:19], v8 offset:8448
    s_waitcnt lgkmcnt(6)
    v_mfma_f32_16x16x16_bf16 v[80:83], v[22:23], v[46:47], v[80:83]
    ds_read_b64_tr_b16 v[20:21], v9 offset:8448
    s_waitcnt lgkmcnt(6)
    v_mfma_f32_16x16x16_bf16 v[84:87], v[24:25], v[46:47], v[84:87]
    ds_read_b64_tr_b16 v[22:23], v10 offset:8448
    s_waitcnt lgkmcnt(6)
    v_mfma_f32_16x16x16_bf16 v[88:91], v[26:27], v[46:47], v[88:91]
    ds_read_b64_tr_b16 v[24:25], v11 offset:8448
    s_waitcnt lgkmcnt(6)
    v_mfma_f32_16x16x16_bf16 v[92:95], v[28:29], v[46:47], v[92:95]
    ds_read_b64_tr_b16 v[26:27], v12 offset:8448
    s_waitcnt lgkmcnt(6)
    v_mfma_f32_16x16x16_bf16 v[96:99], v[14:15], v[46:47], v[96:99]
    ds_read_b64_tr_b16 v[28:29], v13 offset:8448
    s_waitcnt lgkmcnt(6)
    v_mfma_f32_16x16x16_bf16 v[100:103], v[16:17], v[46:47], v[100:103]
    s_waitcnt lgkmcnt(5)
    v_mfma_f32_16x16x16_bf16 v[104:107], v[18:19], v[46:47], v[104:107]
    s_waitcnt lgkmcnt(4)
    v_mfma_f32_16x16x16_bf16 v[108:111], v[20:21], v[46:47], v[108:111]
    s_waitcnt lgkmcnt(3)
    v_mfma_f32_16x16x16_bf16 v[112:115], v[22:23], v[46:47], v[112:115]
    s_waitcnt lgkmcnt(2)
    v_mfma_f32_16x16x16_bf16 v[116:119], v[24:25], v[46:47], v[116:119]
    s_waitcnt lgkmcnt(1)
    v_mfma_f32_16x16x16_bf16 v[120:123], v[26:27], v[46:47], v[120:123]
    s_waitcnt lgkmcnt(0)
    v_mfma_f32_16x16x16_bf16 v[124:127], v[28:29], v[46:47], v[124:127]
    s_add_u32 m0, s56, 8192
    s_add_u32 s69, s57, 1179648
    buffer_load_dwordx4 v2, s[16:19], s69 offen offset:0 nt lds
    buffer_load_dwordx4 v3, s[16:19], s69 offen offset:1024 nt lds
    buffer_load_dwordx4 v4, s[16:19], s69 offen offset:2048 nt lds
    buffer_load_dwordx4 v5, s[16:19], s69 offen offset:3072 nt lds
    s_add_u32 m0, s56, 12288
    s_add_u32 s69, s69, 4096
    buffer_load_dwordx4 v2, s[16:19], s69 offen offset:0 nt lds
    buffer_load_dwordx4 v3, s[16:19], s69 offen offset:1024 nt lds
    buffer_load_dwordx4 v4, s[16:19], s69 offen offset:2048 nt lds
    buffer_load_dwordx4 v5, s[16:19], s69 offen offset:3072 nt lds
    s_waitcnt vmcnt(8)
    ds_read_b64_tr_b16 v[14:15], v6 offset:0
    ds_read_b64_tr_b16 v[16:17], v7 offset:0
    ds_read_b64_tr_b16 v[18:19], v8 offset:0
    ds_read_b64_tr_b16 v[20:21], v9 offset:0
    ds_read_b64_tr_b16 v[22:23], v10 offset:0
    ds_read_b64_tr_b16 v[24:25], v11 offset:0
    ds_read_b64_tr_b16 v[26:27], v12 offset:0
    ds_read_b64_tr_b16 v[28:29], v13 offset:0
    s_waitcnt lgkmcnt(7)
    v_mfma_f32_16x16x16_bf16 v[64:67], v[14:15], v[48:49], v[64:67]
    s_waitcnt lgkmcnt(6)
    v_mfma_f32_16x16x16_bf16 v[68:71], v[16:17], v[48:49], v[68:71]
    ds_read_b64_tr_b16 v[14:15], v6 offset:256
    s_waitcnt lgkmcnt(6)
    v_mfma_f32_16x16x16_bf16 v[72:75], v[18:19], v[48:49], v[72:75]
    ds_read_b64_tr_b16 v[16:17], v7 offset:256
    s_waitcnt lgkmcnt(6)
    v_mfma_f32_16x16x16_bf16 v[76:79], v[20:21], v[48:49], v[76:79]
    ds_read_b64_tr_b16 v[18:19], v8 offset:256
    s_waitcnt lgkmcnt(6)
    v_mfma_f32_16x16x16_bf16 v[80:83], v[22:23], v[48:49], v[80:83]
    ds_read_b64_tr_b16 v[20:21], v9 offset:256
    s_waitcnt lgkmcnt(6)
    v_mfma_f32_16x16x16_bf16 v[84:87], v[24:25], v[48:49], v[84:87]
    ds_read_b64_tr_b16 v[22:23], v10 offset:256
    s_waitcnt lgkmcnt(6)
    v_mfma_f32_16x16x16_bf16 v[88:91], v[26:27], v[48:49], v[88:91]
    ds_read_b64_tr_b16 v[24:25], v11 offset:256
    s_waitcnt lgkmcnt(6)
    v_mfma_f32_16x16x16_bf16 v[92:95], v[28:29], v[48:49], v[92:95]
    ds_read_b64_tr_b16 v[26:27], v12 offset:256
    s_waitcnt lgkmcnt(6)
    v_mfma_f32_16x16x16_bf16 v[96:99], v[14:15], v[48:49], v[96:99]
    ds_read_b64_tr_b16 v[28:29], v13 offset:256
    s_waitcnt lgkmcnt(6)
    v_mfma_f32_16x16x16_bf16 v[100:103], v[16:17], v[48:49], v[100:103]
    s_waitcnt lgkmcnt(5)
    v_mfma_f32_16x16x16_bf16 v[104:107], v[18:19], v[48:49], v[104:107]
    s_waitcnt lgkmcnt(4)
    v_mfma_f32_16x16x16_bf16 v[108:111], v[20:21], v[48:49], v[108:111]
    s_waitcnt lgkmcnt(3)
    v_mfma_f32_16x16x16_bf16 v[112:115], v[22:23], v[48:49], v[112:115]
    s_waitcnt lgkmcnt(2)
    v_mfma_f32_16x16x16_bf16 v[116:119], v[24:25], v[48:49], v[116:119]
    s_waitcnt lgkmcnt(1)
    v_mfma_f32_16x16x16_bf16 v[120:123], v[26:27], v[48:49], v[120:123]
    s_waitcnt lgkmcnt(0)
    v_mfma_f32_16x16x16_bf16 v[124:127], v[28:29], v[48:49], v[124:127]
    s_add_u32 m0, s56, 0
    s_add_u32 s69, s57, 1310720
    buffer_load_dwordx4 v2, s[16:19], s69 offen offset:0 nt lds
    buffer_load_dwordx4 v3, s[16:19], s69 offen offset:1024 nt lds
    buffer_load_dwordx4 v4, s[16:19], s69 offen offset:2048 nt lds
    buffer_load_dwordx4 v5, s[16:19], s69 offen offset:3072 nt lds
    s_add_u32 m0, s56, 4096
    s_add_u32 s69, s69, 4096
    buffer_load_dwordx4 v2, s[16:19], s69 offen offset:0 nt lds
    buffer_load_dwordx4 v3, s[16:19], s69 offen offset:1024 nt lds
    buffer_load_dwordx4 v4, s[16:19], s69 offen offset:2048 nt lds
    buffer_load_dwordx4 v5, s[16:19], s69 offen offset:3072 nt lds
    s_waitcnt vmcnt(8)
    ds_read_b64_tr_b16 v[14:15], v6 offset:8192
    ds_read_b64_tr_b16 v[16:17], v7 offset:8192
    ds_read_b64_tr_b16 v[18:19], v8 offset:8192
    ds_read_b64_tr_b16 v[20:21], v9 offset:8192
    ds_read_b64_tr_b16 v[22:23], v10 offset:8192
    ds_read_b64_tr_b16 v[24:25], v11 offset:8192
    ds_read_b64_tr_b16 v[26:27], v12 offset:8192
    ds_read_b64_tr_b16 v[28:29], v13 offset:8192
    s_waitcnt lgkmcnt(7)
    v_mfma_f32_16x16x16_bf16 v[64:67], v[14:15], v[50:51], v[64:67]
    s_waitcnt lgkmcnt(6)
    v_mfma_f32_16x16x16_bf16 v[68:71], v[16:17], v[50:51], v[68:71]
    ds_read_b64_tr_b16 v[14:15], v6 offset:8448
    s_waitcnt lgkmcnt(6)
    v_mfma_f32_16x16x16_bf16 v[72:75], v[18:19], v[50:51], v[72:75]
    ds_read_b64_tr_b16 v[16:17], v7 offset:8448
    s_waitcnt lgkmcnt(6)
    v_mfma_f32_16x16x16_bf16 v[76:79], v[20:21], v[50:51], v[76:79]
    ds_read_b64_tr_b16 v[18:19], v8 offset:8448
    s_waitcnt lgkmcnt(6)
    v_mfma_f32_16x16x16_bf16 v[80:83], v[22:23], v[50:51], v[80:83]
    ds_read_b64_tr_b16 v[20:21], v9 offset:8448
    s_waitcnt lgkmcnt(6)
    v_mfma_f32_16x16x16_bf16 v[84:87], v[24:25], v[50:51], v[84:87]
    ds_read_b64_tr_b16 v[22:23], v10 offset:8448
    s_waitcnt lgkmcnt(6)
    v_mfma_f32_16x16x16_bf16 v[88:91], v[26:27], v[50:51], v[88:91]
    ds_read_b64_tr_b16 v[24:25], v11 offset:8448
    s_waitcnt lgkmcnt(6)
    v_mfma_f32_16x16x16_bf16 v[92:95], v[28:29], v[50:51], v[92:95]
    ds_read_b64_tr_b16 v[26:27], v12 offset:8448
    s_waitcnt lgkmcnt(6)
    v_mfma_f32_16x16x16_bf16 v[96:99], v[14:15], v[50:51], v[96:99]
    ds_read_b64_tr_b16 v[28:29], v13 offset:8448
    s_waitcnt lgkmcnt(6)
    v_mfma_f32_16x16x16_bf16 v[100:103], v[16:17], v[50:51], v[100:103]
    s_waitcnt lgkmcnt(5)
    v_mfma_f32_16x16x16_bf16 v[104:107], v[18:19], v[50:51], v[104:107]
    s_waitcnt lgkmcnt(4)
    v_mfma_f32_16x16x16_bf16 v[108:111], v[20:21], v[50:51], v[108:111]
    s_waitcnt lgkmcnt(3)
    v_mfma_f32_16x16x16_bf16 v[112:115], v[22:23], v[50:51], v[112:115]
    s_waitcnt lgkmcnt(2)
    v_mfma_f32_16x16x16_bf16 v[116:119], v[24:25], v[50:51], v[116:119]
    s_waitcnt lgkmcnt(1)
    v_mfma_f32_16x16x16_bf16 v[120:123], v[26:27], v[50:51], v[120:123]
    s_waitcnt lgkmcnt(0)
    v_mfma_f32_16x16x16_bf16 v[124:127], v[28:29], v[50:51], v[124:127]
    s_add_u32 m0, s56, 8192
    s_add_u32 s69, s57, 1441792
    buffer_load_dwordx4 v2, s[16:19], s69 offen offset:0 nt lds
    buffer_load_dwordx4 v3, s[16:19], s69 offen offset:1024 nt lds
    buffer_load_dwordx4 v4, s[16:19], s69 offen offset:2048 nt lds
    buffer_load_dwordx4 v5, s[16:19], s69 offen offset:3072 nt lds
    s_add_u32 m0, s56, 12288
    s_add_u32 s69, s69, 4096
    buffer_load_dwordx4 v2, s[16:19], s69 offen offset:0 nt lds
    buffer_load_dwordx4 v3, s[16:19], s69 offen offset:1024 nt lds
    buffer_load_dwordx4 v4, s[16:19], s69 offen offset:2048 nt lds
    buffer_load_dwordx4 v5, s[16:19], s69 offen offset:3072 nt lds
    s_waitcnt vmcnt(8)
    ds_read_b64_tr_b16 v[14:15], v6 offset:0
    ds_read_b64_tr_b16 v[16:17], v7 offset:0
    ds_read_b64_tr_b16 v[18:19], v8 offset:0
    ds_read_b64_tr_b16 v[20:21], v9 offset:0
    ds_read_b64_tr_b16 v[22:23], v10 offset:0
    ds_read_b64_tr_b16 v[24:25], v11 offset:0
    ds_read_b64_tr_b16 v[26:27], v12 offset:0
    ds_read_b64_tr_b16 v[28:29], v13 offset:0
    s_waitcnt lgkmcnt(7)
    v_mfma_f32_16x16x16_bf16 v[64:67], v[14:15], v[52:53], v[64:67]
    s_waitcnt lgkmcnt(6)
    v_mfma_f32_16x16x16_bf16 v[68:71], v[16:17], v[52:53], v[68:71]
    ds_read_b64_tr_b16 v[14:15], v6 offset:256
    s_waitcnt lgkmcnt(6)
    v_mfma_f32_16x16x16_bf16 v[72:75], v[18:19], v[52:53], v[72:75]
    ds_read_b64_tr_b16 v[16:17], v7 offset:256
    s_waitcnt lgkmcnt(6)
    v_mfma_f32_16x16x16_bf16 v[76:79], v[20:21], v[52:53], v[76:79]
    ds_read_b64_tr_b16 v[18:19], v8 offset:256
    s_waitcnt lgkmcnt(6)
    v_mfma_f32_16x16x16_bf16 v[80:83], v[22:23], v[52:53], v[80:83]
    ds_read_b64_tr_b16 v[20:21], v9 offset:256
    s_waitcnt lgkmcnt(6)
    v_mfma_f32_16x16x16_bf16 v[84:87], v[24:25], v[52:53], v[84:87]
    ds_read_b64_tr_b16 v[22:23], v10 offset:256
    s_waitcnt lgkmcnt(6)
    v_mfma_f32_16x16x16_bf16 v[88:91], v[26:27], v[52:53], v[88:91]
    ds_read_b64_tr_b16 v[24:25], v11 offset:256
    s_waitcnt lgkmcnt(6)
    v_mfma_f32_16x16x16_bf16 v[92:95], v[28:29], v[52:53], v[92:95]
    ds_read_b64_tr_b16 v[26:27], v12 offset:256
    s_waitcnt lgkmcnt(6)
    v_mfma_f32_16x16x16_bf16 v[96:99], v[14:15], v[52:53], v[96:99]
    ds_read_b64_tr_b16 v[28:29], v13 offset:256
    s_waitcnt lgkmcnt(6)
    v_mfma_f32_16x16x16_bf16 v[100:103], v[16:17], v[52:53], v[100:103]
    s_waitcnt lgkmcnt(5)
    v_mfma_f32_16x16x16_bf16 v[104:107], v[18:19], v[52:53], v[104:107]
    s_waitcnt lgkmcnt(4)
    v_mfma_f32_16x16x16_bf16 v[108:111], v[20:21], v[52:53], v[108:111]
    s_waitcnt lgkmcnt(3)
    v_mfma_f32_16x16x16_bf16 v[112:115], v[22:23], v[52:53], v[112:115]
    s_waitcnt lgkmcnt(2)
    v_mfma_f32_16x16x16_bf16 v[116:119], v[24:25], v[52:53], v[116:119]
    s_waitcnt lgkmcnt(1)
    v_mfma_f32_16x16x16_bf16 v[120:123], v[26:27], v[52:53], v[120:123]
    s_waitcnt lgkmcnt(0)
    v_mfma_f32_16x16x16_bf16 v[124:127], v[28:29], v[52:53], v[124:127]
    s_add_u32 m0, s56, 0
    s_add_u32 s69, s57, 1572864
    buffer_load_dwordx4 v2, s[16:19], s69 offen offset:0 nt lds
    buffer_load_dwordx4 v3, s[16:19], s69 offen offset:1024 nt lds
    buffer_load_dwordx4 v4, s[16:19], s69 offen offset:2048 nt lds
    buffer_load_dwordx4 v5, s[16:19], s69 offen offset:3072 nt lds
    s_add_u32 m0, s56, 4096
    s_add_u32 s69, s69, 4096
    buffer_load_dwordx4 v2, s[16:19], s69 offen offset:0 nt lds
    buffer_load_dwordx4 v3, s[16:19], s69 offen offset:1024 nt lds
    buffer_load_dwordx4 v4, s[16:19], s69 offen offset:2048 nt lds
    buffer_load_dwordx4 v5, s[16:19], s69 offen offset:3072 nt lds
    s_waitcnt vmcnt(8)
    ds_read_b64_tr_b16 v[14:15], v6 offset:8192
    ds_read_b64_tr_b16 v[16:17], v7 offset:8192
    ds_read_b64_tr_b16 v[18:19], v8 offset:8192
    ds_read_b64_tr_b16 v[20:21], v9 offset:8192
    ds_read_b64_tr_b16 v[22:23], v10 offset:8192
    ds_read_b64_tr_b16 v[24:25], v11 offset:8192
    ds_read_b64_tr_b16 v[26:27], v12 offset:8192
    ds_read_b64_tr_b16 v[28:29], v13 offset:8192
    s_waitcnt lgkmcnt(7)
    v_mfma_f32_16x16x16_bf16 v[64:67], v[14:15], v[54:55], v[64:67]
    s_waitcnt lgkmcnt(6)
    v_mfma_f32_16x16x16_bf16 v[68:71], v[16:17], v[54:55], v[68:71]
    ds_read_b64_tr_b16 v[14:15], v6 offset:8448
    s_waitcnt lgkmcnt(6)
    v_mfma_f32_16x16x16_bf16 v[72:75], v[18:19], v[54:55], v[72:75]
    ds_read_b64_tr_b16 v[16:17], v7 offset:8448
    s_waitcnt lgkmcnt(6)
    v_mfma_f32_16x16x16_bf16 v[76:79], v[20:21], v[54:55], v[76:79]
    ds_read_b64_tr_b16 v[18:19], v8 offset:8448
    s_waitcnt lgkmcnt(6)
    v_mfma_f32_16x16x16_bf16 v[80:83], v[22:23], v[54:55], v[80:83]
    ds_read_b64_tr_b16 v[20:21], v9 offset:8448
    s_waitcnt lgkmcnt(6)
    v_mfma_f32_16x16x16_bf16 v[84:87], v[24:25], v[54:55], v[84:87]
    ds_read_b64_tr_b16 v[22:23], v10 offset:8448
    s_waitcnt lgkmcnt(6)
    v_mfma_f32_16x16x16_bf16 v[88:91], v[26:27], v[54:55], v[88:91]
    ds_read_b64_tr_b16 v[24:25], v11 offset:8448
    s_waitcnt lgkmcnt(6)
    v_mfma_f32_16x16x16_bf16 v[92:95], v[28:29], v[54:55], v[92:95]
    ds_read_b64_tr_b16 v[26:27], v12 offset:8448
    s_waitcnt lgkmcnt(6)
    v_mfma_f32_16x16x16_bf16 v[96:99], v[14:15], v[54:55], v[96:99]
    ds_read_b64_tr_b16 v[28:29], v13 offset:8448
    s_waitcnt lgkmcnt(6)
    v_mfma_f32_16x16x16_bf16 v[100:103], v[16:17], v[54:55], v[100:103]
    s_waitcnt lgkmcnt(5)
    v_mfma_f32_16x16x16_bf16 v[104:107], v[18:19], v[54:55], v[104:107]
    s_waitcnt lgkmcnt(4)
    v_mfma_f32_16x16x16_bf16 v[108:111], v[20:21], v[54:55], v[108:111]
    s_waitcnt lgkmcnt(3)
    v_mfma_f32_16x16x16_bf16 v[112:115], v[22:23], v[54:55], v[112:115]
    s_waitcnt lgkmcnt(2)
    v_mfma_f32_16x16x16_bf16 v[116:119], v[24:25], v[54:55], v[116:119]
    s_waitcnt lgkmcnt(1)
    v_mfma_f32_16x16x16_bf16 v[120:123], v[26:27], v[54:55], v[120:123]
    s_waitcnt lgkmcnt(0)
    v_mfma_f32_16x16x16_bf16 v[124:127], v[28:29], v[54:55], v[124:127]
    s_add_u32 m0, s56, 8192
    s_add_u32 s69, s57, 1703936
    buffer_load_dwordx4 v2, s[16:19], s69 offen offset:0 nt lds
    buffer_load_dwordx4 v3, s[16:19], s69 offen offset:1024 nt lds
    buffer_load_dwordx4 v4, s[16:19], s69 offen offset:2048 nt lds
    buffer_load_dwordx4 v5, s[16:19], s69 offen offset:3072 nt lds
    s_add_u32 m0, s56, 12288
    s_add_u32 s69, s69, 4096
    buffer_load_dwordx4 v2, s[16:19], s69 offen offset:0 nt lds
    buffer_load_dwordx4 v3, s[16:19], s69 offen offset:1024 nt lds
    buffer_load_dwordx4 v4, s[16:19], s69 offen offset:2048 nt lds
    buffer_load_dwordx4 v5, s[16:19], s69 offen offset:3072 nt lds
    s_waitcnt vmcnt(8)
    ds_read_b64_tr_b16 v[14:15], v6 offset:0
    ds_read_b64_tr_b16 v[16:17], v7 offset:0
    ds_read_b64_tr_b16 v[18:19], v8 offset:0
    ds_read_b64_tr_b16 v[20:21], v9 offset:0
    ds_read_b64_tr_b16 v[22:23], v10 offset:0
    ds_read_b64_tr_b16 v[24:25], v11 offset:0
    ds_read_b64_tr_b16 v[26:27], v12 offset:0
    ds_read_b64_tr_b16 v[28:29], v13 offset:0
    s_waitcnt lgkmcnt(7)
    v_mfma_f32_16x16x16_bf16 v[64:67], v[14:15], v[56:57], v[64:67]
    s_waitcnt lgkmcnt(6)
    v_mfma_f32_16x16x16_bf16 v[68:71], v[16:17], v[56:57], v[68:71]
    ds_read_b64_tr_b16 v[14:15], v6 offset:256
    s_waitcnt lgkmcnt(6)
    v_mfma_f32_16x16x16_bf16 v[72:75], v[18:19], v[56:57], v[72:75]
    ds_read_b64_tr_b16 v[16:17], v7 offset:256
    s_waitcnt lgkmcnt(6)
    v_mfma_f32_16x16x16_bf16 v[76:79], v[20:21], v[56:57], v[76:79]
    ds_read_b64_tr_b16 v[18:19], v8 offset:256
    s_waitcnt lgkmcnt(6)
    v_mfma_f32_16x16x16_bf16 v[80:83], v[22:23], v[56:57], v[80:83]
    ds_read_b64_tr_b16 v[20:21], v9 offset:256
    s_waitcnt lgkmcnt(6)
    v_mfma_f32_16x16x16_bf16 v[84:87], v[24:25], v[56:57], v[84:87]
    ds_read_b64_tr_b16 v[22:23], v10 offset:256
    s_waitcnt lgkmcnt(6)
    v_mfma_f32_16x16x16_bf16 v[88:91], v[26:27], v[56:57], v[88:91]
    ds_read_b64_tr_b16 v[24:25], v11 offset:256
    s_waitcnt lgkmcnt(6)
    v_mfma_f32_16x16x16_bf16 v[92:95], v[28:29], v[56:57], v[92:95]
    ds_read_b64_tr_b16 v[26:27], v12 offset:256
    s_waitcnt lgkmcnt(6)
    v_mfma_f32_16x16x16_bf16 v[96:99], v[14:15], v[56:57], v[96:99]
    ds_read_b64_tr_b16 v[28:29], v13 offset:256
    s_waitcnt lgkmcnt(6)
    v_mfma_f32_16x16x16_bf16 v[100:103], v[16:17], v[56:57], v[100:103]
    s_waitcnt lgkmcnt(5)
    v_mfma_f32_16x16x16_bf16 v[104:107], v[18:19], v[56:57], v[104:107]
    s_waitcnt lgkmcnt(4)
    v_mfma_f32_16x16x16_bf16 v[108:111], v[20:21], v[56:57], v[108:111]
    s_waitcnt lgkmcnt(3)
    v_mfma_f32_16x16x16_bf16 v[112:115], v[22:23], v[56:57], v[112:115]
    s_waitcnt lgkmcnt(2)
    v_mfma_f32_16x16x16_bf16 v[116:119], v[24:25], v[56:57], v[116:119]
    s_waitcnt lgkmcnt(1)
    v_mfma_f32_16x16x16_bf16 v[120:123], v[26:27], v[56:57], v[120:123]
    s_waitcnt lgkmcnt(0)
    v_mfma_f32_16x16x16_bf16 v[124:127], v[28:29], v[56:57], v[124:127]
    s_add_u32 m0, s56, 0
    s_add_u32 s69, s57, 1835008
    buffer_load_dwordx4 v2, s[16:19], s69 offen offset:0 nt lds
    buffer_load_dwordx4 v3, s[16:19], s69 offen offset:1024 nt lds
    buffer_load_dwordx4 v4, s[16:19], s69 offen offset:2048 nt lds
    buffer_load_dwordx4 v5, s[16:19], s69 offen offset:3072 nt lds
    s_add_u32 m0, s56, 4096
    s_add_u32 s69, s69, 4096
    buffer_load_dwordx4 v2, s[16:19], s69 offen offset:0 nt lds
    buffer_load_dwordx4 v3, s[16:19], s69 offen offset:1024 nt lds
    buffer_load_dwordx4 v4, s[16:19], s69 offen offset:2048 nt lds
    buffer_load_dwordx4 v5, s[16:19], s69 offen offset:3072 nt lds
    s_waitcnt vmcnt(8)
    ds_read_b64_tr_b16 v[14:15], v6 offset:8192
    ds_read_b64_tr_b16 v[16:17], v7 offset:8192
    ds_read_b64_tr_b16 v[18:19], v8 offset:8192
    ds_read_b64_tr_b16 v[20:21], v9 offset:8192
    ds_read_b64_tr_b16 v[22:23], v10 offset:8192
    ds_read_b64_tr_b16 v[24:25], v11 offset:8192
    ds_read_b64_tr_b16 v[26:27], v12 offset:8192
    ds_read_b64_tr_b16 v[28:29], v13 offset:8192
    s_waitcnt lgkmcnt(7)
    v_mfma_f32_16x16x16_bf16 v[64:67], v[14:15], v[58:59], v[64:67]
    s_waitcnt lgkmcnt(6)
    v_mfma_f32_16x16x16_bf16 v[68:71], v[16:17], v[58:59], v[68:71]
    ds_read_b64_tr_b16 v[14:15], v6 offset:8448
    s_waitcnt lgkmcnt(6)
    v_mfma_f32_16x16x16_bf16 v[72:75], v[18:19], v[58:59], v[72:75]
    ds_read_b64_tr_b16 v[16:17], v7 offset:8448
    s_waitcnt lgkmcnt(6)
    v_mfma_f32_16x16x16_bf16 v[76:79], v[20:21], v[58:59], v[76:79]
    ds_read_b64_tr_b16 v[18:19], v8 offset:8448
    s_waitcnt lgkmcnt(6)
    v_mfma_f32_16x16x16_bf16 v[80:83], v[22:23], v[58:59], v[80:83]
    ds_read_b64_tr_b16 v[20:21], v9 offset:8448
    s_waitcnt lgkmcnt(6)
    v_mfma_f32_16x16x16_bf16 v[84:87], v[24:25], v[58:59], v[84:87]
    ds_read_b64_tr_b16 v[22:23], v10 offset:8448
    s_waitcnt lgkmcnt(6)
    v_mfma_f32_16x16x16_bf16 v[88:91], v[26:27], v[58:59], v[88:91]
    ds_read_b64_tr_b16 v[24:25], v11 offset:8448
    s_waitcnt lgkmcnt(6)
    v_mfma_f32_16x16x16_bf16 v[92:95], v[28:29], v[58:59], v[92:95]
    ds_read_b64_tr_b16 v[26:27], v12 offset:8448
    s_waitcnt lgkmcnt(6)
    v_mfma_f32_16x16x16_bf16 v[96:99], v[14:15], v[58:59], v[96:99]
    ds_read_b64_tr_b16 v[28:29], v13 offset:8448
    s_waitcnt lgkmcnt(6)
    v_mfma_f32_16x16x16_bf16 v[100:103], v[16:17], v[58:59], v[100:103]
    s_waitcnt lgkmcnt(5)
    v_mfma_f32_16x16x16_bf16 v[104:107], v[18:19], v[58:59], v[104:107]
    s_waitcnt lgkmcnt(4)
    v_mfma_f32_16x16x16_bf16 v[108:111], v[20:21], v[58:59], v[108:111]
    s_waitcnt lgkmcnt(3)
    v_mfma_f32_16x16x16_bf16 v[112:115], v[22:23], v[58:59], v[112:115]
    s_waitcnt lgkmcnt(2)
    v_mfma_f32_16x16x16_bf16 v[116:119], v[24:25], v[58:59], v[116:119]
    s_waitcnt lgkmcnt(1)
    v_mfma_f32_16x16x16_bf16 v[120:123], v[26:27], v[58:59], v[120:123]
    s_waitcnt lgkmcnt(0)
    v_mfma_f32_16x16x16_bf16 v[124:127], v[28:29], v[58:59], v[124:127]
    s_add_u32 m0, s56, 8192
    s_add_u32 s69, s57, 1966080
    buffer_load_dwordx4 v2, s[16:19], s69 offen offset:0 nt lds
    buffer_load_dwordx4 v3, s[16:19], s69 offen offset:1024 nt lds
    buffer_load_dwordx4 v4, s[16:19], s69 offen offset:2048 nt lds
    buffer_load_dwordx4 v5, s[16:19], s69 offen offset:3072 nt lds
    s_add_u32 m0, s56, 12288
    s_add_u32 s69, s69, 4096
    buffer_load_dwordx4 v2, s[16:19], s69 offen offset:0 nt lds
    buffer_load_dwordx4 v3, s[16:19], s69 offen offset:1024 nt lds
    buffer_load_dwordx4 v4, s[16:19], s69 offen offset:2048 nt lds
    buffer_load_dwordx4 v5, s[16:19], s69 offen offset:3072 nt lds
    s_waitcnt vmcnt(8)
    ds_read_b64_tr_b16 v[14:15], v6 offset:0
    ds_read_b64_tr_b16 v[16:17], v7 offset:0
    ds_read_b64_tr_b16 v[18:19], v8 offset:0
    ds_read_b64_tr_b16 v[20:21], v9 offset:0
    ds_read_b64_tr_b16 v[22:23], v10 offset:0
    ds_read_b64_tr_b16 v[24:25], v11 offset:0
    ds_read_b64_tr_b16 v[26:27], v12 offset:0
    ds_read_b64_tr_b16 v[28:29], v13 offset:0
    s_waitcnt lgkmcnt(7)
    v_mfma_f32_16x16x16_bf16 v[64:67], v[14:15], v[60:61], v[64:67]
    s_waitcnt lgkmcnt(6)
    v_mfma_f32_16x16x16_bf16 v[68:71], v[16:17], v[60:61], v[68:71]
    ds_read_b64_tr_b16 v[14:15], v6 offset:256
    s_waitcnt lgkmcnt(6)
    v_mfma_f32_16x16x16_bf16 v[72:75], v[18:19], v[60:61], v[72:75]
    ds_read_b64_tr_b16 v[16:17], v7 offset:256
    s_waitcnt lgkmcnt(6)
    v_mfma_f32_16x16x16_bf16 v[76:79], v[20:21], v[60:61], v[76:79]
    ds_read_b64_tr_b16 v[18:19], v8 offset:256
    s_waitcnt lgkmcnt(6)
    v_mfma_f32_16x16x16_bf16 v[80:83], v[22:23], v[60:61], v[80:83]
    ds_read_b64_tr_b16 v[20:21], v9 offset:256
    s_waitcnt lgkmcnt(6)
    v_mfma_f32_16x16x16_bf16 v[84:87], v[24:25], v[60:61], v[84:87]
    ds_read_b64_tr_b16 v[22:23], v10 offset:256
    s_waitcnt lgkmcnt(6)
    v_mfma_f32_16x16x16_bf16 v[88:91], v[26:27], v[60:61], v[88:91]
    ds_read_b64_tr_b16 v[24:25], v11 offset:256
    s_waitcnt lgkmcnt(6)
    v_mfma_f32_16x16x16_bf16 v[92:95], v[28:29], v[60:61], v[92:95]
    ds_read_b64_tr_b16 v[26:27], v12 offset:256
    s_waitcnt lgkmcnt(6)
    v_mfma_f32_16x16x16_bf16 v[96:99], v[14:15], v[60:61], v[96:99]
    ds_read_b64_tr_b16 v[28:29], v13 offset:256
    s_waitcnt lgkmcnt(6)
    v_mfma_f32_16x16x16_bf16 v[100:103], v[16:17], v[60:61], v[100:103]
    s_waitcnt lgkmcnt(5)
    v_mfma_f32_16x16x16_bf16 v[104:107], v[18:19], v[60:61], v[104:107]
    s_waitcnt lgkmcnt(4)
    v_mfma_f32_16x16x16_bf16 v[108:111], v[20:21], v[60:61], v[108:111]
    s_waitcnt lgkmcnt(3)
    v_mfma_f32_16x16x16_bf16 v[112:115], v[22:23], v[60:61], v[112:115]
    s_waitcnt lgkmcnt(2)
    v_mfma_f32_16x16x16_bf16 v[116:119], v[24:25], v[60:61], v[116:119]
    s_waitcnt lgkmcnt(1)
    v_mfma_f32_16x16x16_bf16 v[120:123], v[26:27], v[60:61], v[120:123]
    s_waitcnt lgkmcnt(0)
    v_mfma_f32_16x16x16_bf16 v[124:127], v[28:29], v[60:61], v[124:127]
    s_waitcnt vmcnt(0)
    ds_read_b64_tr_b16 v[14:15], v6 offset:8192
    ds_read_b64_tr_b16 v[16:17], v7 offset:8192
    ds_read_b64_tr_b16 v[18:19], v8 offset:8192
    ds_read_b64_tr_b16 v[20:21], v9 offset:8192
    ds_read_b64_tr_b16 v[22:23], v10 offset:8192
    ds_read_b64_tr_b16 v[24:25], v11 offset:8192
    ds_read_b64_tr_b16 v[26:27], v12 offset:8192
    ds_read_b64_tr_b16 v[28:29], v13 offset:8192
    s_waitcnt lgkmcnt(7)
    v_mfma_f32_16x16x16_bf16 v[64:67], v[14:15], v[62:63], v[64:67]
    s_waitcnt lgkmcnt(6)
    v_mfma_f32_16x16x16_bf16 v[68:71], v[16:17], v[62:63], v[68:71]
    ds_read_b64_tr_b16 v[14:15], v6 offset:8448
    s_waitcnt lgkmcnt(6)
    v_mfma_f32_16x16x16_bf16 v[72:75], v[18:19], v[62:63], v[72:75]
    ds_read_b64_tr_b16 v[16:17], v7 offset:8448
    s_waitcnt lgkmcnt(6)
    v_mfma_f32_16x16x16_bf16 v[76:79], v[20:21], v[62:63], v[76:79]
    ds_read_b64_tr_b16 v[18:19], v8 offset:8448
    s_waitcnt lgkmcnt(6)
    v_mfma_f32_16x16x16_bf16 v[80:83], v[22:23], v[62:63], v[80:83]
    ds_read_b64_tr_b16 v[20:21], v9 offset:8448
    s_waitcnt lgkmcnt(6)
    v_mfma_f32_16x16x16_bf16 v[84:87], v[24:25], v[62:63], v[84:87]
    ds_read_b64_tr_b16 v[22:23], v10 offset:8448
    s_waitcnt lgkmcnt(6)
    v_mfma_f32_16x16x16_bf16 v[88:91], v[26:27], v[62:63], v[88:91]
    ds_read_b64_tr_b16 v[24:25], v11 offset:8448
    s_waitcnt lgkmcnt(6)
    v_mfma_f32_16x16x16_bf16 v[92:95], v[28:29], v[62:63], v[92:95]
    ds_read_b64_tr_b16 v[26:27], v12 offset:8448
    s_waitcnt lgkmcnt(6)
    v_mfma_f32_16x16x16_bf16 v[96:99], v[14:15], v[62:63], v[96:99]
    ds_read_b64_tr_b16 v[28:29], v13 offset:8448
    s_waitcnt lgkmcnt(6)
    v_mfma_f32_16x16x16_bf16 v[100:103], v[16:17], v[62:63], v[100:103]
    s_waitcnt lgkmcnt(5)
    v_mfma_f32_16x16x16_bf16 v[104:107], v[18:19], v[62:63], v[104:107]
    s_waitcnt lgkmcnt(4)
    v_mfma_f32_16x16x16_bf16 v[108:111], v[20:21], v[62:63], v[108:111]
    s_waitcnt lgkmcnt(3)
    v_mfma_f32_16x16x16_bf16 v[112:115], v[22:23], v[62:63], v[112:115]
    s_waitcnt lgkmcnt(2)
    v_mfma_f32_16x16x16_bf16 v[116:119], v[24:25], v[62:63], v[116:119]
    s_waitcnt lgkmcnt(1)
    v_mfma_f32_16x16x16_bf16 v[120:123], v[26:27], v[62:63], v[120:123]
    s_waitcnt lgkmcnt(0)
    v_mfma_f32_16x16x16_bf16 v[124:127], v[28:29], v[62:63], v[124:127]
    v_and_b32 v30, 1, v1
    v_lshlrev_b32 v30, 10, v30
    v_lshrrev_b32 v31, 4, v1
    v_lshl_add_u32 v30, v31, 4, v30
    s_lshl_b32 s69, s52, 11
    s_add_u32 s69, s69, 126976
    v_add_u32 v30, s69, v30
    s_nop 7
    s_mov_b64 exec, s[70:71]
    ds_write_b128 v30, v[64:67] offset:0
    ds_write_b128 v30, v[68:71] offset:64
    ds_write_b128 v30, v[72:75] offset:128
    ds_write_b128 v30, v[76:79] offset:192
    ds_write_b128 v30, v[80:83] offset:256
    ds_write_b128 v30, v[84:87] offset:320
    ds_write_b128 v30, v[88:91] offset:384
    ds_write_b128 v30, v[92:95] offset:448
    ds_write_b128 v30, v[96:99] offset:512
    ds_write_b128 v30, v[100:103] offset:576
    ds_write_b128 v30, v[104:107] offset:640
    ds_write_b128 v30, v[108:111] offset:704
    s_waitcnt lgkmcnt(4)
    ds_write_b128 v30, v[112:115] offset:768
    ds_write_b128 v30, v[116:119] offset:832
    ds_write_b128 v30, v[120:123] offset:896
    ds_write_b128 v30, v[124:127] offset:960
    s_mov_b64 exec, -1
    s_waitcnt lgkmcnt(0)
    v_mov_b32 v30, s84
    v_mov_b32 v31, 14
    ds_write_b32 v30, v31
    v_mov_b32 v30, s85
Lps_98:
    ds_read_b32 v31, v30
    s_waitcnt lgkmcnt(0)
    v_cmp_gt_u32 vcc, 14, v31
    s_cbranch_vccz Lpd_99
    s_cmp_eq_u32 s83, 0
    s_cbranch_scc1 Lpd_99
    s_sub_u32 s83, s83, 1
    s_branch Lps_98
Lpd_99:
    s_lshl_b32 s69, s54, 5
    s_lshl_b32 s72, s82, 3
    s_add_u32 s69, s69, s72
    s_add_u32 s69, s69, 135168
    v_mov_b32 v30, s69
    s_mul_i32 s69, s54, 4096
    s_lshl_b32 s72, s82, 10
    s_add_u32 s69, s69, s72
    s_add_u32 s69, s69, 126976
    v_and_b32 v31, 31, v1
    v_lshlrev_b32 v31, 5, v31
    v_add_u32 v31, s69, v31
    ds_read_b64 v[32:33], v30 offset:0
    ds_read_b64 v[34:35], v30 offset:16
    ds_read_b128 v[40:43], v31 offset:0
    ds_read_b128 v[44:47], v31 offset:16
    ds_read_b128 v[48:51], v31 offset:2048
    ds_read_b128 v[52:55], v31 offset:2064
    v_lshlrev_b32 v56, 4, v1
    v_cmp_gt_u32 vcc, 32, v1
    v_mov_b32 v58, 2147483648
    s_nop 0
    v_cndmask_b32 v56, v58, v56, vcc
    v_cmp_eq_u32 vcc, 0, v1
    v_mov_b32 v57, 0
    s_nop 0
    v_cndmask_b32 v57, v58, v57, vcc
    s_waitcnt lgkmcnt(4)
    v_max_f32 v36, v32, v34
    v_sub_f32 v32, v32, v36
    v_sub_f32 v34, v34, v36
    v_exp_f32 v32, v32
    v_exp_f32 v34, v34
    s_nop 0
    v_mul_f32 v37, v32, v33
    v_fmac_f32 v37, v34, v35
    s_waitcnt lgkmcnt(0)
    v_mul_f32 v40, v40, v32
    v_mul_f32 v41, v41, v32
    v_mul_f32 v42, v42, v32
    v_mul_f32 v43, v43, v32
    v_mul_f32 v44, v44, v32
    v_mul_f32 v45, v45, v32
    v_mul_f32 v46, v46, v32
    v_mul_f32 v47, v47, v32
    v_fmac_f32 v40, v48, v34
    v_fmac_f32 v41, v49, v34
    v_fmac_f32 v42, v50, v34
    v_fmac_f32 v43, v51, v34
    v_fmac_f32 v44, v52, v34
    v_fmac_f32 v45, v53, v34
    v_fmac_f32 v46, v54, v34
    v_fmac_f32 v47, v55, v34
    v_cvt_pk_bf16_f32 v48, v40, v41
    v_cvt_pk_bf16_f32 v49, v42, v43
    v_cvt_pk_bf16_f32 v50, v44, v45
    v_cvt_pk_bf16_f32 v51, v46, v47
    v_min_u32 v48, -2, v48
    v_min_u32 v49, -2, v49
    v_min_u32 v50, -2, v50
    v_min_u32 v51, -2, v51
    s_add_u32 s72, s76, 98304
    s_add_u32 s73, s77, 24576
    s_cmp_eq_u32 s100, 0
    s_cbranch_scc1 Lwt_100
    buffer_store_dwordx4 v[48:51], v56, s[36:39], s72 offen
    buffer_store_dwordx2 v[36:37], v57, s[36:39], s73 offen
    s_branch Lwd_101
Lwt_100:
    buffer_store_dwordx4 v[48:51], v56, s[36:39], s72 offen sc1
    buffer_store_dwordx2 v[36:37], v57, s[36:39], s73 offen sc1
Lwd_101:
    s_nop 1
    v_and_b32 v6, 15, v1
    v_lshlrev_b32 v7, 8, v6
    v_lshlrev_b32 v6, 9, v6
    v_lshrrev_b32 v30, 4, v1
    v_lshl_add_u32 v6, v30, 4, v6
    s_lshl_b32 s69, s82, 14
    s_add_u32 s72, s61, 98304
    s_add_u32 s72, s72, s69
    s_add_u32 s73, s62, 24576
    buffer_load_dwordx2 v[22:23], v7, s[36:39], s73 offen offset:0 sc1
    buffer_load_dwordx4 v[32:35], v6, s[36:39], s72 offen offset:0 sc1
    buffer_load_dwordx4 v[36:39], v6, s[36:39], s72 offen offset:64 sc1
    buffer_load_dwordx4 v[40:43], v6, s[36:39], s72 offen offset:128 sc1
    buffer_load_dwordx4 v[44:47], v6, s[36:39], s72 offen offset:192 sc1
    buffer_load_dwordx4 v[48:51], v6, s[36:39], s72 offen offset:256 sc1
    buffer_load_dwordx4 v[52:55], v6, s[36:39], s72 offen offset:320 sc1
    buffer_load_dwordx4 v[56:59], v6, s[36:39], s72 offen offset:384 sc1
    buffer_load_dwordx4 v[60:63], v6, s[36:39], s72 offen offset:448 sc1
    s_add_u32 s79, s73, 4096
    buffer_load_dwordx2 v[24:25], v7, s[36:39], s79 offen sc1
    s_add_u32 s79, s72, 8192
    buffer_load_dwordx4 v[64:67], v6, s[36:39], s79 offen offset:0 sc1
    buffer_load_dwordx4 v[68:71], v6, s[36:39], s79 offen offset:64 sc1
    buffer_load_dwordx4 v[72:75], v6, s[36:39], s79 offen offset:128 sc1
    buffer_load_dwordx4 v[76:79], v6, s[36:39], s79 offen offset:192 sc1
    buffer_load_dwordx4 v[80:83], v6, s[36:39], s79 offen offset:256 sc1
    buffer_load_dwordx4 v[84:87], v6, s[36:39], s79 offen offset:320 sc1
    buffer_load_dwordx4 v[88:91], v6, s[36:39], s79 offen offset:384 sc1
    buffer_load_dwordx4 v[92:95], v6, s[36:39], s79 offen offset:448 sc1
    v_lshrrev_b32 v8, 4, v1
    v_lshlrev_b32 v8, 8, v8
    v_bfe_u32 v9, v1, 2, 2
    v_lshl_add_u32 v8, v9, 5, v8
    v_and_b32 v9, 3, v1
    v_lshl_add_u32 v8, v9, 3, v8
    s_mul_i32 s69, s82, 8192
    s_add_u32 s69, s69, 81920
    v_add_u32 v8, s69, v8
    ds_read_b64_tr_b16 v[96:97], v8 offset:0
    ds_read_b64_tr_b16 v[98:99], v8 offset:128
    ds_read_b64_tr_b16 v[100:101], v8 offset:1024
    ds_read_b64_tr_b16 v[102:103], v8 offset:1152
    ds_read_b64_tr_b16 v[104:105], v8 offset:2048
    ds_read_b64_tr_b16 v[106:107], v8 offset:2176
    ds_read_b64_tr_b16 v[108:109], v8 offset:3072
    ds_read_b64_tr_b16 v[110:111], v8 offset:3200
    s_waitcnt lgkmcnt(4)
    ds_read_b64_tr_b16 v[112:113], v8 offset:4096
    ds_read_b64_tr_b16 v[114:115], v8 offset:4224
    ds_read_b64_tr_b16 v[116:117], v8 offset:5120
    ds_read_b64_tr_b16 v[118:119], v8 offset:5248
    ds_read_b64_tr_b16 v[120:121], v8 offset:6144
    ds_read_b64_tr_b16 v[122:123], v8 offset:6272
    ds_read_b64_tr_b16 v[124:125], v8 offset:7168
    ds_read_b64_tr_b16 v[126:127], v8 offset:7296
    s_waitcnt lgkmcnt(0)
    s_waitcnt vmcnt(0)
Lpolls1_3_102:
    s_mov_b32 s90, 0
    v_max3_u32 v31, v22, v23, v32
    v_max3_u32 v31, v31, v33, v34
    v_max3_u32 v31, v31, v35, v36
    v_max3_u32 v31, v31, v37, v38
    v_max3_u32 v31, v31, v39, v40
    v_max3_u32 v31, v31, v41, v42
    v_max3_u32 v31, v31, v43, v44
    v_max3_u32 v31, v31, v45, v46
    v_max3_u32 v31, v31, v47, v48
    v_max3_u32 v31, v31, v49, v50
    v_max3_u32 v31, v31, v51, v52
    v_max3_u32 v31, v31, v53, v54
    v_max3_u32 v31, v31, v55, v56
    v_max3_u32 v31, v31, v57, v58
    v_max3_u32 v31, v31, v59, v60
    v_max3_u32 v31, v31, v61, v62
    v_max_u32 v31, v31, v63
    v_cmp_eq_u32 vcc, -1, v31
    s_cbranch_vccz Lsks1_3_104
    s_mov_b64 exec, vcc
    buffer_load_dwordx2 v[22:23], v7, s[36:39], s73 offen offset:0 sc1
    buffer_load_dwordx4 v[32:35], v6, s[36:39], s72 offen offset:0 sc1
    buffer_load_dwordx4 v[36:39], v6, s[36:39], s72 offen offset:64 sc1
    buffer_load_dwordx4 v[40:43], v6, s[36:39], s72 offen offset:128 sc1
    buffer_load_dwordx4 v[44:47], v6, s[36:39], s72 offen offset:192 sc1
    buffer_load_dwordx4 v[48:51], v6, s[36:39], s72 offen offset:256 sc1
    buffer_load_dwordx4 v[52:55], v6, s[36:39], s72 offen offset:320 sc1
    buffer_load_dwordx4 v[56:59], v6, s[36:39], s72 offen offset:384 sc1
    buffer_load_dwordx4 v[60:63], v6, s[36:39], s72 offen offset:448 sc1
    s_mov_b64 exec, -1
    s_mov_b32 s90, 1
Lsks1_3_104:
    v_max3_u32 v31, v24, v25, v64
    v_max3_u32 v31, v31, v65, v66
    v_max3_u32 v31, v31, v67, v68
    v_max3_u32 v31, v31, v69, v70
    v_max3_u32 v31, v31, v71, v72
    v_max3_u32 v31, v31, v73, v74
    v_max3_u32 v31, v31, v75, v76
    v_max3_u32 v31, v31, v77, v78
    v_max3_u32 v31, v31, v79, v80
    v_max3_u32 v31, v31, v81, v82
    v_max3_u32 v31, v31, v83, v84
    v_max3_u32 v31, v31, v85, v86
    v_max3_u32 v31, v31, v87, v88
    v_max3_u32 v31, v31, v89, v90
    v_max3_u32 v31, v31, v91, v92
    v_max3_u32 v31, v31, v93, v94
    v_max_u32 v31, v31, v95
    v_cmp_eq_u32 vcc, -1, v31
    s_cbranch_vccz Lsks1_3_105
    s_mov_b64 exec, vcc
    s_add_u32 s79, s73, 4096
    buffer_load_dwordx2 v[24:25], v7, s[36:39], s79 offen sc1
    s_add_u32 s79, s72, 8192
    buffer_load_dwordx4 v[64:67], v6, s[36:39], s79 offen offset:0 sc1
    buffer_load_dwordx4 v[68:71], v6, s[36:39], s79 offen offset:64 sc1
    buffer_load_dwordx4 v[72:75], v6, s[36:39], s79 offen offset:128 sc1
    buffer_load_dwordx4 v[76:79], v6, s[36:39], s79 offen offset:192 sc1
    buffer_load_dwordx4 v[80:83], v6, s[36:39], s79 offen offset:256 sc1
    buffer_load_dwordx4 v[84:87], v6, s[36:39], s79 offen offset:320 sc1
    buffer_load_dwordx4 v[88:91], v6, s[36:39], s79 offen offset:384 sc1
    buffer_load_dwordx4 v[92:95], v6, s[36:39], s79 offen offset:448 sc1
    s_mov_b64 exec, -1
    s_mov_b32 s90, 1
Lsks1_3_105:
    s_cmp_eq_u32 s90, 0
    s_cbranch_scc1 Ldones1_3_103
    s_waitcnt vmcnt(0)
    s_cmp_eq_u32 s65, 0
    s_cbranch_scc1 Ldones1_3_103
    s_sub_u32 s65, s65, 1
    s_sleep 1
    s_branch Lpolls1_3_102
Ldones1_3_103:
    v_mfma_f32_16x16x32_bf16 v[14:17], v[96:99], v[32:35], 0
    v_mfma_f32_16x16x32_bf16 v[18:21], v[96:99], v[64:67], 0
    v_mfma_f32_16x16x32_bf16 v[14:17], v[100:103], v[36:39], v[14:17]
    v_mfma_f32_16x16x32_bf16 v[18:21], v[100:103], v[68:71], v[18:21]
    v_mfma_f32_16x16x32_bf16 v[14:17], v[104:107], v[40:43], v[14:17]
    v_mfma_f32_16x16x32_bf16 v[18:21], v[104:107], v[72:75], v[18:21]
    v_mfma_f32_16x16x32_bf16 v[14:17], v[108:111], v[44:47], v[14:17]
    v_mfma_f32_16x16x32_bf16 v[18:21], v[108:111], v[76:79], v[18:21]
    v_mfma_f32_16x16x32_bf16 v[14:17], v[112:115], v[48:51], v[14:17]
    v_mfma_f32_16x16x32_bf16 v[18:21], v[112:115], v[80:83], v[18:21]
    v_mfma_f32_16x16x32_bf16 v[14:17], v[116:119], v[52:55], v[14:17]
    v_mfma_f32_16x16x32_bf16 v[18:21], v[116:119], v[84:87], v[18:21]
    v_mfma_f32_16x16x32_bf16 v[14:17], v[120:123], v[56:59], v[14:17]
    v_mfma_f32_16x16x32_bf16 v[18:21], v[120:123], v[88:91], v[18:21]
    v_mfma_f32_16x16x32_bf16 v[14:17], v[124:127], v[60:63], v[14:17]
    v_mfma_f32_16x16x32_bf16 v[18:21], v[124:127], v[92:95], v[18:21]
    v_mov_b32 v26, v22
    v_mov_b32 v27, v24
    s_nop 0
    v_max_f32_dpp v26, v26, v26 quad_perm:[1,0,3,2] row_mask:0xf bank_mask:0xf
    v_max_f32_dpp v27, v27, v27 quad_perm:[1,0,3,2] row_mask:0xf bank_mask:0xf
    s_nop 0
    v_max_f32_dpp v26, v26, v26 quad_perm:[2,3,0,1] row_mask:0xf bank_mask:0xf
    v_max_f32_dpp v27, v27, v27 quad_perm:[2,3,0,1] row_mask:0xf bank_mask:0xf
    s_nop 0
    v_max_f32_dpp v26, v26, v26 row_half_mirror row_mask:0xf bank_mask:0xf
    v_max_f32_dpp v27, v27, v27 row_half_mirror row_mask:0xf bank_mask:0xf
    v_sub_f32 v26, v22, v26
    v_sub_f32 v27, v24, v27
    v_exp_f32 v26, v26
    v_exp_f32 v27, v27
    s_nop 0
    v_mul_f32 v28, v26, v23
    v_mul_f32 v29, v27, v25
    s_nop 0
    v_add_f32_dpp v28, v28, v28 quad_perm:[1,0,3,2] row_mask:0xf bank_mask:0xf
    v_add_f32_dpp v29, v29, v29 quad_perm:[1,0,3,2] row_mask:0xf bank_mask:0xf
    s_nop 0
    v_add_f32_dpp v28, v28, v28 quad_perm:[2,3,0,1] row_mask:0xf bank_mask:0xf
    v_add_f32_dpp v29, v29, v29 quad_perm:[2,3,0,1] row_mask:0xf bank_mask:0xf
    s_nop 0
    v_add_f32_dpp v28, v28, v28 row_half_mirror row_mask:0xf bank_mask:0xf
    v_add_f32_dpp v29, v29, v29 row_half_mirror row_mask:0xf bank_mask:0xf
    v_rcp_f32 v28, v28
    v_rcp_f32 v29, v29
    s_nop 0
    v_mul_f32 v26, v26, v28
    v_mul_f32 v27, v27, v29
    v_bfe_u32 v30, v1, 3, 1
    v_lshlrev_b32 v30, 6, v30
    v_lshrrev_b32 v31, 4, v1
    v_lshl_add_u32 v30, v31, 4, v30
    s_lshl_b32 s69, s52, 8
    s_add_u32 s69, s69, 135424
    v_add_u32 v30, s69, v30
    s_nop 3
    v_mul_f32 v14, v14, v26
    v_mul_f32 v18, v18, v27
    v_mul_f32 v15, v15, v26
    v_mul_f32 v19, v19, v27
    v_mul_f32 v16, v16, v26
    v_mul_f32 v20, v20, v27
    v_mul_f32 v17, v17, v26
    v_mul_f32 v21, v21, v27
    v_add_f32_dpp v14, v14, v14 quad_perm:[1,0,3,2] row_mask:0xf bank_mask:0xf
    v_add_f32_dpp v15, v15, v15 quad_perm:[1,0,3,2] row_mask:0xf bank_mask:0xf
    v_add_f32_dpp v16, v16, v16 quad_perm:[1,0,3,2] row_mask:0xf bank_mask:0xf
    v_add_f32_dpp v17, v17, v17 quad_perm:[1,0,3,2] row_mask:0xf bank_mask:0xf
    v_add_f32_dpp v18, v18, v18 quad_perm:[1,0,3,2] row_mask:0xf bank_mask:0xf
    v_add_f32_dpp v19, v19, v19 quad_perm:[1,0,3,2] row_mask:0xf bank_mask:0xf
    v_add_f32_dpp v20, v20, v20 quad_perm:[1,0,3,2] row_mask:0xf bank_mask:0xf
    v_add_f32_dpp v21, v21, v21 quad_perm:[1,0,3,2] row_mask:0xf bank_mask:0xf
    v_add_f32_dpp v14, v14, v14 quad_perm:[2,3,0,1] row_mask:0xf bank_mask:0xf
    v_add_f32_dpp v15, v15, v15 quad_perm:[2,3,0,1] row_mask:0xf bank_mask:0xf
    v_add_f32_dpp v16, v16, v16 quad_perm:[2,3,0,1] row_mask:0xf bank_mask:0xf
    v_add_f32_dpp v17, v17, v17 quad_perm:[2,3,0,1] row_mask:0xf bank_mask:0xf
    v_add_f32_dpp v18, v18, v18 quad_perm:[2,3,0,1] row_mask:0xf bank_mask:0xf
    v_add_f32_dpp v19, v19, v19 quad_perm:[2,3,0,1] row_mask:0xf bank_mask:0xf
    v_add_f32_dpp v20, v20, v20 quad_perm:[2,3,0,1] row_mask:0xf bank_mask:0xf
    v_add_f32_dpp v21, v21, v21 quad_perm:[2,3,0,1] row_mask:0xf bank_mask:0xf
    v_add_f32_dpp v14, v14, v14 row_half_mirror row_mask:0xf bank_mask:0xf
    v_add_f32_dpp v15, v15, v15 row_half_mirror row_mask:0xf bank_mask:0xf
    v_add_f32_dpp v16, v16, v16 row_half_mirror row_mask:0xf bank_mask:0xf
    v_add_f32_dpp v17, v17, v17 row_half_mirror row_mask:0xf bank_mask:0xf
    v_add_f32_dpp v18, v18, v18 row_half_mirror row_mask:0xf bank_mask:0xf
    v_add_f32_dpp v19, v19, v19 row_half_mirror row_mask:0xf bank_mask:0xf
    v_add_f32_dpp v20, v20, v20 row_half_mirror row_mask:0xf bank_mask:0xf
    v_add_f32_dpp v21, v21, v21 row_half_mirror row_mask:0xf bank_mask:0xf
    ds_write_b128 v30, v[14:17]
    ds_write_b128 v30, v[18:21] offset:128
    s_waitcnt lgkmcnt(0)
    v_mov_b32 v30, s84
    v_mov_b32 v31, 15
    ds_write_b32 v30, v31
    v_mov_b32 v30, s85
Lps_106:
    ds_read_b32 v31, v30
    s_waitcnt lgkmcnt(0)
    v_cmp_gt_u32 vcc, 15, v31
    s_cbranch_vccz Lpd_107
    s_cmp_eq_u32 s83, 0
    s_cbranch_scc1 Lpd_107
    s_sub_u32 s83, s83, 1
    s_branch Lps_106
Lpd_107:
    s_add_u32 s72, s63, 10752
    s_lshl_b32 s69, s54, 9
    s_add_u32 s69, s69, 135424
    v_and_b32 v30, 7, v1
    v_lshlrev_b32 v30, 5, v30
    v_add_u32 v30, s69, v30
    ds_read_b128 v[64:67], v30 offset:0
    ds_read_b128 v[68:71], v30 offset:16
    ds_read_b128 v[72:75], v30 offset:256
    ds_read_b128 v[76:79], v30 offset:272
    v_lshlrev_b32 v31, 4, v1
    s_cmp_eq_u32 s82, 0
    s_cselect_b32 s69, 8, 0
    s_cmp_lt_u32 s55, 28
    s_cselect_b32 s69, s69, 0
    v_cmp_gt_u32 vcc, s69, v1
    v_mov_b32 v80, 2147483648
    s_nop 0
    v_cndmask_b32 v31, v80, v31, vcc
    s_waitcnt lgkmcnt(0)
    v_add_f32 v64, v64, v72
    v_add_f32 v65, v65, v73
    v_add_f32 v66, v66, v74
    v_add_f32 v67, v67, v75
    v_add_f32 v68, v68, v76
    v_add_f32 v69, v69, v77
    v_add_f32 v70, v70, v78
    v_add_f32 v71, v71, v79
    v_cvt_pk_bf16_f32 v72, v64, v65
    v_cvt_pk_bf16_f32 v73, v66, v67
    v_cvt_pk_bf16_f32 v74, v68, v69
    v_cvt_pk_bf16_f32 v75, v70, v71
    v_min_u32 v72, -2, v72
    v_min_u32 v73, -2, v73
    v_min_u32 v74, -2, v74
    v_min_u32 v75, -2, v75
    buffer_store_dwordx4 v[72:75], v31, s[36:39], s72 offen sc1
    s_cmp_lg_u32 s82, 0
    s_cbranch_scc1 Lxs_108
    s_cmp_ge_u32 s55, 28
    s_cbranch_scc1 Lxs_108
    s_and_b32 s69, s55, 7
    s_cmp_lg_u32 s69, s53
    s_cbranch_scc1 Lxs_108
    v_lshrrev_b32 v30, 3, v1
    v_mul_u32_u24 v30, 196608, v30
    v_and_b32 v31, 7, v1
    v_lshl_add_u32 v30, v31, 4, v30
    s_lshl_b32 s72, s55, 7
    s_add_u32 s72, s72, s60
    s_add_u32 s72, s72, 145920
    buffer_load_dwordx4 v[32:35], v30, s[36:39], s72 offen sc1
    s_mul_i32 s69, s54, 7168
    s_lshl_b32 s3, s55, 6
    s_add_u32 s69, s69, s3
    s_add_u32 s69, s69, 148224
    v_bfe_u32 v92, v1, 1, 2
    v_mul_u32_u24 v92, 1792, v92
    v_and_b32 v93, 1, v1
    v_lshl_add_u32 v92, v93, 5, v92
    v_add_u32 v92, s69, v92
    ds_read_b128 v[84:87], v92
    ds_read_b128 v[88:91], v92 offset:16
    s_waitcnt vmcnt(0)
Lpollxs_3_109:
    v_max3_u32 v31, v32, v33, v34
    v_max_u32 v31, v31, v35
    v_cmp_eq_u32 vcc, -1, v31
    s_cbranch_vccz Ldonexs_3_110
Lhsxs_3_111:
    s_add_u32 s3, s72, 786432
    s_buffer_load_dword s92, s[36:39], s72 offset:124 glc
    s_buffer_load_dword s93, s[36:39], s72 offset:196732 glc
    s_buffer_load_dword s94, s[36:39], s72 offset:393340 glc
    s_buffer_load_dword s95, s[36:39], s72 offset:589948 glc
    s_buffer_load_dword s96, s[36:39], s3 offset:124 glc
    s_buffer_load_dword s97, s[36:39], s3 offset:196732 glc
    s_buffer_load_dword s98, s[36:39], s3 offset:393340 glc
    s_buffer_load_dword s99, s[36:39], s3 offset:589948 glc
    s_waitcnt lgkmcnt(0)
    s_max_u32 s92, s92, s93
    s_max_u32 s92, s92, s94
    s_max_u32 s92, s92, s95
    s_max_u32 s92, s92, s96
    s_max_u32 s92, s92, s97
    s_max_u32 s92, s92, s98
    s_max_u32 s92, s92, s99
    s_cmp_lg_u32 s92, -1
    s_cbranch_scc1 Lhrxs_3_112
    s_cmp_eq_u32 s65, 0
    s_cbranch_scc1 Ldonexs_3_110
    s_sub_u32 s65, s65, 1
    s_sleep 2
    s_branch Lhsxs_3_111
Lhrxs_3_112:
    s_cbranch_vccz Ldonexs_3_110
    s_mov_b64 exec, vcc
    buffer_load_dwordx4 v[32:35], v30, s[36:39], s72 offen sc1
    s_mov_b64 exec, -1
    s_waitcnt vmcnt(0)
    s_cmp_eq_u32 s65, 0
    s_cbranch_scc1 Ldonexs_3_110
    s_sub_u32 s65, s65, 1
    s_branch Lpollxs_3_109
Ldonexs_3_110:
    v_lshlrev_b32 v40, 16, v32
    v_and_b32 v41, 0xffff0000, v32
    v_lshlrev_b32 v42, 16, v33
    v_and_b32 v43, 0xffff0000, v33
    v_lshlrev_b32 v44, 16, v34
    v_and_b32 v45, 0xffff0000, v34
    v_lshlrev_b32 v46, 16, v35
    v_and_b32 v47, 0xffff0000, v35
    v_add_f32_dpp v40, v40, v40 row_ror:8 row_mask:0xf bank_mask:0xf
    v_add_f32_dpp v41, v41, v41 row_ror:8 row_mask:0xf bank_mask:0xf
    v_add_f32_dpp v42, v42, v42 row_ror:8 row_mask:0xf bank_mask:0xf
    v_add_f32_dpp v43, v43, v43 row_ror:8 row_mask:0xf bank_mask:0xf
    v_add_f32_dpp v44, v44, v44 row_ror:8 row_mask:0xf bank_mask:0xf
    v_add_f32_dpp v45, v45, v45 row_ror:8 row_mask:0xf bank_mask:0xf
    v_add_f32_dpp v46, v46, v46 row_ror:8 row_mask:0xf bank_mask:0xf
    v_add_f32_dpp v47, v47, v47 row_ror:8 row_mask:0xf bank_mask:0xf
    s_nop 0
    v_mov_b32 v48, v40
    v_mov_b32 v49, v41
    v_mov_b32 v50, v42
    v_mov_b32 v51, v43
    v_mov_b32 v52, v44
    v_mov_b32 v53, v45
    v_mov_b32 v54, v46
    v_mov_b32 v55, v47
    s_nop 0
    v_permlane32_swap_b32 v48, v40
    v_permlane32_swap_b32 v49, v41
    v_permlane32_swap_b32 v50, v42
    v_permlane32_swap_b32 v51, v43
    v_permlane32_swap_b32 v52, v44
    v_permlane32_swap_b32 v53, v45
    v_permlane32_swap_b32 v54, v46
    v_permlane32_swap_b32 v55, v47
    s_nop 0
    v_add_f32 v40, v40, v48
    v_add_f32 v41, v41, v49
    v_add_f32 v42, v42, v50
    v_add_f32 v43, v43, v51
    v_add_f32 v44, v44, v52
    v_add_f32 v45, v45, v53
    v_add_f32 v46, v46, v54
    v_add_f32 v47, v47, v55
    v_mov_b32 v48, v40
    v_mov_b32 v49, v41
    v_mov_b32 v50, v42
    v_mov_b32 v51, v43
    v_mov_b32 v52, v44
    v_mov_b32 v53, v45
    v_mov_b32 v54, v46
    v_mov_b32 v55, v47
    s_nop 0
    v_permlane16_swap_b32 v48, v40
    v_permlane16_swap_b32 v49, v41
    v_permlane16_swap_b32 v50, v42
    v_permlane16_swap_b32 v51, v43
    v_permlane16_swap_b32 v52, v44
    v_permlane16_swap_b32 v53, v45
    v_permlane16_swap_b32 v54, v46
    v_permlane16_swap_b32 v55, v47
    s_nop 0
    v_add_f32 v40, v40, v48
    v_add_f32 v41, v41, v49
    v_add_f32 v42, v42, v50
    v_add_f32 v43, v43, v51
    v_add_f32 v44, v44, v52
    v_add_f32 v45, v45, v53
    v_add_f32 v46, v46, v54
    v_add_f32 v47, v47, v55
    s_waitcnt lgkmcnt(0)
    v_add_f32 v40, v40, v84
    v_add_f32 v41, v41, v85
    v_add_f32 v42, v42, v86
    v_add_f32 v43, v43, v87
    v_add_f32 v44, v44, v88
    v_add_f32 v45, v45, v89
    v_add_f32 v46, v46, v90
    v_add_f32 v47, v47, v91
    v_cvt_pk_bf16_f32 v32, v40, v41
    v_cvt_pk_bf16_f32 v33, v42, v43
    v_cvt_pk_bf16_f32 v34, v44, v45
    v_cvt_pk_bf16_f32 v35, v46, v47
    v_lshrrev_b32 v30, 1, v1
    v_mul_u32_u24 v30, 896, v30
    v_and_b32 v31, 1, v1
    v_lshl_add_u32 v30, v31, 4, v30
    s_mul_i32 s72, s54, 3584
    s_lshl_b32 s69, s55, 5
    s_add_u32 s72, s72, s69
    v_cmp_gt_u32 vcc, 8, v1
    v_mov_b32 v31, 2147483648
    s_nop 0
    v_cndmask_b32 v30, v31, v30, vcc
    buffer_store_dwordx4 v[32:35], v30, s[48:51], s72 offen
    s_nop 1
Lxs_108:
Lfin:
    s_waitcnt vmcnt(0)
Lend:
s_endpgm
.section .rodata,"a"
.p2align 6
.amdhsa_kernel interleave_layers__gqa_block_cached__gqa_block_cached__decode_kernel
  .amdhsa_next_free_vgpr 512
  .amdhsa_next_free_sgpr 102
  .amdhsa_accum_offset 256
  .amdhsa_group_segment_fixed_size 0
  .amdhsa_kernarg_size 104
  .amdhsa_user_sgpr_count 2
  .amdhsa_user_sgpr_kernarg_segment_ptr 1
  .amdhsa_system_sgpr_workgroup_id_x 1
.end_amdhsa_kernel
```
